```python
import torch

def _softmax(x, axis=-1):
    return torch.softmax(x, dim=axis)
def _gelu(x):
    return torch.nn.functional.gelu(x, approximate="tanh")
def _silu(x):
    return torch.nn.functional.silu(x)
def _sigmoid(x):
    return torch.sigmoid(x)
def _layernorm(x, axis=-1, eps=1e-5):
    m = x.mean(dim=axis, keepdim=True)
    v = x.var(dim=axis, keepdim=True, unbiased=False)
    return (x - m) / torch.sqrt(v + eps)
def _scatter_add(tgt, idx, src, axis=0):
    return tgt.clone().index_add_(axis, idx, src)
def _segment_sum(src, seg, n):
    out = torch.zeros((n,) + src.shape[1:], dtype=src.dtype)
    return out.index_add_(0, seg, src)
def _pad(x, pw):
    flat = tuple(v for pair in reversed(pw) for v in pair)
    return torch.nn.functional.pad(x, flat)

kernel_name = 'interleave_layers__sliding_block__dense_activation_silu__prompt'

def setup_inputs():

    _w = (lambda a: (lambda t: t.to(torch.bfloat16) if t.is_floating_point() else t)(torch.as_tensor(a)))
    def _A_setup():
        B, S, D = 1, 2048, 1024
        return {
            "x": _w((lambda *s: torch.randn(*s, dtype=torch.bfloat16) * 0.05)(B, S, D)),
            "wqkv": _w((lambda *s: torch.randn(*s, dtype=torch.bfloat16) * 0.05)(D, 3 * D)),
            "wo": _w((lambda *s: torch.randn(*s, dtype=torch.bfloat16) * 0.05)(D, D)),
        }
    _A_in = _A_setup()

    def _B_setup():
        B, S, D, F = 1, 2048, 1024, 3584
        return {
            "x": _w((lambda *s: torch.randn(*s, dtype=torch.bfloat16) * 0.05)(B, S, D)),
            "w1": _w((lambda *s: torch.randn(*s, dtype=torch.bfloat16) * 1.6)(D, F) * (D ** -0.5)),
            "w2": _w((lambda *s: torch.randn(*s, dtype=torch.bfloat16) * 1.6)(F, D) * (F ** -0.5)),
        }
    _B_in = _B_setup()

    return {
        "A_x": _A_in["x"],
        "A_wqkv": _A_in["wqkv"],
        "A_wo": _A_in["wo"],
        "B_x": _B_in["x"],
        "B_w1": _B_in["w1"],
        "B_w2": _B_in["w2"],
    }

def reference(A_x, A_wqkv, A_wo, B_x, B_w1, B_w2):
    def _A_ref(x, wqkv, wo):
        B, S, D = x.shape
        H = 32; Dh = D // H; W = 256
        qkv = (lambda x, *d: x.permute(*d))((x @ wqkv).reshape(B, S, 3, H, Dh), 2, 0, 3, 1, 4)
        q, k, v = qkv[0], qkv[1], qkv[2]
        scores = torch.einsum("bhqd,bhkd->bhqk", q, k) * (Dh ** -0.5)
        idx = torch.arange(S)
        mask = (idx[:, None] - idx[None, :] >= 0) & (idx[:, None] - idx[None, :] < W)
        scores = torch.where(mask[None, None], scores, -1e9)
        p = _softmax(scores, axis=-1)
        o = torch.einsum("bhqk,bhkd->bhqd", p, v)
        return (lambda x, *d: x.permute(*d))(o, 0, 2, 1, 3).reshape(B, S, D) @ wo

    def _B_ref(x, w1, w2):
        h = torch.einsum("bsd,df->bsf", x, w1)
        h = _silu(h)
        out = torch.einsum("bsf,fd->bsd", h, w2)
        return out

    x = A_x
    x = x + _A_ref(_layernorm(x, axis=-1), A_wqkv, A_wo)
    x = x + _B_ref(_layernorm(x, axis=-1), B_w1, B_w2)
    x = x + _A_ref(_layernorm(x, axis=-1), A_wqkv, A_wo)
    x = x + _B_ref(_layernorm(x, axis=-1), B_w1, B_w2)
    return x
```

```asm
; @launch grid=(256,1,1) block=(256,1,1) lds=163840
.amdgcn_target "amdgcn-amd-amdhsa--gfx950"
.text
.globl interleave_layers__sliding_block__dense_activation_silu__prompt_kernel
.p2align 8
.type interleave_layers__sliding_block__dense_activation_silu__prompt_kernel,@function
interleave_layers__sliding_block__dense_activation_silu__prompt_kernel:
s_cmp_ge_u32 s2, 256
s_cbranch_scc1 Lend
s_load_dwordx16 s[48:63], s[0:1], 0
s_load_dwordx2 s[64:65], s[0:1], 64
s_getpc_b64 s[28:29]
Lpc:
s_and_b32 s29, s29, 0xffff
s_mov_b32 s30, Lcodeend-Lpc
s_mov_b32 s31, 0x00020000
s_lshr_b32 s46, s2, 3
s_lshl_b32 s45, s46, 12
v_lshl_add_u32 v4, v0, 4, s45
buffer_load_dword v3, v4, s[28:31], 0 offen
v_lshrrev_b32 v1, 6, v0
v_and_b32 v0, 63, v0
v_readfirstlane_b32 s36, v1
s_and_b32 s45, s2, 7
s_lshr_b32 s37, s45, 1
s_lshl_b32 s37, s37, 2
s_lshr_b32 s3, s46, 3
s_add_u32 s37, s37, s3
s_and_b32 s38, s45, 1
s_lshl_b32 s38, s38, 3
s_and_b32 s3, s46, 7
s_add_u32 s38, s38, s3
s_lshl_b32 s39, s37, 2
s_add_u32 s39, s39, s36
s_lshl_b32 s41, s36, 12
s_mov_b32 s40, 0
s_mov_b32 s47, 0
v_and_b32 v44, 15, v0
v_lshrrev_b32 v45, 4, v0
v_lshrrev_b32 v46, 3, v0
v_and_b32 v61, 7, v0
v_lshlrev_b32 v61, 4, v61
v_lshl_add_u32 v62, v46, 11, v61
s_lshl_b32 s45, s39, 4
v_add_u32 v60, s45, v46
v_mul_u32_u24 v60, 6144, v60
v_add_u32 v60, v60, v61
v_min_u32 v58, 3, v46
v_lshl_add_u32 v58, v58, 10, v61
v_min_u32 v59, 5, v46
v_lshl_add_u32 v59, v59, 10, v61
s_lshl_b32 s43, s2, 2
s_add_u32 s43, s43, s36
s_mul_i32 s42, s43, 6144
s_lshl_b32 s43, s43, 12
s_lshl_b32 s79, s39, 16
s_lshl_b32 s46, s38, 7
s_add_u32 s45, s79, s46
s_mul_i32 s87, s36, 7168
s_add_u32 s87, s87, 135168
s_mov_b32 m0, s87
s_mov_b32 s26, 4194304
s_mov_b32 s27, 0x00020000
s_mov_b32 s10, 6291456
s_mov_b32 s11, 0x00020000
s_lshl_b32 s76, s39, 11
s_add_u32 s3, s76, s46
v_mov_b32 v56, 0
v_and_b32 v57, 31, v0
v_lshlrev_b32 v57, 2, v57
s_mov_b32 s6, 268435456
s_mov_b32 s7, 0x00020000
s_waitcnt lgkmcnt(0)
s_mov_b32 s24, s48
s_and_b32 s25, s49, 0xffff
s_mov_b32 s8, s50
s_and_b32 s9, s51, 0xffff
s_mov_b32 s4, s64
s_and_b32 s5, s65, 0xffff
buffer_store_dword v56, v57, s[4:7], s3 offen sc1
buffer_load_dwordx4 v62, s[24:27], s45 offen lds
s_add_u32 s45, s45, 15360
buffer_load_dwordx4 v62, s[24:27], s45 offen offset:1024 lds
s_add_u32 s45, s45, 15360
buffer_load_dwordx4 v62, s[24:27], s45 offen offset:2048 lds
s_add_u32 s45, s45, 15360
buffer_load_dwordx4 v62, s[24:27], s45 offen offset:3072 lds
s_add_u32 s45, s46, 2048
buffer_load_dwordx4 v[144:147], v60, s[8:11], s45 offen
s_add_u32 s45, s46, 51200
buffer_load_dwordx4 v[148:151], v60, s[8:11], s45 offen
v_lshlrev_b32 v1, 4, v0
s_mov_b32 s12, s52
s_and_b32 s13, s53, 0xffff
s_mov_b32 s14, 2097152
s_mov_b32 s15, 0x00020000
s_mov_b32 s16, s56
s_and_b32 s17, s57, 0xffff
s_mov_b32 s18, 7340032
s_mov_b32 s19, 0x00020000
s_mov_b32 s20, s58
s_and_b32 s21, s59, 0xffff
s_mov_b32 s22, 7340032
s_mov_b32 s23, 0x00020000
s_mov_b32 s32, s62
s_and_b32 s33, s63, 0xffff
s_mov_b32 s34, 256
s_mov_b32 s35, 0x00020000
s_mov_b64 s[98:99], s[60:61]
v_add_u32 v2, 4096, v1
v_cmp_eq_u32 vcc, 0, v0
v_mov_b32 v61, 1073741824
s_nop 0
v_cndmask_b32 v11, v61, v0, vcc
s_lshl_b32 s46, s38, 7
s_add_u32 s45, s76, s46
v_mov_b32 v26, 1
s_andn2_b32 s75, s45, 2048
s_add_u32 s45, s39, s36
s_sub_i32 s45, s45, 8
s_max_i32 s45, s45, 0
s_lshl_b32 s45, s45, 11
s_add_u32 s44, s45, s46
s_and_b32 s3, s38, 1
s_xor_b32 s3, s3, s37
s_and_b32 s3, s3, 1
s_lshl_b32 s45, s37, 0
s_xor_b32 s45, s45, s38
s_and_b32 s45, s45, 1
s_lshl_b32 s45, s45, 13
s_xor_b32 s48, s45, 0
s_xor_b32 s49, s45, 8192
s_xor_b32 s50, s45, 16384
s_xor_b32 s51, s45, 24576
s_xor_b32 s52, s45, 32768
s_xor_b32 s53, s45, 40960
s_xor_b32 s54, s45, 49152
s_xor_b32 s55, s45, 57344
s_and_b32 s45, s38, 1
s_xor_b32 s45, s45, s37
s_and_b32 s45, s45, 1
s_xor_b32 s56, s45, 0
s_lshl_b32 s56, s56, 13
s_xor_b32 s57, s45, 1
s_lshl_b32 s57, s57, 13
s_xor_b32 s58, s45, 2
s_lshl_b32 s58, s58, 13
s_xor_b32 s59, s45, 3
s_lshl_b32 s59, s59, 13
s_lshl_b32 s45, s39, 16
s_add_u32 s68, s45, 2097152
s_add_u32 s70, s45, 10485760
s_mul_i32 s71, s39, 229376
s_add_u32 s71, s71, 23068672
s_lshl_b32 s45, s39, 12
s_add_u32 s73, s45, 1048576
s_add_u32 s74, s45, 1310720
s_lshl_b32 s46, s38, 19
s_add_u32 s46, s46, 14680064
s_lshl_b32 s45, s39, 13
s_add_u32 s72, s45, s46
s_add_u32 s45, s39, s36
s_sub_i32 s45, s45, 8
s_max_i32 s45, s45, 0
s_lshl_b32 s45, s45, 13
s_add_u32 s60, s45, s46
s_add_u32 s45, s39, s36
s_sub_i32 s45, s45, 7
s_max_i32 s45, s45, 0
s_lshl_b32 s45, s45, 13
s_add_u32 s61, s45, s46
s_lshl_b32 s62, s36, 13
s_lshl3_add_u32 s63, s39, s38
s_lshl_b32 s63, s63, 13
v_lshlrev_b32 v34, 3, v1
s_lshr_b32 s45, s38, 2
s_lshl_b32 s94, s45, 13
s_lshl_b32 s45, s45, 19
s_xor_b32 s46, s38, 8
s_lshl_b32 s46, s46, 7
s_add_u32 s88, s45, s46
s_xor_b32 s46, s38, 12
s_lshl_b32 s46, s46, 7
s_add_u32 s89, s45, s46
s_xor_b32 s46, s38, 4
s_lshl_b32 s46, s46, 7
s_add_u32 s90, s45, s46
s_xor_b32 s46, s38, 0
s_lshl_b32 s46, s46, 7
s_add_u32 s91, s45, s46
s_lshl_b32 s92, s3, 18
s_xor_b32 s93, s92, 262144
s_mul_i32 s95, s39, 196608
s_add_u32 s95, s95, 37748736
s_and_b32 s45, s37, 3
s_lshl_b32 s45, s45, 1
s_bfe_u32 s46, s38, 0x10002
s_add_u32 s43, s45, s46
s_and_b32 s42, s38, 3
s_lshl_b32 s42, s42, 3
s_lshl_b32 s0, s43, 7
s_add_u32 s0, s0, s42
s_and_b32 s45, s38, 7
s_sub_i32 s1, 3, s45
s_lshl_b32 s1, s1, 7
s_sub_i32 s77, 8, s39
s_max_i32 s77, s77, 0
s_lshl_b32 s96, -1, s77
s_mov_b32 s97, 0
s_mov_b32 s78, 0xbfb8aa3b
s_mov_b32 s80, 0x22222222
s_mov_b32 s81, 0x22222222
s_mov_b32 s82, 0x44444444
s_mov_b32 s83, 0x44444444
s_mov_b32 s84, 0x88888888
s_mov_b32 s85, 0x88888888
v_add_u32 v32, s41, v1
v_add_u32 v35, 49152, v32
v_lshlrev_b32 v64, 4, v45
v_add_u32 v5, 131072, v64
v_lshlrev_b32 v65, 2, v44
v_add_u32 v6, 131072, v65
s_lshl_b32 s45, s36, 9
s_add_u32 s45, s45, 133120
v_add_u32 v7, s45, v65
v_add_u32 v8, s45, v64
v_lshrrev_b32 v64, 2, v44
v_cmp_eq_u32 vcc, v64, v45
v_lshlrev_b32 v65, 4, v44
v_mov_b32 v66, 1073741824
v_cndmask_b32 v9, v66, v65, vcc
v_cmp_eq_u32 vcc, 3, v46
v_add_u32 v64, 134217856, v1
s_nop 0
v_cndmask_b32 v10, v1, v64, vcc
v_add_u32 v2, 4096, v10
v_lshrrev_b32 v64, 2, v44
v_lshl_add_u32 v64, v45, 2, v64
v_bfe_u32 v65, v64, 1, 2
v_and_b32 v66, 3, v0
v_lshlrev_b32 v66, 3, v66
v_lshl_add_u32 v66, v64, 7, v66
v_xor_b32 v67, 0, v65
v_lshl_add_u32 v12, v67, 5, v66
v_add_u32 v16, 0x10000, v12
v_xor_b32 v67, 1, v65
v_lshl_add_u32 v13, v67, 5, v66
v_add_u32 v17, 0x10000, v13
v_xor_b32 v67, 2, v65
v_lshl_add_u32 v14, v67, 5, v66
v_add_u32 v18, 0x10000, v14
v_xor_b32 v67, 3, v65
v_lshl_add_u32 v15, v67, 5, v66
v_add_u32 v19, 0x10000, v15
v_lshlrev_b32 v64, 1, v45
v_and_b32 v65, 7, v0
v_xor_b32 v65, v65, v64
v_lshlrev_b32 v47, 4, v65
s_lshl_b32 s46, s38, 7
v_add_u32 v66, s46, v47
s_lshl_b32 s45, s36, 5
v_add_u32 v67, s45, v46
v_mul_u32_u24 v68, 6144, v67
v_add_u32 v20, v68, v66
v_mul_u32_u24 v68, 7168, v67
v_add_u32 v22, v68, v66
v_lshl_add_u32 v24, v67, 11, v47
v_lshrrev_b32 v68, 5, v0
v_lshlrev_b32 v68, 4, v68
v_and_b32 v69, 3, v46
s_lshl_b32 s45, s36, 6
v_add3_u32 v68, v68, v69, s45
v_lshl_add_u32 v21, v68, 11, v66
v_add_u32 v23, 0x10000, v1
s_mul_i32 s64, s38, 327680
s_add_u32 s64, s64, 125829120
s_lshl_b32 s45, s3, 13
s_xor_b32 s45, s45, s41
s_add_u32 s65, s64, s45
s_add_u32 s65, s65, 262144
s_add_u32 s64, s64, s41
v_bfe_u32 v64, v0, 2, 1
v_and_b32 v65, 1, v45
v_cmp_eq_u32 vcc, v64, v65
v_mov_b32 v66, 0x3f803f80
s_nop 0
v_cndmask_b32 v36, 0, v66, vcc
v_cndmask_b32 v37, 0, v66, vcc
v_cndmask_b32 v38, 0, v66, vcc
v_cndmask_b32 v39, 0, v66, vcc
v_add_u32 v64, 0, v45
v_xor_b32 v65, v44, v64
v_lshlrev_b32 v65, 4, v65
v_lshl_add_u32 v48, v64, 11, v65
v_add_u32 v64, 4, v45
v_xor_b32 v65, v44, v64
v_lshlrev_b32 v65, 4, v65
v_lshl_add_u32 v49, v64, 11, v65
v_subrev_u32 v49, 1024, v49
v_add_u32 v64, 8, v45
v_xor_b32 v65, v44, v64
v_lshlrev_b32 v65, 4, v65
v_lshl_add_u32 v50, v64, 11, v65
v_subrev_u32 v50, 2048, v50
v_add_u32 v64, 12, v45
v_xor_b32 v65, v44, v64
v_lshlrev_b32 v65, 4, v65
v_lshl_add_u32 v51, v64, 11, v65
v_subrev_u32 v51, 3072, v51
v_lshrrev_b32 v64, 1, v45
v_xor_b32 v64, v64, v44
v_lshlrev_b32 v64, 4, v64
v_and_b32 v65, 1, v45
v_lshlrev_b32 v65, 3, v65
v_lshl_add_u32 v65, v44, 8, v65
v_add_u32 v65, s62, v65
v_xor_b32 v66, 0, v64
v_add_u32 v248, v66, v65
v_xor_b32 v66, 32, v64
v_add_u32 v249, v66, v65
v_xor_b32 v66, 64, v64
v_add_u32 v250, v66, v65
v_xor_b32 v66, 96, v64
v_add_u32 v251, v66, v65
v_xor_b32 v66, 128, v64
v_add_u32 v252, v66, v65
v_xor_b32 v66, 160, v64
v_add_u32 v253, v66, v65
v_xor_b32 v66, 192, v64
v_add_u32 v254, v66, v65
v_xor_b32 v66, 224, v64
v_add_u32 v255, v66, v65
v_lshlrev_b32 v64, 7, v44
v_lshl_add_u32 v64, v45, 3, v64
v_add_u32 v64, s87, v64
v_mov_b32 v56, 0x3f803f80
v_mov_b32 v57, 0x3f803f80
v_mov_b32 v58, 0x3f803f80
v_mov_b32 v59, 0x3f803f80
s_lshl_b32 s3, s38, 8
s_add_u32 s3, s3, s73
v_bfe_u32 v0, v1, 4, 3
v_cmp_eq_u32 vcc, 0, v0
v_mov_b32 v132, 0x3f80
s_nop 0
v_cndmask_b32 v128, 0, v132, vcc
v_cmp_eq_u32 vcc, 1, v0
v_mov_b32 v132, 0x3f800000
s_nop 0
v_cndmask_b32 v128, v128, v132, vcc
v_cmp_eq_u32 vcc, 2, v0
v_mov_b32 v132, 0x3f80
s_nop 0
v_cndmask_b32 v129, 0, v132, vcc
v_cmp_eq_u32 vcc, 3, v0
v_mov_b32 v132, 0x3f800000
s_nop 0
v_cndmask_b32 v129, v129, v132, vcc
v_cmp_eq_u32 vcc, 4, v0
v_mov_b32 v132, 0x3f80
s_nop 0
v_cndmask_b32 v130, 0, v132, vcc
v_cmp_eq_u32 vcc, 5, v0
v_mov_b32 v132, 0x3f800000
s_nop 0
v_cndmask_b32 v130, v130, v132, vcc
v_cmp_eq_u32 vcc, 6, v0
v_mov_b32 v132, 0x3f80
s_nop 0
v_cndmask_b32 v131, 0, v132, vcc
v_cmp_eq_u32 vcc, 7, v0
v_mov_b32 v132, 0x3f800000
s_nop 0
v_cndmask_b32 v131, v131, v132, vcc
s_lshl_b32 s46, s38, 7
s_add_u32 s45, s46, 4096
buffer_load_dwordx4 v[152:155], v60, s[8:11], s45 offen
s_add_u32 s45, s46, 53248
buffer_load_dwordx4 v[156:159], v60, s[8:11], s45 offen
s_add_u32 s45, s46, 0
buffer_load_dwordx4 v[160:163], v60, s[8:11], s45 offen
s_add_u32 s45, s46, 49152
buffer_load_dwordx4 v[164:167], v60, s[8:11], s45 offen
s_waitcnt vmcnt(10)
s_barrier
s_lshl_b32 s45, s37, 4
s_cmp_lg_u32 s36, 0
s_cbranch_scc1 Lskip1
buffer_atomic_add v26, v11, s[32:35], s45 offen sc1
Lskip1:
s_cmp_lg_u32 s36, 0
s_cbranch_scc1 Ltw3
s_call_b64 s[42:43], Lst0
s_branch Ltd2
Ltw3:
s_cmp_lg_u32 s36, 1
s_cbranch_scc1 Ltw4
s_call_b64 s[42:43], Lst1
s_branch Ltd2
Ltw4:
s_cmp_lg_u32 s36, 2
s_cbranch_scc1 Ltw5
s_call_b64 s[42:43], Lst2
s_branch Ltd2
Ltw5:
s_call_b64 s[42:43], Lst5
Ltd2:
s_cmp_lg_u32 s36, 0
s_cbranch_scc1 Ltw8
s_call_b64 s[42:43], Lst3
s_branch Ltd7
Ltw8:
s_cmp_lg_u32 s36, 1
s_cbranch_scc1 Ltw9
s_call_b64 s[42:43], Lst4
s_branch Ltd7
Ltw9:
s_cmp_lg_u32 s36, 2
s_cbranch_scc1 Ltw10
s_call_b64 s[42:43], Lst6
s_branch Ltd7
Ltw10:
s_call_b64 s[42:43], Lst7
Ltd7:
s_mul_i32 s45, s0, 6144
s_add_u32 s45, s45, s1
s_add_u32 s45, s45, 2048
buffer_load_dword v3, v20, s[8:11], s45 offen
s_add_u32 m0, s62, 0
s_lshr_b32 s43, s48, 5
s_add_u32 s43, s43, s79
buffer_load_dwordx4 v48, s[24:27], s43 offen lds
buffer_load_dwordx4 v49, s[24:27], s43 offen offset:1024 lds
buffer_load_dwordx4 v50, s[24:27], s43 offen offset:2048 lds
buffer_load_dwordx4 v51, s[24:27], s43 offen offset:3072 lds
s_add_u32 m0, s62, 4096
s_add_u32 s43, s43, 32768
buffer_load_dwordx4 v48, s[24:27], s43 offen lds
buffer_load_dwordx4 v49, s[24:27], s43 offen offset:1024 lds
buffer_load_dwordx4 v50, s[24:27], s43 offen offset:2048 lds
buffer_load_dwordx4 v51, s[24:27], s43 offen offset:3072 lds
s_branch Lpk
.p2align 12
Lpage0:
Lst0:
s_setpc_b64 s[42:43]
Lpk:
s_waitcnt vmcnt(15)
ds_read_b64 v[208:209], v64 offset:0
ds_read_b64 v[210:211], v64 offset:32
ds_read_b64 v[212:213], v64 offset:2048
ds_read_b64 v[214:215], v64 offset:2080
ds_read_b64 v[216:217], v64 offset:64
ds_read_b64 v[218:219], v64 offset:96
ds_read_b64 v[220:221], v64 offset:2112
ds_read_b64 v[222:223], v64 offset:2144
s_waitcnt lgkmcnt(0)
v_mfma_f32_16x16x32_bf16 v[228:231], v[208:211], v[208:211], 0
v_mfma_f32_16x16x32_bf16 v[224:227], v[56:59], v[208:211], 0
v_mfma_f32_16x16x32_bf16 v[236:239], v[212:215], v[212:215], 0
v_mfma_f32_16x16x32_bf16 v[232:235], v[56:59], v[212:215], 0
v_mfma_f32_16x16x32_bf16 v[228:231], v[216:219], v[216:219], v[228:231]
v_mfma_f32_16x16x32_bf16 v[224:227], v[56:59], v[216:219], v[224:227]
v_mfma_f32_16x16x32_bf16 v[236:239], v[220:223], v[220:223], v[236:239]
v_mfma_f32_16x16x32_bf16 v[232:235], v[56:59], v[220:223], v[232:235]
v_lshlrev_b32 v176, 16, v208
v_and_b32 v177, 0xffff0000, v208
v_lshlrev_b32 v178, 16, v209
v_and_b32 v179, 0xffff0000, v209
v_lshlrev_b32 v184, 16, v210
v_and_b32 v185, 0xffff0000, v210
v_lshlrev_b32 v186, 16, v211
v_and_b32 v187, 0xffff0000, v211
v_lshlrev_b32 v180, 16, v212
v_and_b32 v181, 0xffff0000, v212
v_lshlrev_b32 v182, 16, v213
v_and_b32 v183, 0xffff0000, v213
v_lshlrev_b32 v188, 16, v214
v_and_b32 v189, 0xffff0000, v214
v_lshlrev_b32 v190, 16, v215
v_and_b32 v191, 0xffff0000, v215
v_lshlrev_b32 v192, 16, v216
v_and_b32 v193, 0xffff0000, v216
v_lshlrev_b32 v194, 16, v217
v_and_b32 v195, 0xffff0000, v217
v_lshlrev_b32 v200, 16, v218
v_and_b32 v201, 0xffff0000, v218
v_lshlrev_b32 v202, 16, v219
v_and_b32 v203, 0xffff0000, v219
v_lshlrev_b32 v196, 16, v220
v_and_b32 v197, 0xffff0000, v220
v_lshlrev_b32 v198, 16, v221
v_and_b32 v199, 0xffff0000, v221
v_lshlrev_b32 v204, 16, v222
v_and_b32 v205, 0xffff0000, v222
v_lshlrev_b32 v206, 16, v223
v_and_b32 v207, 0xffff0000, v223
s_lshl_b32 s69, s36, 4
s_add_u32 s69, s69, s38
s_lshl_b32 s69, s69, 7
v_add_u32 v28, 2048, v20
v_add_u32 v29, 50176, v20
v_add_u32 v30, 98304, v20
v_add_u32 v31, 146432, v20
s_add_u32 m0, s41, 65536
s_mul_i32 s42, s48, 96
buffer_load_dwordx4 v28, s[8:11], s42 offen sc1 lds
buffer_load_dwordx4 v29, s[8:11], s42 offen offset:1024 sc1 lds
buffer_load_dwordx4 v30, s[8:11], s42 offen offset:2048 sc1 lds
buffer_load_dwordx4 v31, s[8:11], s42 offen offset:3072 sc1 lds
s_waitcnt vmcnt(13)
v_mfma_f32_16x16x32_bf16 v[112:115], v[128:131], v[144:147], 0
v_mfma_f32_16x16x32_bf16 v[112:115], v[128:131], v[148:151], v[112:115]
s_add_u32 m0, s62, 32768
s_lshr_b32 s43, s49, 5
s_add_u32 s43, s43, s79
buffer_load_dwordx4 v48, s[24:27], s43 offen lds
v_mfma_f32_16x16x32_bf16 v[116:119], v[128:131], v[152:155], 0
v_mfma_f32_16x16x32_bf16 v[116:119], v[128:131], v[156:159], v[116:119]
buffer_load_dwordx4 v49, s[24:27], s43 offen offset:1024 lds
v_mfma_f32_16x16x32_bf16 v[120:123], v[128:131], v[160:163], 0
v_mfma_f32_16x16x32_bf16 v[120:123], v[128:131], v[164:167], v[120:123]
buffer_load_dwordx4 v50, s[24:27], s43 offen offset:2048 lds
s_waitcnt vmcnt(11)
ds_read_b64 a[0:1], v248 offset:0
ds_read_b64 a[2:3], v249 offset:0
ds_read_b64 a[8:9], v250 offset:0
ds_read_b64 a[10:11], v251 offset:0
ds_read_b64 a[16:17], v252 offset:0
ds_read_b64 a[18:19], v253 offset:0
ds_read_b64 a[24:25], v254 offset:0
ds_read_b64 a[26:27], v255 offset:0
buffer_load_dwordx4 v51, s[24:27], s43 offen offset:3072 lds
s_add_u32 m0, s62, 36864
s_add_u32 s43, s43, 32768
buffer_load_dwordx4 v48, s[24:27], s43 offen lds
s_waitcnt vmcnt(9)
ds_read_b64 a[4:5], v248 offset:4096
ds_read_b64 a[6:7], v249 offset:4096
ds_read_b64 a[12:13], v250 offset:4096
ds_read_b64 a[14:15], v251 offset:4096
ds_read_b64 a[20:21], v252 offset:4096
ds_read_b64 a[22:23], v253 offset:4096
ds_read_b64 a[28:29], v254 offset:4096
ds_read_b64 a[30:31], v255 offset:4096
v_bfe_u32 v168, v1, 7, 1
v_lshlrev_b32 v168, 10, v168
v_bfe_u32 v169, v1, 4, 3
v_lshl_add_u32 v168, v169, 5, v168
v_bfe_u32 v169, v1, 8, 1
v_lshl_add_u32 v168, v169, 4, v168
v_add_u32 v168, s87, v168
ds_write_b128 v168, v[112:115] offset:0
ds_write_b128 v168, v[116:119] offset:256
ds_write_b128 v168, v[120:123] offset:512
buffer_load_dwordx4 v49, s[24:27], s43 offen offset:1024 lds
buffer_load_dwordx4 v50, s[24:27], s43 offen offset:2048 lds
buffer_load_dwordx4 v51, s[24:27], s43 offen offset:3072 lds
s_waitcnt vmcnt(8) lgkmcnt(0)
s_barrier
ds_read_b64_tr_b16 v[64:65], v16 offset:0
ds_read_b64_tr_b16 v[66:67], v16 offset:2048
ds_read_b64_tr_b16 v[68:69], v16 offset:4096
ds_read_b64_tr_b16 v[70:71], v16 offset:6144
ds_read_b64_tr_b16 v[72:73], v16 offset:8192
ds_read_b64_tr_b16 v[74:75], v16 offset:10240
ds_read_b64_tr_b16 v[76:77], v16 offset:12288
ds_read_b64_tr_b16 v[78:79], v16 offset:14336
ds_read_b64_tr_b16 v[80:81], v17 offset:0
ds_read_b64_tr_b16 v[82:83], v17 offset:2048
ds_read_b64_tr_b16 v[84:85], v17 offset:4096
ds_read_b64_tr_b16 v[86:87], v17 offset:6144
ds_read_b64_tr_b16 v[88:89], v17 offset:8192
ds_read_b64_tr_b16 v[90:91], v17 offset:10240
ds_read_b64_tr_b16 v[92:93], v17 offset:12288
ds_read_b64_tr_b16 v[94:95], v17 offset:14336
s_add_u32 m0, s41, 81920
s_mul_i32 s42, s49, 96
buffer_load_dwordx4 v28, s[8:11], s42 offen sc1 lds
buffer_load_dwordx4 v29, s[8:11], s42 offen offset:1024 sc1 lds
buffer_load_dwordx4 v30, s[8:11], s42 offen offset:2048 sc1 lds
buffer_load_dwordx4 v31, s[8:11], s42 offen offset:3072 sc1 lds
v_lshrrev_b32 v0, 6, v1
v_lshlrev_b32 v0, 4, v0
buffer_load_dword v25, v0, s[32:35], 0 offen sc1
s_waitcnt lgkmcnt(8)
v_mfma_f32_16x16x32_bf16 v[112:115], v[64:67], a[0:3], 0
s_min_u32 s45, s36, 2
ds_read_b64_tr_b16 v[96:97], v18 offset:0
s_lshl_b32 s46, s38, 3
s_add_u32 s46, s46, s45
v_mfma_f32_16x16x32_bf16 v[112:115], v[68:71], a[8:11], v[112:115]
s_add_u32 s46, s46, 0
ds_read_b64_tr_b16 v[98:99], v18 offset:2048
s_lshl_b32 s46, s46, 4
s_add_u32 s46, s46, s37
s_lshl_b32 s46, s46, 8
v_mfma_f32_16x16x32_bf16 v[112:115], v[72:75], a[16:19], v[112:115]
s_add_u32 s46, s46, 131072
ds_read_b64_tr_b16 v[100:101], v18 offset:4096
s_lshl_b32 s45, s45, 8
s_add_u32 s45, s45, 135168
v_lshrrev_b32 v152, 8, v1
v_mfma_f32_16x16x32_bf16 v[112:115], v[76:79], a[24:27], v[112:115]
ds_read_b64_tr_b16 v[102:103], v18 offset:6144
v_mul_u32_u24 v152, 7168, v152
v_and_b32 v153, 0xf0, v1
v_add3_u32 v152, v152, v153, s45
v_mfma_f32_16x16x32_bf16 v[116:119], v[76:79], a[28:31], 0
ds_read_b64_tr_b16 v[104:105], v18 offset:8192
ds_read_b128 v[144:147], v152 offset:0
ds_read_b128 v[148:151], v152 offset:1024
s_add_u32 m0, s62, 0
s_lshr_b32 s43, s50, 5
v_mfma_f32_16x16x32_bf16 v[116:119], v[72:75], a[20:23], v[116:119]
s_add_u32 s43, s43, s79
ds_read_b64_tr_b16 v[106:107], v18 offset:10240
buffer_load_dwordx4 v48, s[24:27], s43 offen lds
s_waitcnt vmcnt(10)
ds_read_b64 a[32:33], v248 offset:32768
v_mfma_f32_16x16x32_bf16 v[116:119], v[68:71], a[12:15], v[116:119]
ds_read_b64_tr_b16 v[108:109], v18 offset:12288
buffer_load_dwordx4 v49, s[24:27], s43 offen offset:1024 lds
ds_read_b64 a[34:35], v249 offset:32768
buffer_load_dwordx4 v50, s[24:27], s43 offen offset:2048 lds
ds_read_b64 a[40:41], v250 offset:32768
buffer_load_dwordx4 v51, s[24:27], s43 offen offset:3072 lds
ds_read_b64 a[42:43], v251 offset:32768
v_mfma_f32_16x16x32_bf16 v[116:119], v[64:67], a[4:7], v[116:119]
s_waitcnt lgkmcnt(13)
ds_read_b64_tr_b16 v[110:111], v18 offset:14336
v_mfma_f32_16x16x32_bf16 v[124:127], v[80:83], a[4:7], 0
s_add_u32 m0, s41, 98304
ds_read_b64_tr_b16 v[64:65], v19 offset:0
s_mul_i32 s42, s50, 96
v_mfma_f32_16x16x32_bf16 v[124:127], v[84:87], a[12:15], v[124:127]
ds_read_b64_tr_b16 v[66:67], v19 offset:2048
buffer_load_dwordx4 v28, s[8:11], s42 offen sc1 lds
v_mfma_f32_16x16x32_bf16 v[124:127], v[88:91], a[20:23], v[124:127]
ds_read_b64_tr_b16 v[68:69], v19 offset:4096
ds_read_b64 a[48:49], v252 offset:32768
v_mfma_f32_16x16x32_bf16 v[124:127], v[92:95], a[28:31], v[124:127]
ds_read_b64_tr_b16 v[70:71], v19 offset:6144
buffer_load_dwordx4 v29, s[8:11], s42 offen offset:1024 sc1 lds
v_mfma_f32_16x16x32_bf16 v[120:123], v[92:95], a[24:27], 0
ds_read_b64_tr_b16 v[72:73], v19 offset:8192
ds_read_b64 a[50:51], v253 offset:32768
v_mfma_f32_16x16x32_bf16 v[120:123], v[88:91], a[16:19], v[120:123]
ds_read_b64_tr_b16 v[74:75], v19 offset:10240
buffer_load_dwordx4 v30, s[8:11], s42 offen offset:2048 sc1 lds
v_mfma_f32_16x16x32_bf16 v[120:123], v[84:87], a[8:11], v[120:123]
ds_read_b64_tr_b16 v[76:77], v19 offset:12288
ds_read_b64 a[56:57], v254 offset:32768
buffer_load_dwordx4 v31, s[8:11], s42 offen offset:3072 sc1 lds
ds_read_b64 a[58:59], v255 offset:32768
v_mfma_f32_16x16x32_bf16 v[120:123], v[80:83], a[0:3], v[120:123]
s_waitcnt vmcnt(9) lgkmcnt(11)
s_barrier
ds_read_b64_tr_b16 v[78:79], v19 offset:14336
v_mfma_f32_16x16x32_bf16 v[128:131], v[96:99], a[0:3], 0
s_add_u32 m0, s62, 4096
ds_read_b64_tr_b16 v[80:81], v16 offset:16384
s_add_u32 s43, s43, 32768
buffer_load_dwordx4 v48, s[24:27], s43 offen lds
v_mfma_f32_16x16x32_bf16 v[128:131], v[100:103], a[8:11], v[128:131]
ds_read_b64_tr_b16 v[82:83], v16 offset:18432
v_add_f32 v144, v144, v148
v_add_f32 v145, v145, v149
ds_read_b64 a[36:37], v248 offset:36864
v_mfma_f32_16x16x32_bf16 v[128:131], v[104:107], a[16:19], v[128:131]
ds_read_b64_tr_b16 v[84:85], v16 offset:20480
v_add_f32 v146, v146, v150
v_add_f32 v147, v147, v151
v_mov_b32 v148, v144
ds_read_b64 a[38:39], v249 offset:36864
v_mov_b32 v149, v145
v_mfma_f32_16x16x32_bf16 v[128:131], v[108:111], a[24:27], v[128:131]
ds_read_b64_tr_b16 v[86:87], v16 offset:22528
v_mov_b32 v150, v146
v_mov_b32 v151, v147
buffer_load_dwordx4 v49, s[24:27], s43 offen offset:1024 lds
v_permlane32_swap_b32 v144, v148
v_mfma_f32_16x16x32_bf16 v[132:135], v[108:111], a[28:31], 0
ds_read_b64_tr_b16 v[88:89], v16 offset:24576
v_permlane32_swap_b32 v145, v149
v_permlane32_swap_b32 v146, v150
ds_read_b64 a[44:45], v250 offset:36864
v_permlane32_swap_b32 v147, v151
v_add_f32 v144, v144, v148
v_mfma_f32_16x16x32_bf16 v[132:135], v[104:107], a[20:23], v[132:135]
ds_read_b64_tr_b16 v[90:91], v16 offset:26624
v_add_f32 v145, v145, v149
ds_read_b64 a[46:47], v251 offset:36864
v_add_f32 v146, v146, v150
v_add_f32 v147, v147, v151
v_mfma_f32_16x16x32_bf16 v[132:135], v[100:103], a[12:15], v[132:135]
ds_read_b64_tr_b16 v[92:93], v16 offset:28672
v_mov_b32 v148, v144
buffer_load_dwordx4 v50, s[24:27], s43 offen offset:2048 lds
v_mov_b32 v149, v145
v_mov_b32 v150, v146
v_mov_b32 v151, v147
ds_read_b64 a[52:53], v252 offset:36864
v_mfma_f32_16x16x32_bf16 v[132:135], v[96:99], a[4:7], v[132:135]
s_waitcnt lgkmcnt(12)
ds_read_b64_tr_b16 v[94:95], v16 offset:30720
v_permlane16_swap_b32 v144, v148
v_permlane16_swap_b32 v145, v149
v_mfma_f32_16x16x32_bf16 v[140:143], v[64:67], a[4:7], 0
ds_read_b64_tr_b16 v[96:97], v17 offset:16384
ds_read_b64 a[54:55], v253 offset:36864
v_permlane16_swap_b32 v146, v150
v_permlane16_swap_b32 v147, v151
v_add_f32 v144, v144, v148
v_mfma_f32_16x16x32_bf16 v[140:143], v[68:71], a[12:15], v[140:143]
ds_read_b64_tr_b16 v[98:99], v17 offset:18432
ds_read_b64 a[60:61], v254 offset:36864
v_add_f32 v145, v145, v149
v_add_f32 v146, v146, v150
v_add_f32 v147, v147, v151
v_mfma_f32_16x16x32_bf16 v[140:143], v[72:75], a[20:23], v[140:143]
ds_read_b64_tr_b16 v[100:101], v17 offset:20480
ds_read_b64 a[62:63], v255 offset:36864
buffer_store_dwordx4 v[144:147], v9, s[4:7], s46 offen sc1
v_mfma_f32_16x16x32_bf16 v[140:143], v[76:79], a[28:31], v[140:143]
ds_read_b64_tr_b16 v[102:103], v17 offset:22528
v_cndmask_b32 v241, v228, v229, s[80:81]
buffer_load_dwordx4 v51, s[24:27], s43 offen offset:3072 lds
v_cndmask_b32 v241, v241, v230, s[82:83]
v_mfma_f32_16x16x32_bf16 v[136:139], v[76:79], a[24:27], 0
ds_read_b64_tr_b16 v[104:105], v17 offset:24576
v_cndmask_b32 v241, v241, v231, s[84:85]
v_mov_b32 v240, v224
s_add_u32 m0, s62, 32768
v_mfma_f32_16x16x32_bf16 v[136:139], v[72:75], a[16:19], v[136:139]
s_lshr_b32 s43, s51, 5
ds_read_b64_tr_b16 v[106:107], v17 offset:26624
s_add_u32 s43, s43, s79
buffer_load_dwordx4 v48, s[24:27], s43 offen lds
v_cndmask_b32 v243, v236, v237, s[80:81]
v_mfma_f32_16x16x32_bf16 v[136:139], v[68:71], a[8:11], v[136:139]
ds_read_b64_tr_b16 v[108:109], v17 offset:28672
v_cndmask_b32 v243, v243, v238, s[82:83]
v_cndmask_b32 v243, v243, v239, s[84:85]
buffer_load_dwordx4 v49, s[24:27], s43 offen offset:1024 lds
v_mov_b32 v242, v232
buffer_store_dwordx4 v[240:243], v9, s[4:7], s3 offen sc1
v_mfma_f32_16x16x32_bf16 v[136:139], v[64:67], a[0:3], v[136:139]
s_waitcnt lgkmcnt(4)
ds_read_b64_tr_b16 v[110:111], v17 offset:30720
v_mfma_f32_16x16x32_bf16 v[112:115], v[80:83], a[32:35], v[112:115]
ds_read_b64_tr_b16 v[64:65], v18 offset:16384
buffer_load_dwordx4 v50, s[24:27], s43 offen offset:2048 lds
v_mfma_f32_16x16x32_bf16 v[112:115], v[84:87], a[40:43], v[112:115]
s_waitcnt vmcnt(13)
ds_read_b64_tr_b16 v[66:67], v18 offset:18432
ds_read_b64 a[64:65], v248 offset:0
v_mfma_f32_16x16x32_bf16 v[112:115], v[88:91], a[48:51], v[112:115]
ds_read_b64_tr_b16 v[68:69], v18 offset:20480
buffer_load_dwordx4 v51, s[24:27], s43 offen offset:3072 lds
v_mfma_f32_16x16x32_bf16 v[112:115], v[92:95], a[56:59], v[112:115]
ds_read_b64_tr_b16 v[70:71], v18 offset:22528
ds_read_b64 a[66:67], v249 offset:0
v_mfma_f32_16x16x32_bf16 v[116:119], v[92:95], a[60:63], v[116:119]
s_add_u32 m0, s62, 36864
ds_read_b64_tr_b16 v[72:73], v18 offset:24576
s_add_u32 s43, s43, 32768
v_mfma_f32_16x16x32_bf16 v[116:119], v[88:91], a[52:55], v[116:119]
ds_read_b64_tr_b16 v[74:75], v18 offset:26624
buffer_load_dwordx4 v48, s[24:27], s43 offen lds
v_mfma_f32_16x16x32_bf16 v[116:119], v[84:87], a[44:47], v[116:119]
ds_read_b64_tr_b16 v[76:77], v18 offset:28672
ds_read_b64 a[72:73], v250 offset:0
buffer_load_dwordx4 v49, s[24:27], s43 offen offset:1024 lds
v_mfma_f32_16x16x32_bf16 v[116:119], v[80:83], a[36:39], v[116:119]
s_waitcnt lgkmcnt(10)
ds_read_b64_tr_b16 v[78:79], v18 offset:30720
v_mfma_f32_16x16x32_bf16 v[124:127], v[96:99], a[36:39], v[124:127]
ds_read_b64_tr_b16 v[80:81], v19 offset:16384
buffer_load_dwordx4 v50, s[24:27], s43 offen offset:2048 lds
v_mfma_f32_16x16x32_bf16 v[124:127], v[100:103], a[44:47], v[124:127]
ds_read_b64_tr_b16 v[82:83], v19 offset:18432
ds_read_b64 a[74:75], v251 offset:0
v_mfma_f32_16x16x32_bf16 v[124:127], v[104:107], a[52:55], v[124:127]
ds_read_b64_tr_b16 v[84:85], v19 offset:20480
ds_read_b64 a[80:81], v252 offset:0
v_mfma_f32_16x16x32_bf16 v[124:127], v[108:111], a[60:63], v[124:127]
ds_read_b64_tr_b16 v[86:87], v19 offset:22528
buffer_load_dwordx4 v51, s[24:27], s43 offen offset:3072 lds
v_mfma_f32_16x16x32_bf16 v[120:123], v[108:111], a[56:59], v[120:123]
ds_read_b64_tr_b16 v[88:89], v19 offset:24576
ds_read_b64 a[82:83], v253 offset:0
v_mfma_f32_16x16x32_bf16 v[120:123], v[104:107], a[48:51], v[120:123]
ds_read_b64_tr_b16 v[90:91], v19 offset:26624
ds_read_b64 a[88:89], v254 offset:0
v_mfma_f32_16x16x32_bf16 v[120:123], v[100:103], a[40:43], v[120:123]
s_add_u32 m0, s41, 114688
ds_read_b64_tr_b16 v[92:93], v19 offset:28672
s_mul_i32 s42, s51, 96
buffer_load_dwordx4 v28, s[8:11], s42 offen sc1 lds
ds_read_b64 a[90:91], v255 offset:0
v_mfma_f32_16x16x32_bf16 v[120:123], v[96:99], a[32:35], v[120:123]
s_waitcnt vmcnt(15) lgkmcnt(12)
s_barrier
ds_read_b64_tr_b16 v[94:95], v19 offset:30720
v_mfma_f32_16x16x32_bf16 v[128:131], v[64:67], a[32:35], v[128:131]
ds_read_b64_tr_b16 v[96:97], v16 offset:32768
buffer_load_dwordx4 v29, s[8:11], s42 offen offset:1024 sc1 lds
v_mfma_f32_16x16x32_bf16 v[128:131], v[68:71], a[40:43], v[128:131]
s_waitcnt vmcnt(11)
ds_read_b64_tr_b16 v[98:99], v16 offset:34816
ds_read_b64 a[68:69], v248 offset:4096
buffer_load_dwordx4 v30, s[8:11], s42 offen offset:2048 sc1 lds
v_mfma_f32_16x16x32_bf16 v[128:131], v[72:75], a[48:51], v[128:131]
ds_read_b64_tr_b16 v[100:101], v16 offset:36864
ds_read_b64 a[70:71], v249 offset:4096
buffer_load_dwordx4 v31, s[8:11], s42 offen offset:3072 sc1 lds
v_mfma_f32_16x16x32_bf16 v[128:131], v[76:79], a[56:59], v[128:131]
ds_read_b64_tr_b16 v[102:103], v16 offset:38912
ds_read_b64 a[76:77], v250 offset:4096
s_add_u32 m0, s41, 65536
v_mfma_f32_16x16x32_bf16 v[132:135], v[76:79], a[60:63], v[132:135]
s_mul_i32 s42, s52, 96
ds_read_b64_tr_b16 v[104:105], v16 offset:40960
buffer_load_dwordx4 v28, s[8:11], s42 offen sc1 lds
v_mfma_f32_16x16x32_bf16 v[132:135], v[72:75], a[52:55], v[132:135]
ds_read_b64_tr_b16 v[106:107], v16 offset:43008
ds_read_b64 a[78:79], v251 offset:4096
buffer_load_dwordx4 v29, s[8:11], s42 offen offset:1024 sc1 lds
v_mfma_f32_16x16x32_bf16 v[132:135], v[68:71], a[44:47], v[132:135]
ds_read_b64_tr_b16 v[108:109], v16 offset:45056
ds_read_b64 a[84:85], v252 offset:4096
buffer_load_dwordx4 v30, s[8:11], s42 offen offset:2048 sc1 lds
v_mfma_f32_16x16x32_bf16 v[132:135], v[64:67], a[36:39], v[132:135]
s_waitcnt lgkmcnt(12)
ds_read_b64_tr_b16 v[110:111], v16 offset:47104
v_mfma_f32_16x16x32_bf16 v[140:143], v[80:83], a[36:39], v[140:143]
ds_read_b64_tr_b16 v[64:65], v17 offset:32768
ds_read_b64 a[86:87], v253 offset:4096
v_mfma_f32_16x16x32_bf16 v[140:143], v[84:87], a[44:47], v[140:143]
ds_read_b64_tr_b16 v[66:67], v17 offset:34816
ds_read_b64 a[92:93], v254 offset:4096
v_mfma_f32_16x16x32_bf16 v[140:143], v[88:91], a[52:55], v[140:143]
ds_read_b64_tr_b16 v[68:69], v17 offset:36864
ds_read_b64 a[94:95], v255 offset:4096
v_mfma_f32_16x16x32_bf16 v[140:143], v[92:95], a[60:63], v[140:143]
ds_read_b64_tr_b16 v[70:71], v17 offset:38912
buffer_load_dwordx4 v31, s[8:11], s42 offen offset:3072 sc1 lds
v_mfma_f32_16x16x32_bf16 v[136:139], v[92:95], a[56:59], v[136:139]
ds_read_b64_tr_b16 v[72:73], v17 offset:40960
s_add_u32 m0, s62, 0
v_mfma_f32_16x16x32_bf16 v[136:139], v[88:91], a[48:51], v[136:139]
s_lshr_b32 s43, s52, 5
ds_read_b64_tr_b16 v[74:75], v17 offset:43008
s_add_u32 s43, s43, s79
v_mfma_f32_16x16x32_bf16 v[136:139], v[84:87], a[40:43], v[136:139]
ds_read_b64_tr_b16 v[76:77], v17 offset:45056
buffer_load_dwordx4 v48, s[24:27], s43 offen lds
buffer_load_dwordx4 v49, s[24:27], s43 offen offset:1024 lds
v_mfma_f32_16x16x32_bf16 v[136:139], v[80:83], a[32:35], v[136:139]
s_waitcnt lgkmcnt(4)
ds_read_b64_tr_b16 v[78:79], v17 offset:47104
v_mfma_f32_16x16x32_bf16 v[112:115], v[96:99], a[64:67], v[112:115]
ds_read_b64_tr_b16 v[80:81], v18 offset:32768
buffer_load_dwordx4 v50, s[24:27], s43 offen offset:2048 lds
v_mfma_f32_16x16x32_bf16 v[112:115], v[100:103], a[72:75], v[112:115]
s_waitcnt vmcnt(15)
ds_read_b64_tr_b16 v[82:83], v18 offset:34816
ds_read_b64 a[96:97], v248 offset:32768
ds_read_b64 a[98:99], v249 offset:32768
v_mfma_f32_16x16x32_bf16 v[112:115], v[104:107], a[80:83], v[112:115]
ds_read_b64_tr_b16 v[84:85], v18 offset:36864
buffer_load_dwordx4 v51, s[24:27], s43 offen offset:3072 lds
v_mfma_f32_16x16x32_bf16 v[112:115], v[108:111], a[88:91], v[112:115]
ds_read_b64_tr_b16 v[86:87], v18 offset:38912
ds_read_b64 a[104:105], v250 offset:32768
v_mfma_f32_16x16x32_bf16 v[116:119], v[108:111], a[92:95], v[116:119]
s_add_u32 m0, s62, 4096
ds_read_b64_tr_b16 v[88:89], v18 offset:40960
s_add_u32 s43, s43, 32768
v_mfma_f32_16x16x32_bf16 v[116:119], v[104:107], a[84:87], v[116:119]
ds_read_b64_tr_b16 v[90:91], v18 offset:43008
buffer_load_dwordx4 v48, s[24:27], s43 offen lds
v_mfma_f32_16x16x32_bf16 v[116:119], v[100:103], a[76:79], v[116:119]
ds_read_b64_tr_b16 v[92:93], v18 offset:45056
ds_read_b64 a[106:107], v251 offset:32768
v_cmp_gt_u32 vcc, 16, v25
s_cbranch_vccz Lpok13
Lpw12:
s_sleep 8
buffer_load_dword v25, v0, s[32:35], 0 offen sc1
s_add_u32 s47, s47, 1
s_cmp_ge_u32 s47, 0x40000
s_cbranch_scc1 Lend
s_waitcnt vmcnt(0)
v_cmp_gt_u32 vcc, 16, v25
s_cbranch_vccnz Lpw12
Lpok13:
v_mfma_f32_16x16x32_bf16 v[116:119], v[96:99], a[68:71], v[116:119]
s_waitcnt lgkmcnt(11)
ds_read_b64_tr_b16 v[94:95], v18 offset:47104
v_mfma_f32_16x16x32_bf16 v[124:127], v[64:67], a[68:71], v[124:127]
ds_read_b64_tr_b16 v[96:97], v19 offset:32768
buffer_load_dwordx4 v49, s[24:27], s43 offen offset:1024 lds
v_mfma_f32_16x16x32_bf16 v[124:127], v[68:71], a[76:79], v[124:127]
ds_read_b64_tr_b16 v[98:99], v19 offset:34816
ds_read_b64 a[112:113], v252 offset:32768
ds_read_b64 a[114:115], v253 offset:32768
v_mfma_f32_16x16x32_bf16 v[124:127], v[72:75], a[84:87], v[124:127]
ds_read_b64_tr_b16 v[100:101], v19 offset:36864
buffer_load_dwordx4 v50, s[24:27], s43 offen offset:2048 lds
v_mfma_f32_16x16x32_bf16 v[124:127], v[76:79], a[92:95], v[124:127]
ds_read_b64_tr_b16 v[102:103], v19 offset:38912
ds_read_b64 a[120:121], v254 offset:32768
buffer_load_dwordx4 v51, s[24:27], s43 offen offset:3072 lds
v_mfma_f32_16x16x32_bf16 v[120:123], v[76:79], a[88:91], v[120:123]
ds_read_b64_tr_b16 v[104:105], v19 offset:40960
ds_read_b64 a[122:123], v255 offset:32768
v_mfma_f32_16x16x32_bf16 v[120:123], v[72:75], a[80:83], v[120:123]
ds_read_b64_tr_b16 v[106:107], v19 offset:43008
s_cmp_lg_u32 s40, 0
s_cbranch_scc1 Lc014
v_lshrrev_b32 v0, 7, v1
v_mul_u32_u24 v0, 896, v0
v_add_u32 v0, v0, v1
s_lshl_b32 s46, s2, 2
s_add_u32 s46, s46, s36
s_sub_u32 s45, s46, 0
s_cmp_lt_u32 s45, 768
s_cselect_b32 s45, s45, 131072
s_lshl_b32 s45, s45, 13
buffer_load_dwordx4 v[208:211], v0, s[8:11], s45 offen offset:384
s_sub_u32 s45, s46, 768
s_cmp_lt_u32 s45, 256
s_cselect_b32 s45, s45, 131072
s_lshl_b32 s45, s45, 13
buffer_load_dwordx4 v[212:215], v0, s[12:15], s45 offen offset:384
s_sub_u32 s45, s46, 0
s_cmp_lt_u32 s45, 896
s_cselect_b32 s45, s45, 131072
s_lshl_b32 s45, s45, 13
buffer_load_dwordx4 v[216:219], v0, s[16:19], s45 offen offset:384
s_sub_u32 s45, s46, 128
s_cmp_lt_u32 s45, 896
s_cselect_b32 s45, s45, 131072
s_lshl_b32 s45, s45, 13
buffer_load_dwordx4 v[220:223], v0, s[20:23], s45 offen offset:384
Lc014:
v_mfma_f32_16x16x32_bf16 v[120:123], v[68:71], a[72:75], v[120:123]
ds_read_b64_tr_b16 v[108:109], v19 offset:45056
buffer_atomic_add v26, v11, s[4:7], s69 offen offset:60 sc1
buffer_atomic_add v26, v11, s[4:7], s76 offen offset:56 sc1
v_mfma_f32_16x16x32_bf16 v[120:123], v[64:67], a[64:67], v[120:123]
s_waitcnt vmcnt(14) lgkmcnt(11)
s_barrier
ds_read_b64_tr_b16 v[110:111], v19 offset:47104
v_mfma_f32_16x16x32_bf16 v[128:131], v[80:83], a[64:67], v[128:131]
s_add_u32 m0, s41, 81920
ds_read_b64_tr_b16 v[64:65], v16 offset:49152
s_mul_i32 s42, s53, 96
v_mfma_f32_16x16x32_bf16 v[128:131], v[84:87], a[72:75], v[128:131]
ds_read_b64_tr_b16 v[66:67], v16 offset:51200
buffer_load_dwordx4 v28, s[8:11], s42 offen sc1 lds
v_mfma_f32_16x16x32_bf16 v[128:131], v[88:91], a[80:83], v[128:131]
ds_read_b64_tr_b16 v[68:69], v16 offset:53248
ds_read_b64 a[100:101], v248 offset:36864
ds_read_b64 a[102:103], v249 offset:36864
v_mfma_f32_16x16x32_bf16 v[128:131], v[92:95], a[88:91], v[128:131]
ds_read_b64_tr_b16 v[70:71], v16 offset:55296
buffer_load_dwordx4 v29, s[8:11], s42 offen offset:1024 sc1 lds
v_mfma_f32_16x16x32_bf16 v[132:135], v[92:95], a[92:95], v[132:135]
ds_read_b64_tr_b16 v[72:73], v16 offset:57344
ds_read_b64 a[108:109], v250 offset:36864
v_mfma_f32_16x16x32_bf16 v[132:135], v[88:91], a[84:87], v[132:135]
ds_read_b64_tr_b16 v[74:75], v16 offset:59392
ds_read_b64 a[110:111], v251 offset:36864
v_mfma_f32_16x16x32_bf16 v[132:135], v[84:87], a[76:79], v[132:135]
ds_read_b64_tr_b16 v[76:77], v16 offset:61440
buffer_load_dwordx4 v30, s[8:11], s42 offen offset:2048 sc1 lds
ds_read_b64 a[116:117], v252 offset:36864
v_mfma_f32_16x16x32_bf16 v[132:135], v[80:83], a[68:71], v[132:135]
s_waitcnt lgkmcnt(12)
ds_read_b64_tr_b16 v[78:79], v16 offset:63488
v_mfma_f32_16x16x32_bf16 v[140:143], v[96:99], a[68:71], v[140:143]
ds_read_b64_tr_b16 v[80:81], v17 offset:49152
ds_read_b64 a[118:119], v253 offset:36864
v_mfma_f32_16x16x32_bf16 v[140:143], v[100:103], a[76:79], v[140:143]
ds_read_b64_tr_b16 v[82:83], v17 offset:51200
ds_read_b64 a[124:125], v254 offset:36864
v_mfma_f32_16x16x32_bf16 v[140:143], v[104:107], a[84:87], v[140:143]
ds_read_b64_tr_b16 v[84:85], v17 offset:53248
ds_read_b64 a[126:127], v255 offset:36864
v_mfma_f32_16x16x32_bf16 v[140:143], v[108:111], a[92:95], v[140:143]
ds_read_b64_tr_b16 v[86:87], v17 offset:55296
buffer_load_dwordx4 v31, s[8:11], s42 offen offset:3072 sc1 lds
v_mfma_f32_16x16x32_bf16 v[136:139], v[108:111], a[88:91], v[136:139]
ds_read_b64_tr_b16 v[88:89], v17 offset:57344
s_add_u32 m0, s62, 32768
v_mfma_f32_16x16x32_bf16 v[136:139], v[104:107], a[80:83], v[136:139]
s_lshr_b32 s43, s53, 5
ds_read_b64_tr_b16 v[90:91], v17 offset:59392
s_add_u32 s43, s43, s79
v_mfma_f32_16x16x32_bf16 v[136:139], v[100:103], a[72:75], v[136:139]
ds_read_b64_tr_b16 v[92:93], v17 offset:61440
buffer_load_dwordx4 v48, s[24:27], s43 offen lds
buffer_load_dwordx4 v49, s[24:27], s43 offen offset:1024 lds
v_mfma_f32_16x16x32_bf16 v[136:139], v[96:99], a[64:67], v[136:139]
s_waitcnt lgkmcnt(4)
ds_read_b64_tr_b16 v[94:95], v17 offset:63488
v_mfma_f32_16x16x32_bf16 v[112:115], v[64:67], a[96:99], v[112:115]
ds_read_b64_tr_b16 v[96:97], v18 offset:49152
buffer_load_dwordx4 v50, s[24:27], s43 offen offset:2048 lds
v_mfma_f32_16x16x32_bf16 v[112:115], v[68:71], a[104:107], v[112:115]
s_waitcnt vmcnt(13)
ds_read_b64_tr_b16 v[98:99], v18 offset:51200
ds_read_b64 a[128:129], v248 offset:0
v_mfma_f32_16x16x32_bf16 v[112:115], v[72:75], a[112:115], v[112:115]
ds_read_b64_tr_b16 v[100:101], v18 offset:53248
ds_read_b64 a[130:131], v249 offset:0
v_mfma_f32_16x16x32_bf16 v[112:115], v[76:79], a[120:123], v[112:115]
ds_read_b64_tr_b16 v[102:103], v18 offset:55296
buffer_load_dwordx4 v51, s[24:27], s43 offen offset:3072 lds
v_mfma_f32_16x16x32_bf16 v[116:119], v[76:79], a[124:127], v[116:119]
s_branch Lso1
Lst1:
s_setpc_b64 s[42:43]
Lso1:
ds_read_b64_tr_b16 v[104:105], v18 offset:57344
ds_read_b64 a[136:137], v250 offset:0
v_mfma_f32_16x16x32_bf16 v[116:119], v[72:75], a[116:119], v[116:119]
s_add_u32 m0, s62, 36864
ds_read_b64_tr_b16 v[106:107], v18 offset:59392
s_add_u32 s43, s43, 32768
v_mfma_f32_16x16x32_bf16 v[116:119], v[68:71], a[108:111], v[116:119]
ds_read_b64_tr_b16 v[108:109], v18 offset:61440
buffer_load_dwordx4 v48, s[24:27], s43 offen lds
ds_read_b64 a[138:139], v251 offset:0
v_mfma_f32_16x16x32_bf16 v[116:119], v[64:67], a[100:103], v[116:119]
s_waitcnt lgkmcnt(11)
ds_read_b64_tr_b16 v[110:111], v18 offset:63488
v_mfma_f32_16x16x32_bf16 v[124:127], v[80:83], a[100:103], v[124:127]
ds_read_b64_tr_b16 v[64:65], v19 offset:49152
buffer_load_dwordx4 v49, s[24:27], s43 offen offset:1024 lds
v_mfma_f32_16x16x32_bf16 v[124:127], v[84:87], a[108:111], v[124:127]
ds_read_b64_tr_b16 v[66:67], v19 offset:51200
ds_read_b64 a[144:145], v252 offset:0
v_mfma_f32_16x16x32_bf16 v[124:127], v[88:91], a[116:119], v[124:127]
ds_read_b64_tr_b16 v[68:69], v19 offset:53248
ds_read_b64 a[146:147], v253 offset:0
v_mfma_f32_16x16x32_bf16 v[124:127], v[92:95], a[124:127], v[124:127]
ds_read_b64_tr_b16 v[70:71], v19 offset:55296
buffer_load_dwordx4 v50, s[24:27], s43 offen offset:2048 lds
v_mfma_f32_16x16x32_bf16 v[120:123], v[92:95], a[120:123], v[120:123]
ds_read_b64_tr_b16 v[72:73], v19 offset:57344
ds_read_b64 a[152:153], v254 offset:0
v_mfma_f32_16x16x32_bf16 v[120:123], v[88:91], a[112:115], v[120:123]
ds_read_b64_tr_b16 v[74:75], v19 offset:59392
buffer_load_dwordx4 v51, s[24:27], s43 offen offset:3072 lds
v_mfma_f32_16x16x32_bf16 v[120:123], v[84:87], a[104:107], v[120:123]
ds_read_b64_tr_b16 v[76:77], v19 offset:61440
ds_read_b64 a[154:155], v255 offset:0
v_mfma_f32_16x16x32_bf16 v[120:123], v[80:83], a[96:99], v[120:123]
s_waitcnt lgkmcnt(11)
s_barrier
ds_read_b64_tr_b16 v[78:79], v19 offset:63488
v_mfma_f32_16x16x32_bf16 v[128:131], v[96:99], a[96:99], v[128:131]
s_add_u32 m0, s41, 98304
ds_read_b64_tr_b16 v[80:81], v16 offset:0
s_mul_i32 s42, s54, 96
v_mfma_f32_16x16x32_bf16 v[128:131], v[100:103], a[104:107], v[128:131]
ds_read_b64_tr_b16 v[82:83], v16 offset:2048
buffer_load_dwordx4 v28, s[8:11], s42 offen sc1 lds
v_mfma_f32_16x16x32_bf16 v[128:131], v[104:107], a[112:115], v[128:131]
s_waitcnt vmcnt(15)
ds_read_b64_tr_b16 v[84:85], v16 offset:4096
ds_read_b64 a[132:133], v248 offset:4096
ds_read_b64 a[134:135], v249 offset:4096
v_mfma_f32_16x16x32_bf16 v[128:131], v[108:111], a[120:123], v[128:131]
ds_read_b64_tr_b16 v[86:87], v16 offset:6144
buffer_load_dwordx4 v29, s[8:11], s42 offen offset:1024 sc1 lds
v_mfma_f32_16x16x32_bf16 v[132:135], v[108:111], a[124:127], v[132:135]
ds_read_b64_tr_b16 v[88:89], v16 offset:8192
ds_read_b64 a[140:141], v250 offset:4096
v_mfma_f32_16x16x32_bf16 v[132:135], v[104:107], a[116:119], v[132:135]
ds_read_b64_tr_b16 v[90:91], v16 offset:10240
ds_read_b64 a[142:143], v251 offset:4096
v_mfma_f32_16x16x32_bf16 v[132:135], v[100:103], a[108:111], v[132:135]
ds_read_b64_tr_b16 v[92:93], v16 offset:12288
buffer_load_dwordx4 v30, s[8:11], s42 offen offset:2048 sc1 lds
ds_read_b64 a[148:149], v252 offset:4096
v_mfma_f32_16x16x32_bf16 v[132:135], v[96:99], a[100:103], v[132:135]
s_waitcnt lgkmcnt(12)
ds_read_b64_tr_b16 v[94:95], v16 offset:14336
v_mfma_f32_16x16x32_bf16 v[140:143], v[64:67], a[100:103], v[140:143]
ds_read_b64_tr_b16 v[96:97], v17 offset:0
ds_read_b64 a[150:151], v253 offset:4096
v_mfma_f32_16x16x32_bf16 v[140:143], v[68:71], a[108:111], v[140:143]
ds_read_b64_tr_b16 v[98:99], v17 offset:2048
ds_read_b64 a[156:157], v254 offset:4096
v_mfma_f32_16x16x32_bf16 v[140:143], v[72:75], a[116:119], v[140:143]
ds_read_b64_tr_b16 v[100:101], v17 offset:4096
ds_read_b64 a[158:159], v255 offset:4096
v_mfma_f32_16x16x32_bf16 v[140:143], v[76:79], a[124:127], v[140:143]
ds_read_b64_tr_b16 v[102:103], v17 offset:6144
buffer_load_dwordx4 v31, s[8:11], s42 offen offset:3072 sc1 lds
v_mfma_f32_16x16x32_bf16 v[136:139], v[76:79], a[120:123], v[136:139]
ds_read_b64_tr_b16 v[104:105], v17 offset:8192
s_add_u32 m0, s62, 0
v_mfma_f32_16x16x32_bf16 v[136:139], v[72:75], a[112:115], v[136:139]
s_lshr_b32 s43, s54, 5
ds_read_b64_tr_b16 v[106:107], v17 offset:10240
s_add_u32 s43, s43, s79
v_mfma_f32_16x16x32_bf16 v[136:139], v[68:71], a[104:107], v[136:139]
ds_read_b64_tr_b16 v[108:109], v17 offset:12288
buffer_load_dwordx4 v48, s[24:27], s43 offen lds
buffer_load_dwordx4 v49, s[24:27], s43 offen offset:1024 lds
v_mfma_f32_16x16x32_bf16 v[136:139], v[64:67], a[96:99], v[136:139]
s_waitcnt lgkmcnt(4)
ds_read_b64_tr_b16 v[110:111], v17 offset:14336
v_mfma_f32_16x16x32_bf16 v[112:115], v[80:83], a[128:131], v[112:115]
ds_read_b64_tr_b16 v[64:65], v18 offset:0
buffer_load_dwordx4 v50, s[24:27], s43 offen offset:2048 lds
v_mfma_f32_16x16x32_bf16 v[112:115], v[84:87], a[136:139], v[112:115]
s_waitcnt vmcnt(11)
ds_read_b64_tr_b16 v[66:67], v18 offset:2048
ds_read_b64 a[160:161], v248 offset:32768
v_mfma_f32_16x16x32_bf16 v[112:115], v[88:91], a[144:147], v[112:115]
ds_read_b64_tr_b16 v[68:69], v18 offset:4096
ds_read_b64 a[162:163], v249 offset:32768
v_mfma_f32_16x16x32_bf16 v[112:115], v[92:95], a[152:155], v[112:115]
ds_read_b64_tr_b16 v[70:71], v18 offset:6144
buffer_load_dwordx4 v51, s[24:27], s43 offen offset:3072 lds
v_mfma_f32_16x16x32_bf16 v[116:119], v[92:95], a[156:159], v[116:119]
ds_read_b64_tr_b16 v[72:73], v18 offset:8192
ds_read_b64 a[168:169], v250 offset:32768
v_mfma_f32_16x16x32_bf16 v[116:119], v[88:91], a[148:151], v[116:119]
s_add_u32 m0, s62, 4096
ds_read_b64_tr_b16 v[74:75], v18 offset:10240
s_add_u32 s43, s43, 32768
v_mfma_f32_16x16x32_bf16 v[116:119], v[84:87], a[140:143], v[116:119]
ds_read_b64_tr_b16 v[76:77], v18 offset:12288
buffer_load_dwordx4 v48, s[24:27], s43 offen lds
ds_read_b64 a[170:171], v251 offset:32768
v_mfma_f32_16x16x32_bf16 v[116:119], v[80:83], a[132:135], v[116:119]
s_waitcnt lgkmcnt(11)
ds_read_b64_tr_b16 v[78:79], v18 offset:14336
v_mfma_f32_16x16x32_bf16 v[124:127], v[96:99], a[132:135], v[124:127]
ds_read_b64_tr_b16 v[80:81], v19 offset:0
buffer_load_dwordx4 v49, s[24:27], s43 offen offset:1024 lds
v_mfma_f32_16x16x32_bf16 v[124:127], v[100:103], a[140:143], v[124:127]
ds_read_b64_tr_b16 v[82:83], v19 offset:2048
ds_read_b64 a[176:177], v252 offset:32768
v_mfma_f32_16x16x32_bf16 v[124:127], v[104:107], a[148:151], v[124:127]
ds_read_b64_tr_b16 v[84:85], v19 offset:4096
ds_read_b64 a[178:179], v253 offset:32768
v_mfma_f32_16x16x32_bf16 v[124:127], v[108:111], a[156:159], v[124:127]
ds_read_b64_tr_b16 v[86:87], v19 offset:6144
buffer_load_dwordx4 v50, s[24:27], s43 offen offset:2048 lds
v_mfma_f32_16x16x32_bf16 v[120:123], v[108:111], a[152:155], v[120:123]
ds_read_b64_tr_b16 v[88:89], v19 offset:8192
ds_read_b64 a[184:185], v254 offset:32768
v_mfma_f32_16x16x32_bf16 v[120:123], v[104:107], a[144:147], v[120:123]
ds_read_b64_tr_b16 v[90:91], v19 offset:10240
buffer_load_dwordx4 v51, s[24:27], s43 offen offset:3072 lds
v_mfma_f32_16x16x32_bf16 v[120:123], v[100:103], a[136:139], v[120:123]
ds_read_b64_tr_b16 v[92:93], v19 offset:12288
ds_read_b64 a[186:187], v255 offset:32768
v_mfma_f32_16x16x32_bf16 v[120:123], v[96:99], a[128:131], v[120:123]
s_waitcnt lgkmcnt(11)
s_barrier
ds_read_b64_tr_b16 v[94:95], v19 offset:14336
v_mfma_f32_16x16x32_bf16 v[128:131], v[64:67], a[128:131], v[128:131]
s_add_u32 m0, s41, 114688
ds_read_b64_tr_b16 v[96:97], v16 offset:16384
s_mul_i32 s42, s55, 96
buffer_load_dwordx4 v28, s[8:11], s42 offen sc1 lds
v_mfma_f32_16x16x32_bf16 v[128:131], v[68:71], a[136:139], v[128:131]
s_waitcnt vmcnt(13)
ds_read_b64_tr_b16 v[98:99], v16 offset:18432
ds_read_b64 a[164:165], v248 offset:36864
ds_read_b64 a[166:167], v249 offset:36864
v_mfma_f32_16x16x32_bf16 v[128:131], v[72:75], a[144:147], v[128:131]
ds_read_b64_tr_b16 v[100:101], v16 offset:20480
buffer_load_dwordx4 v29, s[8:11], s42 offen offset:1024 sc1 lds
ds_read_b64 a[172:173], v250 offset:36864
v_mfma_f32_16x16x32_bf16 v[128:131], v[76:79], a[152:155], v[128:131]
ds_read_b64_tr_b16 v[102:103], v16 offset:22528
ds_read_b64 a[174:175], v251 offset:36864
buffer_load_dwordx4 v30, s[8:11], s42 offen offset:2048 sc1 lds
v_mfma_f32_16x16x32_bf16 v[132:135], v[76:79], a[156:159], v[132:135]
ds_read_b64_tr_b16 v[104:105], v16 offset:24576
ds_read_b64 a[180:181], v252 offset:36864
s_mul_i32 s45, s0, 6144
v_mfma_f32_16x16x32_bf16 v[132:135], v[72:75], a[148:151], v[132:135]
s_add_u32 s45, s45, s1
ds_read_b64_tr_b16 v[106:107], v16 offset:26624
s_add_u32 s45, s45, 4096
buffer_load_dword v3, v20, s[8:11], s45 offen
v_mfma_f32_16x16x32_bf16 v[132:135], v[68:71], a[140:143], v[132:135]
ds_read_b64_tr_b16 v[108:109], v16 offset:28672
v_mov_b32 v25, 0
buffer_atomic_add v25, v11, s[4:7], s69 offen offset:60 sc0 sc1
v_mov_b32 v33, 0
buffer_atomic_add v33, v11, s[4:7], s76 offen offset:56 sc0 sc1
v_mfma_f32_16x16x32_bf16 v[132:135], v[64:67], a[132:135], v[132:135]
s_waitcnt lgkmcnt(12)
ds_read_b64_tr_b16 v[110:111], v16 offset:30720
v_mfma_f32_16x16x32_bf16 v[140:143], v[80:83], a[132:135], v[140:143]
ds_read_b64_tr_b16 v[64:65], v17 offset:16384
ds_read_b64 a[182:183], v253 offset:36864
s_waitcnt vmcnt(10)
v_mfma_f32_16x16x32_bf16 v[140:143], v[84:87], a[140:143], v[140:143]
ds_read_b64_tr_b16 v[66:67], v17 offset:18432
ds_read_b64 a[192:193], v248 offset:0
ds_read_b64 a[188:189], v254 offset:36864
v_mfma_f32_16x16x32_bf16 v[140:143], v[88:91], a[148:151], v[140:143]
ds_read_b64_tr_b16 v[68:69], v17 offset:20480
ds_read_b64 a[190:191], v255 offset:36864
ds_read_b64 a[194:195], v249 offset:0
v_mfma_f32_16x16x32_bf16 v[140:143], v[92:95], a[156:159], v[140:143]
ds_read_b64_tr_b16 v[70:71], v17 offset:22528
buffer_load_dwordx4 v31, s[8:11], s42 offen offset:3072 sc1 lds
v_mfma_f32_16x16x32_bf16 v[136:139], v[92:95], a[152:155], v[136:139]
ds_read_b64_tr_b16 v[72:73], v17 offset:24576
s_add_u32 m0, s62, 32768
v_mfma_f32_16x16x32_bf16 v[136:139], v[88:91], a[144:147], v[136:139]
s_lshr_b32 s43, s55, 5
ds_read_b64_tr_b16 v[74:75], v17 offset:26624
s_add_u32 s43, s43, s79
v_mfma_f32_16x16x32_bf16 v[136:139], v[84:87], a[136:139], v[136:139]
ds_read_b64_tr_b16 v[76:77], v17 offset:28672
buffer_load_dwordx4 v48, s[24:27], s43 offen lds
ds_read_b64 a[200:201], v250 offset:0
buffer_load_dwordx4 v49, s[24:27], s43 offen offset:1024 lds
v_mfma_f32_16x16x32_bf16 v[136:139], v[80:83], a[128:131], v[136:139]
s_waitcnt lgkmcnt(6)
ds_read_b64_tr_b16 v[78:79], v17 offset:30720
v_mfma_f32_16x16x32_bf16 v[112:115], v[96:99], a[160:163], v[112:115]
ds_read_b64_tr_b16 v[80:81], v18 offset:16384
buffer_load_dwordx4 v50, s[24:27], s43 offen offset:2048 lds
v_mfma_f32_16x16x32_bf16 v[112:115], v[100:103], a[168:171], v[112:115]
ds_read_b64_tr_b16 v[82:83], v18 offset:18432
ds_read_b64 a[202:203], v251 offset:0
v_mfma_f32_16x16x32_bf16 v[112:115], v[104:107], a[176:179], v[112:115]
ds_read_b64_tr_b16 v[84:85], v18 offset:20480
ds_read_b64 a[208:209], v252 offset:0
v_mfma_f32_16x16x32_bf16 v[112:115], v[108:111], a[184:187], v[112:115]
ds_read_b64_tr_b16 v[86:87], v18 offset:22528
buffer_load_dwordx4 v51, s[24:27], s43 offen offset:3072 lds
v_mfma_f32_16x16x32_bf16 v[116:119], v[108:111], a[188:191], v[116:119]
ds_read_b64_tr_b16 v[88:89], v18 offset:24576
ds_read_b64 a[210:211], v253 offset:0
ds_read_b64 a[216:217], v254 offset:0
v_mfma_f32_16x16x32_bf16 v[116:119], v[104:107], a[180:183], v[116:119]
s_add_u32 m0, s62, 36864
ds_read_b64_tr_b16 v[90:91], v18 offset:26624
s_add_u32 s43, s43, 32768
v_mfma_f32_16x16x32_bf16 v[116:119], v[100:103], a[172:175], v[116:119]
ds_read_b64_tr_b16 v[92:93], v18 offset:28672
buffer_load_dwordx4 v48, s[24:27], s43 offen lds
ds_read_b64 a[218:219], v255 offset:0
s_waitcnt vmcnt(12)
ds_read_b64 a[196:197], v248 offset:4096
v_mfma_f32_16x16x32_bf16 v[116:119], v[96:99], a[164:167], v[116:119]
s_waitcnt lgkmcnt(13)
ds_read_b64_tr_b16 v[94:95], v18 offset:30720
v_mfma_f32_16x16x32_bf16 v[124:127], v[64:67], a[164:167], v[124:127]
ds_read_b64_tr_b16 v[96:97], v19 offset:16384
buffer_load_dwordx4 v49, s[24:27], s43 offen offset:1024 lds
v_mfma_f32_16x16x32_bf16 v[124:127], v[68:71], a[172:175], v[124:127]
ds_read_b64_tr_b16 v[98:99], v19 offset:18432
ds_read_b64 a[198:199], v249 offset:4096
ds_read_b64 a[204:205], v250 offset:4096
v_mfma_f32_16x16x32_bf16 v[124:127], v[72:75], a[180:183], v[124:127]
ds_read_b64_tr_b16 v[100:101], v19 offset:20480
ds_read_b64 a[206:207], v251 offset:4096
v_mfma_f32_16x16x32_bf16 v[124:127], v[76:79], a[188:191], v[124:127]
ds_read_b64_tr_b16 v[102:103], v19 offset:22528
buffer_load_dwordx4 v50, s[24:27], s43 offen offset:2048 lds
v_mfma_f32_16x16x32_bf16 v[120:123], v[76:79], a[184:187], v[120:123]
ds_read_b64_tr_b16 v[104:105], v19 offset:24576
ds_read_b64 a[212:213], v252 offset:4096
ds_read_b64 a[214:215], v253 offset:4096
v_mfma_f32_16x16x32_bf16 v[120:123], v[72:75], a[176:179], v[120:123]
ds_read_b64_tr_b16 v[106:107], v19 offset:26624
buffer_load_dwordx4 v51, s[24:27], s43 offen offset:3072 lds
v_mfma_f32_16x16x32_bf16 v[120:123], v[68:71], a[168:171], v[120:123]
ds_read_b64_tr_b16 v[108:109], v19 offset:28672
ds_read_b64 a[220:221], v254 offset:4096
ds_read_b64 a[222:223], v255 offset:4096
s_cmp_lg_u32 s40, 0
s_cbranch_scc1 Lc01015
v_lshrrev_b32 v0, 7, v1
v_mul_u32_u24 v0, 896, v0
v_add_u32 v0, v0, v1
s_lshl_b32 s46, s2, 2
s_add_u32 s46, s46, s36
s_waitcnt vmcnt(41)
s_sub_u32 s45, s46, 0
s_cmp_lt_u32 s45, 768
s_cselect_b32 s45, s45, 131072
s_lshl_b32 s45, s45, 13
s_add_u32 s45, s45, 100663424
buffer_store_dwordx4 v[208:211], v0, s[4:7], s45 offen offset:384 sc1
s_sub_u32 s45, s46, 768
s_cmp_lt_u32 s45, 256
s_cselect_b32 s45, s45, 131072
s_lshl_b32 s45, s45, 13
s_add_u32 s45, s45, 107020416
buffer_store_dwordx4 v[212:215], v0, s[4:7], s45 offen offset:384 sc1
s_sub_u32 s45, s46, 0
s_cmp_lt_u32 s45, 896
s_cselect_b32 s45, s45, 131072
s_lshl_b32 s45, s45, 13
s_add_u32 s45, s45, 109183104
buffer_store_dwordx4 v[216:219], v0, s[4:7], s45 offen offset:384 sc1
s_sub_u32 s45, s46, 128
s_cmp_lt_u32 s45, 896
s_cselect_b32 s45, s45, 131072
s_lshl_b32 s45, s45, 13
s_add_u32 s45, s45, 116588672
buffer_store_dwordx4 v[220:223], v0, s[4:7], s45 offen offset:384 sc1
Lc01015:
v_mfma_f32_16x16x32_bf16 v[120:123], v[64:67], a[160:163], v[120:123]
s_waitcnt lgkmcnt(0)
s_barrier
ds_read_b64_tr_b16 v[110:111], v19 offset:30720
v_mfma_f32_16x16x32_bf16 v[128:131], v[80:83], a[160:163], v[128:131]
ds_read_b64_tr_b16 v[64:65], v16 offset:32768
s_waitcnt vmcnt(9)
v_readfirstlane_b32 s45, v25
s_nop 0
s_cmp_lt_u32 s45, 16
s_cbranch_scc1 Lslow2016
Lback2017:
v_mfma_f32_16x16x32_bf16 v[128:131], v[84:87], a[168:171], v[128:131]
ds_read_b64_tr_b16 v[66:67], v16 offset:34816
v_readfirstlane_b32 s45, v33
s_nop 0
s_cmp_lt_u32 s45, 16
s_cbranch_scc1 Lslow2018
Lback2019:
v_mfma_f32_16x16x32_bf16 v[128:131], v[88:91], a[176:179], v[128:131]
s_min_u32 s45, s36, 2
ds_read_b64_tr_b16 v[68:69], v16 offset:36864
s_lshl_b32 s46, s38, 3
v_mfma_f32_16x16x32_bf16 v[128:131], v[92:95], a[184:187], v[128:131]
s_add_u32 s46, s46, s45
ds_read_b64_tr_b16 v[70:71], v16 offset:38912
s_add_u32 s46, s46, 0
v_mfma_f32_16x16x32_bf16 v[132:135], v[92:95], a[188:191], v[132:135]
s_lshl_b32 s46, s46, 12
ds_read_b64_tr_b16 v[72:73], v16 offset:40960
s_add_u32 s46, s46, 131072
v_mfma_f32_16x16x32_bf16 v[132:135], v[88:91], a[180:183], v[132:135]
ds_read_b64_tr_b16 v[74:75], v16 offset:43008
buffer_load_dwordx4 v[144:147], v1, s[4:7], s46 offen sc1
v_mfma_f32_16x16x32_bf16 v[132:135], v[84:87], a[172:175], v[132:135]
ds_read_b64_tr_b16 v[76:77], v16 offset:45056
buffer_load_dwordx4 v[148:151], v1, s[4:7], s46 offen offset:1024 sc1
v_mfma_f32_16x16x32_bf16 v[132:135], v[80:83], a[164:167], v[132:135]
s_waitcnt lgkmcnt(7)
ds_read_b64_tr_b16 v[78:79], v16 offset:47104
v_mfma_f32_16x16x32_bf16 v[140:143], v[96:99], a[164:167], v[140:143]
ds_read_b64_tr_b16 v[80:81], v17 offset:32768
buffer_load_dwordx4 v[152:155], v1, s[4:7], s46 offen offset:2048 sc1
v_mfma_f32_16x16x32_bf16 v[140:143], v[100:103], a[172:175], v[140:143]
ds_read_b64_tr_b16 v[82:83], v17 offset:34816
v_mfma_f32_16x16x32_bf16 v[140:143], v[104:107], a[180:183], v[140:143]
ds_read_b64_tr_b16 v[84:85], v17 offset:36864
v_mfma_f32_16x16x32_bf16 v[140:143], v[108:111], a[188:191], v[140:143]
ds_read_b64_tr_b16 v[86:87], v17 offset:38912
v_mfma_f32_16x16x32_bf16 v[136:139], v[108:111], a[184:187], v[136:139]
ds_read_b64_tr_b16 v[88:89], v17 offset:40960
buffer_load_dwordx4 v[156:159], v1, s[4:7], s46 offen offset:3072 sc1
v_mfma_f32_16x16x32_bf16 v[136:139], v[104:107], a[176:179], v[136:139]
ds_read_b64_tr_b16 v[90:91], v17 offset:43008
v_mfma_f32_16x16x32_bf16 v[136:139], v[100:103], a[168:171], v[136:139]
ds_read_b64_tr_b16 v[92:93], v17 offset:45056
v_mfma_f32_16x16x32_bf16 v[136:139], v[96:99], a[160:163], v[136:139]
s_waitcnt lgkmcnt(7)
ds_read_b64_tr_b16 v[94:95], v17 offset:47104
v_mfma_f32_16x16x32_bf16 v[112:115], v[64:67], a[192:195], v[112:115]
s_waitcnt vmcnt(8)
ds_read_b64_tr_b16 v[96:97], v18 offset:32768
ds_read_b64 a[224:225], v248 offset:32768
ds_read_b64 a[226:227], v249 offset:32768
v_mfma_f32_16x16x32_bf16 v[112:115], v[68:71], a[200:203], v[112:115]
ds_read_b64_tr_b16 v[98:99], v18 offset:34816
ds_read_b64 a[232:233], v250 offset:32768
ds_read_b64 a[234:235], v251 offset:32768
v_mfma_f32_16x16x32_bf16 v[112:115], v[72:75], a[208:211], v[112:115]
ds_read_b64_tr_b16 v[100:101], v18 offset:36864
v_add_u32 v28, 4096, v20
v_add_u32 v29, 52224, v20
v_mfma_f32_16x16x32_bf16 v[112:115], v[76:79], a[216:219], v[112:115]
ds_read_b64_tr_b16 v[102:103], v18 offset:38912
v_add_u32 v30, 100352, v20
v_add_u32 v31, 148480, v20
v_mfma_f32_16x16x32_bf16 v[116:119], v[76:79], a[220:223], v[116:119]
s_add_u32 m0, s41, 0
ds_read_b64_tr_b16 v[104:105], v18 offset:40960
s_mul_i32 s42, s48, 96
buffer_load_dwordx4 v28, s[8:11], s42 offen sc1 lds
v_mfma_f32_16x16x32_bf16 v[116:119], v[72:75], a[212:215], v[116:119]
ds_read_b64_tr_b16 v[106:107], v18 offset:43008
buffer_load_dwordx4 v29, s[8:11], s42 offen offset:1024 sc1 lds
v_mfma_f32_16x16x32_bf16 v[116:119], v[68:71], a[204:207], v[116:119]
ds_read_b64_tr_b16 v[108:109], v18 offset:45056
buffer_load_dwordx4 v[208:211], v1, s[4:7], s73 offen sc1
buffer_load_dwordx4 v[212:215], v1, s[4:7], s73 offen offset:1024 sc1
v_mfma_f32_16x16x32_bf16 v[116:119], v[64:67], a[196:199], v[116:119]
s_waitcnt lgkmcnt(11)
ds_read_b64_tr_b16 v[110:111], v18 offset:47104
v_mfma_f32_16x16x32_bf16 v[124:127], v[80:83], a[196:199], v[124:127]
ds_read_b64_tr_b16 v[64:65], v19 offset:32768
ds_read_b64 a[240:241], v252 offset:32768
ds_read_b64 a[242:243], v253 offset:32768
v_mfma_f32_16x16x32_bf16 v[124:127], v[84:87], a[204:207], v[124:127]
ds_read_b64_tr_b16 v[66:67], v19 offset:34816
ds_read_b64 a[248:249], v254 offset:32768
v_mfma_f32_16x16x32_bf16 v[124:127], v[88:91], a[212:215], v[124:127]
ds_read_b64_tr_b16 v[68:69], v19 offset:36864
ds_read_b64 a[250:251], v255 offset:32768
v_mfma_f32_16x16x32_bf16 v[124:127], v[92:95], a[220:223], v[124:127]
ds_read_b64_tr_b16 v[70:71], v19 offset:38912
buffer_load_dwordx4 v30, s[8:11], s42 offen offset:2048 sc1 lds
v_mfma_f32_16x16x32_bf16 v[120:123], v[92:95], a[216:219], v[120:123]
ds_read_b64_tr_b16 v[72:73], v19 offset:40960
buffer_load_dwordx4 v31, s[8:11], s42 offen offset:3072 sc1 lds
v_mfma_f32_16x16x32_bf16 v[120:123], v[88:91], a[208:211], v[120:123]
ds_read_b64_tr_b16 v[74:75], v19 offset:43008
buffer_load_dwordx4 v[216:219], v1, s[4:7], s73 offen offset:2048 sc1
v_mfma_f32_16x16x32_bf16 v[120:123], v[84:87], a[200:203], v[120:123]
ds_read_b64_tr_b16 v[76:77], v19 offset:45056
buffer_load_dwordx4 v[220:223], v1, s[4:7], s73 offen offset:3072 sc1
v_mfma_f32_16x16x32_bf16 v[120:123], v[80:83], a[192:195], v[120:123]
s_waitcnt lgkmcnt(11)
s_barrier
ds_read_b64_tr_b16 v[78:79], v19 offset:47104
v_mfma_f32_16x16x32_bf16 v[128:131], v[96:99], a[192:195], v[128:131]
s_waitcnt vmcnt(12)
ds_read_b64_tr_b16 v[80:81], v16 offset:49152
ds_read_b64 a[228:229], v248 offset:36864
v_mfma_f32_16x16x32_bf16 v[128:131], v[100:103], a[200:203], v[128:131]
ds_read_b64_tr_b16 v[82:83], v16 offset:51200
ds_read_b64 a[230:231], v249 offset:36864
v_mfma_f32_16x16x32_bf16 v[128:131], v[104:107], a[208:211], v[128:131]
ds_read_b64_tr_b16 v[84:85], v16 offset:53248
ds_read_b64 a[236:237], v250 offset:36864
v_mfma_f32_16x16x32_bf16 v[128:131], v[108:111], a[216:219], v[128:131]
ds_read_b64_tr_b16 v[86:87], v16 offset:55296
ds_read_b64 a[238:239], v251 offset:36864
v_mfma_f32_16x16x32_bf16 v[132:135], v[108:111], a[220:223], v[132:135]
ds_read_b64_tr_b16 v[88:89], v16 offset:57344
ds_read_b64 a[244:245], v252 offset:36864
v_mfma_f32_16x16x32_bf16 v[132:135], v[104:107], a[212:215], v[132:135]
s_add_u32 m0, s41, 16384
ds_read_b64_tr_b16 v[90:91], v16 offset:59392
s_mul_i32 s42, s49, 96
v_mfma_f32_16x16x32_bf16 v[132:135], v[100:103], a[204:207], v[132:135]
ds_read_b64_tr_b16 v[92:93], v16 offset:61440
buffer_load_dwordx4 v28, s[8:11], s42 offen sc1 lds
buffer_load_dwordx4 v29, s[8:11], s42 offen offset:1024 sc1 lds
v_mfma_f32_16x16x32_bf16 v[132:135], v[96:99], a[196:199], v[132:135]
s_waitcnt lgkmcnt(12)
ds_read_b64_tr_b16 v[94:95], v16 offset:63488
s_lshl_b32 s35, s36, 4
s_add_u32 s35, s35, s38
s_lshl_b32 s35, s35, 7
v_mfma_f32_16x16x32_bf16 v[140:143], v[64:67], a[196:199], v[140:143]
ds_read_b64_tr_b16 v[96:97], v17 offset:49152
ds_read_b64 a[246:247], v253 offset:36864
v_mfma_f32_16x16x32_bf16 v[140:143], v[68:71], a[204:207], v[140:143]
ds_read_b64_tr_b16 v[98:99], v17 offset:51200
ds_read_b64 a[252:253], v254 offset:36864
v_mfma_f32_16x16x32_bf16 v[140:143], v[72:75], a[212:215], v[140:143]
ds_read_b64_tr_b16 v[100:101], v17 offset:53248
ds_read_b64 a[254:255], v255 offset:36864
v_mfma_f32_16x16x32_bf16 v[140:143], v[76:79], a[220:223], v[140:143]
ds_read_b64_tr_b16 v[102:103], v17 offset:55296
buffer_load_dwordx4 v30, s[8:11], s42 offen offset:2048 sc1 lds
v_mfma_f32_16x16x32_bf16 v[136:139], v[76:79], a[216:219], v[136:139]
ds_read_b64_tr_b16 v[104:105], v17 offset:57344
buffer_load_dwordx4 v31, s[8:11], s42 offen offset:3072 sc1 lds
v_mfma_f32_16x16x32_bf16 v[136:139], v[72:75], a[208:211], v[136:139]
s_and_b32 s32, s38, 12
ds_read_b64_tr_b16 v[106:107], v17 offset:59392
s_lshl_b32 s32, s32, 7
v_mfma_f32_16x16x32_bf16 v[136:139], v[68:71], a[200:203], v[136:139]
s_add_u32 s32, s32, s76
ds_read_b64_tr_b16 v[108:109], v17 offset:61440
s_add_u32 s32, s32, 128
v_mfma_f32_16x16x32_bf16 v[136:139], v[64:67], a[192:195], v[136:139]
s_waitcnt lgkmcnt(4)
ds_read_b64_tr_b16 v[110:111], v17 offset:63488
s_and_b32 s33, s38, 3
s_lshl_b32 s33, s33, 7
s_add_u32 s33, s33, s76
s_add_u32 s33, s33, 1024
s_and_b32 s34, s38, 11
s_lshl_b32 s34, s34, 7
s_add_u32 s34, s34, s76
s_add_u32 s34, s34, 512
v_mfma_f32_16x16x32_bf16 v[112:115], v[80:83], a[224:227], v[112:115]
s_waitcnt vmcnt(12)
ds_read_b64_tr_b16 v[64:65], v18 offset:49152
v_add_f32 v144, v144, v152
v_add_f32 v145, v145, v153
v_mfma_f32_16x16x32_bf16 v[112:115], v[84:87], a[232:235], v[112:115]
ds_read_b64_tr_b16 v[66:67], v18 offset:51200
v_add_f32 v146, v146, v154
v_add_f32 v147, v147, v155
v_mfma_f32_16x16x32_bf16 v[112:115], v[88:91], a[240:243], v[112:115]
ds_read_b64_tr_b16 v[68:69], v18 offset:53248
v_add_f32 v148, v148, v156
v_add_f32 v149, v149, v157
v_mfma_f32_16x16x32_bf16 v[112:115], v[92:95], a[248:251], v[112:115]
ds_read_b64_tr_b16 v[70:71], v18 offset:55296
v_add_f32 v150, v150, v158
v_mfma_f32_16x16x32_bf16 v[116:119], v[92:95], a[252:255], v[116:119]
ds_read_b64_tr_b16 v[72:73], v18 offset:57344
v_add_f32 v151, v151, v159
v_add_f32 v144, v144, v148
v_mfma_f32_16x16x32_bf16 v[116:119], v[88:91], a[244:247], v[116:119]
ds_read_b64_tr_b16 v[74:75], v18 offset:59392
v_add_f32 v145, v145, v149
v_mfma_f32_16x16x32_bf16 v[116:119], v[84:87], a[236:239], v[116:119]
ds_read_b64_tr_b16 v[76:77], v18 offset:61440
v_add_f32 v146, v146, v150
v_add_f32 v147, v147, v151
v_mfma_f32_16x16x32_bf16 v[116:119], v[80:83], a[228:231], v[116:119]
s_waitcnt lgkmcnt(7)
ds_read_b64_tr_b16 v[78:79], v18 offset:63488
v_mov_b32 v148, v144
s_and_b32 s24, s38, 11
v_mfma_f32_16x16x32_bf16 v[124:127], v[96:99], a[228:231], v[124:127]
s_mul_i32 s45, s0, 6144
ds_read_b64_tr_b16 v[80:81], v19 offset:49152
s_add_u32 s45, s45, s1
v_mfma_f32_16x16x32_bf16 v[124:127], v[100:103], a[236:239], v[124:127]
ds_read_b64_tr_b16 v[82:83], v19 offset:51200
buffer_load_dword v3, v20, s[8:11], s45 offen
v_mfma_f32_16x16x32_bf16 v[124:127], v[104:107], a[244:247], v[124:127]
ds_read_b64_tr_b16 v[84:85], v19 offset:53248
v_mov_b32 v149, v145
v_mov_b32 v150, v146
v_mfma_f32_16x16x32_bf16 v[124:127], v[108:111], a[252:255], v[124:127]
ds_read_b64_tr_b16 v[86:87], v19 offset:55296
v_mov_b32 v151, v147
v_permlane32_swap_b32 v144, v148
v_mfma_f32_16x16x32_bf16 v[120:123], v[108:111], a[248:251], v[120:123]
ds_read_b64_tr_b16 v[88:89], v19 offset:57344
v_permlane32_swap_b32 v145, v149
v_permlane32_swap_b32 v146, v150
v_mfma_f32_16x16x32_bf16 v[120:123], v[104:107], a[240:243], v[120:123]
ds_read_b64_tr_b16 v[90:91], v19 offset:59392
v_permlane32_swap_b32 v147, v151
v_mfma_f32_16x16x32_bf16 v[120:123], v[100:103], a[232:235], v[120:123]
ds_read_b64_tr_b16 v[92:93], v19 offset:61440
v_add_f32 v144, v144, v148
v_add_f32 v145, v145, v149
v_mfma_f32_16x16x32_bf16 v[120:123], v[96:99], a[224:227], v[120:123]
s_waitcnt vmcnt(7) lgkmcnt(7)
s_barrier
ds_read_b64_tr_b16 v[94:95], v19 offset:63488
v_add_f32 v146, v146, v150
s_lshl_b32 s69, s39, 16
s_add_u32 s69, s69, 6291456
v_mfma_f32_16x16x32_bf16 v[128:131], v[64:67], a[224:227], v[128:131]
s_add_u32 m0, s41, 32768
ds_read_b64_tr_b16 v[96:97], v12 offset:0
s_mul_i32 s42, s50, 96
v_mfma_f32_16x16x32_bf16 v[128:131], v[68:71], a[232:235], v[128:131]
ds_read_b64_tr_b16 v[98:99], v12 offset:2048
buffer_load_dwordx4 v28, s[8:11], s42 offen sc1 lds
v_mfma_f32_16x16x32_bf16 v[128:131], v[72:75], a[240:243], v[128:131]
ds_read_b64_tr_b16 v[100:101], v12 offset:4096
v_add_f32 v147, v147, v151
v_mov_b32 v148, v144
v_mfma_f32_16x16x32_bf16 v[128:131], v[76:79], a[248:251], v[128:131]
ds_read_b64_tr_b16 v[102:103], v12 offset:6144
v_mov_b32 v149, v145
v_mov_b32 v150, v146
v_mfma_f32_16x16x32_bf16 v[132:135], v[76:79], a[252:255], v[132:135]
ds_read_b64_tr_b16 v[104:105], v12 offset:8192
buffer_load_dwordx4 v29, s[8:11], s42 offen offset:1024 sc1 lds
v_mfma_f32_16x16x32_bf16 v[132:135], v[72:75], a[244:247], v[132:135]
ds_read_b64_tr_b16 v[106:107], v12 offset:10240
v_mov_b32 v151, v147
v_mfma_f32_16x16x32_bf16 v[132:135], v[68:71], a[236:239], v[132:135]
ds_read_b64_tr_b16 v[108:109], v12 offset:12288
v_permlane16_swap_b32 v144, v148
v_permlane16_swap_b32 v145, v149
v_mfma_f32_16x16x32_bf16 v[132:135], v[64:67], a[228:231], v[132:135]
s_waitcnt lgkmcnt(7)
ds_read_b64_tr_b16 v[110:111], v12 offset:14336
v_permlane16_swap_b32 v146, v150
v_mfma_f32_16x16x32_bf16 v[140:143], v[80:83], a[228:231], v[140:143]
s_branch Lso2
Lst2:
s_setpc_b64 s[42:43]
Lso2:
ds_read_b64_tr_b16 v[64:65], v13 offset:0
buffer_load_dwordx4 v30, s[8:11], s42 offen offset:2048 sc1 lds
v_mfma_f32_16x16x32_bf16 v[140:143], v[84:87], a[236:239], v[140:143]
ds_read_b64_tr_b16 v[66:67], v13 offset:2048
v_permlane16_swap_b32 v147, v151
v_mfma_f32_16x16x32_bf16 v[140:143], v[88:91], a[244:247], v[140:143]
ds_read_b64_tr_b16 v[68:69], v13 offset:4096
v_add_f32 v144, v144, v148
v_add_f32 v145, v145, v149
v_mfma_f32_16x16x32_bf16 v[140:143], v[92:95], a[252:255], v[140:143]
ds_read_b64_tr_b16 v[70:71], v13 offset:6144
v_mfma_f32_16x16x32_bf16 v[136:139], v[92:95], a[248:251], v[136:139]
ds_read_b64_tr_b16 v[72:73], v13 offset:8192
buffer_load_dwordx4 v31, s[8:11], s42 offen offset:3072 sc1 lds
v_mfma_f32_16x16x32_bf16 v[136:139], v[88:91], a[240:243], v[136:139]
ds_read_b64_tr_b16 v[74:75], v13 offset:10240
v_add_f32 v146, v146, v150
v_add_f32 v147, v147, v151
v_mfma_f32_16x16x32_bf16 v[136:139], v[84:87], a[232:235], v[136:139]
s_min_u32 s45, s36, 2
ds_read_b64_tr_b16 v[76:77], v13 offset:12288
s_lshl_b32 s45, s45, 8
s_add_u32 s45, s45, 131072
v_and_b32 v152, 0xf0, v1
v_add_u32 v152, s45, v152
ds_write_b128 v152, v[144:147]
v_mfma_f32_16x16x32_bf16 v[136:139], v[80:83], a[224:227], v[136:139]
s_waitcnt lgkmcnt(8)
ds_read_b64_tr_b16 v[78:79], v13 offset:14336
s_waitcnt vmcnt(5)
s_branch Ljoin
Lst3:
s_branch Lst8
Llayer:
s_add_u32 s43, s48, s68
buffer_load_dwordx4 a[0:3], v10, s[4:7], s43 offen sc1
buffer_load_dwordx4 a[4:7], v10, s[4:7], s43 offen offset:1024 sc1
buffer_load_dwordx4 a[8:11], v10, s[4:7], s43 offen offset:2048 sc1
buffer_load_dwordx4 a[12:15], v10, s[4:7], s43 offen offset:3072 sc1
buffer_load_dwordx4 a[16:19], v2, s[4:7], s43 offen sc1
buffer_load_dwordx4 a[20:23], v2, s[4:7], s43 offen offset:1024 sc1
buffer_load_dwordx4 a[24:27], v2, s[4:7], s43 offen offset:2048 sc1
buffer_load_dwordx4 a[28:31], v2, s[4:7], s43 offen offset:3072 sc1
s_add_u32 s43, s49, s68
buffer_load_dwordx4 a[32:35], v10, s[4:7], s43 offen sc1
buffer_load_dwordx4 a[36:39], v10, s[4:7], s43 offen offset:1024 sc1
buffer_load_dwordx4 a[40:43], v10, s[4:7], s43 offen offset:2048 sc1
buffer_load_dwordx4 a[44:47], v10, s[4:7], s43 offen offset:3072 sc1
buffer_load_dwordx4 a[48:51], v2, s[4:7], s43 offen sc1
buffer_load_dwordx4 a[52:55], v2, s[4:7], s43 offen offset:1024 sc1
buffer_load_dwordx4 a[56:59], v2, s[4:7], s43 offen offset:2048 sc1
buffer_load_dwordx4 a[60:63], v2, s[4:7], s43 offen offset:3072 sc1
s_waitcnt vmcnt(14) lgkmcnt(8)
v_mfma_f32_16x16x32_bf16 v[112:115], v[64:67], a[0:3], 0
s_add_u32 s43, s50, s68
ds_read_b64_tr_b16 v[96:97], v12 offset:8192
buffer_load_dwordx4 a[64:67], v10, s[4:7], s43 offen sc1
v_mfma_f32_16x16x32_bf16 v[116:119], v[64:67], a[4:7], 0
ds_read_b64_tr_b16 v[98:99], v12 offset:10240
v_mfma_f32_16x16x32_bf16 v[120:123], v[68:71], a[0:3], 0
ds_read_b64_tr_b16 v[100:101], v13 offset:8192
v_mfma_f32_16x16x32_bf16 v[124:127], v[68:71], a[4:7], 0
ds_read_b64_tr_b16 v[102:103], v13 offset:10240
v_mfma_f32_16x16x32_bf16 v[128:131], v[72:75], a[0:3], 0
ds_read_b64_tr_b16 v[104:105], v14 offset:8192
buffer_load_dwordx4 a[68:71], v10, s[4:7], s43 offen offset:1024 sc1
v_mfma_f32_16x16x32_bf16 v[132:135], v[72:75], a[4:7], 0
ds_read_b64_tr_b16 v[106:107], v14 offset:10240
v_mfma_f32_16x16x32_bf16 v[136:139], v[76:79], a[0:3], 0
ds_read_b64_tr_b16 v[108:109], v15 offset:8192
v_mfma_f32_16x16x32_bf16 v[140:143], v[76:79], a[4:7], 0
s_waitcnt vmcnt(14) lgkmcnt(7)
ds_read_b64_tr_b16 v[110:111], v15 offset:10240
v_mfma_f32_16x16x32_bf16 v[112:115], v[80:83], a[8:11], v[112:115]
ds_read_b64_tr_b16 v[64:65], v12 offset:12288
buffer_load_dwordx4 a[72:75], v10, s[4:7], s43 offen offset:2048 sc1
v_mfma_f32_16x16x32_bf16 v[116:119], v[80:83], a[12:15], v[116:119]
ds_read_b64_tr_b16 v[66:67], v12 offset:14336
v_mfma_f32_16x16x32_bf16 v[120:123], v[84:87], a[8:11], v[120:123]
ds_read_b64_tr_b16 v[68:69], v13 offset:12288
v_mfma_f32_16x16x32_bf16 v[124:127], v[84:87], a[12:15], v[124:127]
ds_read_b64_tr_b16 v[70:71], v13 offset:14336
v_mfma_f32_16x16x32_bf16 v[128:131], v[88:91], a[8:11], v[128:131]
ds_read_b64_tr_b16 v[72:73], v14 offset:12288
buffer_load_dwordx4 a[76:79], v10, s[4:7], s43 offen offset:3072 sc1
v_mfma_f32_16x16x32_bf16 v[132:135], v[88:91], a[12:15], v[132:135]
ds_read_b64_tr_b16 v[74:75], v14 offset:14336
v_mfma_f32_16x16x32_bf16 v[136:139], v[92:95], a[8:11], v[136:139]
ds_read_b64_tr_b16 v[76:77], v15 offset:12288
v_mfma_f32_16x16x32_bf16 v[140:143], v[92:95], a[12:15], v[140:143]
s_waitcnt vmcnt(14) lgkmcnt(7)
ds_read_b64_tr_b16 v[78:79], v15 offset:14336
v_mfma_f32_16x16x32_bf16 v[112:115], v[96:99], a[16:19], v[112:115]
ds_read_b64_tr_b16 v[80:81], v12 offset:16384
buffer_load_dwordx4 a[80:83], v2, s[4:7], s43 offen sc1
v_mfma_f32_16x16x32_bf16 v[116:119], v[96:99], a[20:23], v[116:119]
ds_read_b64_tr_b16 v[82:83], v12 offset:18432
v_mfma_f32_16x16x32_bf16 v[120:123], v[100:103], a[16:19], v[120:123]
ds_read_b64_tr_b16 v[84:85], v12 offset:20480
v_mfma_f32_16x16x32_bf16 v[124:127], v[100:103], a[20:23], v[124:127]
ds_read_b64_tr_b16 v[86:87], v12 offset:22528
v_mfma_f32_16x16x32_bf16 v[128:131], v[104:107], a[16:19], v[128:131]
ds_read_b64_tr_b16 v[88:89], v12 offset:24576
buffer_load_dwordx4 a[84:87], v2, s[4:7], s43 offen offset:1024 sc1
v_mfma_f32_16x16x32_bf16 v[132:135], v[104:107], a[20:23], v[132:135]
ds_read_b64_tr_b16 v[90:91], v12 offset:26624
v_mfma_f32_16x16x32_bf16 v[136:139], v[108:111], a[16:19], v[136:139]
ds_read_b64_tr_b16 v[92:93], v12 offset:28672
v_mfma_f32_16x16x32_bf16 v[140:143], v[108:111], a[20:23], v[140:143]
s_waitcnt vmcnt(14) lgkmcnt(7)
ds_read_b64_tr_b16 v[94:95], v12 offset:30720
v_mfma_f32_16x16x32_bf16 v[112:115], v[64:67], a[24:27], v[112:115]
ds_read_b64_tr_b16 v[96:97], v13 offset:16384
buffer_load_dwordx4 a[88:91], v2, s[4:7], s43 offen offset:2048 sc1
v_mfma_f32_16x16x32_bf16 v[116:119], v[64:67], a[28:31], v[116:119]
ds_read_b64_tr_b16 v[98:99], v13 offset:18432
v_mfma_f32_16x16x32_bf16 v[120:123], v[68:71], a[24:27], v[120:123]
ds_read_b64_tr_b16 v[100:101], v13 offset:20480
v_mfma_f32_16x16x32_bf16 v[124:127], v[68:71], a[28:31], v[124:127]
ds_read_b64_tr_b16 v[102:103], v13 offset:22528
v_mfma_f32_16x16x32_bf16 v[128:131], v[72:75], a[24:27], v[128:131]
ds_read_b64_tr_b16 v[104:105], v13 offset:24576
buffer_load_dwordx4 a[92:95], v2, s[4:7], s43 offen offset:3072 sc1
v_mfma_f32_16x16x32_bf16 v[132:135], v[72:75], a[28:31], v[132:135]
ds_read_b64_tr_b16 v[106:107], v13 offset:26624
v_mfma_f32_16x16x32_bf16 v[136:139], v[76:79], a[24:27], v[136:139]
ds_read_b64_tr_b16 v[108:109], v13 offset:28672
v_mfma_f32_16x16x32_bf16 v[140:143], v[76:79], a[28:31], v[140:143]
s_waitcnt vmcnt(8) lgkmcnt(7)
ds_read_b64_tr_b16 v[110:111], v13 offset:30720
v_mfma_f32_16x16x32_bf16 v[112:115], v[80:83], a[32:35], v[112:115]
s_add_u32 s43, s51, s68
ds_read_b64_tr_b16 v[64:65], v14 offset:16384
buffer_load_dwordx4 a[96:99], v10, s[4:7], s43 offen sc1
v_mfma_f32_16x16x32_bf16 v[112:115], v[84:87], a[40:43], v[112:115]
ds_read_b64_tr_b16 v[66:67], v14 offset:18432
v_mfma_f32_16x16x32_bf16 v[112:115], v[88:91], a[48:51], v[112:115]
ds_read_b64_tr_b16 v[68:69], v14 offset:20480
v_mfma_f32_16x16x32_bf16 v[112:115], v[92:95], a[56:59], v[112:115]
ds_read_b64_tr_b16 v[70:71], v14 offset:22528
v_mfma_f32_16x16x32_bf16 v[116:119], v[92:95], a[60:63], v[116:119]
ds_read_b64_tr_b16 v[72:73], v14 offset:24576
buffer_load_dwordx4 a[100:103], v10, s[4:7], s43 offen offset:1024 sc1
v_mfma_f32_16x16x32_bf16 v[116:119], v[88:91], a[52:55], v[116:119]
ds_read_b64_tr_b16 v[74:75], v14 offset:26624
v_mfma_f32_16x16x32_bf16 v[116:119], v[84:87], a[44:47], v[116:119]
ds_read_b64_tr_b16 v[76:77], v14 offset:28672
v_mfma_f32_16x16x32_bf16 v[116:119], v[80:83], a[36:39], v[116:119]
s_waitcnt lgkmcnt(7)
ds_read_b64_tr_b16 v[78:79], v14 offset:30720
v_mfma_f32_16x16x32_bf16 v[124:127], v[96:99], a[36:39], v[124:127]
ds_read_b64_tr_b16 v[80:81], v15 offset:16384
buffer_load_dwordx4 a[104:107], v10, s[4:7], s43 offen offset:2048 sc1
v_mfma_f32_16x16x32_bf16 v[124:127], v[100:103], a[44:47], v[124:127]
ds_read_b64_tr_b16 v[82:83], v15 offset:18432
v_mfma_f32_16x16x32_bf16 v[124:127], v[104:107], a[52:55], v[124:127]
ds_read_b64_tr_b16 v[84:85], v15 offset:20480
v_mfma_f32_16x16x32_bf16 v[124:127], v[108:111], a[60:63], v[124:127]
ds_read_b64_tr_b16 v[86:87], v15 offset:22528
v_mfma_f32_16x16x32_bf16 v[120:123], v[108:111], a[56:59], v[120:123]
ds_read_b64_tr_b16 v[88:89], v15 offset:24576
buffer_load_dwordx4 a[108:111], v10, s[4:7], s43 offen offset:3072 sc1
v_mfma_f32_16x16x32_bf16 v[120:123], v[104:107], a[48:51], v[120:123]
ds_read_b64_tr_b16 v[90:91], v15 offset:26624
v_mfma_f32_16x16x32_bf16 v[120:123], v[100:103], a[40:43], v[120:123]
ds_read_b64_tr_b16 v[92:93], v15 offset:28672
v_mfma_f32_16x16x32_bf16 v[120:123], v[96:99], a[32:35], v[120:123]
s_waitcnt lgkmcnt(7)
s_barrier
ds_read_b64_tr_b16 v[94:95], v15 offset:30720
v_mfma_f32_16x16x32_bf16 v[128:131], v[64:67], a[32:35], v[128:131]
ds_read_b64_tr_b16 v[96:97], v12 offset:32768
buffer_load_dwordx4 a[112:115], v2, s[4:7], s43 offen sc1
v_mfma_f32_16x16x32_bf16 v[128:131], v[68:71], a[40:43], v[128:131]
ds_read_b64_tr_b16 v[98:99], v12 offset:34816
v_mfma_f32_16x16x32_bf16 v[128:131], v[72:75], a[48:51], v[128:131]
ds_read_b64_tr_b16 v[100:101], v12 offset:36864
v_mfma_f32_16x16x32_bf16 v[128:131], v[76:79], a[56:59], v[128:131]
ds_read_b64_tr_b16 v[102:103], v12 offset:38912
v_mfma_f32_16x16x32_bf16 v[132:135], v[76:79], a[60:63], v[132:135]
ds_read_b64_tr_b16 v[104:105], v12 offset:40960
buffer_load_dwordx4 a[116:119], v2, s[4:7], s43 offen offset:1024 sc1
v_mfma_f32_16x16x32_bf16 v[132:135], v[72:75], a[52:55], v[132:135]
ds_read_b64_tr_b16 v[106:107], v12 offset:43008
v_mfma_f32_16x16x32_bf16 v[132:135], v[68:71], a[44:47], v[132:135]
ds_read_b64_tr_b16 v[108:109], v12 offset:45056
v_mfma_f32_16x16x32_bf16 v[132:135], v[64:67], a[36:39], v[132:135]
s_waitcnt lgkmcnt(7)
ds_read_b64_tr_b16 v[110:111], v12 offset:47104
v_mfma_f32_16x16x32_bf16 v[140:143], v[80:83], a[36:39], v[140:143]
ds_read_b64_tr_b16 v[64:65], v13 offset:32768
buffer_load_dwordx4 a[120:123], v2, s[4:7], s43 offen offset:2048 sc1
v_mfma_f32_16x16x32_bf16 v[140:143], v[84:87], a[44:47], v[140:143]
ds_read_b64_tr_b16 v[66:67], v13 offset:34816
v_mfma_f32_16x16x32_bf16 v[140:143], v[88:91], a[52:55], v[140:143]
ds_read_b64_tr_b16 v[68:69], v13 offset:36864
v_mfma_f32_16x16x32_bf16 v[140:143], v[92:95], a[60:63], v[140:143]
ds_read_b64_tr_b16 v[70:71], v13 offset:38912
v_mfma_f32_16x16x32_bf16 v[136:139], v[92:95], a[56:59], v[136:139]
ds_read_b64_tr_b16 v[72:73], v13 offset:40960
buffer_load_dwordx4 a[124:127], v2, s[4:7], s43 offen offset:3072 sc1
v_mfma_f32_16x16x32_bf16 v[136:139], v[88:91], a[48:51], v[136:139]
ds_read_b64_tr_b16 v[74:75], v13 offset:43008
v_mfma_f32_16x16x32_bf16 v[136:139], v[84:87], a[40:43], v[136:139]
ds_read_b64_tr_b16 v[76:77], v13 offset:45056
v_mfma_f32_16x16x32_bf16 v[136:139], v[80:83], a[32:35], v[136:139]
s_waitcnt vmcnt(8) lgkmcnt(7)
ds_read_b64_tr_b16 v[78:79], v13 offset:47104
v_mfma_f32_16x16x32_bf16 v[112:115], v[96:99], a[64:67], v[112:115]
s_add_u32 s43, s52, s68
ds_read_b64_tr_b16 v[80:81], v14 offset:32768
buffer_load_dwordx4 a[128:131], v10, s[4:7], s43 offen sc1
v_mfma_f32_16x16x32_bf16 v[112:115], v[100:103], a[72:75], v[112:115]
ds_read_b64_tr_b16 v[82:83], v14 offset:34816
v_mfma_f32_16x16x32_bf16 v[112:115], v[104:107], a[80:83], v[112:115]
ds_read_b64_tr_b16 v[84:85], v14 offset:36864
v_mfma_f32_16x16x32_bf16 v[112:115], v[108:111], a[88:91], v[112:115]
ds_read_b64_tr_b16 v[86:87], v14 offset:38912
v_mfma_f32_16x16x32_bf16 v[116:119], v[108:111], a[92:95], v[116:119]
ds_read_b64_tr_b16 v[88:89], v14 offset:40960
buffer_load_dwordx4 a[132:135], v10, s[4:7], s43 offen offset:1024 sc1
v_mfma_f32_16x16x32_bf16 v[116:119], v[104:107], a[84:87], v[116:119]
ds_read_b64_tr_b16 v[90:91], v14 offset:43008
v_mfma_f32_16x16x32_bf16 v[116:119], v[100:103], a[76:79], v[116:119]
ds_read_b64_tr_b16 v[92:93], v14 offset:45056
v_mfma_f32_16x16x32_bf16 v[116:119], v[96:99], a[68:71], v[116:119]
s_waitcnt lgkmcnt(7)
ds_read_b64_tr_b16 v[94:95], v14 offset:47104
v_mfma_f32_16x16x32_bf16 v[124:127], v[64:67], a[68:71], v[124:127]
ds_read_b64_tr_b16 v[96:97], v15 offset:32768
buffer_load_dwordx4 a[136:139], v10, s[4:7], s43 offen offset:2048 sc1
v_mfma_f32_16x16x32_bf16 v[124:127], v[68:71], a[76:79], v[124:127]
ds_read_b64_tr_b16 v[98:99], v15 offset:34816
v_mfma_f32_16x16x32_bf16 v[124:127], v[72:75], a[84:87], v[124:127]
ds_read_b64_tr_b16 v[100:101], v15 offset:36864
v_mfma_f32_16x16x32_bf16 v[124:127], v[76:79], a[92:95], v[124:127]
ds_read_b64_tr_b16 v[102:103], v15 offset:38912
v_mfma_f32_16x16x32_bf16 v[120:123], v[76:79], a[88:91], v[120:123]
ds_read_b64_tr_b16 v[104:105], v15 offset:40960
buffer_load_dwordx4 a[140:143], v10, s[4:7], s43 offen offset:3072 sc1
v_mfma_f32_16x16x32_bf16 v[120:123], v[72:75], a[80:83], v[120:123]
ds_read_b64_tr_b16 v[106:107], v15 offset:43008
v_mfma_f32_16x16x32_bf16 v[120:123], v[68:71], a[72:75], v[120:123]
ds_read_b64_tr_b16 v[108:109], v15 offset:45056
v_mfma_f32_16x16x32_bf16 v[120:123], v[64:67], a[64:67], v[120:123]
s_waitcnt lgkmcnt(7)
ds_read_b64_tr_b16 v[110:111], v15 offset:47104
v_mfma_f32_16x16x32_bf16 v[128:131], v[80:83], a[64:67], v[128:131]
ds_read_b64_tr_b16 v[64:65], v12 offset:49152
buffer_load_dwordx4 a[144:147], v2, s[4:7], s43 offen sc1
v_mfma_f32_16x16x32_bf16 v[128:131], v[84:87], a[72:75], v[128:131]
ds_read_b64_tr_b16 v[66:67], v12 offset:51200
v_mfma_f32_16x16x32_bf16 v[128:131], v[88:91], a[80:83], v[128:131]
ds_read_b64_tr_b16 v[68:69], v12 offset:53248
v_mfma_f32_16x16x32_bf16 v[128:131], v[92:95], a[88:91], v[128:131]
ds_read_b64_tr_b16 v[70:71], v12 offset:55296
v_mfma_f32_16x16x32_bf16 v[132:135], v[92:95], a[92:95], v[132:135]
ds_read_b64_tr_b16 v[72:73], v12 offset:57344
buffer_load_dwordx4 a[148:151], v2, s[4:7], s43 offen offset:1024 sc1
v_mfma_f32_16x16x32_bf16 v[132:135], v[88:91], a[84:87], v[132:135]
ds_read_b64_tr_b16 v[74:75], v12 offset:59392
v_mfma_f32_16x16x32_bf16 v[132:135], v[84:87], a[76:79], v[132:135]
ds_read_b64_tr_b16 v[76:77], v12 offset:61440
v_mfma_f32_16x16x32_bf16 v[132:135], v[80:83], a[68:71], v[132:135]
s_waitcnt lgkmcnt(7)
ds_read_b64_tr_b16 v[78:79], v12 offset:63488
v_mfma_f32_16x16x32_bf16 v[140:143], v[96:99], a[68:71], v[140:143]
ds_read_b64_tr_b16 v[80:81], v13 offset:49152
buffer_load_dwordx4 a[152:155], v2, s[4:7], s43 offen offset:2048 sc1
v_mfma_f32_16x16x32_bf16 v[140:143], v[100:103], a[76:79], v[140:143]
ds_read_b64_tr_b16 v[82:83], v13 offset:51200
v_mfma_f32_16x16x32_bf16 v[140:143], v[104:107], a[84:87], v[140:143]
ds_read_b64_tr_b16 v[84:85], v13 offset:53248
v_mfma_f32_16x16x32_bf16 v[140:143], v[108:111], a[92:95], v[140:143]
ds_read_b64_tr_b16 v[86:87], v13 offset:55296
v_mfma_f32_16x16x32_bf16 v[136:139], v[108:111], a[88:91], v[136:139]
ds_read_b64_tr_b16 v[88:89], v13 offset:57344
buffer_load_dwordx4 a[156:159], v2, s[4:7], s43 offen offset:3072 sc1
v_mfma_f32_16x16x32_bf16 v[136:139], v[104:107], a[80:83], v[136:139]
ds_read_b64_tr_b16 v[90:91], v13 offset:59392
v_mfma_f32_16x16x32_bf16 v[136:139], v[100:103], a[72:75], v[136:139]
ds_read_b64_tr_b16 v[92:93], v13 offset:61440
v_mfma_f32_16x16x32_bf16 v[136:139], v[96:99], a[64:67], v[136:139]
s_waitcnt vmcnt(8) lgkmcnt(7)
ds_read_b64_tr_b16 v[94:95], v13 offset:63488
v_mfma_f32_16x16x32_bf16 v[112:115], v[64:67], a[96:99], v[112:115]
s_add_u32 s43, s53, s68
ds_read_b64_tr_b16 v[96:97], v14 offset:49152
buffer_load_dwordx4 a[160:163], v10, s[4:7], s43 offen sc1
v_mfma_f32_16x16x32_bf16 v[112:115], v[68:71], a[104:107], v[112:115]
ds_read_b64_tr_b16 v[98:99], v14 offset:51200
v_mfma_f32_16x16x32_bf16 v[112:115], v[72:75], a[112:115], v[112:115]
ds_read_b64_tr_b16 v[100:101], v14 offset:53248
v_mfma_f32_16x16x32_bf16 v[112:115], v[76:79], a[120:123], v[112:115]
ds_read_b64_tr_b16 v[102:103], v14 offset:55296
v_mfma_f32_16x16x32_bf16 v[116:119], v[76:79], a[124:127], v[116:119]
ds_read_b64_tr_b16 v[104:105], v14 offset:57344
buffer_load_dwordx4 a[164:167], v10, s[4:7], s43 offen offset:1024 sc1
v_mfma_f32_16x16x32_bf16 v[116:119], v[72:75], a[116:119], v[116:119]
ds_read_b64_tr_b16 v[106:107], v14 offset:59392
v_mfma_f32_16x16x32_bf16 v[116:119], v[68:71], a[108:111], v[116:119]
ds_read_b64_tr_b16 v[108:109], v14 offset:61440
v_mfma_f32_16x16x32_bf16 v[116:119], v[64:67], a[100:103], v[116:119]
s_waitcnt lgkmcnt(7)
ds_read_b64_tr_b16 v[110:111], v14 offset:63488
v_mfma_f32_16x16x32_bf16 v[124:127], v[80:83], a[100:103], v[124:127]
ds_read_b64_tr_b16 v[64:65], v15 offset:49152
buffer_load_dwordx4 a[168:171], v10, s[4:7], s43 offen offset:2048 sc1
v_mfma_f32_16x16x32_bf16 v[124:127], v[84:87], a[108:111], v[124:127]
ds_read_b64_tr_b16 v[66:67], v15 offset:51200
v_mfma_f32_16x16x32_bf16 v[124:127], v[88:91], a[116:119], v[124:127]
ds_read_b64_tr_b16 v[68:69], v15 offset:53248
v_mfma_f32_16x16x32_bf16 v[124:127], v[92:95], a[124:127], v[124:127]
ds_read_b64_tr_b16 v[70:71], v15 offset:55296
v_mfma_f32_16x16x32_bf16 v[120:123], v[92:95], a[120:123], v[120:123]
ds_read_b64_tr_b16 v[72:73], v15 offset:57344
buffer_load_dwordx4 a[172:175], v10, s[4:7], s43 offen offset:3072 sc1
v_mfma_f32_16x16x32_bf16 v[120:123], v[88:91], a[112:115], v[120:123]
ds_read_b64_tr_b16 v[74:75], v15 offset:59392
v_mfma_f32_16x16x32_bf16 v[120:123], v[84:87], a[104:107], v[120:123]
ds_read_b64_tr_b16 v[76:77], v15 offset:61440
v_mfma_f32_16x16x32_bf16 v[120:123], v[80:83], a[96:99], v[120:123]
s_waitcnt lgkmcnt(7)
ds_read_b64_tr_b16 v[78:79], v15 offset:63488
v_mfma_f32_16x16x32_bf16 v[128:131], v[96:99], a[96:99], v[128:131]
ds_read_b64_tr_b16 v[80:81], v16 offset:0
buffer_load_dwordx4 a[176:179], v2, s[4:7], s43 offen sc1
v_mfma_f32_16x16x32_bf16 v[128:131], v[100:103], a[104:107], v[128:131]
ds_read_b64_tr_b16 v[82:83], v16 offset:2048
v_mfma_f32_16x16x32_bf16 v[128:131], v[104:107], a[112:115], v[128:131]
ds_read_b64_tr_b16 v[84:85], v16 offset:4096
v_mfma_f32_16x16x32_bf16 v[128:131], v[108:111], a[120:123], v[128:131]
ds_read_b64_tr_b16 v[86:87], v16 offset:6144
v_mfma_f32_16x16x32_bf16 v[132:135], v[108:111], a[124:127], v[132:135]
ds_read_b64_tr_b16 v[88:89], v16 offset:8192
buffer_load_dwordx4 a[180:183], v2, s[4:7], s43 offen offset:1024 sc1
v_mfma_f32_16x16x32_bf16 v[132:135], v[104:107], a[116:119], v[132:135]
ds_read_b64_tr_b16 v[90:91], v16 offset:10240
v_mfma_f32_16x16x32_bf16 v[132:135], v[100:103], a[108:111], v[132:135]
ds_read_b64_tr_b16 v[92:93], v16 offset:12288
v_mfma_f32_16x16x32_bf16 v[132:135], v[96:99], a[100:103], v[132:135]
s_waitcnt lgkmcnt(7)
ds_read_b64_tr_b16 v[94:95], v16 offset:14336
v_mfma_f32_16x16x32_bf16 v[140:143], v[64:67], a[100:103], v[140:143]
ds_read_b64_tr_b16 v[96:97], v17 offset:0
buffer_load_dwordx4 a[184:187], v2, s[4:7], s43 offen offset:2048 sc1
v_mfma_f32_16x16x32_bf16 v[140:143], v[68:71], a[108:111], v[140:143]
ds_read_b64_tr_b16 v[98:99], v17 offset:2048
v_mfma_f32_16x16x32_bf16 v[140:143], v[72:75], a[116:119], v[140:143]
ds_read_b64_tr_b16 v[100:101], v17 offset:4096
v_mfma_f32_16x16x32_bf16 v[140:143], v[76:79], a[124:127], v[140:143]
ds_read_b64_tr_b16 v[102:103], v17 offset:6144
v_mfma_f32_16x16x32_bf16 v[136:139], v[76:79], a[120:123], v[136:139]
ds_read_b64_tr_b16 v[104:105], v17 offset:8192
buffer_load_dwordx4 a[188:191], v2, s[4:7], s43 offen offset:3072 sc1
v_mfma_f32_16x16x32_bf16 v[136:139], v[72:75], a[112:115], v[136:139]
ds_read_b64_tr_b16 v[106:107], v17 offset:10240
v_mfma_f32_16x16x32_bf16 v[136:139], v[68:71], a[104:107], v[136:139]
ds_read_b64_tr_b16 v[108:109], v17 offset:12288
v_mfma_f32_16x16x32_bf16 v[136:139], v[64:67], a[96:99], v[136:139]
s_waitcnt vmcnt(8) lgkmcnt(7)
ds_read_b64_tr_b16 v[110:111], v17 offset:14336
v_mfma_f32_16x16x32_bf16 v[112:115], v[80:83], a[128:131], v[112:115]
s_add_u32 s43, s54, s68
ds_read_b64_tr_b16 v[64:65], v18 offset:0
buffer_load_dwordx4 a[192:195], v10, s[4:7], s43 offen sc1
v_mfma_f32_16x16x32_bf16 v[112:115], v[84:87], a[136:139], v[112:115]
ds_read_b64_tr_b16 v[66:67], v18 offset:2048
v_mfma_f32_16x16x32_bf16 v[112:115], v[88:91], a[144:147], v[112:115]
ds_read_b64_tr_b16 v[68:69], v18 offset:4096
v_mfma_f32_16x16x32_bf16 v[112:115], v[92:95], a[152:155], v[112:115]
ds_read_b64_tr_b16 v[70:71], v18 offset:6144
v_mfma_f32_16x16x32_bf16 v[116:119], v[92:95], a[156:159], v[116:119]
ds_read_b64_tr_b16 v[72:73], v18 offset:8192
buffer_load_dwordx4 a[196:199], v10, s[4:7], s43 offen offset:1024 sc1
v_mfma_f32_16x16x32_bf16 v[116:119], v[88:91], a[148:151], v[116:119]
ds_read_b64_tr_b16 v[74:75], v18 offset:10240
v_mfma_f32_16x16x32_bf16 v[116:119], v[84:87], a[140:143], v[116:119]
ds_read_b64_tr_b16 v[76:77], v18 offset:12288
v_mfma_f32_16x16x32_bf16 v[116:119], v[80:83], a[132:135], v[116:119]
s_waitcnt lgkmcnt(7)
ds_read_b64_tr_b16 v[78:79], v18 offset:14336
v_mfma_f32_16x16x32_bf16 v[124:127], v[96:99], a[132:135], v[124:127]
ds_read_b64_tr_b16 v[80:81], v19 offset:0
buffer_load_dwordx4 a[200:203], v10, s[4:7], s43 offen offset:2048 sc1
v_mfma_f32_16x16x32_bf16 v[124:127], v[100:103], a[140:143], v[124:127]
ds_read_b64_tr_b16 v[82:83], v19 offset:2048
v_mfma_f32_16x16x32_bf16 v[124:127], v[104:107], a[148:151], v[124:127]
ds_read_b64_tr_b16 v[84:85], v19 offset:4096
v_mfma_f32_16x16x32_bf16 v[124:127], v[108:111], a[156:159], v[124:127]
ds_read_b64_tr_b16 v[86:87], v19 offset:6144
v_mfma_f32_16x16x32_bf16 v[120:123], v[108:111], a[152:155], v[120:123]
ds_read_b64_tr_b16 v[88:89], v19 offset:8192
buffer_load_dwordx4 a[204:207], v10, s[4:7], s43 offen offset:3072 sc1
v_mfma_f32_16x16x32_bf16 v[120:123], v[104:107], a[144:147], v[120:123]
ds_read_b64_tr_b16 v[90:91], v19 offset:10240
v_mfma_f32_16x16x32_bf16 v[120:123], v[100:103], a[136:139], v[120:123]
ds_read_b64_tr_b16 v[92:93], v19 offset:12288
v_mfma_f32_16x16x32_bf16 v[120:123], v[96:99], a[128:131], v[120:123]
s_waitcnt lgkmcnt(7)
ds_read_b64_tr_b16 v[94:95], v19 offset:14336
v_mfma_f32_16x16x32_bf16 v[128:131], v[64:67], a[128:131], v[128:131]
ds_read_b64_tr_b16 v[96:97], v16 offset:16384
buffer_load_dwordx4 a[208:211], v2, s[4:7], s43 offen sc1
v_mfma_f32_16x16x32_bf16 v[128:131], v[68:71], a[136:139], v[128:131]
ds_read_b64_tr_b16 v[98:99], v16 offset:18432
v_mfma_f32_16x16x32_bf16 v[128:131], v[72:75], a[144:147], v[128:131]
ds_read_b64_tr_b16 v[100:101], v16 offset:20480
v_mfma_f32_16x16x32_bf16 v[128:131], v[76:79], a[152:155], v[128:131]
ds_read_b64_tr_b16 v[102:103], v16 offset:22528
v_mfma_f32_16x16x32_bf16 v[132:135], v[76:79], a[156:159], v[132:135]
ds_read_b64_tr_b16 v[104:105], v16 offset:24576
buffer_load_dwordx4 a[212:215], v2, s[4:7], s43 offen offset:1024 sc1
v_mfma_f32_16x16x32_bf16 v[132:135], v[72:75], a[148:151], v[132:135]
ds_read_b64_tr_b16 v[106:107], v16 offset:26624
v_mfma_f32_16x16x32_bf16 v[132:135], v[68:71], a[140:143], v[132:135]
ds_read_b64_tr_b16 v[108:109], v16 offset:28672
v_mfma_f32_16x16x32_bf16 v[132:135], v[64:67], a[132:135], v[132:135]
s_waitcnt lgkmcnt(7)
ds_read_b64_tr_b16 v[110:111], v16 offset:30720
v_mfma_f32_16x16x32_bf16 v[140:143], v[80:83], a[132:135], v[140:143]
ds_read_b64_tr_b16 v[64:65], v17 offset:16384
buffer_load_dwordx4 a[216:219], v2, s[4:7], s43 offen offset:2048 sc1
v_mfma_f32_16x16x32_bf16 v[140:143], v[84:87], a[140:143], v[140:143]
ds_read_b64_tr_b16 v[66:67], v17 offset:18432
v_mfma_f32_16x16x32_bf16 v[140:143], v[88:91], a[148:151], v[140:143]
ds_read_b64_tr_b16 v[68:69], v17 offset:20480
v_mfma_f32_16x16x32_bf16 v[140:143], v[92:95], a[156:159], v[140:143]
ds_read_b64_tr_b16 v[70:71], v17 offset:22528
v_mfma_f32_16x16x32_bf16 v[136:139], v[92:95], a[152:155], v[136:139]
ds_read_b64_tr_b16 v[72:73], v17 offset:24576
buffer_load_dwordx4 a[220:223], v2, s[4:7], s43 offen offset:3072 sc1
v_mfma_f32_16x16x32_bf16 v[136:139], v[88:91], a[144:147], v[136:139]
ds_read_b64_tr_b16 v[74:75], v17 offset:26624
v_mfma_f32_16x16x32_bf16 v[136:139], v[84:87], a[136:139], v[136:139]
ds_read_b64_tr_b16 v[76:77], v17 offset:28672
v_mfma_f32_16x16x32_bf16 v[136:139], v[80:83], a[128:131], v[136:139]
s_waitcnt vmcnt(8) lgkmcnt(7)
ds_read_b64_tr_b16 v[78:79], v17 offset:30720
v_mfma_f32_16x16x32_bf16 v[112:115], v[96:99], a[160:163], v[112:115]
s_add_u32 s43, s55, s68
ds_read_b64_tr_b16 v[80:81], v18 offset:16384
buffer_load_dwordx4 a[224:227], v10, s[4:7], s43 offen sc1
v_mfma_f32_16x16x32_bf16 v[112:115], v[100:103], a[168:171], v[112:115]
ds_read_b64_tr_b16 v[82:83], v18 offset:18432
v_mfma_f32_16x16x32_bf16 v[112:115], v[104:107], a[176:179], v[112:115]
ds_read_b64_tr_b16 v[84:85], v18 offset:20480
v_mfma_f32_16x16x32_bf16 v[112:115], v[108:111], a[184:187], v[112:115]
ds_read_b64_tr_b16 v[86:87], v18 offset:22528
v_mfma_f32_16x16x32_bf16 v[116:119], v[108:111], a[188:191], v[116:119]
ds_read_b64_tr_b16 v[88:89], v18 offset:24576
buffer_load_dwordx4 a[228:231], v10, s[4:7], s43 offen offset:1024 sc1
v_mfma_f32_16x16x32_bf16 v[116:119], v[104:107], a[180:183], v[116:119]
ds_read_b64_tr_b16 v[90:91], v18 offset:26624
v_mfma_f32_16x16x32_bf16 v[116:119], v[100:103], a[172:175], v[116:119]
ds_read_b64_tr_b16 v[92:93], v18 offset:28672
v_mfma_f32_16x16x32_bf16 v[116:119], v[96:99], a[164:167], v[116:119]
s_waitcnt lgkmcnt(7)
ds_read_b64_tr_b16 v[94:95], v18 offset:30720
v_mfma_f32_16x16x32_bf16 v[124:127], v[64:67], a[164:167], v[124:127]
ds_read_b64_tr_b16 v[96:97], v19 offset:16384
buffer_load_dwordx4 a[232:235], v10, s[4:7], s43 offen offset:2048 sc1
v_mfma_f32_16x16x32_bf16 v[124:127], v[68:71], a[172:175], v[124:127]
ds_read_b64_tr_b16 v[98:99], v19 offset:18432
v_mfma_f32_16x16x32_bf16 v[124:127], v[72:75], a[180:183], v[124:127]
ds_read_b64_tr_b16 v[100:101], v19 offset:20480
v_mfma_f32_16x16x32_bf16 v[124:127], v[76:79], a[188:191], v[124:127]
ds_read_b64_tr_b16 v[102:103], v19 offset:22528
v_mfma_f32_16x16x32_bf16 v[120:123], v[76:79], a[184:187], v[120:123]
ds_read_b64_tr_b16 v[104:105], v19 offset:24576
buffer_load_dwordx4 a[236:239], v10, s[4:7], s43 offen offset:3072 sc1
v_mfma_f32_16x16x32_bf16 v[120:123], v[72:75], a[176:179], v[120:123]
ds_read_b64_tr_b16 v[106:107], v19 offset:26624
v_mfma_f32_16x16x32_bf16 v[120:123], v[68:71], a[168:171], v[120:123]
ds_read_b64_tr_b16 v[108:109], v19 offset:28672
v_mfma_f32_16x16x32_bf16 v[120:123], v[64:67], a[160:163], v[120:123]
s_waitcnt lgkmcnt(7)
s_barrier
ds_read_b64_tr_b16 v[110:111], v19 offset:30720
v_mfma_f32_16x16x32_bf16 v[128:131], v[80:83], a[160:163], v[128:131]
ds_read_b64_tr_b16 v[64:65], v16 offset:32768
buffer_load_dwordx4 a[240:243], v2, s[4:7], s43 offen sc1
v_mfma_f32_16x16x32_bf16 v[128:131], v[84:87], a[168:171], v[128:131]
ds_read_b64_tr_b16 v[66:67], v16 offset:34816
v_mfma_f32_16x16x32_bf16 v[128:131], v[88:91], a[176:179], v[128:131]
ds_read_b64_tr_b16 v[68:69], v16 offset:36864
v_mfma_f32_16x16x32_bf16 v[128:131], v[92:95], a[184:187], v[128:131]
ds_read_b64_tr_b16 v[70:71], v16 offset:38912
v_mfma_f32_16x16x32_bf16 v[132:135], v[92:95], a[188:191], v[132:135]
ds_read_b64_tr_b16 v[72:73], v16 offset:40960
buffer_load_dwordx4 a[244:247], v2, s[4:7], s43 offen offset:1024 sc1
v_mfma_f32_16x16x32_bf16 v[132:135], v[88:91], a[180:183], v[132:135]
ds_read_b64_tr_b16 v[74:75], v16 offset:43008
v_mfma_f32_16x16x32_bf16 v[132:135], v[84:87], a[172:175], v[132:135]
ds_read_b64_tr_b16 v[76:77], v16 offset:45056
v_mfma_f32_16x16x32_bf16 v[132:135], v[80:83], a[164:167], v[132:135]
s_waitcnt lgkmcnt(7)
ds_read_b64_tr_b16 v[78:79], v16 offset:47104
v_mfma_f32_16x16x32_bf16 v[140:143], v[96:99], a[164:167], v[140:143]
ds_read_b64_tr_b16 v[80:81], v17 offset:32768
buffer_load_dwordx4 a[248:251], v2, s[4:7], s43 offen offset:2048 sc1
v_mfma_f32_16x16x32_bf16 v[140:143], v[100:103], a[172:175], v[140:143]
ds_read_b64_tr_b16 v[82:83], v17 offset:34816
v_mfma_f32_16x16x32_bf16 v[140:143], v[104:107], a[180:183], v[140:143]
ds_read_b64_tr_b16 v[84:85], v17 offset:36864
buffer_load_dwordx4 a[252:255], v2, s[4:7], s43 offen offset:3072 sc1
v_mfma_f32_16x16x32_bf16 v[140:143], v[108:111], a[188:191], v[140:143]
ds_read_b64_tr_b16 v[86:87], v17 offset:38912
v_add_u32 v28, 4096, v20
v_add_u32 v29, 52224, v20
v_mfma_f32_16x16x32_bf16 v[136:139], v[108:111], a[184:187], v[136:139]
ds_read_b64_tr_b16 v[88:89], v17 offset:40960
v_add_u32 v30, 100352, v20
v_add_u32 v31, 148480, v20
v_mfma_f32_16x16x32_bf16 v[136:139], v[104:107], a[176:179], v[136:139]
s_add_u32 m0, s41, 0
ds_read_b64_tr_b16 v[90:91], v17 offset:43008
s_mul_i32 s42, s48, 96
v_mfma_f32_16x16x32_bf16 v[136:139], v[100:103], a[168:171], v[136:139]
ds_read_b64_tr_b16 v[92:93], v17 offset:45056
buffer_load_dwordx4 v28, s[8:11], s42 offen sc1 lds
buffer_load_dwordx4 v29, s[8:11], s42 offen offset:1024 sc1 lds
v_mfma_f32_16x16x32_bf16 v[136:139], v[96:99], a[160:163], v[136:139]
s_waitcnt vmcnt(10) lgkmcnt(7)
ds_read_b64_tr_b16 v[94:95], v17 offset:47104
v_mfma_f32_16x16x32_bf16 v[112:115], v[64:67], a[192:195], v[112:115]
ds_read_b64_tr_b16 v[96:97], v18 offset:32768
buffer_load_dwordx4 v30, s[8:11], s42 offen offset:2048 sc1 lds
v_mfma_f32_16x16x32_bf16 v[112:115], v[68:71], a[200:203], v[112:115]
ds_read_b64_tr_b16 v[98:99], v18 offset:34816
v_mfma_f32_16x16x32_bf16 v[112:115], v[72:75], a[208:211], v[112:115]
ds_read_b64_tr_b16 v[100:101], v18 offset:36864
v_mfma_f32_16x16x32_bf16 v[112:115], v[76:79], a[216:219], v[112:115]
ds_read_b64_tr_b16 v[102:103], v18 offset:38912
v_mfma_f32_16x16x32_bf16 v[116:119], v[76:79], a[220:223], v[116:119]
ds_read_b64_tr_b16 v[104:105], v18 offset:40960
v_mfma_f32_16x16x32_bf16 v[116:119], v[72:75], a[212:215], v[116:119]
s_branch Lso4
Lst4:
s_branch Lst9
Lso4:
ds_read_b64_tr_b16 v[106:107], v18 offset:43008
v_mfma_f32_16x16x32_bf16 v[116:119], v[68:71], a[204:207], v[116:119]
ds_read_b64_tr_b16 v[108:109], v18 offset:45056
v_mfma_f32_16x16x32_bf16 v[116:119], v[64:67], a[196:199], v[116:119]
s_waitcnt lgkmcnt(7)
ds_read_b64_tr_b16 v[110:111], v18 offset:47104
v_mfma_f32_16x16x32_bf16 v[124:127], v[80:83], a[196:199], v[124:127]
ds_read_b64_tr_b16 v[64:65], v19 offset:32768
buffer_load_dwordx4 v31, s[8:11], s42 offen offset:3072 sc1 lds
v_mfma_f32_16x16x32_bf16 v[124:127], v[84:87], a[204:207], v[124:127]
ds_read_b64_tr_b16 v[66:67], v19 offset:34816
v_mfma_f32_16x16x32_bf16 v[124:127], v[88:91], a[212:215], v[124:127]
ds_read_b64_tr_b16 v[68:69], v19 offset:36864
v_mfma_f32_16x16x32_bf16 v[124:127], v[92:95], a[220:223], v[124:127]
ds_read_b64_tr_b16 v[70:71], v19 offset:38912
v_mfma_f32_16x16x32_bf16 v[120:123], v[92:95], a[216:219], v[120:123]
ds_read_b64_tr_b16 v[72:73], v19 offset:40960
v_mfma_f32_16x16x32_bf16 v[120:123], v[88:91], a[208:211], v[120:123]
ds_read_b64_tr_b16 v[74:75], v19 offset:43008
v_mfma_f32_16x16x32_bf16 v[120:123], v[84:87], a[200:203], v[120:123]
ds_read_b64_tr_b16 v[76:77], v19 offset:45056
v_mfma_f32_16x16x32_bf16 v[120:123], v[80:83], a[192:195], v[120:123]
s_waitcnt lgkmcnt(7)
ds_read_b64_tr_b16 v[78:79], v19 offset:47104
v_mfma_f32_16x16x32_bf16 v[128:131], v[96:99], a[192:195], v[128:131]
ds_read_b64_tr_b16 v[80:81], v16 offset:49152
buffer_load_dwordx4 v[208:211], v1, s[4:7], s73 offen sc1
v_mfma_f32_16x16x32_bf16 v[128:131], v[100:103], a[200:203], v[128:131]
ds_read_b64_tr_b16 v[82:83], v16 offset:51200
v_mfma_f32_16x16x32_bf16 v[128:131], v[104:107], a[208:211], v[128:131]
ds_read_b64_tr_b16 v[84:85], v16 offset:53248
v_mfma_f32_16x16x32_bf16 v[128:131], v[108:111], a[216:219], v[128:131]
ds_read_b64_tr_b16 v[86:87], v16 offset:55296
v_mfma_f32_16x16x32_bf16 v[132:135], v[108:111], a[220:223], v[132:135]
ds_read_b64_tr_b16 v[88:89], v16 offset:57344
buffer_load_dwordx4 v[212:215], v1, s[4:7], s73 offen offset:1024 sc1
v_mfma_f32_16x16x32_bf16 v[132:135], v[104:107], a[212:215], v[132:135]
ds_read_b64_tr_b16 v[90:91], v16 offset:59392
v_mfma_f32_16x16x32_bf16 v[132:135], v[100:103], a[204:207], v[132:135]
ds_read_b64_tr_b16 v[92:93], v16 offset:61440
v_mfma_f32_16x16x32_bf16 v[132:135], v[96:99], a[196:199], v[132:135]
s_waitcnt lgkmcnt(7)
ds_read_b64_tr_b16 v[94:95], v16 offset:63488
v_mfma_f32_16x16x32_bf16 v[140:143], v[64:67], a[196:199], v[140:143]
ds_read_b64_tr_b16 v[96:97], v17 offset:49152
buffer_load_dwordx4 v[216:219], v1, s[4:7], s73 offen offset:2048 sc1
v_mfma_f32_16x16x32_bf16 v[140:143], v[68:71], a[204:207], v[140:143]
ds_read_b64_tr_b16 v[98:99], v17 offset:51200
v_mfma_f32_16x16x32_bf16 v[140:143], v[72:75], a[212:215], v[140:143]
ds_read_b64_tr_b16 v[100:101], v17 offset:53248
v_mfma_f32_16x16x32_bf16 v[140:143], v[76:79], a[220:223], v[140:143]
ds_read_b64_tr_b16 v[102:103], v17 offset:55296
v_mfma_f32_16x16x32_bf16 v[136:139], v[76:79], a[216:219], v[136:139]
ds_read_b64_tr_b16 v[104:105], v17 offset:57344
buffer_load_dwordx4 v[220:223], v1, s[4:7], s73 offen offset:3072 sc1
v_mfma_f32_16x16x32_bf16 v[136:139], v[72:75], a[208:211], v[136:139]
ds_read_b64_tr_b16 v[106:107], v17 offset:59392
v_mfma_f32_16x16x32_bf16 v[136:139], v[68:71], a[200:203], v[136:139]
ds_read_b64_tr_b16 v[108:109], v17 offset:61440
v_mfma_f32_16x16x32_bf16 v[136:139], v[64:67], a[192:195], v[136:139]
s_waitcnt vmcnt(8) lgkmcnt(7)
ds_read_b64_tr_b16 v[110:111], v17 offset:63488
v_mfma_f32_16x16x32_bf16 v[112:115], v[80:83], a[224:227], v[112:115]
s_add_u32 m0, s41, 16384
ds_read_b64_tr_b16 v[64:65], v18 offset:49152
s_mul_i32 s42, s49, 96
v_mfma_f32_16x16x32_bf16 v[112:115], v[84:87], a[232:235], v[112:115]
ds_read_b64_tr_b16 v[66:67], v18 offset:51200
buffer_load_dwordx4 v28, s[8:11], s42 offen sc1 lds
v_mfma_f32_16x16x32_bf16 v[112:115], v[88:91], a[240:243], v[112:115]
ds_read_b64_tr_b16 v[68:69], v18 offset:53248
v_mfma_f32_16x16x32_bf16 v[112:115], v[92:95], a[248:251], v[112:115]
ds_read_b64_tr_b16 v[70:71], v18 offset:55296
v_mfma_f32_16x16x32_bf16 v[116:119], v[92:95], a[252:255], v[116:119]
ds_read_b64_tr_b16 v[72:73], v18 offset:57344
buffer_load_dwordx4 v29, s[8:11], s42 offen offset:1024 sc1 lds
v_mfma_f32_16x16x32_bf16 v[116:119], v[88:91], a[244:247], v[116:119]
ds_read_b64_tr_b16 v[74:75], v18 offset:59392
v_mfma_f32_16x16x32_bf16 v[116:119], v[84:87], a[236:239], v[116:119]
ds_read_b64_tr_b16 v[76:77], v18 offset:61440
v_mfma_f32_16x16x32_bf16 v[116:119], v[80:83], a[228:231], v[116:119]
s_waitcnt lgkmcnt(7)
ds_read_b64_tr_b16 v[78:79], v18 offset:63488
v_mfma_f32_16x16x32_bf16 v[124:127], v[96:99], a[228:231], v[124:127]
ds_read_b64_tr_b16 v[80:81], v19 offset:49152
buffer_load_dwordx4 v30, s[8:11], s42 offen offset:2048 sc1 lds
v_mfma_f32_16x16x32_bf16 v[124:127], v[100:103], a[236:239], v[124:127]
ds_read_b64_tr_b16 v[82:83], v19 offset:51200
v_mfma_f32_16x16x32_bf16 v[124:127], v[104:107], a[244:247], v[124:127]
ds_read_b64_tr_b16 v[84:85], v19 offset:53248
v_mfma_f32_16x16x32_bf16 v[124:127], v[108:111], a[252:255], v[124:127]
ds_read_b64_tr_b16 v[86:87], v19 offset:55296
v_mfma_f32_16x16x32_bf16 v[120:123], v[108:111], a[248:251], v[120:123]
ds_read_b64_tr_b16 v[88:89], v19 offset:57344
buffer_load_dwordx4 v31, s[8:11], s42 offen offset:3072 sc1 lds
v_mfma_f32_16x16x32_bf16 v[120:123], v[104:107], a[240:243], v[120:123]
ds_read_b64_tr_b16 v[90:91], v19 offset:59392
v_mfma_f32_16x16x32_bf16 v[120:123], v[100:103], a[232:235], v[120:123]
ds_read_b64_tr_b16 v[92:93], v19 offset:61440
v_mfma_f32_16x16x32_bf16 v[120:123], v[96:99], a[224:227], v[120:123]
s_waitcnt vmcnt(8) lgkmcnt(7)
s_barrier
ds_read_b64_tr_b16 v[94:95], v19 offset:63488
v_mfma_f32_16x16x32_bf16 v[128:131], v[64:67], a[224:227], v[128:131]
s_add_u32 m0, s41, 32768
ds_read_b64_tr_b16 v[96:97], v12 offset:0
s_mul_i32 s42, s50, 96
v_mfma_f32_16x16x32_bf16 v[128:131], v[68:71], a[232:235], v[128:131]
ds_read_b64_tr_b16 v[98:99], v12 offset:2048
buffer_load_dwordx4 v28, s[8:11], s42 offen sc1 lds
v_mfma_f32_16x16x32_bf16 v[128:131], v[72:75], a[240:243], v[128:131]
ds_read_b64_tr_b16 v[100:101], v12 offset:4096
v_mfma_f32_16x16x32_bf16 v[128:131], v[76:79], a[248:251], v[128:131]
ds_read_b64_tr_b16 v[102:103], v12 offset:6144
v_mfma_f32_16x16x32_bf16 v[132:135], v[76:79], a[252:255], v[132:135]
ds_read_b64_tr_b16 v[104:105], v12 offset:8192
buffer_load_dwordx4 v29, s[8:11], s42 offen offset:1024 sc1 lds
v_mfma_f32_16x16x32_bf16 v[132:135], v[72:75], a[244:247], v[132:135]
ds_read_b64_tr_b16 v[106:107], v12 offset:10240
v_mfma_f32_16x16x32_bf16 v[132:135], v[68:71], a[236:239], v[132:135]
ds_read_b64_tr_b16 v[108:109], v12 offset:12288
v_mfma_f32_16x16x32_bf16 v[132:135], v[64:67], a[228:231], v[132:135]
s_waitcnt lgkmcnt(7)
ds_read_b64_tr_b16 v[110:111], v12 offset:14336
v_mfma_f32_16x16x32_bf16 v[140:143], v[80:83], a[228:231], v[140:143]
ds_read_b64_tr_b16 v[64:65], v13 offset:0
buffer_load_dwordx4 v30, s[8:11], s42 offen offset:2048 sc1 lds
v_mfma_f32_16x16x32_bf16 v[140:143], v[84:87], a[236:239], v[140:143]
ds_read_b64_tr_b16 v[66:67], v13 offset:2048
v_mfma_f32_16x16x32_bf16 v[140:143], v[88:91], a[244:247], v[140:143]
ds_read_b64_tr_b16 v[68:69], v13 offset:4096
v_mfma_f32_16x16x32_bf16 v[140:143], v[92:95], a[252:255], v[140:143]
ds_read_b64_tr_b16 v[70:71], v13 offset:6144
v_mfma_f32_16x16x32_bf16 v[136:139], v[92:95], a[248:251], v[136:139]
ds_read_b64_tr_b16 v[72:73], v13 offset:8192
buffer_load_dwordx4 v31, s[8:11], s42 offen offset:3072 sc1 lds
v_mfma_f32_16x16x32_bf16 v[136:139], v[88:91], a[240:243], v[136:139]
ds_read_b64_tr_b16 v[74:75], v13 offset:10240
v_mfma_f32_16x16x32_bf16 v[136:139], v[84:87], a[232:235], v[136:139]
ds_read_b64_tr_b16 v[76:77], v13 offset:12288
v_mfma_f32_16x16x32_bf16 v[136:139], v[80:83], a[224:227], v[136:139]
s_waitcnt lgkmcnt(7)
ds_read_b64_tr_b16 v[78:79], v13 offset:14336
s_branch Lso5
Lst5:
s_setpc_b64 s[42:43]
Lso5:
Ljoin:
v_mfma_f32_16x16x32_bf16 v[144:147], a[0:3], v[96:99], 0
s_add_u32 m0, s41, 49152
ds_read_b64_tr_b16 v[80:81], v14 offset:0
s_mul_i32 s42, s51, 96
v_mfma_f32_16x16x32_bf16 v[144:147], a[8:11], v[100:103], v[144:147]
ds_read_b64_tr_b16 v[82:83], v14 offset:2048
buffer_load_dwordx4 v28, s[8:11], s42 offen sc1 lds
v_mfma_f32_16x16x32_bf16 v[144:147], a[16:19], v[104:107], v[144:147]
s_waitcnt vmcnt(9)
ds_read_b64_tr_b16 v[84:85], v14 offset:4096
v_add_f32 v208, v208, v212
v_mfma_f32_16x16x32_bf16 v[144:147], a[24:27], v[108:111], v[144:147]
ds_read_b64_tr_b16 v[86:87], v14 offset:6144
v_add_f32 v209, v209, v213
v_mfma_f32_16x16x32_bf16 v[148:151], a[28:31], v[108:111], 0
ds_read_b64_tr_b16 v[88:89], v14 offset:8192
buffer_load_dwordx4 v29, s[8:11], s42 offen offset:1024 sc1 lds
v_mfma_f32_16x16x32_bf16 v[148:151], a[20:23], v[104:107], v[148:151]
ds_read_b64_tr_b16 v[90:91], v14 offset:10240
v_add_f32 v210, v210, v214
v_mfma_f32_16x16x32_bf16 v[148:151], a[12:15], v[100:103], v[148:151]
ds_read_b64_tr_b16 v[92:93], v14 offset:12288
v_add_f32 v211, v211, v215
v_mfma_f32_16x16x32_bf16 v[148:151], a[4:7], v[96:99], v[148:151]
s_waitcnt lgkmcnt(7)
ds_read_b64_tr_b16 v[94:95], v14 offset:14336
v_add_f32 v216, v216, v220
v_mfma_f32_16x16x32_bf16 v[156:159], a[4:7], v[64:67], 0
ds_read_b64_tr_b16 v[96:97], v15 offset:0
buffer_load_dwordx4 v30, s[8:11], s42 offen offset:2048 sc1 lds
v_mfma_f32_16x16x32_bf16 v[156:159], a[12:15], v[68:71], v[156:159]
ds_read_b64_tr_b16 v[98:99], v15 offset:2048
v_add_f32 v217, v217, v221
v_mfma_f32_16x16x32_bf16 v[156:159], a[20:23], v[72:75], v[156:159]
ds_read_b64_tr_b16 v[100:101], v15 offset:4096
v_add_f32 v218, v218, v222
v_mfma_f32_16x16x32_bf16 v[156:159], a[28:31], v[76:79], v[156:159]
ds_read_b64_tr_b16 v[102:103], v15 offset:6144
v_add_f32 v219, v219, v223
v_mfma_f32_16x16x32_bf16 v[152:155], a[24:27], v[76:79], 0
ds_read_b64_tr_b16 v[104:105], v15 offset:8192
buffer_load_dwordx4 v31, s[8:11], s42 offen offset:3072 sc1 lds
v_mfma_f32_16x16x32_bf16 v[152:155], a[16:19], v[72:75], v[152:155]
ds_read_b64_tr_b16 v[106:107], v15 offset:10240
v_add_f32 v208, v208, v216
v_mfma_f32_16x16x32_bf16 v[152:155], a[8:11], v[68:71], v[152:155]
ds_read_b64_tr_b16 v[108:109], v15 offset:12288
v_add_f32 v209, v209, v217
v_mfma_f32_16x16x32_bf16 v[152:155], a[0:3], v[64:67], v[152:155]
s_waitcnt vmcnt(8) lgkmcnt(7)
s_barrier
ds_read_b64_tr_b16 v[110:111], v15 offset:14336
v_add_f32 v210, v210, v218
v_mfma_f32_16x16x32_bf16 v[160:163], a[0:3], v[80:83], 0
s_add_u32 m0, s41, 65536
ds_read_b64_tr_b16 v[64:65], v12 offset:16384
s_mul_i32 s42, s52, 96
v_mfma_f32_16x16x32_bf16 v[160:163], a[8:11], v[84:87], v[160:163]
ds_read_b64_tr_b16 v[66:67], v12 offset:18432
buffer_load_dwordx4 v28, s[8:11], s42 offen sc1 lds
v_mfma_f32_16x16x32_bf16 v[160:163], a[16:19], v[88:91], v[160:163]
ds_read_b64_tr_b16 v[68:69], v12 offset:20480
v_add_f32 v211, v211, v219
v_mfma_f32_16x16x32_bf16 v[160:163], a[24:27], v[92:95], v[160:163]
ds_read_b64_tr_b16 v[70:71], v12 offset:22528
v_mfma_f32_16x16x32_bf16 v[164:167], a[28:31], v[92:95], 0
ds_read_b64_tr_b16 v[72:73], v12 offset:24576
buffer_load_dwordx4 v29, s[8:11], s42 offen offset:1024 sc1 lds
v_mfma_f32_16x16x32_bf16 v[164:167], a[20:23], v[88:91], v[164:167]
ds_read_b64_tr_b16 v[74:75], v12 offset:26624
ds_read_b128 v[48:51], v5 offset:0
v_mfma_f32_16x16x32_bf16 v[164:167], a[12:15], v[84:87], v[164:167]
ds_read_b64_tr_b16 v[76:77], v12 offset:28672
ds_read_b128 v[52:55], v5 offset:64
ds_read_b128 v[56:59], v5 offset:128
ds_read_b128 v[60:63], v5 offset:192
v_mfma_f32_16x16x32_bf16 v[164:167], a[4:7], v[80:83], v[164:167]
s_waitcnt lgkmcnt(11)
ds_read_b64_tr_b16 v[78:79], v12 offset:30720
v_mfma_f32_16x16x32_bf16 v[172:175], a[4:7], v[96:99], 0
ds_read_b64_tr_b16 v[80:81], v13 offset:16384
buffer_load_dwordx4 v30, s[8:11], s42 offen offset:2048 sc1 lds
v_mfma_f32_16x16x32_bf16 v[172:175], a[12:15], v[100:103], v[172:175]
ds_read_b64_tr_b16 v[82:83], v13 offset:18432
v_mov_b32 v212, v208
v_mfma_f32_16x16x32_bf16 v[172:175], a[20:23], v[104:107], v[172:175]
ds_read_b64_tr_b16 v[84:85], v13 offset:20480
v_mov_b32 v213, v209
v_mfma_f32_16x16x32_bf16 v[172:175], a[28:31], v[108:111], v[172:175]
ds_read_b64_tr_b16 v[86:87], v13 offset:22528
v_mov_b32 v214, v210
v_mfma_f32_16x16x32_bf16 v[168:171], a[24:27], v[108:111], 0
ds_read_b64_tr_b16 v[88:89], v13 offset:24576
buffer_load_dwordx4 v31, s[8:11], s42 offen offset:3072 sc1 lds
v_mfma_f32_16x16x32_bf16 v[168:171], a[16:19], v[104:107], v[168:171]
ds_read_b64_tr_b16 v[90:91], v13 offset:26624
v_mov_b32 v215, v211
v_mfma_f32_16x16x32_bf16 v[168:171], a[8:11], v[100:103], v[168:171]
ds_read_b64_tr_b16 v[92:93], v13 offset:28672
v_permlane32_swap_b32 v208, v212
v_mfma_f32_16x16x32_bf16 v[168:171], a[0:3], v[96:99], v[168:171]
s_waitcnt lgkmcnt(7)
ds_read_b64_tr_b16 v[94:95], v13 offset:30720
v_permlane32_swap_b32 v209, v213
v_mfma_f32_16x16x32_bf16 v[144:147], a[32:35], v[64:67], v[144:147]
s_add_u32 m0, s41, 81920
ds_read_b64_tr_b16 v[96:97], v14 offset:16384
s_mul_i32 s42, s53, 96
v_mfma_f32_16x16x32_bf16 v[144:147], a[40:43], v[68:71], v[144:147]
ds_read_b64_tr_b16 v[98:99], v14 offset:18432
buffer_load_dwordx4 v28, s[8:11], s42 offen sc1 lds
v_mfma_f32_16x16x32_bf16 v[144:147], a[48:51], v[72:75], v[144:147]
ds_read_b64_tr_b16 v[100:101], v14 offset:20480
v_permlane32_swap_b32 v210, v214
v_mfma_f32_16x16x32_bf16 v[144:147], a[56:59], v[76:79], v[144:147]
ds_read_b64_tr_b16 v[102:103], v14 offset:22528
v_permlane32_swap_b32 v211, v215
v_mfma_f32_16x16x32_bf16 v[148:151], a[60:63], v[76:79], v[148:151]
ds_read_b64_tr_b16 v[104:105], v14 offset:24576
v_add_f32 v208, v208, v212
v_mfma_f32_16x16x32_bf16 v[148:151], a[52:55], v[72:75], v[148:151]
ds_read_b64_tr_b16 v[106:107], v14 offset:26624
buffer_load_dwordx4 v29, s[8:11], s42 offen offset:1024 sc1 lds
v_mfma_f32_16x16x32_bf16 v[148:151], a[44:47], v[68:71], v[148:151]
ds_read_b64_tr_b16 v[108:109], v14 offset:28672
v_add_f32 v209, v209, v213
v_mfma_f32_16x16x32_bf16 v[148:151], a[36:39], v[64:67], v[148:151]
s_waitcnt lgkmcnt(7)
ds_read_b64_tr_b16 v[110:111], v14 offset:30720
v_add_f32 v210, v210, v214
v_mfma_f32_16x16x32_bf16 v[156:159], a[36:39], v[80:83], v[156:159]
ds_read_b64_tr_b16 v[64:65], v15 offset:16384
buffer_load_dwordx4 v30, s[8:11], s42 offen offset:2048 sc1 lds
v_mfma_f32_16x16x32_bf16 v[156:159], a[44:47], v[84:87], v[156:159]
ds_read_b64_tr_b16 v[66:67], v15 offset:18432
v_add_f32 v211, v211, v215
v_mfma_f32_16x16x32_bf16 v[156:159], a[52:55], v[88:91], v[156:159]
ds_read_b64_tr_b16 v[68:69], v15 offset:20480
v_mov_b32 v212, v208
v_mfma_f32_16x16x32_bf16 v[156:159], a[60:63], v[92:95], v[156:159]
ds_read_b64_tr_b16 v[70:71], v15 offset:22528
v_mov_b32 v213, v209
v_mfma_f32_16x16x32_bf16 v[152:155], a[56:59], v[92:95], v[152:155]
ds_read_b64_tr_b16 v[72:73], v15 offset:24576
buffer_load_dwordx4 v31, s[8:11], s42 offen offset:3072 sc1 lds
v_mfma_f32_16x16x32_bf16 v[152:155], a[48:51], v[88:91], v[152:155]
ds_read_b64_tr_b16 v[74:75], v15 offset:26624
v_mov_b32 v214, v210
v_mfma_f32_16x16x32_bf16 v[152:155], a[40:43], v[84:87], v[152:155]
ds_read_b64_tr_b16 v[76:77], v15 offset:28672
v_mov_b32 v215, v211
v_mfma_f32_16x16x32_bf16 v[152:155], a[32:35], v[80:83], v[152:155]
s_waitcnt vmcnt(8) lgkmcnt(7)
s_barrier
ds_read_b64_tr_b16 v[78:79], v15 offset:30720
v_permlane16_swap_b32 v208, v212
v_mfma_f32_16x16x32_bf16 v[160:163], a[32:35], v[96:99], v[160:163]
s_lshr_b32 s45, s63, 1
ds_read_b64_tr_b16 v[80:81], v12 offset:32768
s_cmp_lt_u32 s24, 8
v_mfma_f32_16x16x32_bf16 v[160:163], a[40:43], v[100:103], v[160:163]
s_cselect_b32 s45, s45, 1073741824
ds_read_b64_tr_b16 v[82:83], v12 offset:34816
v_min_u32 v0, 3968, v34
v_mfma_f32_16x16x32_bf16 v[160:163], a[48:51], v[104:107], v[160:163]
ds_read_b64_tr_b16 v[84:85], v12 offset:36864
buffer_load_dword v3, v0, s[12:15], s45 offen
v_mfma_f32_16x16x32_bf16 v[160:163], a[56:59], v[108:111], v[160:163]
ds_read_b64_tr_b16 v[86:87], v12 offset:38912
v_permlane16_swap_b32 v209, v213
v_mfma_f32_16x16x32_bf16 v[164:167], a[60:63], v[108:111], v[164:167]
ds_read_b64_tr_b16 v[88:89], v12 offset:40960
s_cmp_lg_u32 s40, 0
s_cbranch_scc1 Lc02020
s_mov_b32 s3, m0
s_lshl_b32 s45, s39, 4
v_lshrrev_b32 v0, 7, v1
v_add_u32 v0, s45, v0
v_mul_u32_u24 v0, 7168, v0
v_and_b32 v33, 112, v1
v_add_u32 v0, v0, v33
s_lshl_b32 s46, s38, 7
s_add_u32 m0, s87, 0
s_add_u32 s45, s46, 0
buffer_load_dwordx4 v0, s[16:19], s45 offen lds
s_add_u32 m0, s87, 1024
s_add_u32 s45, s46, 57344
buffer_load_dwordx4 v0, s[16:19], s45 offen lds
s_mov_b32 m0, s3
Lc02020:
v_mfma_f32_16x16x32_bf16 v[164:167], a[52:55], v[104:107], v[164:167]
ds_read_b64_tr_b16 v[90:91], v12 offset:43008
v_permlane16_swap_b32 v210, v214
v_mfma_f32_16x16x32_bf16 v[164:167], a[44:47], v[100:103], v[164:167]
s_add_u32 m0, s41, 98304
ds_read_b64_tr_b16 v[92:93], v12 offset:45056
s_mul_i32 s42, s54, 96
buffer_load_dwordx4 v28, s[8:11], s42 offen sc1 lds
v_mfma_f32_16x16x32_bf16 v[164:167], a[36:39], v[96:99], v[164:167]
s_waitcnt lgkmcnt(7)
ds_read_b64_tr_b16 v[94:95], v12 offset:47104
v_mfma_f32_16x16x32_bf16 v[172:175], a[36:39], v[64:67], v[172:175]
ds_read_b64_tr_b16 v[96:97], v13 offset:32768
buffer_load_dwordx4 v29, s[8:11], s42 offen offset:1024 sc1 lds
v_mfma_f32_16x16x32_bf16 v[172:175], a[44:47], v[68:71], v[172:175]
ds_read_b64_tr_b16 v[98:99], v13 offset:34816
v_permlane16_swap_b32 v211, v215
v_mfma_f32_16x16x32_bf16 v[172:175], a[52:55], v[72:75], v[172:175]
ds_read_b64_tr_b16 v[100:101], v13 offset:36864
v_add_f32 v208, v208, v212
v_mfma_f32_16x16x32_bf16 v[172:175], a[60:63], v[76:79], v[172:175]
ds_read_b64_tr_b16 v[102:103], v13 offset:38912
v_add_f32 v209, v209, v213
v_mfma_f32_16x16x32_bf16 v[168:171], a[56:59], v[76:79], v[168:171]
ds_read_b64_tr_b16 v[104:105], v13 offset:40960
v_add_f32 v210, v210, v214
v_mfma_f32_16x16x32_bf16 v[168:171], a[48:51], v[72:75], v[168:171]
ds_read_b64_tr_b16 v[106:107], v13 offset:43008
v_add_f32 v211, v211, v215
v_mfma_f32_16x16x32_bf16 v[168:171], a[40:43], v[68:71], v[168:171]
ds_read_b64_tr_b16 v[108:109], v13 offset:45056
v_mul_f32 v42, 0xba800000, v208
v_mul_f32 v43, 0xba800000, v210
v_mfma_f32_16x16x32_bf16 v[168:171], a[32:35], v[64:67], v[168:171]
s_waitcnt lgkmcnt(7)
ds_read_b64_tr_b16 v[110:111], v13 offset:47104
v_mul_f32 v209, 0x3a800000, v209
v_mfma_f32_16x16x32_bf16 v[144:147], a[64:67], v[80:83], v[144:147]
ds_read_b64_tr_b16 v[64:65], v14 offset:32768
buffer_load_dwordx4 v30, s[8:11], s42 offen offset:2048 sc1 lds
v_mfma_f32_16x16x32_bf16 v[144:147], a[72:75], v[84:87], v[144:147]
ds_read_b64_tr_b16 v[66:67], v14 offset:34816
v_mul_f32 v211, 0x3a800000, v211
v_mfma_f32_16x16x32_bf16 v[144:147], a[80:83], v[88:91], v[144:147]
ds_read_b64_tr_b16 v[68:69], v14 offset:36864
v_fma_f32 v209, -v42, v42, v209
v_mfma_f32_16x16x32_bf16 v[144:147], a[88:91], v[92:95], v[144:147]
ds_read_b64_tr_b16 v[70:71], v14 offset:38912
v_fma_f32 v211, -v43, v43, v211
v_mfma_f32_16x16x32_bf16 v[148:151], a[92:95], v[92:95], v[148:151]
ds_read_b64_tr_b16 v[72:73], v14 offset:40960
v_max_f32 v209, 0, v209
v_mfma_f32_16x16x32_bf16 v[148:151], a[84:87], v[88:91], v[148:151]
ds_read_b64_tr_b16 v[74:75], v14 offset:43008
v_max_f32 v211, 0, v211
v_mfma_f32_16x16x32_bf16 v[148:151], a[76:79], v[84:87], v[148:151]
ds_read_b64_tr_b16 v[76:77], v14 offset:45056
v_add_f32 v209, 0x3727c5ac, v209
v_mfma_f32_16x16x32_bf16 v[148:151], a[68:71], v[80:83], v[148:151]
s_waitcnt lgkmcnt(7)
ds_read_b64_tr_b16 v[78:79], v14 offset:47104
v_add_f32 v211, 0x3727c5ac, v211
v_mfma_f32_16x16x32_bf16 v[156:159], a[68:71], v[96:99], v[156:159]
ds_read_b64_tr_b16 v[80:81], v15 offset:32768
buffer_load_dwordx4 v31, s[8:11], s42 offen offset:3072 sc1 lds
v_mfma_f32_16x16x32_bf16 v[156:159], a[76:79], v[100:103], v[156:159]
ds_read_b64_tr_b16 v[82:83], v15 offset:34816
v_rsq_f32 v40, v209
v_mfma_f32_16x16x32_bf16 v[156:159], a[84:87], v[104:107], v[156:159]
ds_read_b64_tr_b16 v[84:85], v15 offset:36864
v_rsq_f32 v41, v211
v_mfma_f32_16x16x32_bf16 v[156:159], a[92:95], v[108:111], v[156:159]
ds_read_b64_tr_b16 v[86:87], v15 offset:38912
ds_write_b32 v7, v42 offset:128
v_mfma_f32_16x16x32_bf16 v[152:155], a[88:91], v[108:111], v[152:155]
ds_read_b64_tr_b16 v[88:89], v15 offset:40960
ds_write_b32 v7, v43 offset:192
v_mfma_f32_16x16x32_bf16 v[152:155], a[80:83], v[104:107], v[152:155]
ds_read_b64_tr_b16 v[90:91], v15 offset:43008
ds_write_b32 v7, v40 offset:0
v_mfma_f32_16x16x32_bf16 v[152:155], a[72:75], v[100:103], v[152:155]
ds_read_b64_tr_b16 v[92:93], v15 offset:45056
ds_write_b32 v7, v41 offset:64
v_mfma_f32_16x16x32_bf16 v[152:155], a[64:67], v[96:99], v[152:155]
s_waitcnt lgkmcnt(11)
ds_read_b64_tr_b16 v[94:95], v15 offset:47104
v_mfma_f32_16x16x32_bf16 v[160:163], a[64:67], v[64:67], v[160:163]
s_add_u32 m0, s41, 114688
ds_read_b64_tr_b16 v[96:97], v12 offset:49152
s_mul_i32 s42, s55, 96
v_mfma_f32_16x16x32_bf16 v[160:163], a[72:75], v[68:71], v[160:163]
ds_read_b64_tr_b16 v[98:99], v12 offset:51200
buffer_load_dwordx4 v28, s[8:11], s42 offen sc1 lds
v_mfma_f32_16x16x32_bf16 v[160:163], a[80:83], v[72:75], v[160:163]
ds_read_b64_tr_b16 v[100:101], v12 offset:53248
v_fmac_f32 v112, v48, v42
v_mfma_f32_16x16x32_bf16 v[160:163], a[88:91], v[76:79], v[160:163]
ds_read_b64_tr_b16 v[102:103], v12 offset:55296
v_fmac_f32 v113, v49, v42
v_mfma_f32_16x16x32_bf16 v[164:167], a[92:95], v[76:79], v[164:167]
ds_read_b64_tr_b16 v[104:105], v12 offset:57344
v_fmac_f32 v114, v50, v42
v_mfma_f32_16x16x32_bf16 v[164:167], a[84:87], v[72:75], v[164:167]
ds_read_b64_tr_b16 v[106:107], v12 offset:59392
v_fmac_f32 v115, v51, v42
v_mfma_f32_16x16x32_bf16 v[164:167], a[76:79], v[68:71], v[164:167]
ds_read_b64_tr_b16 v[108:109], v12 offset:61440
v_mul_f32 v112, v40, v112
v_mul_f32 v113, v40, v113
v_mfma_f32_16x16x32_bf16 v[164:167], a[68:71], v[64:67], v[164:167]
s_waitcnt lgkmcnt(7)
ds_read_b64_tr_b16 v[110:111], v12 offset:63488
v_mul_f32 v114, v40, v114
v_mfma_f32_16x16x32_bf16 v[172:175], a[68:71], v[80:83], v[172:175]
ds_read_b64_tr_b16 v[64:65], v13 offset:49152
buffer_load_dwordx4 v29, s[8:11], s42 offen offset:1024 sc1 lds
v_mfma_f32_16x16x32_bf16 v[172:175], a[76:79], v[84:87], v[172:175]
ds_read_b64_tr_b16 v[66:67], v13 offset:51200
v_mul_f32 v115, v40, v115
v_mfma_f32_16x16x32_bf16 v[172:175], a[84:87], v[88:91], v[172:175]
ds_read_b64_tr_b16 v[68:69], v13 offset:53248
v_cvt_pk_bf16_f32 v208, v112, v113
v_mfma_f32_16x16x32_bf16 v[172:175], a[92:95], v[92:95], v[172:175]
ds_read_b64_tr_b16 v[70:71], v13 offset:55296
v_cvt_pk_bf16_f32 v209, v114, v115
v_mfma_f32_16x16x32_bf16 v[168:171], a[88:91], v[92:95], v[168:171]
ds_read_b64_tr_b16 v[72:73], v13 offset:57344
v_fmac_f32 v120, v52, v42
v_mfma_f32_16x16x32_bf16 v[168:171], a[80:83], v[88:91], v[168:171]
ds_read_b64_tr_b16 v[74:75], v13 offset:59392
v_fmac_f32 v121, v53, v42
v_mfma_f32_16x16x32_bf16 v[168:171], a[72:75], v[84:87], v[168:171]
ds_read_b64_tr_b16 v[76:77], v13 offset:61440
v_fmac_f32 v122, v54, v42
v_fmac_f32 v123, v55, v42
v_mfma_f32_16x16x32_bf16 v[168:171], a[64:67], v[80:83], v[168:171]
s_waitcnt lgkmcnt(7)
ds_read_b64_tr_b16 v[78:79], v13 offset:63488
v_mul_f32 v120, v40, v120
v_mfma_f32_16x16x32_bf16 v[144:147], a[96:99], v[96:99], v[144:147]
ds_read_b64_tr_b16 v[80:81], v14 offset:49152
buffer_load_dwordx4 v30, s[8:11], s42 offen offset:2048 sc1 lds
v_mfma_f32_16x16x32_bf16 v[144:147], a[104:107], v[100:103], v[144:147]
ds_read_b64_tr_b16 v[82:83], v14 offset:51200
v_mul_f32 v121, v40, v121
v_mfma_f32_16x16x32_bf16 v[144:147], a[112:115], v[104:107], v[144:147]
ds_read_b64_tr_b16 v[84:85], v14 offset:53248
v_mul_f32 v122, v40, v122
v_mfma_f32_16x16x32_bf16 v[144:147], a[120:123], v[108:111], v[144:147]
ds_read_b64_tr_b16 v[86:87], v14 offset:55296
v_mul_f32 v123, v40, v123
v_mfma_f32_16x16x32_bf16 v[148:151], a[124:127], v[108:111], v[148:151]
ds_read_b64_tr_b16 v[88:89], v14 offset:57344
v_cvt_pk_bf16_f32 v210, v120, v121
v_mfma_f32_16x16x32_bf16 v[148:151], a[116:119], v[104:107], v[148:151]
ds_read_b64_tr_b16 v[90:91], v14 offset:59392
v_cvt_pk_bf16_f32 v211, v122, v123
v_mfma_f32_16x16x32_bf16 v[148:151], a[108:111], v[100:103], v[148:151]
ds_read_b64_tr_b16 v[92:93], v14 offset:61440
v_fmac_f32 v116, v48, v43
v_fmac_f32 v117, v49, v43
v_mfma_f32_16x16x32_bf16 v[148:151], a[100:103], v[96:99], v[148:151]
s_waitcnt lgkmcnt(7)
ds_read_b64_tr_b16 v[94:95], v14 offset:63488
v_fmac_f32 v118, v50, v43
v_mfma_f32_16x16x32_bf16 v[156:159], a[100:103], v[64:67], v[156:159]
ds_read_b64_tr_b16 v[96:97], v15 offset:49152
buffer_load_dwordx4 v31, s[8:11], s42 offen offset:3072 sc1 lds
v_mfma_f32_16x16x32_bf16 v[156:159], a[108:111], v[68:71], v[156:159]
ds_read_b64_tr_b16 v[98:99], v15 offset:51200
v_fmac_f32 v119, v51, v43
v_mfma_f32_16x16x32_bf16 v[156:159], a[116:119], v[72:75], v[156:159]
ds_read_b64_tr_b16 v[100:101], v15 offset:53248
v_mul_f32 v116, v41, v116
v_mfma_f32_16x16x32_bf16 v[156:159], a[124:127], v[76:79], v[156:159]
ds_read_b64_tr_b16 v[102:103], v15 offset:55296
v_mul_f32 v117, v41, v117
v_mfma_f32_16x16x32_bf16 v[152:155], a[120:123], v[76:79], v[152:155]
ds_read_b64_tr_b16 v[104:105], v15 offset:57344
v_mul_f32 v118, v41, v118
v_mfma_f32_16x16x32_bf16 v[152:155], a[112:115], v[72:75], v[152:155]
ds_read_b64_tr_b16 v[106:107], v15 offset:59392
v_mul_f32 v119, v41, v119
v_mfma_f32_16x16x32_bf16 v[152:155], a[104:107], v[68:71], v[152:155]
ds_read_b64_tr_b16 v[108:109], v15 offset:61440
v_cvt_pk_bf16_f32 v212, v116, v117
v_cvt_pk_bf16_f32 v213, v118, v119
v_mfma_f32_16x16x32_bf16 v[152:155], a[96:99], v[64:67], v[152:155]
s_waitcnt vmcnt(9) lgkmcnt(7)
s_barrier
ds_read_b64_tr_b16 v[110:111], v15 offset:63488
v_fmac_f32 v124, v52, v43
v_mfma_f32_16x16x32_bf16 v[160:163], a[96:99], v[80:83], v[160:163]
ds_read_b64_tr_b16 v[64:65], v16 offset:0
v_mov_b32 v28, v20
v_mfma_f32_16x16x32_bf16 v[160:163], a[104:107], v[84:87], v[160:163]
ds_read_b64_tr_b16 v[66:67], v16 offset:2048
v_add_u32 v29, 48128, v20
v_mfma_f32_16x16x32_bf16 v[160:163], a[112:115], v[88:91], v[160:163]
ds_read_b64_tr_b16 v[68:69], v16 offset:4096
v_add_u32 v30, 96256, v20
v_mfma_f32_16x16x32_bf16 v[160:163], a[120:123], v[92:95], v[160:163]
ds_read_b64_tr_b16 v[70:71], v16 offset:6144
v_add_u32 v31, 144384, v20
v_mfma_f32_16x16x32_bf16 v[164:167], a[124:127], v[92:95], v[164:167]
s_add_u32 m0, s41, 0
ds_read_b64_tr_b16 v[72:73], v16 offset:8192
s_mul_i32 s42, s48, 96
v_mfma_f32_16x16x32_bf16 v[164:167], a[116:119], v[88:91], v[164:167]
ds_read_b64_tr_b16 v[74:75], v16 offset:10240
buffer_load_dwordx4 v28, s[8:11], s42 offen sc1 lds
v_mfma_f32_16x16x32_bf16 v[164:167], a[108:111], v[84:87], v[164:167]
ds_read_b64_tr_b16 v[76:77], v16 offset:12288
v_fmac_f32 v125, v53, v43
v_fmac_f32 v126, v54, v43
v_mfma_f32_16x16x32_bf16 v[164:167], a[100:103], v[80:83], v[164:167]
s_waitcnt lgkmcnt(7)
ds_read_b64_tr_b16 v[78:79], v16 offset:14336
v_fmac_f32 v127, v55, v43
v_mfma_f32_16x16x32_bf16 v[172:175], a[100:103], v[96:99], v[172:175]
ds_read_b64_tr_b16 v[80:81], v17 offset:0
buffer_load_dwordx4 v29, s[8:11], s42 offen offset:1024 sc1 lds
v_mfma_f32_16x16x32_bf16 v[172:175], a[108:111], v[100:103], v[172:175]
ds_read_b64_tr_b16 v[82:83], v17 offset:2048
v_mul_f32 v124, v41, v124
v_mfma_f32_16x16x32_bf16 v[172:175], a[116:119], v[104:107], v[172:175]
ds_read_b64_tr_b16 v[84:85], v17 offset:4096
v_mul_f32 v125, v41, v125
v_mfma_f32_16x16x32_bf16 v[172:175], a[124:127], v[108:111], v[172:175]
ds_read_b64_tr_b16 v[86:87], v17 offset:6144
v_mul_f32 v126, v41, v126
v_mfma_f32_16x16x32_bf16 v[168:171], a[120:123], v[108:111], v[168:171]
ds_read_b64_tr_b16 v[88:89], v17 offset:8192
v_mul_f32 v127, v41, v127
v_mfma_f32_16x16x32_bf16 v[168:171], a[112:115], v[104:107], v[168:171]
s_branch Lso6
Lst6:
s_branch Lst10
Lso6:
ds_read_b64_tr_b16 v[90:91], v17 offset:10240
v_cvt_pk_bf16_f32 v214, v124, v125
v_mfma_f32_16x16x32_bf16 v[168:171], a[104:107], v[100:103], v[168:171]
ds_read_b64_tr_b16 v[92:93], v17 offset:12288
v_cvt_pk_bf16_f32 v215, v126, v127
v_permlane16_swap_b32 v208, v212
v_mfma_f32_16x16x32_bf16 v[168:171], a[96:99], v[96:99], v[168:171]
s_waitcnt lgkmcnt(7)
ds_read_b64_tr_b16 v[94:95], v17 offset:14336
v_permlane16_swap_b32 v209, v213
v_mfma_f32_16x16x32_bf16 v[144:147], a[128:131], v[64:67], v[144:147]
ds_read_b64_tr_b16 v[96:97], v18 offset:0
buffer_load_dwordx4 v30, s[8:11], s42 offen offset:2048 sc1 lds
v_mfma_f32_16x16x32_bf16 v[144:147], a[136:139], v[68:71], v[144:147]
ds_read_b64_tr_b16 v[98:99], v18 offset:2048
v_permlane16_swap_b32 v210, v214
v_mfma_f32_16x16x32_bf16 v[144:147], a[144:147], v[72:75], v[144:147]
ds_read_b64_tr_b16 v[100:101], v18 offset:4096
v_permlane16_swap_b32 v211, v215
v_mfma_f32_16x16x32_bf16 v[144:147], a[152:155], v[76:79], v[144:147]
ds_read_b64_tr_b16 v[102:103], v18 offset:6144
v_mfma_f32_16x16x32_bf16 v[148:151], a[156:159], v[76:79], v[148:151]
ds_read_b64_tr_b16 v[104:105], v18 offset:8192
buffer_store_dwordx4 v[208:211], v10, s[4:7], s72 offen sc1
v_mfma_f32_16x16x32_bf16 v[148:151], a[148:151], v[72:75], v[148:151]
ds_read_b64_tr_b16 v[106:107], v18 offset:10240
v_mfma_f32_16x16x32_bf16 v[148:151], a[140:143], v[68:71], v[148:151]
ds_read_b64_tr_b16 v[108:109], v18 offset:12288
v_mfma_f32_16x16x32_bf16 v[148:151], a[132:135], v[64:67], v[148:151]
s_waitcnt lgkmcnt(7)
ds_read_b64_tr_b16 v[110:111], v18 offset:14336
v_mfma_f32_16x16x32_bf16 v[156:159], a[132:135], v[80:83], v[156:159]
ds_read_b64_tr_b16 v[64:65], v19 offset:0
buffer_load_dwordx4 v31, s[8:11], s42 offen offset:3072 sc1 lds
v_mfma_f32_16x16x32_bf16 v[156:159], a[140:143], v[84:87], v[156:159]
ds_read_b64_tr_b16 v[66:67], v19 offset:2048
v_mfma_f32_16x16x32_bf16 v[156:159], a[148:151], v[88:91], v[156:159]
ds_read_b64_tr_b16 v[68:69], v19 offset:4096
v_mfma_f32_16x16x32_bf16 v[156:159], a[156:159], v[92:95], v[156:159]
ds_read_b64_tr_b16 v[70:71], v19 offset:6144
buffer_store_dwordx4 v[212:215], v10, s[4:7], s72 offen offset:1024 sc1
v_mfma_f32_16x16x32_bf16 v[152:155], a[152:155], v[92:95], v[152:155]
ds_read_b64_tr_b16 v[72:73], v19 offset:8192
v_fmac_f32 v128, v56, v42
v_mfma_f32_16x16x32_bf16 v[152:155], a[144:147], v[88:91], v[152:155]
ds_read_b64_tr_b16 v[74:75], v19 offset:10240
v_fmac_f32 v129, v57, v42
v_mfma_f32_16x16x32_bf16 v[152:155], a[136:139], v[84:87], v[152:155]
ds_read_b64_tr_b16 v[76:77], v19 offset:12288
v_fmac_f32 v130, v58, v42
v_mfma_f32_16x16x32_bf16 v[152:155], a[128:131], v[80:83], v[152:155]
s_waitcnt lgkmcnt(7)
ds_read_b64_tr_b16 v[78:79], v19 offset:14336
v_fmac_f32 v131, v59, v42
v_mfma_f32_16x16x32_bf16 v[160:163], a[128:131], v[96:99], v[160:163]
s_add_u32 m0, s41, 16384
ds_read_b64_tr_b16 v[80:81], v16 offset:16384
s_mul_i32 s42, s49, 96
v_mfma_f32_16x16x32_bf16 v[160:163], a[136:139], v[100:103], v[160:163]
ds_read_b64_tr_b16 v[82:83], v16 offset:18432
buffer_load_dwordx4 v28, s[8:11], s42 offen sc1 lds
v_mfma_f32_16x16x32_bf16 v[160:163], a[144:147], v[104:107], v[160:163]
ds_read_b64_tr_b16 v[84:85], v16 offset:20480
v_mul_f32 v128, v40, v128
v_mfma_f32_16x16x32_bf16 v[160:163], a[152:155], v[108:111], v[160:163]
ds_read_b64_tr_b16 v[86:87], v16 offset:22528
v_mul_f32 v129, v40, v129
v_mfma_f32_16x16x32_bf16 v[164:167], a[156:159], v[108:111], v[164:167]
ds_read_b64_tr_b16 v[88:89], v16 offset:24576
v_mul_f32 v130, v40, v130
v_mfma_f32_16x16x32_bf16 v[164:167], a[148:151], v[104:107], v[164:167]
ds_read_b64_tr_b16 v[90:91], v16 offset:26624
v_mul_f32 v131, v40, v131
v_mfma_f32_16x16x32_bf16 v[164:167], a[140:143], v[100:103], v[164:167]
ds_read_b64_tr_b16 v[92:93], v16 offset:28672
v_cvt_pk_bf16_f32 v216, v128, v129
v_cvt_pk_bf16_f32 v217, v130, v131
v_mfma_f32_16x16x32_bf16 v[164:167], a[132:135], v[96:99], v[164:167]
s_waitcnt lgkmcnt(7)
ds_read_b64_tr_b16 v[94:95], v16 offset:30720
v_fmac_f32 v136, v60, v42
v_mfma_f32_16x16x32_bf16 v[172:175], a[132:135], v[64:67], v[172:175]
ds_read_b64_tr_b16 v[96:97], v17 offset:16384
buffer_load_dwordx4 v29, s[8:11], s42 offen offset:1024 sc1 lds
v_mfma_f32_16x16x32_bf16 v[172:175], a[140:143], v[68:71], v[172:175]
ds_read_b64_tr_b16 v[98:99], v17 offset:18432
v_fmac_f32 v137, v61, v42
v_mfma_f32_16x16x32_bf16 v[172:175], a[148:151], v[72:75], v[172:175]
ds_read_b64_tr_b16 v[100:101], v17 offset:20480
v_fmac_f32 v138, v62, v42
v_mfma_f32_16x16x32_bf16 v[172:175], a[156:159], v[76:79], v[172:175]
ds_read_b64_tr_b16 v[102:103], v17 offset:22528
v_fmac_f32 v139, v63, v42
v_mfma_f32_16x16x32_bf16 v[168:171], a[152:155], v[76:79], v[168:171]
ds_read_b64_tr_b16 v[104:105], v17 offset:24576
v_mul_f32 v136, v40, v136
v_mfma_f32_16x16x32_bf16 v[168:171], a[144:147], v[72:75], v[168:171]
ds_read_b64_tr_b16 v[106:107], v17 offset:26624
v_mul_f32 v137, v40, v137
v_mfma_f32_16x16x32_bf16 v[168:171], a[136:139], v[68:71], v[168:171]
ds_read_b64_tr_b16 v[108:109], v17 offset:28672
v_mul_f32 v138, v40, v138
v_mul_f32 v139, v40, v139
v_mfma_f32_16x16x32_bf16 v[168:171], a[128:131], v[64:67], v[168:171]
s_waitcnt lgkmcnt(7)
ds_read_b64_tr_b16 v[110:111], v17 offset:30720
v_cvt_pk_bf16_f32 v218, v136, v137
v_mfma_f32_16x16x32_bf16 v[144:147], a[160:163], v[80:83], v[144:147]
ds_read_b64_tr_b16 v[64:65], v18 offset:16384
buffer_load_dwordx4 v30, s[8:11], s42 offen offset:2048 sc1 lds
v_mfma_f32_16x16x32_bf16 v[144:147], a[168:171], v[84:87], v[144:147]
ds_read_b64_tr_b16 v[66:67], v18 offset:18432
v_cvt_pk_bf16_f32 v219, v138, v139
v_mfma_f32_16x16x32_bf16 v[144:147], a[176:179], v[88:91], v[144:147]
ds_read_b64_tr_b16 v[68:69], v18 offset:20480
v_fmac_f32 v132, v56, v43
v_mfma_f32_16x16x32_bf16 v[144:147], a[184:187], v[92:95], v[144:147]
ds_read_b64_tr_b16 v[70:71], v18 offset:22528
v_fmac_f32 v133, v57, v43
v_mfma_f32_16x16x32_bf16 v[148:151], a[188:191], v[92:95], v[148:151]
ds_read_b64_tr_b16 v[72:73], v18 offset:24576
v_fmac_f32 v134, v58, v43
v_mfma_f32_16x16x32_bf16 v[148:151], a[180:183], v[88:91], v[148:151]
ds_read_b64_tr_b16 v[74:75], v18 offset:26624
v_fmac_f32 v135, v59, v43
v_mfma_f32_16x16x32_bf16 v[148:151], a[172:175], v[84:87], v[148:151]
ds_read_b64_tr_b16 v[76:77], v18 offset:28672
v_mul_f32 v132, v41, v132
v_mfma_f32_16x16x32_bf16 v[148:151], a[164:167], v[80:83], v[148:151]
s_waitcnt lgkmcnt(7)
ds_read_b64_tr_b16 v[78:79], v18 offset:30720
v_mul_f32 v133, v41, v133
v_mfma_f32_16x16x32_bf16 v[156:159], a[164:167], v[96:99], v[156:159]
ds_read_b64_tr_b16 v[80:81], v19 offset:16384
buffer_load_dwordx4 v31, s[8:11], s42 offen offset:3072 sc1 lds
v_mfma_f32_16x16x32_bf16 v[156:159], a[172:175], v[100:103], v[156:159]
ds_read_b64_tr_b16 v[82:83], v19 offset:18432
v_mul_f32 v134, v41, v134
v_mfma_f32_16x16x32_bf16 v[156:159], a[180:183], v[104:107], v[156:159]
ds_read_b64_tr_b16 v[84:85], v19 offset:20480
v_mul_f32 v135, v41, v135
v_mfma_f32_16x16x32_bf16 v[156:159], a[188:191], v[108:111], v[156:159]
ds_read_b64_tr_b16 v[86:87], v19 offset:22528
v_cvt_pk_bf16_f32 v220, v132, v133
v_mfma_f32_16x16x32_bf16 v[152:155], a[184:187], v[108:111], v[152:155]
ds_read_b64_tr_b16 v[88:89], v19 offset:24576
v_cvt_pk_bf16_f32 v221, v134, v135
v_mfma_f32_16x16x32_bf16 v[152:155], a[176:179], v[104:107], v[152:155]
ds_read_b64_tr_b16 v[90:91], v19 offset:26624
v_fmac_f32 v140, v60, v43
v_mfma_f32_16x16x32_bf16 v[152:155], a[168:171], v[100:103], v[152:155]
ds_read_b64_tr_b16 v[92:93], v19 offset:28672
v_fmac_f32 v141, v61, v43
v_fmac_f32 v142, v62, v43
v_mfma_f32_16x16x32_bf16 v[152:155], a[160:163], v[96:99], v[152:155]
s_waitcnt vmcnt(10) lgkmcnt(7)
s_barrier
ds_read_b64_tr_b16 v[94:95], v19 offset:30720
v_fmac_f32 v143, v63, v43
v_mfma_f32_16x16x32_bf16 v[160:163], a[160:163], v[64:67], v[160:163]
s_add_u32 m0, s41, 32768
ds_read_b64_tr_b16 v[96:97], v16 offset:32768
s_mul_i32 s42, s50, 96
v_mfma_f32_16x16x32_bf16 v[160:163], a[168:171], v[68:71], v[160:163]
ds_read_b64_tr_b16 v[98:99], v16 offset:34816
buffer_load_dwordx4 v28, s[8:11], s42 offen sc1 lds
v_mfma_f32_16x16x32_bf16 v[160:163], a[176:179], v[72:75], v[160:163]
ds_read_b64_tr_b16 v[100:101], v16 offset:36864
v_mul_f32 v140, v41, v140
v_mfma_f32_16x16x32_bf16 v[160:163], a[184:187], v[76:79], v[160:163]
ds_read_b64_tr_b16 v[102:103], v16 offset:38912
v_mul_f32 v141, v41, v141
v_mfma_f32_16x16x32_bf16 v[164:167], a[188:191], v[76:79], v[164:167]
ds_read_b64_tr_b16 v[104:105], v16 offset:40960
v_mul_f32 v142, v41, v142
v_mul_f32 v143, v41, v143
v_mfma_f32_16x16x32_bf16 v[164:167], a[180:183], v[72:75], v[164:167]
ds_read_b64_tr_b16 v[106:107], v16 offset:43008
v_cvt_pk_bf16_f32 v222, v140, v141
v_mfma_f32_16x16x32_bf16 v[164:167], a[172:175], v[68:71], v[164:167]
ds_read_b64_tr_b16 v[108:109], v16 offset:45056
v_cvt_pk_bf16_f32 v223, v142, v143
v_permlane16_swap_b32 v216, v220
v_mfma_f32_16x16x32_bf16 v[164:167], a[164:167], v[64:67], v[164:167]
s_waitcnt lgkmcnt(7)
ds_read_b64_tr_b16 v[110:111], v16 offset:47104
v_permlane16_swap_b32 v217, v221
v_mfma_f32_16x16x32_bf16 v[172:175], a[164:167], v[80:83], v[172:175]
ds_read_b64_tr_b16 v[64:65], v17 offset:32768
buffer_load_dwordx4 v29, s[8:11], s42 offen offset:1024 sc1 lds
v_mfma_f32_16x16x32_bf16 v[172:175], a[172:175], v[84:87], v[172:175]
ds_read_b64_tr_b16 v[66:67], v17 offset:34816
v_permlane16_swap_b32 v218, v222
v_mfma_f32_16x16x32_bf16 v[172:175], a[180:183], v[88:91], v[172:175]
ds_read_b64_tr_b16 v[68:69], v17 offset:36864
v_permlane16_swap_b32 v219, v223
v_mfma_f32_16x16x32_bf16 v[172:175], a[188:191], v[92:95], v[172:175]
ds_read_b64_tr_b16 v[70:71], v17 offset:38912
ds_read_b128 v[240:243], v8 offset:0
v_mfma_f32_16x16x32_bf16 v[168:171], a[184:187], v[92:95], v[168:171]
ds_read_b64_tr_b16 v[72:73], v17 offset:40960
buffer_store_dwordx4 v[216:219], v10, s[4:7], s72 offen offset:2048 sc1
v_mfma_f32_16x16x32_bf16 v[168:171], a[176:179], v[88:91], v[168:171]
ds_read_b64_tr_b16 v[74:75], v17 offset:43008
v_mfma_f32_16x16x32_bf16 v[168:171], a[168:171], v[84:87], v[168:171]
ds_read_b64_tr_b16 v[76:77], v17 offset:45056
v_mfma_f32_16x16x32_bf16 v[168:171], a[160:163], v[80:83], v[168:171]
s_waitcnt lgkmcnt(8)
ds_read_b64_tr_b16 v[78:79], v17 offset:47104
v_mfma_f32_16x16x32_bf16 v[144:147], a[192:195], v[96:99], v[144:147]
ds_read_b64_tr_b16 v[80:81], v18 offset:32768
buffer_load_dwordx4 v30, s[8:11], s42 offen offset:2048 sc1 lds
v_mfma_f32_16x16x32_bf16 v[144:147], a[200:203], v[100:103], v[144:147]
ds_read_b64_tr_b16 v[82:83], v18 offset:34816
v_mfma_f32_16x16x32_bf16 v[144:147], a[208:211], v[104:107], v[144:147]
ds_read_b64_tr_b16 v[84:85], v18 offset:36864
v_mfma_f32_16x16x32_bf16 v[144:147], a[216:219], v[108:111], v[144:147]
ds_read_b64_tr_b16 v[86:87], v18 offset:38912
v_mfma_f32_16x16x32_bf16 v[148:151], a[220:223], v[108:111], v[148:151]
ds_read_b64_tr_b16 v[88:89], v18 offset:40960
buffer_store_dwordx4 v[220:223], v10, s[4:7], s72 offen offset:3072 sc1
v_mfma_f32_16x16x32_bf16 v[148:151], a[212:215], v[104:107], v[148:151]
ds_read_b64_tr_b16 v[90:91], v18 offset:43008
ds_read_b128 v[244:247], v8 offset:64
v_mfma_f32_16x16x32_bf16 v[148:151], a[204:207], v[100:103], v[148:151]
ds_read_b64_tr_b16 v[92:93], v18 offset:45056
ds_read_b128 v[248:251], v8 offset:128
v_mfma_f32_16x16x32_bf16 v[148:151], a[196:199], v[96:99], v[148:151]
s_waitcnt lgkmcnt(9)
ds_read_b64_tr_b16 v[94:95], v18 offset:47104
v_mfma_f32_16x16x32_bf16 v[156:159], a[196:199], v[64:67], v[156:159]
ds_read_b64_tr_b16 v[96:97], v19 offset:32768
buffer_load_dwordx4 v31, s[8:11], s42 offen offset:3072 sc1 lds
v_mfma_f32_16x16x32_bf16 v[156:159], a[204:207], v[68:71], v[156:159]
ds_read_b64_tr_b16 v[98:99], v19 offset:34816
ds_read_b128 v[252:255], v8 offset:192
v_mfma_f32_16x16x32_bf16 v[156:159], a[212:215], v[72:75], v[156:159]
ds_read_b64_tr_b16 v[100:101], v19 offset:36864
ds_read_b32 v48, v6 offset:256
v_mfma_f32_16x16x32_bf16 v[156:159], a[220:223], v[76:79], v[156:159]
ds_read_b64_tr_b16 v[102:103], v19 offset:38912
v_mfma_f32_16x16x32_bf16 v[152:155], a[216:219], v[76:79], v[152:155]
ds_read_b64_tr_b16 v[104:105], v19 offset:40960
v_mfma_f32_16x16x32_bf16 v[152:155], a[208:211], v[72:75], v[152:155]
ds_read_b64_tr_b16 v[106:107], v19 offset:43008
v_mfma_f32_16x16x32_bf16 v[152:155], a[200:203], v[68:71], v[152:155]
ds_read_b64_tr_b16 v[108:109], v19 offset:45056
v_mfma_f32_16x16x32_bf16 v[152:155], a[192:195], v[64:67], v[152:155]
s_waitcnt lgkmcnt(9)
ds_read_b64_tr_b16 v[110:111], v19 offset:47104
v_mfma_f32_16x16x32_bf16 v[160:163], a[192:195], v[80:83], v[160:163]
s_lshl_b32 s45, s0, 11
ds_read_b64_tr_b16 v[64:65], v16 offset:49152
s_or_b32 s46, s38, 7
v_mfma_f32_16x16x32_bf16 v[160:163], a[200:203], v[84:87], v[160:163]
s_sub_u32 s46, s46, 4
ds_read_b64_tr_b16 v[66:67], v16 offset:51200
s_lshl_b32 s46, s46, 7
v_mfma_f32_16x16x32_bf16 v[160:163], a[208:211], v[88:91], v[160:163]
s_add_u32 s45, s45, s46
ds_read_b64_tr_b16 v[68:69], v16 offset:53248
buffer_load_dword v3, v24, s[12:15], s45 offen
v_mfma_f32_16x16x32_bf16 v[160:163], a[216:219], v[92:95], v[160:163]
s_add_u32 m0, s41, 49152
ds_read_b64_tr_b16 v[70:71], v16 offset:55296
s_mul_i32 s42, s51, 96
v_mfma_f32_16x16x32_bf16 v[164:167], a[220:223], v[92:95], v[164:167]
ds_read_b64_tr_b16 v[72:73], v16 offset:57344
buffer_load_dwordx4 v28, s[8:11], s42 offen sc1 lds
v_mfma_f32_16x16x32_bf16 v[164:167], a[212:215], v[88:91], v[164:167]
ds_read_b64_tr_b16 v[74:75], v16 offset:59392
ds_read_b32 v49, v6 offset:320
v_mfma_f32_16x16x32_bf16 v[164:167], a[204:207], v[84:87], v[164:167]
ds_read_b64_tr_b16 v[76:77], v16 offset:61440
ds_read_b32 v50, v6 offset:384
v_mfma_f32_16x16x32_bf16 v[164:167], a[196:199], v[80:83], v[164:167]
s_waitcnt lgkmcnt(9)
ds_read_b64_tr_b16 v[78:79], v16 offset:63488
v_mfma_f32_16x16x32_bf16 v[172:175], a[196:199], v[96:99], v[172:175]
ds_read_b64_tr_b16 v[80:81], v17 offset:49152
buffer_load_dwordx4 v29, s[8:11], s42 offen offset:1024 sc1 lds
v_mfma_f32_16x16x32_bf16 v[172:175], a[204:207], v[100:103], v[172:175]
ds_read_b64_tr_b16 v[82:83], v17 offset:51200
ds_read_b32 v51, v6 offset:448
v_mfma_f32_16x16x32_bf16 v[172:175], a[212:215], v[104:107], v[172:175]
ds_read_b64_tr_b16 v[84:85], v17 offset:53248
v_mfma_f32_16x16x32_bf16 v[172:175], a[220:223], v[108:111], v[172:175]
ds_read_b64_tr_b16 v[86:87], v17 offset:55296
v_mfma_f32_16x16x32_bf16 v[168:171], a[216:219], v[108:111], v[168:171]
ds_read_b64_tr_b16 v[88:89], v17 offset:57344
v_mfma_f32_16x16x32_bf16 v[168:171], a[208:211], v[104:107], v[168:171]
ds_read_b64_tr_b16 v[90:91], v17 offset:59392
v_mfma_f32_16x16x32_bf16 v[168:171], a[200:203], v[100:103], v[168:171]
ds_read_b64_tr_b16 v[92:93], v17 offset:61440
v_mfma_f32_16x16x32_bf16 v[168:171], a[192:195], v[96:99], v[168:171]
s_waitcnt lgkmcnt(8)
ds_read_b64_tr_b16 v[94:95], v17 offset:63488
v_mfma_f32_16x16x32_bf16 v[144:147], a[224:227], v[64:67], v[144:147]
ds_read_b64_tr_b16 v[96:97], v18 offset:49152
buffer_load_dwordx4 v30, s[8:11], s42 offen offset:2048 sc1 lds
v_mfma_f32_16x16x32_bf16 v[144:147], a[232:235], v[68:71], v[144:147]
ds_read_b64_tr_b16 v[98:99], v18 offset:51200
v_mfma_f32_16x16x32_bf16 v[144:147], a[240:243], v[72:75], v[144:147]
ds_read_b64_tr_b16 v[100:101], v18 offset:53248
v_mfma_f32_16x16x32_bf16 v[144:147], a[248:251], v[76:79], v[144:147]
ds_read_b64_tr_b16 v[102:103], v18 offset:55296
v_mfma_f32_16x16x32_bf16 v[148:151], a[252:255], v[76:79], v[148:151]
ds_read_b64_tr_b16 v[104:105], v18 offset:57344
v_mfma_f32_16x16x32_bf16 v[148:151], a[244:247], v[72:75], v[148:151]
ds_read_b64_tr_b16 v[106:107], v18 offset:59392
v_mfma_f32_16x16x32_bf16 v[148:151], a[236:239], v[68:71], v[148:151]
ds_read_b64_tr_b16 v[108:109], v18 offset:61440
v_mfma_f32_16x16x32_bf16 v[148:151], a[228:231], v[64:67], v[148:151]
s_waitcnt lgkmcnt(7)
ds_read_b64_tr_b16 v[110:111], v18 offset:63488
v_mfma_f32_16x16x32_bf16 v[156:159], a[228:231], v[80:83], v[156:159]
ds_read_b64_tr_b16 v[64:65], v19 offset:49152
buffer_load_dwordx4 v31, s[8:11], s42 offen offset:3072 sc1 lds
v_mfma_f32_16x16x32_bf16 v[156:159], a[236:239], v[84:87], v[156:159]
ds_read_b64_tr_b16 v[66:67], v19 offset:51200
v_mfma_f32_16x16x32_bf16 v[156:159], a[244:247], v[88:91], v[156:159]
ds_read_b64_tr_b16 v[68:69], v19 offset:53248
v_mfma_f32_16x16x32_bf16 v[156:159], a[252:255], v[92:95], v[156:159]
ds_read_b64_tr_b16 v[70:71], v19 offset:55296
v_mfma_f32_16x16x32_bf16 v[152:155], a[248:251], v[92:95], v[152:155]
ds_read_b64_tr_b16 v[72:73], v19 offset:57344
v_mfma_f32_16x16x32_bf16 v[152:155], a[240:243], v[88:91], v[152:155]
ds_read_b64_tr_b16 v[74:75], v19 offset:59392
v_mfma_f32_16x16x32_bf16 v[152:155], a[232:235], v[84:87], v[152:155]
ds_read_b64_tr_b16 v[76:77], v19 offset:61440
v_mfma_f32_16x16x32_bf16 v[152:155], a[224:227], v[80:83], v[152:155]
s_waitcnt vmcnt(11) lgkmcnt(7)
s_barrier
ds_read_b64_tr_b16 v[78:79], v19 offset:63488
v_mfma_f32_16x16x32_bf16 v[160:163], a[224:227], v[96:99], v[160:163]
s_add_u32 m0, s41, 65536
ds_read_b64_tr_b16 v[80:81], v12 offset:0
s_mul_i32 s42, s52, 96
v_mfma_f32_16x16x32_bf16 v[160:163], a[232:235], v[100:103], v[160:163]
ds_read_b64_tr_b16 v[82:83], v12 offset:2048
buffer_load_dwordx4 v28, s[8:11], s42 offen sc1 lds
v_mfma_f32_16x16x32_bf16 v[160:163], a[240:243], v[104:107], v[160:163]
ds_read_b64_tr_b16 v[84:85], v12 offset:4096
v_fmac_f32 v144, v48, v248
v_mfma_f32_16x16x32_bf16 v[160:163], a[248:251], v[108:111], v[160:163]
ds_read_b64_tr_b16 v[86:87], v12 offset:6144
v_fmac_f32 v145, v48, v249
v_mfma_f32_16x16x32_bf16 v[164:167], a[252:255], v[108:111], v[164:167]
ds_read_b64_tr_b16 v[88:89], v12 offset:8192
v_fmac_f32 v146, v48, v250
v_fmac_f32 v147, v48, v251
v_mfma_f32_16x16x32_bf16 v[164:167], a[244:247], v[104:107], v[164:167]
ds_read_b64_tr_b16 v[90:91], v12 offset:10240
v_mul_f32 v144, v240, v144
v_mfma_f32_16x16x32_bf16 v[164:167], a[236:239], v[100:103], v[164:167]
ds_read_b64_tr_b16 v[92:93], v12 offset:12288
v_mul_f32 v145, v241, v145
v_mul_f32 v146, v242, v146
v_mfma_f32_16x16x32_bf16 v[164:167], a[228:231], v[96:99], v[164:167]
s_waitcnt lgkmcnt(7)
ds_read_b64_tr_b16 v[94:95], v12 offset:14336
v_mul_f32 v147, v243, v147
v_mfma_f32_16x16x32_bf16 v[172:175], a[228:231], v[64:67], v[172:175]
ds_read_b64_tr_b16 v[96:97], v13 offset:0
buffer_load_dwordx4 v29, s[8:11], s42 offen offset:1024 sc1 lds
v_mfma_f32_16x16x32_bf16 v[172:175], a[236:239], v[68:71], v[172:175]
ds_read_b64_tr_b16 v[98:99], v13 offset:2048
v_cvt_pk_bf16_f32 v224, v144, v145
v_mfma_f32_16x16x32_bf16 v[172:175], a[244:247], v[72:75], v[172:175]
ds_read_b64_tr_b16 v[100:101], v13 offset:4096
v_cvt_pk_bf16_f32 v225, v146, v147
v_mfma_f32_16x16x32_bf16 v[172:175], a[252:255], v[76:79], v[172:175]
ds_read_b64_tr_b16 v[102:103], v13 offset:6144
v_fmac_f32 v152, v49, v248
v_mfma_f32_16x16x32_bf16 v[168:171], a[248:251], v[76:79], v[168:171]
s_waitcnt vmcnt(8)
ds_read_b64_tr_b16 v[104:105], v13 offset:8192
v_fmac_f32 v153, v49, v249
v_fmac_f32 v154, v49, v250
v_mfma_f32_16x16x32_bf16 v[168:171], a[240:243], v[72:75], v[168:171]
ds_read_b64_tr_b16 v[106:107], v13 offset:10240
buffer_atomic_add v26, v11, s[4:7], s75 offen offset:4 sc1
v_mfma_f32_16x16x32_bf16 v[168:171], a[232:235], v[68:71], v[168:171]
ds_read_b64_tr_b16 v[108:109], v13 offset:12288
v_fmac_f32 v155, v49, v251
v_mfma_f32_16x16x32_bf16 v[168:171], a[224:227], v[64:67], v[168:171]
s_waitcnt lgkmcnt(7)
ds_read_b64_tr_b16 v[110:111], v13 offset:14336
v_mul_f32 v152, v240, v152
v_mfma_f32_16x16x32_bf16 v[112:115], v[80:83], a[0:3], 0
ds_read_b64_tr_b16 v[64:65], v14 offset:0
buffer_load_dwordx4 v30, s[8:11], s42 offen offset:2048 sc1 lds
v_mfma_f32_16x16x32_bf16 v[112:115], v[84:87], a[8:11], v[112:115]
ds_read_b64_tr_b16 v[66:67], v14 offset:2048
v_mul_f32 v153, v241, v153
v_mfma_f32_16x16x32_bf16 v[112:115], v[88:91], a[16:19], v[112:115]
ds_read_b64_tr_b16 v[68:69], v14 offset:4096
v_mul_f32 v154, v242, v154
v_mfma_f32_16x16x32_bf16 v[112:115], v[92:95], a[24:27], v[112:115]
ds_read_b64_tr_b16 v[70:71], v14 offset:6144
v_mul_f32 v155, v243, v155
v_mfma_f32_16x16x32_bf16 v[116:119], v[92:95], a[28:31], 0
ds_read_b64_tr_b16 v[72:73], v14 offset:8192
v_cvt_pk_bf16_f32 v226, v152, v153
v_mfma_f32_16x16x32_bf16 v[116:119], v[88:91], a[20:23], v[116:119]
ds_read_b64_tr_b16 v[74:75], v14 offset:10240
v_cvt_pk_bf16_f32 v227, v154, v155
v_mfma_f32_16x16x32_bf16 v[116:119], v[84:87], a[12:15], v[116:119]
ds_read_b64_tr_b16 v[76:77], v14 offset:12288
v_fmac_f32 v148, v48, v252
v_fmac_f32 v149, v48, v253
v_mfma_f32_16x16x32_bf16 v[116:119], v[80:83], a[4:7], v[116:119]
s_waitcnt lgkmcnt(7)
ds_read_b64_tr_b16 v[78:79], v14 offset:14336
v_fmac_f32 v150, v48, v254
v_mfma_f32_16x16x32_bf16 v[124:127], v[96:99], a[4:7], 0
ds_read_b64_tr_b16 v[80:81], v15 offset:0
buffer_load_dwordx4 v31, s[8:11], s42 offen offset:3072 sc1 lds
v_mfma_f32_16x16x32_bf16 v[124:127], v[100:103], a[12:15], v[124:127]
ds_read_b64_tr_b16 v[82:83], v15 offset:2048
v_fmac_f32 v151, v48, v255
v_mfma_f32_16x16x32_bf16 v[124:127], v[104:107], a[20:23], v[124:127]
ds_read_b64_tr_b16 v[84:85], v15 offset:4096
v_mul_f32 v148, v244, v148
v_mfma_f32_16x16x32_bf16 v[124:127], v[108:111], a[28:31], v[124:127]
ds_read_b64_tr_b16 v[86:87], v15 offset:6144
v_mul_f32 v149, v245, v149
v_mfma_f32_16x16x32_bf16 v[120:123], v[108:111], a[24:27], 0
ds_read_b64_tr_b16 v[88:89], v15 offset:8192
v_mul_f32 v150, v246, v150
v_mul_f32 v151, v247, v151
v_mfma_f32_16x16x32_bf16 v[120:123], v[104:107], a[16:19], v[120:123]
ds_read_b64_tr_b16 v[90:91], v15 offset:10240
v_cvt_pk_bf16_f32 v228, v148, v149
v_mfma_f32_16x16x32_bf16 v[120:123], v[100:103], a[8:11], v[120:123]
ds_read_b64_tr_b16 v[92:93], v15 offset:12288
v_cvt_pk_bf16_f32 v229, v150, v151
v_fmac_f32 v156, v49, v252
v_mfma_f32_16x16x32_bf16 v[120:123], v[96:99], a[0:3], v[120:123]
s_waitcnt lgkmcnt(7)
ds_read_b64_tr_b16 v[94:95], v15 offset:14336
v_fmac_f32 v157, v49, v253
v_mfma_f32_16x16x32_bf16 v[128:131], v[64:67], a[0:3], 0
s_add_u32 m0, s41, 81920
ds_read_b64_tr_b16 v[96:97], v12 offset:16384
s_mul_i32 s42, s53, 96
v_mfma_f32_16x16x32_bf16 v[128:131], v[68:71], a[8:11], v[128:131]
ds_read_b64_tr_b16 v[98:99], v12 offset:18432
buffer_load_dwordx4 v28, s[8:11], s42 offen sc1 lds
v_mfma_f32_16x16x32_bf16 v[128:131], v[72:75], a[16:19], v[128:131]
ds_read_b64_tr_b16 v[100:101], v12 offset:20480
v_fmac_f32 v158, v49, v254
v_fmac_f32 v159, v49, v255
v_mfma_f32_16x16x32_bf16 v[128:131], v[76:79], a[24:27], v[128:131]
ds_read_b64_tr_b16 v[102:103], v12 offset:22528
v_mul_f32 v156, v244, v156
v_mfma_f32_16x16x32_bf16 v[132:135], v[76:79], a[28:31], 0
ds_read_b64_tr_b16 v[104:105], v12 offset:24576
v_mul_f32 v157, v245, v157
v_mul_f32 v158, v246, v158
v_mfma_f32_16x16x32_bf16 v[132:135], v[72:75], a[20:23], v[132:135]
ds_read_b64_tr_b16 v[106:107], v12 offset:26624
v_mul_f32 v159, v247, v159
v_mfma_f32_16x16x32_bf16 v[132:135], v[68:71], a[12:15], v[132:135]
ds_read_b64_tr_b16 v[108:109], v12 offset:28672
v_cvt_pk_bf16_f32 v230, v156, v157
v_cvt_pk_bf16_f32 v231, v158, v159
v_mfma_f32_16x16x32_bf16 v[132:135], v[64:67], a[4:7], v[132:135]
s_waitcnt lgkmcnt(7)
ds_read_b64_tr_b16 v[110:111], v12 offset:30720
v_permlane16_swap_b32 v224, v226
v_mfma_f32_16x16x32_bf16 v[140:143], v[80:83], a[4:7], 0
ds_read_b64_tr_b16 v[64:65], v13 offset:16384
buffer_load_dwordx4 v29, s[8:11], s42 offen offset:1024 sc1 lds
v_mfma_f32_16x16x32_bf16 v[140:143], v[84:87], a[12:15], v[140:143]
ds_read_b64_tr_b16 v[66:67], v13 offset:18432
v_permlane16_swap_b32 v225, v227
v_mfma_f32_16x16x32_bf16 v[140:143], v[88:91], a[20:23], v[140:143]
ds_read_b64_tr_b16 v[68:69], v13 offset:20480
v_permlane16_swap_b32 v228, v230
v_mfma_f32_16x16x32_bf16 v[140:143], v[92:95], a[28:31], v[140:143]
ds_read_b64_tr_b16 v[70:71], v13 offset:22528
v_permlane16_swap_b32 v229, v231
v_mfma_f32_16x16x32_bf16 v[136:139], v[92:95], a[24:27], 0
ds_read_b64_tr_b16 v[72:73], v13 offset:24576
v_permlane32_swap_b32 v224, v226
v_mfma_f32_16x16x32_bf16 v[136:139], v[88:91], a[16:19], v[136:139]
ds_read_b64_tr_b16 v[74:75], v13 offset:26624
v_permlane32_swap_b32 v225, v227
v_mfma_f32_16x16x32_bf16 v[136:139], v[84:87], a[8:11], v[136:139]
ds_read_b64_tr_b16 v[76:77], v13 offset:28672
v_permlane32_swap_b32 v228, v230
v_mfma_f32_16x16x32_bf16 v[136:139], v[80:83], a[0:3], v[136:139]
s_waitcnt lgkmcnt(7)
ds_read_b64_tr_b16 v[78:79], v13 offset:30720
v_permlane32_swap_b32 v229, v231
v_mfma_f32_16x16x32_bf16 v[112:115], v[96:99], a[32:35], v[112:115]
ds_read_b64_tr_b16 v[80:81], v14 offset:16384
buffer_load_dwordx4 v30, s[8:11], s42 offen offset:2048 sc1 lds
v_mfma_f32_16x16x32_bf16 v[112:115], v[100:103], a[40:43], v[112:115]
ds_read_b64_tr_b16 v[82:83], v14 offset:18432
v_mfma_f32_16x16x32_bf16 v[112:115], v[104:107], a[48:51], v[112:115]
ds_read_b64_tr_b16 v[84:85], v14 offset:20480
buffer_store_dwordx4 v[224:227], v2, s[4:7], s72 offen sc1
v_mfma_f32_16x16x32_bf16 v[112:115], v[108:111], a[56:59], v[112:115]
ds_read_b64_tr_b16 v[86:87], v14 offset:22528
v_mfma_f32_16x16x32_bf16 v[116:119], v[108:111], a[60:63], v[116:119]
ds_read_b64_tr_b16 v[88:89], v14 offset:24576
v_mfma_f32_16x16x32_bf16 v[116:119], v[104:107], a[52:55], v[116:119]
ds_read_b64_tr_b16 v[90:91], v14 offset:26624
buffer_store_dwordx4 v[228:231], v2, s[4:7], s72 offen offset:1024 sc1
v_mfma_f32_16x16x32_bf16 v[116:119], v[100:103], a[44:47], v[116:119]
ds_read_b64_tr_b16 v[92:93], v14 offset:28672
v_mfma_f32_16x16x32_bf16 v[116:119], v[96:99], a[36:39], v[116:119]
s_waitcnt lgkmcnt(7)
ds_read_b64_tr_b16 v[94:95], v14 offset:30720
v_mfma_f32_16x16x32_bf16 v[124:127], v[64:67], a[36:39], v[124:127]
ds_read_b64_tr_b16 v[96:97], v15 offset:16384
buffer_load_dwordx4 v31, s[8:11], s42 offen offset:3072 sc1 lds
v_mfma_f32_16x16x32_bf16 v[124:127], v[68:71], a[44:47], v[124:127]
ds_read_b64_tr_b16 v[98:99], v15 offset:18432
v_fmac_f32 v160, v50, v248
v_mfma_f32_16x16x32_bf16 v[124:127], v[72:75], a[52:55], v[124:127]
ds_read_b64_tr_b16 v[100:101], v15 offset:20480
v_fmac_f32 v161, v50, v249
v_mfma_f32_16x16x32_bf16 v[124:127], v[76:79], a[60:63], v[124:127]
ds_read_b64_tr_b16 v[102:103], v15 offset:22528
v_fmac_f32 v162, v50, v250
v_mfma_f32_16x16x32_bf16 v[120:123], v[76:79], a[56:59], v[120:123]
ds_read_b64_tr_b16 v[104:105], v15 offset:24576
v_mov_b32 v25, 0
v_mfma_f32_16x16x32_bf16 v[120:123], v[72:75], a[48:51], v[120:123]
ds_read_b64_tr_b16 v[106:107], v15 offset:26624
buffer_atomic_add v25, v11, s[4:7], s44 offen offset:4 sc0 sc1
v_mfma_f32_16x16x32_bf16 v[120:123], v[68:71], a[40:43], v[120:123]
ds_read_b64_tr_b16 v[108:109], v15 offset:28672
v_fmac_f32 v163, v50, v251
v_mul_f32 v160, v240, v160
v_mfma_f32_16x16x32_bf16 v[120:123], v[64:67], a[32:35], v[120:123]
s_waitcnt vmcnt(12) lgkmcnt(7)
s_barrier
ds_read_b64_tr_b16 v[110:111], v15 offset:30720
v_mul_f32 v161, v241, v161
v_mfma_f32_16x16x32_bf16 v[128:131], v[80:83], a[32:35], v[128:131]
s_add_u32 m0, s41, 98304
ds_read_b64_tr_b16 v[64:65], v12 offset:32768
s_mul_i32 s42, s54, 96
v_mfma_f32_16x16x32_bf16 v[128:131], v[84:87], a[40:43], v[128:131]
ds_read_b64_tr_b16 v[66:67], v12 offset:34816
buffer_load_dwordx4 v28, s[8:11], s42 offen sc1 lds
v_mfma_f32_16x16x32_bf16 v[128:131], v[88:91], a[48:51], v[128:131]
ds_read_b64_tr_b16 v[68:69], v12 offset:36864
v_mul_f32 v162, v242, v162
v_mfma_f32_16x16x32_bf16 v[128:131], v[92:95], a[56:59], v[128:131]
ds_read_b64_tr_b16 v[70:71], v12 offset:38912
v_mul_f32 v163, v243, v163
v_mfma_f32_16x16x32_bf16 v[132:135], v[92:95], a[60:63], v[132:135]
ds_read_b64_tr_b16 v[72:73], v12 offset:40960
v_cvt_pk_bf16_f32 v232, v160, v161
v_cvt_pk_bf16_f32 v233, v162, v163
v_mfma_f32_16x16x32_bf16 v[132:135], v[88:91], a[52:55], v[132:135]
ds_read_b64_tr_b16 v[74:75], v12 offset:43008
v_fmac_f32 v168, v51, v248
v_mfma_f32_16x16x32_bf16 v[132:135], v[84:87], a[44:47], v[132:135]
ds_read_b64_tr_b16 v[76:77], v12 offset:45056
v_fmac_f32 v169, v51, v249
v_fmac_f32 v170, v51, v250
v_mfma_f32_16x16x32_bf16 v[132:135], v[80:83], a[36:39], v[132:135]
s_waitcnt lgkmcnt(7)
ds_read_b64_tr_b16 v[78:79], v12 offset:47104
v_fmac_f32 v171, v51, v251
v_mfma_f32_16x16x32_bf16 v[140:143], v[96:99], a[36:39], v[140:143]
ds_read_b64_tr_b16 v[80:81], v13 offset:32768
buffer_load_dwordx4 v29, s[8:11], s42 offen offset:1024 sc1 lds
v_mfma_f32_16x16x32_bf16 v[140:143], v[100:103], a[44:47], v[140:143]
s_branch Lso7
Lst7:
s_setpc_b64 s[42:43]
Lso7:
ds_read_b64_tr_b16 v[82:83], v13 offset:34816
v_mul_f32 v168, v240, v168
v_mfma_f32_16x16x32_bf16 v[140:143], v[104:107], a[52:55], v[140:143]
ds_read_b64_tr_b16 v[84:85], v13 offset:36864
v_mul_f32 v169, v241, v169
v_mfma_f32_16x16x32_bf16 v[140:143], v[108:111], a[60:63], v[140:143]
ds_read_b64_tr_b16 v[86:87], v13 offset:38912
v_mul_f32 v170, v242, v170
v_mfma_f32_16x16x32_bf16 v[136:139], v[108:111], a[56:59], v[136:139]
ds_read_b64_tr_b16 v[88:89], v13 offset:40960
v_mul_f32 v171, v243, v171
v_cvt_pk_bf16_f32 v234, v168, v169
v_mfma_f32_16x16x32_bf16 v[136:139], v[104:107], a[48:51], v[136:139]
ds_read_b64_tr_b16 v[90:91], v13 offset:43008
v_cvt_pk_bf16_f32 v235, v170, v171
v_mfma_f32_16x16x32_bf16 v[136:139], v[100:103], a[40:43], v[136:139]
ds_read_b64_tr_b16 v[92:93], v13 offset:45056
v_fmac_f32 v164, v50, v252
v_fmac_f32 v165, v50, v253
v_mfma_f32_16x16x32_bf16 v[136:139], v[96:99], a[32:35], v[136:139]
s_waitcnt lgkmcnt(7)
ds_read_b64_tr_b16 v[94:95], v13 offset:47104
v_fmac_f32 v166, v50, v254
v_mfma_f32_16x16x32_bf16 v[112:115], v[64:67], a[64:67], v[112:115]
ds_read_b64_tr_b16 v[96:97], v14 offset:32768
buffer_load_dwordx4 v30, s[8:11], s42 offen offset:2048 sc1 lds
v_mfma_f32_16x16x32_bf16 v[112:115], v[68:71], a[72:75], v[112:115]
ds_read_b64_tr_b16 v[98:99], v14 offset:34816
v_fmac_f32 v167, v50, v255
v_mfma_f32_16x16x32_bf16 v[112:115], v[72:75], a[80:83], v[112:115]
ds_read_b64_tr_b16 v[100:101], v14 offset:36864
v_mul_f32 v164, v244, v164
v_mfma_f32_16x16x32_bf16 v[112:115], v[76:79], a[88:91], v[112:115]
ds_read_b64_tr_b16 v[102:103], v14 offset:38912
v_mul_f32 v165, v245, v165
v_mfma_f32_16x16x32_bf16 v[116:119], v[76:79], a[92:95], v[116:119]
ds_read_b64_tr_b16 v[104:105], v14 offset:40960
v_mul_f32 v166, v246, v166
v_mul_f32 v167, v247, v167
v_mfma_f32_16x16x32_bf16 v[116:119], v[72:75], a[84:87], v[116:119]
ds_read_b64_tr_b16 v[106:107], v14 offset:43008
v_cvt_pk_bf16_f32 v236, v164, v165
v_mfma_f32_16x16x32_bf16 v[116:119], v[68:71], a[76:79], v[116:119]
ds_read_b64_tr_b16 v[108:109], v14 offset:45056
v_cvt_pk_bf16_f32 v237, v166, v167
v_fmac_f32 v172, v51, v252
v_mfma_f32_16x16x32_bf16 v[116:119], v[64:67], a[68:71], v[116:119]
s_waitcnt lgkmcnt(7)
ds_read_b64_tr_b16 v[110:111], v14 offset:47104
v_fmac_f32 v173, v51, v253
v_mfma_f32_16x16x32_bf16 v[124:127], v[80:83], a[68:71], v[124:127]
ds_read_b64_tr_b16 v[64:65], v15 offset:32768
buffer_load_dwordx4 v31, s[8:11], s42 offen offset:3072 sc1 lds
v_mfma_f32_16x16x32_bf16 v[124:127], v[84:87], a[76:79], v[124:127]
ds_read_b64_tr_b16 v[66:67], v15 offset:34816
v_fmac_f32 v174, v51, v254
v_mfma_f32_16x16x32_bf16 v[124:127], v[88:91], a[84:87], v[124:127]
ds_read_b64_tr_b16 v[68:69], v15 offset:36864
v_fmac_f32 v175, v51, v255
v_mfma_f32_16x16x32_bf16 v[124:127], v[92:95], a[92:95], v[124:127]
ds_read_b64_tr_b16 v[70:71], v15 offset:38912
v_mul_f32 v172, v244, v172
v_mfma_f32_16x16x32_bf16 v[120:123], v[92:95], a[88:91], v[120:123]
ds_read_b64_tr_b16 v[72:73], v15 offset:40960
v_mul_f32 v173, v245, v173
v_mul_f32 v174, v246, v174
v_mfma_f32_16x16x32_bf16 v[120:123], v[88:91], a[80:83], v[120:123]
ds_read_b64_tr_b16 v[74:75], v15 offset:43008
v_mul_f32 v175, v247, v175
v_mfma_f32_16x16x32_bf16 v[120:123], v[84:87], a[72:75], v[120:123]
ds_read_b64_tr_b16 v[76:77], v15 offset:45056
v_cvt_pk_bf16_f32 v238, v172, v173
v_cvt_pk_bf16_f32 v239, v174, v175
v_mfma_f32_16x16x32_bf16 v[120:123], v[80:83], a[64:67], v[120:123]
s_waitcnt lgkmcnt(7)
ds_read_b64_tr_b16 v[78:79], v15 offset:47104
v_permlane16_swap_b32 v232, v234
v_mfma_f32_16x16x32_bf16 v[128:131], v[96:99], a[64:67], v[128:131]
s_add_u32 m0, s41, 114688
ds_read_b64_tr_b16 v[80:81], v12 offset:49152
s_mul_i32 s42, s55, 96
v_mfma_f32_16x16x32_bf16 v[128:131], v[100:103], a[72:75], v[128:131]
ds_read_b64_tr_b16 v[82:83], v12 offset:51200
buffer_load_dwordx4 v28, s[8:11], s42 offen sc1 lds
v_mfma_f32_16x16x32_bf16 v[128:131], v[104:107], a[80:83], v[128:131]
ds_read_b64_tr_b16 v[84:85], v12 offset:53248
v_permlane16_swap_b32 v233, v235
v_mfma_f32_16x16x32_bf16 v[128:131], v[108:111], a[88:91], v[128:131]
ds_read_b64_tr_b16 v[86:87], v12 offset:55296
v_permlane16_swap_b32 v236, v238
v_mfma_f32_16x16x32_bf16 v[132:135], v[108:111], a[92:95], v[132:135]
ds_read_b64_tr_b16 v[88:89], v12 offset:57344
v_permlane16_swap_b32 v237, v239
v_mfma_f32_16x16x32_bf16 v[132:135], v[104:107], a[84:87], v[132:135]
ds_read_b64_tr_b16 v[90:91], v12 offset:59392
v_permlane32_swap_b32 v232, v234
v_mfma_f32_16x16x32_bf16 v[132:135], v[100:103], a[76:79], v[132:135]
ds_read_b64_tr_b16 v[92:93], v12 offset:61440
v_permlane32_swap_b32 v233, v235
v_permlane32_swap_b32 v236, v238
v_mfma_f32_16x16x32_bf16 v[132:135], v[96:99], a[68:71], v[132:135]
s_waitcnt lgkmcnt(7)
ds_read_b64_tr_b16 v[94:95], v12 offset:63488
v_permlane32_swap_b32 v237, v239
v_mfma_f32_16x16x32_bf16 v[140:143], v[64:67], a[68:71], v[140:143]
ds_read_b64_tr_b16 v[96:97], v13 offset:49152
buffer_load_dwordx4 v29, s[8:11], s42 offen offset:1024 sc1 lds
v_mfma_f32_16x16x32_bf16 v[140:143], v[68:71], a[76:79], v[140:143]
ds_read_b64_tr_b16 v[98:99], v13 offset:51200
v_mfma_f32_16x16x32_bf16 v[140:143], v[72:75], a[84:87], v[140:143]
ds_read_b64_tr_b16 v[100:101], v13 offset:53248
buffer_store_dwordx4 v[232:235], v2, s[4:7], s72 offen offset:2048 sc1
v_mfma_f32_16x16x32_bf16 v[140:143], v[76:79], a[92:95], v[140:143]
ds_read_b64_tr_b16 v[102:103], v13 offset:55296
v_mfma_f32_16x16x32_bf16 v[136:139], v[76:79], a[88:91], v[136:139]
ds_read_b64_tr_b16 v[104:105], v13 offset:57344
v_mfma_f32_16x16x32_bf16 v[136:139], v[72:75], a[80:83], v[136:139]
ds_read_b64_tr_b16 v[106:107], v13 offset:59392
buffer_store_dwordx4 v[236:239], v2, s[4:7], s72 offen offset:3072 sc1
v_mfma_f32_16x16x32_bf16 v[136:139], v[68:71], a[72:75], v[136:139]
ds_read_b64_tr_b16 v[108:109], v13 offset:61440
v_mfma_f32_16x16x32_bf16 v[136:139], v[64:67], a[64:67], v[136:139]
s_waitcnt lgkmcnt(7)
ds_read_b64_tr_b16 v[110:111], v13 offset:63488
v_mfma_f32_16x16x32_bf16 v[112:115], v[80:83], a[96:99], v[112:115]
ds_read_b64_tr_b16 v[64:65], v14 offset:49152
buffer_load_dwordx4 v30, s[8:11], s42 offen offset:2048 sc1 lds
v_mfma_f32_16x16x32_bf16 v[112:115], v[84:87], a[104:107], v[112:115]
ds_read_b64_tr_b16 v[66:67], v14 offset:51200
v_mov_b32 v27, 0xf149f2ca
v_mfma_f32_16x16x32_bf16 v[112:115], v[88:91], a[112:115], v[112:115]
s_mov_b32 vcc_lo, 0
ds_read_b64_tr_b16 v[68:69], v14 offset:53248
s_mov_b32 vcc_hi, 15
v_mfma_f32_16x16x32_bf16 v[112:115], v[92:95], a[120:123], v[112:115]
ds_read_b64_tr_b16 v[70:71], v14 offset:55296
v_cndmask_b32 v144, 0, v27, vcc
v_mfma_f32_16x16x32_bf16 v[116:119], v[92:95], a[124:127], v[116:119]
ds_read_b64_tr_b16 v[72:73], v14 offset:57344
v_cndmask_b32_e64 v160, v27, 0, vcc
v_mfma_f32_16x16x32_bf16 v[116:119], v[88:91], a[116:119], v[116:119]
ds_read_b64_tr_b16 v[74:75], v14 offset:59392
v_mfma_f32_16x16x32_bf16 v[116:119], v[84:87], a[108:111], v[116:119]
ds_read_b64_tr_b16 v[76:77], v14 offset:61440
v_mfma_f32_16x16x32_bf16 v[116:119], v[80:83], a[100:103], v[116:119]
s_waitcnt lgkmcnt(7)
ds_read_b64_tr_b16 v[78:79], v14 offset:63488
v_mfma_f32_16x16x32_bf16 v[124:127], v[96:99], a[100:103], v[124:127]
ds_read_b64_tr_b16 v[80:81], v15 offset:49152
buffer_load_dwordx4 v31, s[8:11], s42 offen offset:3072 sc1 lds
v_mfma_f32_16x16x32_bf16 v[124:127], v[100:103], a[108:111], v[124:127]
ds_read_b64_tr_b16 v[82:83], v15 offset:51200
s_waitcnt vmcnt(10)
v_readfirstlane_b32 s45, v25
s_nop 0
s_cmp_lt_u32 s45, 2
s_cbranch_scc1 Lslow3021
Lback3022:
v_mfma_f32_16x16x32_bf16 v[124:127], v[104:107], a[116:119], v[124:127]
ds_read_b64_tr_b16 v[84:85], v15 offset:53248
v_mfma_f32_16x16x32_bf16 v[124:127], v[108:111], a[124:127], v[124:127]
ds_read_b64_tr_b16 v[86:87], v15 offset:55296
v_mfma_f32_16x16x32_bf16 v[120:123], v[108:111], a[120:123], v[120:123]
ds_read_b64_tr_b16 v[88:89], v15 offset:57344
v_mfma_f32_16x16x32_bf16 v[120:123], v[104:107], a[112:115], v[120:123]
ds_read_b64_tr_b16 v[90:91], v15 offset:59392
v_mfma_f32_16x16x32_bf16 v[120:123], v[100:103], a[104:107], v[120:123]
ds_read_b64_tr_b16 v[92:93], v15 offset:61440
v_mfma_f32_16x16x32_bf16 v[120:123], v[96:99], a[96:99], v[120:123]
s_waitcnt lgkmcnt(7)
s_barrier
ds_read_b64_tr_b16 v[94:95], v15 offset:63488
v_mfma_f32_16x16x32_bf16 v[128:131], v[64:67], a[96:99], v[128:131]
s_add_u32 m0, s62, 0
ds_read_b64_tr_b16 v[96:97], v16 offset:0
s_mov_b32 vcc_lo, 1
v_mfma_f32_16x16x32_bf16 v[128:131], v[68:71], a[104:107], v[128:131]
s_mov_b32 vcc_hi, 31
ds_read_b64_tr_b16 v[98:99], v16 offset:2048
v_cndmask_b32 v145, 0, v27, vcc
v_mfma_f32_16x16x32_bf16 v[128:131], v[72:75], a[112:115], v[128:131]
ds_read_b64_tr_b16 v[100:101], v16 offset:4096
v_cndmask_b32_e64 v161, v27, 0, vcc
v_mfma_f32_16x16x32_bf16 v[128:131], v[76:79], a[120:123], v[128:131]
ds_read_b64_tr_b16 v[102:103], v16 offset:6144
buffer_load_dwordx4 v10, s[4:7], s60 offen sc1 lds
v_mfma_f32_16x16x32_bf16 v[132:135], v[76:79], a[124:127], v[132:135]
ds_read_b64_tr_b16 v[104:105], v16 offset:8192
v_mfma_f32_16x16x32_bf16 v[132:135], v[72:75], a[116:119], v[132:135]
ds_read_b64_tr_b16 v[106:107], v16 offset:10240
v_mfma_f32_16x16x32_bf16 v[132:135], v[68:71], a[108:111], v[132:135]
ds_read_b64_tr_b16 v[108:109], v16 offset:12288
v_mfma_f32_16x16x32_bf16 v[132:135], v[64:67], a[100:103], v[132:135]
s_waitcnt lgkmcnt(7)
ds_read_b64_tr_b16 v[110:111], v16 offset:14336
v_mfma_f32_16x16x32_bf16 v[140:143], v[80:83], a[100:103], v[140:143]
ds_read_b64_tr_b16 v[64:65], v17 offset:0
buffer_load_dwordx4 v10, s[4:7], s60 offen offset:1024 sc1 lds
v_mfma_f32_16x16x32_bf16 v[140:143], v[84:87], a[108:111], v[140:143]
s_mov_b32 vcc_lo, 3
ds_read_b64_tr_b16 v[66:67], v17 offset:2048
s_mov_b32 vcc_hi, 63
v_mfma_f32_16x16x32_bf16 v[140:143], v[88:91], a[116:119], v[140:143]
ds_read_b64_tr_b16 v[68:69], v17 offset:4096
v_cndmask_b32 v146, 0, v27, vcc
v_mfma_f32_16x16x32_bf16 v[140:143], v[92:95], a[124:127], v[140:143]
ds_read_b64_tr_b16 v[70:71], v17 offset:6144
v_cndmask_b32_e64 v162, v27, 0, vcc
v_mfma_f32_16x16x32_bf16 v[136:139], v[92:95], a[120:123], v[136:139]
ds_read_b64_tr_b16 v[72:73], v17 offset:8192
v_mfma_f32_16x16x32_bf16 v[136:139], v[88:91], a[112:115], v[136:139]
ds_read_b64_tr_b16 v[74:75], v17 offset:10240
v_mfma_f32_16x16x32_bf16 v[136:139], v[84:87], a[104:107], v[136:139]
ds_read_b64_tr_b16 v[76:77], v17 offset:12288
v_mfma_f32_16x16x32_bf16 v[136:139], v[80:83], a[96:99], v[136:139]
s_waitcnt lgkmcnt(7)
ds_read_b64_tr_b16 v[78:79], v17 offset:14336
v_mfma_f32_16x16x32_bf16 v[112:115], v[96:99], a[128:131], v[112:115]
ds_read_b64_tr_b16 v[80:81], v18 offset:0
buffer_load_dwordx4 v10, s[4:7], s60 offen offset:2048 sc1 lds
v_mfma_f32_16x16x32_bf16 v[112:115], v[100:103], a[136:139], v[112:115]
s_mov_b32 vcc_lo, 7
ds_read_b64_tr_b16 v[82:83], v18 offset:2048
s_mov_b32 vcc_hi, 127
v_mfma_f32_16x16x32_bf16 v[112:115], v[104:107], a[144:147], v[112:115]
ds_read_b64_tr_b16 v[84:85], v18 offset:4096
v_cndmask_b32 v147, 0, v27, vcc
v_mfma_f32_16x16x32_bf16 v[112:115], v[108:111], a[152:155], v[112:115]
ds_read_b64_tr_b16 v[86:87], v18 offset:6144
v_cndmask_b32_e64 v163, v27, 0, vcc
v_mfma_f32_16x16x32_bf16 v[116:119], v[108:111], a[156:159], v[116:119]
s_mov_b32 vcc_lo, 255
ds_read_b64_tr_b16 v[88:89], v18 offset:8192
s_mov_b32 vcc_hi, 4095
v_mfma_f32_16x16x32_bf16 v[116:119], v[104:107], a[148:151], v[116:119]
ds_read_b64_tr_b16 v[90:91], v18 offset:10240
v_cndmask_b32 v148, 0, v27, vcc
v_mfma_f32_16x16x32_bf16 v[116:119], v[100:103], a[140:143], v[116:119]
ds_read_b64_tr_b16 v[92:93], v18 offset:12288
v_cndmask_b32_e64 v164, v27, 0, vcc
v_mfma_f32_16x16x32_bf16 v[116:119], v[96:99], a[132:135], v[116:119]
s_waitcnt lgkmcnt(7)
ds_read_b64_tr_b16 v[94:95], v18 offset:14336
v_mfma_f32_16x16x32_bf16 v[124:127], v[64:67], a[132:135], v[124:127]
ds_read_b64_tr_b16 v[96:97], v19 offset:0
buffer_load_dwordx4 v10, s[4:7], s60 offen offset:3072 sc1 lds
v_mfma_f32_16x16x32_bf16 v[124:127], v[68:71], a[140:143], v[124:127]
s_mov_b32 vcc_lo, 511
ds_read_b64_tr_b16 v[98:99], v19 offset:2048
s_mov_b32 vcc_hi, 8191
v_mfma_f32_16x16x32_bf16 v[124:127], v[72:75], a[148:151], v[124:127]
ds_read_b64_tr_b16 v[100:101], v19 offset:4096
v_cndmask_b32 v149, 0, v27, vcc
v_mfma_f32_16x16x32_bf16 v[124:127], v[76:79], a[156:159], v[124:127]
ds_read_b64_tr_b16 v[102:103], v19 offset:6144
v_cndmask_b32_e64 v165, v27, 0, vcc
v_mfma_f32_16x16x32_bf16 v[120:123], v[76:79], a[152:155], v[120:123]
ds_read_b64_tr_b16 v[104:105], v19 offset:8192
v_mfma_f32_16x16x32_bf16 v[120:123], v[72:75], a[144:147], v[120:123]
ds_read_b64_tr_b16 v[106:107], v19 offset:10240
v_mfma_f32_16x16x32_bf16 v[120:123], v[68:71], a[136:139], v[120:123]
ds_read_b64_tr_b16 v[108:109], v19 offset:12288
v_mfma_f32_16x16x32_bf16 v[120:123], v[64:67], a[128:131], v[120:123]
s_waitcnt lgkmcnt(7)
ds_read_b64_tr_b16 v[110:111], v19 offset:14336
v_mfma_f32_16x16x32_bf16 v[128:131], v[80:83], a[128:131], v[128:131]
s_waitcnt vmcnt(6)
ds_read_b64_tr_b16 v[64:65], v16 offset:16384
buffer_atomic_add v26, v11, s[4:7], s75 offen offset:8 sc1
v_mfma_f32_16x16x32_bf16 v[128:131], v[84:87], a[136:139], v[128:131]
s_add_u32 m0, s62, 4096
ds_read_b64_tr_b16 v[66:67], v16 offset:18432
v_mfma_f32_16x16x32_bf16 v[128:131], v[88:91], a[144:147], v[128:131]
ds_read_b64_tr_b16 v[68:69], v16 offset:20480
v_mfma_f32_16x16x32_bf16 v[128:131], v[92:95], a[152:155], v[128:131]
ds_read_b64_tr_b16 v[70:71], v16 offset:22528
v_mfma_f32_16x16x32_bf16 v[132:135], v[92:95], a[156:159], v[132:135]
ds_read_b64_tr_b16 v[72:73], v16 offset:24576
buffer_load_dwordx4 v10, s[4:7], s61 offen sc1 lds
v_mfma_f32_16x16x32_bf16 v[132:135], v[88:91], a[148:151], v[132:135]
ds_read_b64_tr_b16 v[74:75], v16 offset:26624
v_mfma_f32_16x16x32_bf16 v[132:135], v[84:87], a[140:143], v[132:135]
ds_read_b64_tr_b16 v[76:77], v16 offset:28672
v_mfma_f32_16x16x32_bf16 v[132:135], v[80:83], a[132:135], v[132:135]
s_waitcnt lgkmcnt(7)
ds_read_b64_tr_b16 v[78:79], v16 offset:30720
v_mfma_f32_16x16x32_bf16 v[140:143], v[96:99], a[132:135], v[140:143]
ds_read_b64_tr_b16 v[80:81], v17 offset:16384
buffer_load_dwordx4 v10, s[4:7], s61 offen offset:1024 sc1 lds
v_mfma_f32_16x16x32_bf16 v[140:143], v[100:103], a[140:143], v[140:143]
s_mov_b32 vcc_lo, 1023
ds_read_b64_tr_b16 v[82:83], v17 offset:18432
s_mov_b32 vcc_hi, 16383
v_mfma_f32_16x16x32_bf16 v[140:143], v[104:107], a[148:151], v[140:143]
ds_read_b64_tr_b16 v[84:85], v17 offset:20480
v_cndmask_b32 v150, 0, v27, vcc
v_mfma_f32_16x16x32_bf16 v[140:143], v[108:111], a[156:159], v[140:143]
ds_read_b64_tr_b16 v[86:87], v17 offset:22528
v_cndmask_b32_e64 v166, v27, 0, vcc
v_mfma_f32_16x16x32_bf16 v[136:139], v[108:111], a[152:155], v[136:139]
s_mov_b32 vcc_lo, 2047
ds_read_b64_tr_b16 v[88:89], v17 offset:24576
s_mov_b32 vcc_hi, 32767
v_mfma_f32_16x16x32_bf16 v[136:139], v[104:107], a[144:147], v[136:139]
ds_read_b64_tr_b16 v[90:91], v17 offset:26624
v_cndmask_b32 v151, 0, v27, vcc
v_mfma_f32_16x16x32_bf16 v[136:139], v[100:103], a[136:139], v[136:139]
ds_read_b64_tr_b16 v[92:93], v17 offset:28672
v_cndmask_b32_e64 v167, v27, 0, vcc
v_mfma_f32_16x16x32_bf16 v[136:139], v[96:99], a[128:131], v[136:139]
s_waitcnt lgkmcnt(7)
ds_read_b64_tr_b16 v[94:95], v17 offset:30720
v_mfma_f32_16x16x32_bf16 v[112:115], v[64:67], a[160:163], v[112:115]
ds_read_b64_tr_b16 v[96:97], v18 offset:16384
buffer_load_dwordx4 v10, s[4:7], s61 offen offset:2048 sc1 lds
v_mfma_f32_16x16x32_bf16 v[112:115], v[68:71], a[168:171], v[112:115]
s_mov_b32 vcc_lo, 65535
ds_read_b64_tr_b16 v[98:99], v18 offset:18432
s_mov_b32 vcc_hi, 1048575
v_mfma_f32_16x16x32_bf16 v[112:115], v[72:75], a[176:179], v[112:115]
ds_read_b64_tr_b16 v[100:101], v18 offset:20480
v_cndmask_b32 v152, 0, v27, vcc
v_mfma_f32_16x16x32_bf16 v[112:115], v[76:79], a[184:187], v[112:115]
ds_read_b64_tr_b16 v[102:103], v18 offset:22528
v_cndmask_b32_e64 v168, v27, 0, vcc
v_mfma_f32_16x16x32_bf16 v[116:119], v[76:79], a[188:191], v[116:119]
ds_read_b64_tr_b16 v[104:105], v18 offset:24576
v_mfma_f32_16x16x32_bf16 v[116:119], v[72:75], a[180:183], v[116:119]
ds_read_b64_tr_b16 v[106:107], v18 offset:26624
v_mfma_f32_16x16x32_bf16 v[116:119], v[68:71], a[172:175], v[116:119]
ds_read_b64_tr_b16 v[108:109], v18 offset:28672
v_mfma_f32_16x16x32_bf16 v[116:119], v[64:67], a[164:167], v[116:119]
s_waitcnt lgkmcnt(7)
ds_read_b64_tr_b16 v[110:111], v18 offset:30720
v_mfma_f32_16x16x32_bf16 v[124:127], v[80:83], a[164:167], v[124:127]
ds_read_b64_tr_b16 v[64:65], v19 offset:16384
buffer_load_dwordx4 v10, s[4:7], s61 offen offset:3072 sc1 lds
v_mfma_f32_16x16x32_bf16 v[124:127], v[84:87], a[172:175], v[124:127]
ds_read_b64_tr_b16 v[66:67], v19 offset:18432
v_mov_b32 v25, 0
v_mfma_f32_16x16x32_bf16 v[124:127], v[88:91], a[180:183], v[124:127]
ds_read_b64_tr_b16 v[68:69], v19 offset:20480
v_mfma_f32_16x16x32_bf16 v[124:127], v[92:95], a[188:191], v[124:127]
ds_read_b64_tr_b16 v[70:71], v19 offset:22528
v_mfma_f32_16x16x32_bf16 v[120:123], v[92:95], a[184:187], v[120:123]
ds_read_b64_tr_b16 v[72:73], v19 offset:24576
buffer_atomic_add v25, v11, s[4:7], s44 offen offset:8 sc0 sc1
v_mfma_f32_16x16x32_bf16 v[120:123], v[88:91], a[176:179], v[120:123]
ds_read_b64_tr_b16 v[74:75], v19 offset:26624
v_mfma_f32_16x16x32_bf16 v[120:123], v[84:87], a[168:171], v[120:123]
ds_read_b64_tr_b16 v[76:77], v19 offset:28672
v_mfma_f32_16x16x32_bf16 v[120:123], v[80:83], a[160:163], v[120:123]
s_waitcnt vmcnt(10) lgkmcnt(7)
s_barrier
ds_read_b64_tr_b16 v[78:79], v19 offset:30720
v_mfma_f32_16x16x32_bf16 v[128:131], v[96:99], a[160:163], v[128:131]
ds_read_b64_tr_b16 v[80:81], v16 offset:32768
ds_write_b128 v32, v[208:211] offset:32768
v_mfma_f32_16x16x32_bf16 v[128:131], v[100:103], a[168:171], v[128:131]
s_mov_b32 vcc_lo, 131071
ds_read_b64_tr_b16 v[82:83], v16 offset:34816
s_mov_b32 vcc_hi, 2097151
v_mfma_f32_16x16x32_bf16 v[128:131], v[104:107], a[176:179], v[128:131]
ds_read_b64_tr_b16 v[84:85], v16 offset:36864
v_cndmask_b32 v153, 0, v27, vcc
v_mfma_f32_16x16x32_bf16 v[128:131], v[108:111], a[184:187], v[128:131]
ds_read_b64_tr_b16 v[86:87], v16 offset:38912
v_cndmask_b32_e64 v169, v27, 0, vcc
v_mfma_f32_16x16x32_bf16 v[132:135], v[108:111], a[188:191], v[132:135]
s_mov_b32 vcc_lo, 262143
ds_read_b64_tr_b16 v[88:89], v16 offset:40960
s_mov_b32 vcc_hi, 4194303
v_mfma_f32_16x16x32_bf16 v[132:135], v[104:107], a[180:183], v[132:135]
ds_read_b64_tr_b16 v[90:91], v16 offset:43008
v_cndmask_b32 v154, 0, v27, vcc
v_mfma_f32_16x16x32_bf16 v[132:135], v[100:103], a[172:175], v[132:135]
ds_read_b64_tr_b16 v[92:93], v16 offset:45056
v_cndmask_b32_e64 v170, v27, 0, vcc
v_mfma_f32_16x16x32_bf16 v[132:135], v[96:99], a[164:167], v[132:135]
s_waitcnt lgkmcnt(8)
ds_read_b64_tr_b16 v[94:95], v16 offset:47104
v_mfma_f32_16x16x32_bf16 v[140:143], v[64:67], a[164:167], v[140:143]
ds_read_b64_tr_b16 v[96:97], v17 offset:32768
ds_write_b128 v32, v[212:215] offset:33792
v_mfma_f32_16x16x32_bf16 v[140:143], v[68:71], a[172:175], v[140:143]
s_mov_b32 vcc_lo, 524287
ds_read_b64_tr_b16 v[98:99], v17 offset:34816
s_mov_b32 vcc_hi, 8388607
v_mfma_f32_16x16x32_bf16 v[140:143], v[72:75], a[180:183], v[140:143]
ds_read_b64_tr_b16 v[100:101], v17 offset:36864
v_cndmask_b32 v155, 0, v27, vcc
v_mfma_f32_16x16x32_bf16 v[140:143], v[76:79], a[188:191], v[140:143]
ds_read_b64_tr_b16 v[102:103], v17 offset:38912
v_cndmask_b32_e64 v171, v27, 0, vcc
v_mfma_f32_16x16x32_bf16 v[136:139], v[76:79], a[184:187], v[136:139]
s_mov_b32 vcc_lo, 16777215
ds_read_b64_tr_b16 v[104:105], v17 offset:40960
s_mov_b32 vcc_hi, 268435455
v_mfma_f32_16x16x32_bf16 v[136:139], v[72:75], a[176:179], v[136:139]
ds_read_b64_tr_b16 v[106:107], v17 offset:43008
v_cndmask_b32 v156, 0, v27, vcc
v_mfma_f32_16x16x32_bf16 v[136:139], v[68:71], a[168:171], v[136:139]
ds_read_b64_tr_b16 v[108:109], v17 offset:45056
v_cndmask_b32_e64 v172, v27, 0, vcc
v_mfma_f32_16x16x32_bf16 v[136:139], v[64:67], a[160:163], v[136:139]
s_waitcnt lgkmcnt(8)
ds_read_b64_tr_b16 v[110:111], v17 offset:47104
v_mfma_f32_16x16x32_bf16 v[112:115], v[80:83], a[192:195], v[112:115]
ds_read_b64_tr_b16 v[64:65], v18 offset:32768
ds_write_b128 v32, v[216:219] offset:34816
v_mfma_f32_16x16x32_bf16 v[112:115], v[84:87], a[200:203], v[112:115]
s_mov_b32 vcc_lo, 33554431
ds_read_b64_tr_b16 v[66:67], v18 offset:34816
s_mov_b32 vcc_hi, 536870911
v_mfma_f32_16x16x32_bf16 v[112:115], v[88:91], a[208:211], v[112:115]
ds_read_b64_tr_b16 v[68:69], v18 offset:36864
v_cndmask_b32 v157, 0, v27, vcc
v_mfma_f32_16x16x32_bf16 v[112:115], v[92:95], a[216:219], v[112:115]
ds_read_b64_tr_b16 v[70:71], v18 offset:38912
v_cndmask_b32_e64 v173, v27, 0, vcc
v_mfma_f32_16x16x32_bf16 v[116:119], v[92:95], a[220:223], v[116:119]
ds_read_b64_tr_b16 v[72:73], v18 offset:40960
ds_read_b128 v[48:51], v5 offset:512
v_mfma_f32_16x16x32_bf16 v[116:119], v[88:91], a[212:215], v[116:119]
ds_read_b64_tr_b16 v[74:75], v18 offset:43008
ds_read_b128 v[52:55], v5 offset:576
v_mfma_f32_16x16x32_bf16 v[116:119], v[84:87], a[204:207], v[116:119]
ds_read_b64_tr_b16 v[76:77], v18 offset:45056
v_mfma_f32_16x16x32_bf16 v[116:119], v[80:83], a[196:199], v[116:119]
s_waitcnt lgkmcnt(10)
ds_read_b64_tr_b16 v[78:79], v18 offset:47104
v_mfma_f32_16x16x32_bf16 v[124:127], v[96:99], a[196:199], v[124:127]
ds_read_b64_tr_b16 v[80:81], v19 offset:32768
ds_write_b128 v32, v[220:223] offset:35840
v_mfma_f32_16x16x32_bf16 v[124:127], v[100:103], a[204:207], v[124:127]
s_mov_b32 vcc_lo, 67108863
ds_read_b64_tr_b16 v[82:83], v19 offset:34816
s_mov_b32 vcc_hi, 1073741823
v_mfma_f32_16x16x32_bf16 v[124:127], v[104:107], a[212:215], v[124:127]
ds_read_b64_tr_b16 v[84:85], v19 offset:36864
v_cndmask_b32 v158, 0, v27, vcc
v_mfma_f32_16x16x32_bf16 v[124:127], v[108:111], a[220:223], v[124:127]
ds_read_b64_tr_b16 v[86:87], v19 offset:38912
v_cndmask_b32_e64 v174, v27, 0, vcc
v_mfma_f32_16x16x32_bf16 v[120:123], v[108:111], a[216:219], v[120:123]
ds_read_b64_tr_b16 v[88:89], v19 offset:40960
ds_read_b128 v[56:59], v5 offset:640
v_mfma_f32_16x16x32_bf16 v[120:123], v[104:107], a[208:211], v[120:123]
ds_read_b64_tr_b16 v[90:91], v19 offset:43008
ds_read_b128 v[60:63], v5 offset:704
v_mfma_f32_16x16x32_bf16 v[120:123], v[100:103], a[200:203], v[120:123]
ds_read_b64_tr_b16 v[92:93], v19 offset:45056
v_mfma_f32_16x16x32_bf16 v[120:123], v[96:99], a[192:195], v[120:123]
s_waitcnt vmcnt(1) lgkmcnt(8)
s_barrier
ds_read_b64_tr_b16 v[94:95], v19 offset:47104
v_mfma_f32_16x16x32_bf16 v[128:131], v[64:67], a[192:195], v[128:131]
ds_read_b64_tr_b16 v[96:97], v16 offset:49152
s_waitcnt vmcnt(0)
v_readfirstlane_b32 s45, v25
s_nop 0
s_cmp_lt_u32 s45, 2
s_cbranch_scc1 Lslow3023
Lback3024:
v_mfma_f32_16x16x32_bf16 v[128:131], v[68:71], a[200:203], v[128:131]
s_add_u32 m0, s62, 49152
ds_read_b64_tr_b16 v[98:99], v16 offset:51200
buffer_load_dwordx4 v2, s[4:7], s60 offen sc1 lds
v_mfma_f32_16x16x32_bf16 v[128:131], v[72:75], a[208:211], v[128:131]
ds_read_b64_tr_b16 v[100:101], v16 offset:53248
ds_write_b128 v35, v[224:227] offset:32768
v_mfma_f32_16x16x32_bf16 v[128:131], v[76:79], a[216:219], v[128:131]
ds_read_b64_tr_b16 v[102:103], v16 offset:55296
ds_write_b128 v35, v[228:231] offset:33792
v_mfma_f32_16x16x32_bf16 v[132:135], v[76:79], a[220:223], v[132:135]
ds_read_b64_tr_b16 v[104:105], v16 offset:57344
v_mfma_f32_16x16x32_bf16 v[132:135], v[72:75], a[212:215], v[132:135]
ds_read_b64_tr_b16 v[106:107], v16 offset:59392
v_mfma_f32_16x16x32_bf16 v[132:135], v[68:71], a[204:207], v[132:135]
ds_read_b64_tr_b16 v[108:109], v16 offset:61440
v_mfma_f32_16x16x32_bf16 v[132:135], v[64:67], a[196:199], v[132:135]
s_waitcnt lgkmcnt(9)
ds_read_b64_tr_b16 v[110:111], v16 offset:63488
v_mfma_f32_16x16x32_bf16 v[140:143], v[80:83], a[196:199], v[140:143]
ds_read_b64_tr_b16 v[64:65], v17 offset:49152
buffer_load_dwordx4 v2, s[4:7], s60 offen offset:1024 sc1 lds
v_mfma_f32_16x16x32_bf16 v[140:143], v[84:87], a[204:207], v[140:143]
ds_read_b64_tr_b16 v[66:67], v17 offset:51200
v_mfma_f32_16x16x32_bf16 v[140:143], v[88:91], a[212:215], v[140:143]
ds_read_b64_tr_b16 v[68:69], v17 offset:53248
v_mfma_f32_16x16x32_bf16 v[140:143], v[92:95], a[220:223], v[140:143]
ds_read_b64_tr_b16 v[70:71], v17 offset:55296
v_mfma_f32_16x16x32_bf16 v[136:139], v[92:95], a[216:219], v[136:139]
ds_read_b64_tr_b16 v[72:73], v17 offset:57344
buffer_load_dwordx4 v2, s[4:7], s60 offen offset:2048 sc1 lds
v_mfma_f32_16x16x32_bf16 v[136:139], v[88:91], a[208:211], v[136:139]
ds_read_b64_tr_b16 v[74:75], v17 offset:59392
ds_write_b128 v35, v[232:235] offset:34816
v_mfma_f32_16x16x32_bf16 v[136:139], v[84:87], a[200:203], v[136:139]
ds_read_b64_tr_b16 v[76:77], v17 offset:61440
v_mfma_f32_16x16x32_bf16 v[136:139], v[80:83], a[192:195], v[136:139]
s_waitcnt lgkmcnt(8)
ds_read_b64_tr_b16 v[78:79], v17 offset:63488
v_mfma_f32_16x16x32_bf16 v[112:115], v[96:99], a[224:227], v[112:115]
ds_read_b64_tr_b16 v[80:81], v18 offset:49152
buffer_load_dwordx4 v2, s[4:7], s60 offen offset:3072 sc1 lds
v_mfma_f32_16x16x32_bf16 v[112:115], v[100:103], a[232:235], v[112:115]
s_mov_b32 vcc_lo, 134217727
ds_read_b64_tr_b16 v[82:83], v18 offset:51200
s_mov_b32 vcc_hi, 2147483647
v_mfma_f32_16x16x32_bf16 v[112:115], v[104:107], a[240:243], v[112:115]
ds_read_b64_tr_b16 v[84:85], v18 offset:53248
v_cndmask_b32 v159, 0, v27, vcc
v_mfma_f32_16x16x32_bf16 v[112:115], v[108:111], a[248:251], v[112:115]
ds_read_b64_tr_b16 v[86:87], v18 offset:55296
v_cndmask_b32_e64 v175, v27, 0, vcc
v_mfma_f32_16x16x32_bf16 v[116:119], v[108:111], a[252:255], v[116:119]
ds_read_b64_tr_b16 v[88:89], v18 offset:57344
ds_write_b128 v35, v[236:239] offset:35840
v_mfma_f32_16x16x32_bf16 v[116:119], v[104:107], a[244:247], v[116:119]
ds_read_b64_tr_b16 v[90:91], v18 offset:59392
v_mfma_f32_16x16x32_bf16 v[116:119], v[100:103], a[236:239], v[116:119]
ds_read_b64_tr_b16 v[92:93], v18 offset:61440
v_mfma_f32_16x16x32_bf16 v[116:119], v[96:99], a[228:231], v[116:119]
s_waitcnt lgkmcnt(8)
ds_read_b64_tr_b16 v[94:95], v18 offset:63488
v_mfma_f32_16x16x32_bf16 v[124:127], v[64:67], a[228:231], v[124:127]
s_add_u32 m0, s62, 53248
ds_read_b64_tr_b16 v[96:97], v19 offset:49152
v_mul_f32 v40, 0x3e8293ee, v40
v_mfma_f32_16x16x32_bf16 v[124:127], v[68:71], a[236:239], v[124:127]
ds_read_b64_tr_b16 v[98:99], v19 offset:51200
buffer_load_dwordx4 v2, s[4:7], s61 offen sc1 lds
v_mfma_f32_16x16x32_bf16 v[124:127], v[72:75], a[244:247], v[124:127]
ds_read_b64_tr_b16 v[100:101], v19 offset:53248
v_mul_f32 v41, 0x3e8293ee, v41
v_mfma_f32_16x16x32_bf16 v[124:127], v[76:79], a[252:255], v[124:127]
ds_read_b64_tr_b16 v[102:103], v19 offset:55296
ds_read_b128 a[0:3], v32 offset:0
v_mfma_f32_16x16x32_bf16 v[120:123], v[76:79], a[248:251], v[120:123]
ds_read_b64_tr_b16 v[104:105], v19 offset:57344
ds_read_b128 a[4:7], v32 offset:1024
v_mfma_f32_16x16x32_bf16 v[120:123], v[72:75], a[240:243], v[120:123]
ds_read_b64_tr_b16 v[106:107], v19 offset:59392
ds_read_b128 a[8:11], v32 offset:4096
v_mfma_f32_16x16x32_bf16 v[120:123], v[68:71], a[232:235], v[120:123]
ds_read_b64_tr_b16 v[108:109], v19 offset:61440
ds_read_b128 a[12:15], v32 offset:5120
ds_read_b128 a[16:19], v32 offset:8192
ds_read_b128 a[20:23], v32 offset:9216
v_mfma_f32_16x16x32_bf16 v[120:123], v[64:67], a[224:227], v[120:123]
s_waitcnt lgkmcnt(13)
ds_read_b64_tr_b16 v[110:111], v19 offset:63488
v_mfma_f32_16x16x32_bf16 v[128:131], v[80:83], a[224:227], v[128:131]
buffer_load_dwordx4 v2, s[4:7], s61 offen offset:1024 sc1 lds
v_mfma_f32_16x16x32_bf16 v[128:131], v[84:87], a[232:235], v[128:131]
buffer_load_dwordx4 v2, s[4:7], s61 offen offset:2048 sc1 lds
v_mfma_f32_16x16x32_bf16 v[128:131], v[88:91], a[240:243], v[128:131]
s_branch Lso8
Lst8:
s_setpc_b64 s[42:43]
Lso8:
ds_read_b128 a[24:27], v32 offset:12288
ds_read_b128 a[28:31], v32 offset:13312
ds_read_b128 a[32:35], v32 offset:16384
v_mfma_f32_16x16x32_bf16 v[128:131], v[92:95], a[248:251], v[128:131]
ds_read_b128 a[36:39], v32 offset:17408
ds_read_b128 a[40:43], v32 offset:20480
v_mfma_f32_16x16x32_bf16 v[132:135], v[92:95], a[252:255], v[132:135]
v_fmac_f32 v112, v48, v42
v_fmac_f32 v113, v49, v42
v_fmac_f32 v114, v50, v42
v_mfma_f32_16x16x32_bf16 v[132:135], v[88:91], a[244:247], v[132:135]
v_fmac_f32 v115, v51, v42
v_mul_f32 v112, v40, v112
v_mfma_f32_16x16x32_bf16 v[132:135], v[84:87], a[236:239], v[132:135]
v_mul_f32 v113, v40, v113
v_mul_f32 v114, v40, v114
v_mul_f32 v115, v40, v115
v_mfma_f32_16x16x32_bf16 v[132:135], v[80:83], a[228:231], v[132:135]
s_waitcnt lgkmcnt(5)
v_cvt_pk_bf16_f32 v240, v112, v113
v_cvt_pk_bf16_f32 v241, v114, v115
v_mfma_f32_16x16x32_bf16 v[140:143], v[96:99], a[228:231], v[140:143]
buffer_load_dwordx4 v2, s[4:7], s61 offen offset:3072 sc1 lds
v_mfma_f32_16x16x32_bf16 v[140:143], v[100:103], a[236:239], v[140:143]
ds_read_b128 a[44:47], v32 offset:21504
ds_read_b128 a[48:51], v32 offset:24576
v_mfma_f32_16x16x32_bf16 v[140:143], v[104:107], a[244:247], v[140:143]
ds_read_b128 a[52:55], v32 offset:25600
ds_read_b128 a[56:59], v32 offset:28672
v_mfma_f32_16x16x32_bf16 v[140:143], v[108:111], a[252:255], v[140:143]
ds_read_b128 a[60:63], v32 offset:29696
v_fmac_f32 v120, v52, v42
v_mfma_f32_16x16x32_bf16 v[136:139], v[108:111], a[248:251], v[136:139]
v_fmac_f32 v121, v53, v42
v_fmac_f32 v122, v54, v42
v_mfma_f32_16x16x32_bf16 v[136:139], v[104:107], a[240:243], v[136:139]
v_fmac_f32 v123, v55, v42
v_mul_f32 v120, v40, v120
v_mfma_f32_16x16x32_bf16 v[136:139], v[100:103], a[232:235], v[136:139]
v_mul_f32 v121, v40, v121
v_mul_f32 v122, v40, v122
v_mul_f32 v123, v40, v123
v_mfma_f32_16x16x32_bf16 v[136:139], v[96:99], a[224:227], v[136:139]
v_cvt_pk_bf16_f32 v242, v120, v121
v_cvt_pk_bf16_f32 v243, v122, v123
v_fmac_f32 v116, v48, v43
v_fmac_f32 v117, v49, v43
v_fmac_f32 v118, v50, v43
v_fmac_f32 v119, v51, v43
v_mul_f32 v116, v41, v116
v_mul_f32 v117, v41, v117
v_mul_f32 v118, v41, v118
v_mul_f32 v119, v41, v119
v_cvt_pk_bf16_f32 v244, v116, v117
v_cvt_pk_bf16_f32 v245, v118, v119
v_fmac_f32 v124, v52, v43
v_fmac_f32 v125, v53, v43
v_fmac_f32 v126, v54, v43
v_fmac_f32 v127, v55, v43
v_mul_f32 v124, v41, v124
v_mul_f32 v125, v41, v125
v_mul_f32 v126, v41, v126
v_mul_f32 v127, v41, v127
v_cvt_pk_bf16_f32 v246, v124, v125
v_cvt_pk_bf16_f32 v247, v126, v127
v_permlane16_swap_b32 v240, v244
v_permlane16_swap_b32 v241, v245
v_permlane16_swap_b32 v242, v246
v_permlane16_swap_b32 v243, v247
s_nop 1
v_mfma_f32_32x32x16_bf16 v[80:95], a[0:3], v[240:243], v[160:175]
v_fmac_f32 v128, v56, v42
v_fmac_f32 v129, v57, v42
v_fmac_f32 v130, v58, v42
v_fmac_f32 v131, v59, v42
v_mul_f32 v128, v40, v128
v_mul_f32 v129, v40, v129
v_mul_f32 v130, v40, v130
v_mfma_f32_32x32x16_bf16 v[80:95], a[4:7], v[244:247], v[80:95]
v_mul_f32 v131, v40, v131
v_cvt_pk_bf16_f32 v248, v128, v129
v_cvt_pk_bf16_f32 v249, v130, v131
v_fmac_f32 v136, v60, v42
v_fmac_f32 v137, v61, v42
v_fmac_f32 v138, v62, v42
v_fmac_f32 v139, v63, v42
v_mul_f32 v136, v40, v136
v_mul_f32 v137, v40, v137
v_mul_f32 v138, v40, v138
v_mul_f32 v139, v40, v139
v_cvt_pk_bf16_f32 v250, v136, v137
v_cvt_pk_bf16_f32 v251, v138, v139
v_fmac_f32 v132, v56, v43
v_fmac_f32 v133, v57, v43
v_fmac_f32 v134, v58, v43
v_fmac_f32 v135, v59, v43
v_mul_f32 v132, v41, v132
v_mul_f32 v133, v41, v133
v_mul_f32 v134, v41, v134
v_mul_f32 v135, v41, v135
v_cvt_pk_bf16_f32 v252, v132, v133
v_cvt_pk_bf16_f32 v253, v134, v135
v_fmac_f32 v140, v60, v43
v_fmac_f32 v141, v61, v43
v_fmac_f32 v142, v62, v43
v_fmac_f32 v143, v63, v43
v_mul_f32 v140, v41, v140
v_mul_f32 v141, v41, v141
v_mul_f32 v142, v41, v142
v_mul_f32 v143, v41, v143
v_cvt_pk_bf16_f32 v254, v140, v141
v_cvt_pk_bf16_f32 v255, v142, v143
v_permlane16_swap_b32 v248, v252
v_permlane16_swap_b32 v249, v253
v_permlane16_swap_b32 v250, v254
v_permlane16_swap_b32 v251, v255
s_cmp_eq_u32 s77, 0
s_cbranch_scc1 Lz3025
v_mov_b32 v48, 0
v_mov_b32 v49, 0
v_mov_b32 v50, 0
v_mov_b32 v51, 0
v_mov_b32 v52, 0
v_mov_b32 v53, 0
v_mov_b32 v54, 0
v_mov_b32 v55, 0
v_mov_b32 v56, 0
v_mov_b32 v57, 0
v_mov_b32 v58, 0
v_mov_b32 v59, 0
v_mov_b32 v60, 0
v_mov_b32 v61, 0
v_mov_b32 v62, 0
v_mov_b32 v63, 0
Lz3025:
v_mfma_f32_32x32x16_bf16 v[96:111], a[8:11], v[240:243], 0
s_waitcnt vmcnt(0) lgkmcnt(0)
s_barrier
s_add_u32 s79, s70, 32768
ds_read_b128 a[64:67], v35 offset:0
ds_read_b128 a[68:71], v35 offset:1024
ds_read_b128 a[72:75], v35 offset:4096
ds_read_b128 a[76:79], v35 offset:5120
v_exp_f32 v80, v80
v_exp_f32 v81, v81
v_exp_f32 v82, v82
v_mfma_f32_32x32x16_bf16 v[96:111], a[12:15], v[244:247], v[96:111]
s_bfe_i64 exec, s[96:97], 0x10000
v_exp_f32 v83, v83
v_exp_f32 v84, v84
v_exp_f32 v85, v85
v_exp_f32 v86, v86
v_exp_f32 v87, v87
v_exp_f32 v88, v88
v_exp_f32 v89, v89
v_exp_f32 v90, v90
v_exp_f32 v91, v91
v_exp_f32 v92, v92
v_exp_f32 v93, v93
v_exp_f32 v94, v94
v_exp_f32 v95, v95
v_cvt_pk_bf16_f32 v48, v80, v81
v_cvt_pk_bf16_f32 v49, v82, v83
v_cvt_pk_bf16_f32 v50, v84, v85
v_cvt_pk_bf16_f32 v51, v86, v87
v_cvt_pk_bf16_f32 v52, v88, v89
v_cvt_pk_bf16_f32 v53, v90, v91
v_cvt_pk_bf16_f32 v54, v92, v93
v_cvt_pk_bf16_f32 v55, v94, v95
v_mfma_f32_32x32x16_bf16 v[80:95], a[16:19], v[240:243], 0
s_mov_b64 exec, -1
v_add_u32 v28, 65536, v21
v_add_u32 v29, 72704, v21
v_add_u32 v30, 79872, v21
v_add_u32 v31, 87040, v21
s_add_u32 m0, s41, 98304
s_mul_i32 s42, s58, 64
buffer_load_dwordx4 v28, s[12:15], s42 offen sc1 lds
ds_read_b128 a[80:83], v35 offset:8192
ds_read_b128 a[84:87], v35 offset:9216
v_exp_f32 v96, v96
v_exp_f32 v97, v97
v_exp_f32 v98, v98
v_mfma_f32_32x32x16_bf16 v[80:95], a[20:23], v[244:247], v[80:95]
s_waitcnt lgkmcnt(4)
buffer_load_dwordx4 v29, s[12:15], s42 offen offset:1024 sc1 lds
ds_read_b128 a[88:91], v35 offset:12288
ds_read_b128 a[92:95], v35 offset:13312
v_exp_f32 v99, v99
v_exp_f32 v100, v100
v_exp_f32 v101, v101
v_mfma_f32_32x32x16_bf16 v[112:127], a[64:67], v[48:51], 0
ds_read_b128 a[96:99], v35 offset:16384
v_exp_f32 v102, v102
v_exp_f32 v103, v103
v_exp_f32 v104, v104
v_mfma_f32_32x32x16_bf16 v[112:127], a[68:71], v[52:55], v[112:127]
buffer_load_dwordx4 v30, s[12:15], s42 offen offset:2048 sc1 lds
ds_read_b128 a[100:103], v35 offset:17408
ds_read_b128 a[104:107], v35 offset:20480
v_exp_f32 v105, v105
v_exp_f32 v106, v106
v_exp_f32 v107, v107
v_mfma_f32_16x16x32_bf16 v[44:47], v[36:39], v[48:51], 0
ds_read_b128 a[108:111], v35 offset:21504
v_exp_f32 v108, v108
v_exp_f32 v109, v109
v_mfma_f32_16x16x32_bf16 v[44:47], v[36:39], v[52:55], v[44:47]
s_bfe_i64 exec, s[96:97], 0x10001
v_exp_f32 v110, v110
v_exp_f32 v111, v111
v_cvt_pk_bf16_f32 v56, v96, v97
v_cvt_pk_bf16_f32 v57, v98, v99
v_cvt_pk_bf16_f32 v58, v100, v101
v_cvt_pk_bf16_f32 v59, v102, v103
v_cvt_pk_bf16_f32 v60, v104, v105
v_cvt_pk_bf16_f32 v61, v106, v107
v_cvt_pk_bf16_f32 v62, v108, v109
v_cvt_pk_bf16_f32 v63, v110, v111
v_mfma_f32_32x32x16_bf16 v[96:111], a[24:27], v[240:243], 0
s_mov_b64 exec, -1
buffer_load_dwordx4 v31, s[12:15], s42 offen offset:3072 sc1 lds
ds_read_b128 a[112:115], v35 offset:24576
ds_read_b128 a[116:119], v35 offset:25600
v_exp_f32 v80, v80
v_exp_f32 v81, v81
v_exp_f32 v82, v82
v_mfma_f32_32x32x16_bf16 v[96:111], a[28:31], v[244:247], v[96:111]
s_waitcnt lgkmcnt(10)
s_add_u32 m0, s41, 114688
s_mul_i32 s42, s59, 64
buffer_load_dwordx4 v28, s[12:15], s42 offen sc1 lds
ds_read_b128 a[120:123], v35 offset:28672
v_exp_f32 v83, v83
v_exp_f32 v84, v84
v_exp_f32 v85, v85
v_mfma_f32_32x32x16_bf16 v[112:127], a[72:75], v[56:59], v[112:127]
ds_read_b128 a[124:127], v35 offset:29696
ds_read_b128 a[128:131], v32 offset:2048
v_exp_f32 v86, v86
v_exp_f32 v87, v87
v_exp_f32 v88, v88
v_mfma_f32_32x32x16_bf16 v[112:127], a[76:79], v[60:63], v[112:127]
buffer_load_dwordx4 v29, s[12:15], s42 offen offset:1024 sc1 lds
ds_read_b128 a[132:135], v32 offset:3072
v_exp_f32 v89, v89
v_exp_f32 v90, v90
v_exp_f32 v91, v91
v_mfma_f32_16x16x32_bf16 v[44:47], v[36:39], v[56:59], v[44:47]
ds_read_b128 a[136:139], v32 offset:6144
v_exp_f32 v92, v92
v_exp_f32 v93, v93
v_mfma_f32_16x16x32_bf16 v[44:47], v[36:39], v[60:63], v[44:47]
s_bfe_i64 exec, s[96:97], 0x10002
v_exp_f32 v94, v94
v_exp_f32 v95, v95
v_cvt_pk_bf16_f32 v48, v80, v81
v_cvt_pk_bf16_f32 v49, v82, v83
v_cvt_pk_bf16_f32 v50, v84, v85
v_cvt_pk_bf16_f32 v51, v86, v87
v_cvt_pk_bf16_f32 v52, v88, v89
v_cvt_pk_bf16_f32 v53, v90, v91
v_cvt_pk_bf16_f32 v54, v92, v93
v_cvt_pk_bf16_f32 v55, v94, v95
v_mfma_f32_32x32x16_bf16 v[80:95], a[32:35], v[240:243], 0
s_mov_b64 exec, -1
buffer_load_dwordx4 v30, s[12:15], s42 offen offset:2048 sc1 lds
ds_read_b128 a[140:143], v32 offset:7168
ds_read_b128 a[144:147], v32 offset:10240
v_exp_f32 v96, v96
v_exp_f32 v97, v97
v_exp_f32 v98, v98
v_mfma_f32_32x32x16_bf16 v[80:95], a[36:39], v[244:247], v[80:95]
s_waitcnt lgkmcnt(14)
buffer_load_dwordx4 v31, s[12:15], s42 offen offset:3072 sc1 lds
ds_read_b128 a[148:151], v32 offset:11264
v_exp_f32 v99, v99
v_exp_f32 v100, v100
v_exp_f32 v101, v101
v_mfma_f32_32x32x16_bf16 v[112:127], a[80:83], v[48:51], v[112:127]
ds_read_b128 a[152:155], v32 offset:14336
ds_read_b128 a[156:159], v32 offset:15360
v_exp_f32 v102, v102
v_exp_f32 v103, v103
v_exp_f32 v104, v104
v_mfma_f32_32x32x16_bf16 v[112:127], a[84:87], v[52:55], v[112:127]
s_cmp_lg_u32 s40, 0
s_cbranch_scc1 Lc03026
s_mov_b32 s3, m0
s_lshl_b32 s45, s39, 4
v_lshrrev_b32 v0, 7, v1
v_add_u32 v0, s45, v0
v_mul_u32_u24 v0, 7168, v0
v_and_b32 v33, 112, v1
v_add_u32 v0, v0, v33
s_lshl_b32 s46, s38, 7
s_add_u32 m0, s87, 2048
s_add_u32 s45, s46, 2048
buffer_load_dwordx4 v0, s[16:19], s45 offen lds
s_add_u32 m0, s87, 3072
s_add_u32 s45, s46, 59392
buffer_load_dwordx4 v0, s[16:19], s45 offen lds
s_add_u32 m0, s87, 4096
s_add_u32 s45, s46, 4096
buffer_load_dwordx4 v0, s[16:19], s45 offen lds
s_add_u32 m0, s87, 5120
s_add_u32 s45, s46, 61440
buffer_load_dwordx4 v0, s[16:19], s45 offen lds
s_lshl_b32 s45, s39, 4
v_lshrrev_b32 v0, 6, v1
v_add_u32 v0, s45, v0
v_mul_u32_u24 v0, 7168, v0
v_and_b32 v33, 48, v1
v_add_u32 v0, v0, v33
s_lshl_b32 s46, s38, 6
s_add_u32 m0, s87, 6144
s_add_u32 s45, s46, 6144
buffer_load_dwordx4 v0, s[16:19], s45 offen lds
s_mov_b32 m0, s3
Lc03026:
ds_read_b128 a[160:163], v32 offset:18432
v_exp_f32 v105, v105
v_exp_f32 v106, v106
v_exp_f32 v107, v107
v_mfma_f32_16x16x32_bf16 v[44:47], v[36:39], v[48:51], v[44:47]
ds_read_b128 a[164:167], v32 offset:19456
v_exp_f32 v108, v108
v_exp_f32 v109, v109
v_mfma_f32_16x16x32_bf16 v[44:47], v[36:39], v[52:55], v[44:47]
s_bfe_i64 exec, s[96:97], 0x10003
v_exp_f32 v110, v110
v_exp_f32 v111, v111
v_cvt_pk_bf16_f32 v56, v96, v97
v_cvt_pk_bf16_f32 v57, v98, v99
v_cvt_pk_bf16_f32 v58, v100, v101
v_cvt_pk_bf16_f32 v59, v102, v103
v_cvt_pk_bf16_f32 v60, v104, v105
v_cvt_pk_bf16_f32 v61, v106, v107
v_cvt_pk_bf16_f32 v62, v108, v109
v_cvt_pk_bf16_f32 v63, v110, v111
v_mfma_f32_32x32x16_bf16 v[96:111], a[40:43], v[240:243], 0
s_mov_b64 exec, -1
ds_read_b128 a[168:171], v32 offset:22528
ds_read_b128 a[172:175], v32 offset:23552
v_exp_f32 v80, v80
v_exp_f32 v81, v81
v_exp_f32 v82, v82
v_mfma_f32_32x32x16_bf16 v[96:111], a[44:47], v[244:247], v[96:111]
s_waitcnt lgkmcnt(14)
ds_read_b128 a[176:179], v32 offset:26624
ds_read_b128 a[180:183], v32 offset:27648
v_exp_f32 v83, v83
v_exp_f32 v84, v84
v_exp_f32 v85, v85
v_mfma_f32_32x32x16_bf16 v[112:127], a[88:91], v[56:59], v[112:127]
ds_read_b128 a[184:187], v32 offset:30720
v_exp_f32 v86, v86
v_exp_f32 v87, v87
v_exp_f32 v88, v88
v_mfma_f32_32x32x16_bf16 v[112:127], a[92:95], v[60:63], v[112:127]
ds_read_b128 a[188:191], v32 offset:31744
ds_read_b128 a[192:195], v35 offset:2048
v_exp_f32 v89, v89
v_exp_f32 v90, v90
v_exp_f32 v91, v91
v_mfma_f32_16x16x32_bf16 v[44:47], v[36:39], v[56:59], v[44:47]
ds_read_b128 a[196:199], v35 offset:3072
v_exp_f32 v92, v92
v_exp_f32 v93, v93
v_mfma_f32_16x16x32_bf16 v[44:47], v[36:39], v[60:63], v[44:47]
s_bfe_i64 exec, s[96:97], 0x10004
v_exp_f32 v94, v94
v_exp_f32 v95, v95
v_cvt_pk_bf16_f32 v48, v80, v81
v_cvt_pk_bf16_f32 v49, v82, v83
v_cvt_pk_bf16_f32 v50, v84, v85
v_cvt_pk_bf16_f32 v51, v86, v87
v_cvt_pk_bf16_f32 v52, v88, v89
v_cvt_pk_bf16_f32 v53, v90, v91
v_cvt_pk_bf16_f32 v54, v92, v93
v_cvt_pk_bf16_f32 v55, v94, v95
v_mfma_f32_32x32x16_bf16 v[80:95], a[48:51], v[240:243], 0
s_mov_b64 exec, -1
ds_read_b128 a[200:203], v35 offset:6144
ds_read_b128 a[204:207], v35 offset:7168
v_exp_f32 v96, v96
v_exp_f32 v97, v97
v_exp_f32 v98, v98
v_mfma_f32_32x32x16_bf16 v[80:95], a[52:55], v[244:247], v[80:95]
ds_read_b128 a[208:211], v35 offset:10240
v_exp_f32 v99, v99
v_exp_f32 v100, v100
v_exp_f32 v101, v101
v_mfma_f32_32x32x16_bf16 v[112:127], a[96:99], v[48:51], v[112:127]
ds_read_b128 a[212:215], v35 offset:11264
ds_read_b128 a[216:219], v35 offset:14336
v_exp_f32 v102, v102
v_exp_f32 v103, v103
v_exp_f32 v104, v104
v_mfma_f32_32x32x16_bf16 v[112:127], a[100:103], v[52:55], v[112:127]
ds_read_b128 a[220:223], v35 offset:15360
v_exp_f32 v105, v105
v_exp_f32 v106, v106
v_exp_f32 v107, v107
v_mfma_f32_16x16x32_bf16 v[44:47], v[36:39], v[48:51], v[44:47]
ds_read_b128 a[224:227], v35 offset:18432
v_exp_f32 v108, v108
v_exp_f32 v109, v109
v_mfma_f32_16x16x32_bf16 v[44:47], v[36:39], v[52:55], v[44:47]
s_bfe_i64 exec, s[96:97], 0x10005
v_exp_f32 v110, v110
v_exp_f32 v111, v111
v_cvt_pk_bf16_f32 v56, v96, v97
v_cvt_pk_bf16_f32 v57, v98, v99
v_cvt_pk_bf16_f32 v58, v100, v101
v_cvt_pk_bf16_f32 v59, v102, v103
v_cvt_pk_bf16_f32 v60, v104, v105
v_cvt_pk_bf16_f32 v61, v106, v107
v_cvt_pk_bf16_f32 v62, v108, v109
v_cvt_pk_bf16_f32 v63, v110, v111
v_mfma_f32_32x32x16_bf16 v[96:111], a[56:59], v[240:243], 0
s_mov_b64 exec, -1
ds_read_b128 a[228:231], v35 offset:19456
ds_read_b128 a[232:235], v35 offset:22528
v_exp_f32 v80, v80
v_exp_f32 v81, v81
v_exp_f32 v82, v82
v_mfma_f32_32x32x16_bf16 v[96:111], a[60:63], v[244:247], v[96:111]
ds_read_b128 a[236:239], v35 offset:23552
v_exp_f32 v83, v83
v_exp_f32 v84, v84
v_exp_f32 v85, v85
v_mfma_f32_32x32x16_bf16 v[112:127], a[104:107], v[56:59], v[112:127]
ds_read_b128 a[240:243], v35 offset:26624
ds_read_b128 a[244:247], v35 offset:27648
v_exp_f32 v86, v86
v_exp_f32 v87, v87
v_exp_f32 v88, v88
v_mfma_f32_32x32x16_bf16 v[112:127], a[108:111], v[60:63], v[112:127]
ds_read_b128 a[248:251], v35 offset:30720
v_exp_f32 v89, v89
v_exp_f32 v90, v90
v_exp_f32 v91, v91
v_mfma_f32_16x16x32_bf16 v[44:47], v[36:39], v[56:59], v[44:47]
ds_read_b128 a[252:255], v35 offset:31744
v_exp_f32 v92, v92
v_exp_f32 v93, v93
v_mfma_f32_16x16x32_bf16 v[44:47], v[36:39], v[60:63], v[44:47]
s_bfe_i64 exec, s[96:97], 0x10006
v_exp_f32 v94, v94
v_exp_f32 v95, v95
v_cvt_pk_bf16_f32 v48, v80, v81
v_cvt_pk_bf16_f32 v49, v82, v83
v_cvt_pk_bf16_f32 v50, v84, v85
v_cvt_pk_bf16_f32 v51, v86, v87
v_cvt_pk_bf16_f32 v52, v88, v89
v_cvt_pk_bf16_f32 v53, v90, v91
v_cvt_pk_bf16_f32 v54, v92, v93
v_cvt_pk_bf16_f32 v55, v94, v95
v_mfma_f32_32x32x16_bf16 v[80:95], v[208:211], v[240:243], v[144:159]
s_mov_b64 exec, -1
s_waitcnt lgkmcnt(0)
s_barrier
v_mov_b32 v28, v21
v_add_u32 v29, 7168, v21
v_add_u32 v30, 14336, v21
v_add_u32 v31, 21504, v21
s_add_u32 m0, s41, 0
s_mul_i32 s42, s56, 64
buffer_load_dwordx4 v28, s[12:15], s42 offen sc1 lds
v_exp_f32 v96, v96
v_exp_f32 v97, v97
v_exp_f32 v98, v98
v_mfma_f32_32x32x16_bf16 v[80:95], v[212:215], v[244:247], v[80:95]
buffer_load_dwordx4 v29, s[12:15], s42 offen offset:1024 sc1 lds
v_exp_f32 v99, v99
v_exp_f32 v100, v100
v_exp_f32 v101, v101
v_mfma_f32_32x32x16_bf16 v[112:127], a[112:115], v[48:51], v[112:127]
v_exp_f32 v102, v102
v_exp_f32 v103, v103
v_exp_f32 v104, v104
v_mfma_f32_32x32x16_bf16 v[112:127], a[116:119], v[52:55], v[112:127]
buffer_load_dwordx4 v30, s[12:15], s42 offen offset:2048 sc1 lds
v_exp_f32 v105, v105
v_exp_f32 v106, v106
v_exp_f32 v107, v107
v_mfma_f32_16x16x32_bf16 v[44:47], v[36:39], v[48:51], v[44:47]
v_exp_f32 v108, v108
v_exp_f32 v109, v109
v_mfma_f32_16x16x32_bf16 v[44:47], v[36:39], v[52:55], v[44:47]
s_bfe_i64 exec, s[96:97], 0x10007
v_exp_f32 v110, v110
v_exp_f32 v111, v111
v_cvt_pk_bf16_f32 v56, v96, v97
v_cvt_pk_bf16_f32 v57, v98, v99
v_cvt_pk_bf16_f32 v58, v100, v101
v_cvt_pk_bf16_f32 v59, v102, v103
v_cvt_pk_bf16_f32 v60, v104, v105
v_cvt_pk_bf16_f32 v61, v106, v107
v_cvt_pk_bf16_f32 v62, v108, v109
v_cvt_pk_bf16_f32 v63, v110, v111
v_mfma_f32_32x32x16_bf16 v[96:111], a[128:131], v[248:251], v[160:175]
s_mov_b64 exec, -1
buffer_load_dwordx4 v31, s[12:15], s42 offen offset:3072 sc1 lds
v_exp_f32 v80, v80
v_exp_f32 v81, v81
v_exp_f32 v82, v82
v_mfma_f32_32x32x16_bf16 v[96:111], a[132:135], v[252:255], v[96:111]
s_add_u32 m0, s41, 16384
s_mul_i32 s42, s57, 64
buffer_load_dwordx4 v28, s[12:15], s42 offen sc1 lds
v_exp_f32 v83, v83
v_exp_f32 v84, v84
v_exp_f32 v85, v85
v_mfma_f32_32x32x16_bf16 v[112:127], a[120:123], v[56:59], v[112:127]
buffer_load_dwordx4 v29, s[12:15], s42 offen offset:1024 sc1 lds
v_exp_f32 v86, v86
v_exp_f32 v87, v87
v_mfma_f32_32x32x16_bf16 v[112:127], a[124:127], v[60:63], v[112:127]
s_lshl_b32 s3, s38, 11
s_add_u32 s3, s3, s70
v_exp_f32 v88, v88
v_exp_f32 v89, v89
v_mfma_f32_16x16x32_bf16 v[44:47], v[36:39], v[56:59], v[44:47]
v_exp_f32 v90, v90
v_mfma_f32_16x16x32_bf16 v[44:47], v[36:39], v[60:63], v[44:47]
v_exp_f32 v91, v91
v_cvt_pk_bf16_f32 v48, v80, v81
v_cvt_pk_bf16_f32 v49, v82, v83
v_cvt_pk_bf16_f32 v50, v84, v85
v_cvt_pk_bf16_f32 v51, v86, v87
v_exp_f32 v92, v92
s_nop 0
v_mfma_f32_16x16x32_bf16 v[44:47], v[36:39], v[48:51], v[44:47]
v_exp_f32 v93, v93
v_mfma_f32_32x32x16_bf16 v[112:127], v[224:227], v[48:51], v[112:127]
v_exp_f32 v94, v94
v_exp_f32 v95, v95
v_cvt_pk_bf16_f32 v52, v88, v89
v_cvt_pk_bf16_f32 v53, v90, v91
v_cvt_pk_bf16_f32 v54, v92, v93
v_cvt_pk_bf16_f32 v55, v94, v95
s_nop 1
v_mfma_f32_16x16x32_bf16 v[44:47], v[36:39], v[52:55], v[44:47]
buffer_load_dwordx4 v30, s[12:15], s42 offen offset:2048 sc1 lds
v_exp_f32 v96, v96
v_mfma_f32_32x32x16_bf16 v[112:127], v[228:231], v[52:55], v[112:127]
buffer_load_dwordx4 v31, s[12:15], s42 offen offset:3072 sc1 lds
v_exp_f32 v97, v97
v_exp_f32 v98, v98
v_exp_f32 v99, v99
v_mfma_f32_32x32x16_bf16 v[80:95], a[136:139], v[248:251], 0
s_cmp_eq_u32 s77, 0
s_cbranch_scc1 Lz4027
v_mov_b32 v56, 0
v_mov_b32 v57, 0
v_mov_b32 v58, 0
v_mov_b32 v59, 0
v_mov_b32 v60, 0
v_mov_b32 v61, 0
v_mov_b32 v62, 0
v_mov_b32 v63, 0
Lz4027:
v_lshrrev_b32 v0, 23, v44
v_subrev_u32 v0, 67, v0
v_cmp_lt_u32 vcc, 119, v0
s_cbranch_vccnz Lfb0
Lfbr0:
v_rcp_f32 v27, v44
s_nop 0
v_mul_f32 v112, v27, v112
v_mul_f32 v113, v27, v113
v_mul_f32 v114, v27, v114
v_mul_f32 v115, v27, v115
v_mul_f32 v116, v27, v116
v_mul_f32 v117, v27, v117
v_mul_f32 v118, v27, v118
v_mul_f32 v119, v27, v119
v_mul_f32 v120, v27, v120
v_mul_f32 v121, v27, v121
v_mul_f32 v122, v27, v122
v_mul_f32 v123, v27, v123
v_mul_f32 v124, v27, v124
v_mul_f32 v125, v27, v125
v_mul_f32 v126, v27, v126
v_mul_f32 v127, v27, v127
v_cvt_pk_bf16_f32 v112, v112, v113
v_cvt_pk_bf16_f32 v113, v114, v115
v_cvt_pk_bf16_f32 v114, v116, v117
v_cvt_pk_bf16_f32 v115, v118, v119
v_cvt_pk_bf16_f32 v116, v120, v121
v_cvt_pk_bf16_f32 v117, v122, v123
v_cvt_pk_bf16_f32 v118, v124, v125
v_cvt_pk_bf16_f32 v119, v126, v127
v_permlane16_swap_b32 v112, v116
v_permlane16_swap_b32 v113, v117
v_permlane16_swap_b32 v114, v118
v_permlane16_swap_b32 v115, v119
buffer_store_dwordx4 v[112:115], v10, s[4:7], s3 offen sc1
buffer_store_dwordx4 v[116:119], v10, s[4:7], s3 offen offset:1024 sc1
v_exp_f32 v100, v100
v_exp_f32 v101, v101
v_exp_f32 v102, v102
v_mfma_f32_32x32x16_bf16 v[80:95], a[140:143], v[252:255], v[80:95]
s_bfe_i64 exec, s[96:97], 0x10000
v_exp_f32 v103, v103
v_exp_f32 v104, v104
v_exp_f32 v105, v105
v_exp_f32 v106, v106
v_exp_f32 v107, v107
v_exp_f32 v108, v108
v_exp_f32 v109, v109
v_exp_f32 v110, v110
v_exp_f32 v111, v111
v_cvt_pk_bf16_f32 v56, v96, v97
v_cvt_pk_bf16_f32 v57, v98, v99
v_cvt_pk_bf16_f32 v58, v100, v101
v_cvt_pk_bf16_f32 v59, v102, v103
v_cvt_pk_bf16_f32 v60, v104, v105
v_cvt_pk_bf16_f32 v61, v106, v107
v_cvt_pk_bf16_f32 v62, v108, v109
v_cvt_pk_bf16_f32 v63, v110, v111
v_mfma_f32_32x32x16_bf16 v[96:111], a[144:147], v[248:251], 0
s_mov_b64 exec, -1
s_add_u32 m0, s41, 32768
s_mul_i32 s42, s58, 64
buffer_load_dwordx4 v28, s[12:15], s42 offen sc1 lds
v_exp_f32 v80, v80
v_exp_f32 v81, v81
v_exp_f32 v82, v82
v_mfma_f32_32x32x16_bf16 v[96:111], a[148:151], v[252:255], v[96:111]
buffer_load_dwordx4 v29, s[12:15], s42 offen offset:1024 sc1 lds
v_exp_f32 v83, v83
v_exp_f32 v84, v84
v_exp_f32 v85, v85
v_mfma_f32_32x32x16_bf16 v[128:143], a[192:195], v[56:59], 0
buffer_load_dwordx4 v30, s[12:15], s42 offen offset:2048 sc1 lds
v_exp_f32 v86, v86
v_exp_f32 v87, v87
v_exp_f32 v88, v88
v_mfma_f32_32x32x16_bf16 v[128:143], a[196:199], v[60:63], v[128:143]
s_cmp_eq_u32 s77, 0
s_cbranch_scc1 Lz4028
v_mov_b32 v48, 0
v_mov_b32 v49, 0
v_mov_b32 v50, 0
v_mov_b32 v51, 0
v_mov_b32 v52, 0
v_mov_b32 v53, 0
v_mov_b32 v54, 0
v_mov_b32 v55, 0
Lz4028:
v_exp_f32 v89, v89
v_exp_f32 v90, v90
v_exp_f32 v91, v91
v_mfma_f32_16x16x32_bf16 v[44:47], v[36:39], v[56:59], 0
v_exp_f32 v92, v92
v_exp_f32 v93, v93
v_mfma_f32_16x16x32_bf16 v[44:47], v[36:39], v[60:63], v[44:47]
s_bfe_i64 exec, s[96:97], 0x10001
v_exp_f32 v94, v94
v_exp_f32 v95, v95
v_cvt_pk_bf16_f32 v48, v80, v81
v_cvt_pk_bf16_f32 v49, v82, v83
v_cvt_pk_bf16_f32 v50, v84, v85
v_cvt_pk_bf16_f32 v51, v86, v87
v_cvt_pk_bf16_f32 v52, v88, v89
v_cvt_pk_bf16_f32 v53, v90, v91
v_cvt_pk_bf16_f32 v54, v92, v93
v_cvt_pk_bf16_f32 v55, v94, v95
v_mfma_f32_32x32x16_bf16 v[80:95], a[152:155], v[248:251], 0
s_mov_b64 exec, -1
buffer_load_dwordx4 v31, s[12:15], s42 offen offset:3072 sc1 lds
v_exp_f32 v96, v96
v_exp_f32 v97, v97
v_exp_f32 v98, v98
v_mfma_f32_32x32x16_bf16 v[80:95], a[156:159], v[252:255], v[80:95]
s_add_u32 m0, s41, 49152
s_mul_i32 s42, s59, 64
buffer_load_dwordx4 v28, s[12:15], s42 offen sc1 lds
v_exp_f32 v99, v99
v_exp_f32 v100, v100
v_exp_f32 v101, v101
v_mfma_f32_32x32x16_bf16 v[128:143], a[200:203], v[48:51], v[128:143]
v_exp_f32 v102, v102
v_exp_f32 v103, v103
v_exp_f32 v104, v104
v_mfma_f32_32x32x16_bf16 v[128:143], a[204:207], v[52:55], v[128:143]
buffer_load_dwordx4 v29, s[12:15], s42 offen offset:1024 sc1 lds
v_exp_f32 v105, v105
v_exp_f32 v106, v106
v_exp_f32 v107, v107
v_mfma_f32_16x16x32_bf16 v[44:47], v[36:39], v[48:51], v[44:47]
v_exp_f32 v108, v108
v_exp_f32 v109, v109
v_mfma_f32_16x16x32_bf16 v[44:47], v[36:39], v[52:55], v[44:47]
s_bfe_i64 exec, s[96:97], 0x10002
v_exp_f32 v110, v110
v_exp_f32 v111, v111
v_cvt_pk_bf16_f32 v56, v96, v97
v_cvt_pk_bf16_f32 v57, v98, v99
v_cvt_pk_bf16_f32 v58, v100, v101
v_cvt_pk_bf16_f32 v59, v102, v103
v_cvt_pk_bf16_f32 v60, v104, v105
v_cvt_pk_bf16_f32 v61, v106, v107
s_branch Lso9
Lst9:
s_setpc_b64 s[42:43]
Lso9:
v_cvt_pk_bf16_f32 v62, v108, v109
v_cvt_pk_bf16_f32 v63, v110, v111
v_mfma_f32_32x32x16_bf16 v[96:111], a[160:163], v[248:251], 0
s_mov_b64 exec, -1
s_waitcnt vmcnt(6)
buffer_atomic_add v26, v11, s[4:7], s76 offen offset:12 sc1
v_exp_f32 v80, v80
v_exp_f32 v81, v81
v_exp_f32 v82, v82
v_mfma_f32_32x32x16_bf16 v[96:111], a[164:167], v[252:255], v[96:111]
buffer_load_dwordx4 v30, s[12:15], s42 offen offset:2048 sc1 lds
v_exp_f32 v83, v83
v_exp_f32 v84, v84
v_exp_f32 v85, v85
v_mfma_f32_32x32x16_bf16 v[128:143], a[208:211], v[56:59], v[128:143]
v_exp_f32 v86, v86
v_exp_f32 v87, v87
v_exp_f32 v88, v88
v_mfma_f32_32x32x16_bf16 v[128:143], a[212:215], v[60:63], v[128:143]
buffer_load_dwordx4 v31, s[12:15], s42 offen offset:3072 sc1 lds
v_exp_f32 v89, v89
v_exp_f32 v90, v90
v_exp_f32 v91, v91
v_mfma_f32_16x16x32_bf16 v[44:47], v[36:39], v[56:59], v[44:47]
v_exp_f32 v92, v92
v_exp_f32 v93, v93
v_mfma_f32_16x16x32_bf16 v[44:47], v[36:39], v[60:63], v[44:47]
s_bfe_i64 exec, s[96:97], 0x10003
v_exp_f32 v94, v94
v_exp_f32 v95, v95
v_cvt_pk_bf16_f32 v48, v80, v81
v_cvt_pk_bf16_f32 v49, v82, v83
v_cvt_pk_bf16_f32 v50, v84, v85
v_cvt_pk_bf16_f32 v51, v86, v87
v_cvt_pk_bf16_f32 v52, v88, v89
v_cvt_pk_bf16_f32 v53, v90, v91
v_cvt_pk_bf16_f32 v54, v92, v93
v_cvt_pk_bf16_f32 v55, v94, v95
v_mfma_f32_32x32x16_bf16 v[80:95], a[168:171], v[248:251], 0
s_mov_b64 exec, -1
v_add_u32 v28, 65536, v21
v_add_u32 v29, 72704, v21
v_add_u32 v30, 79872, v21
v_add_u32 v31, 87040, v21
s_add_u32 m0, s41, 65536
s_mul_i32 s42, s56, 64
buffer_load_dwordx4 v28, s[12:15], s42 offen sc1 lds
v_exp_f32 v96, v96
v_exp_f32 v97, v97
v_exp_f32 v98, v98
v_mfma_f32_32x32x16_bf16 v[80:95], a[172:175], v[252:255], v[80:95]
buffer_load_dwordx4 v29, s[12:15], s42 offen offset:1024 sc1 lds
v_exp_f32 v99, v99
v_exp_f32 v100, v100
v_exp_f32 v101, v101
v_mfma_f32_32x32x16_bf16 v[128:143], a[216:219], v[48:51], v[128:143]
v_exp_f32 v102, v102
v_exp_f32 v103, v103
v_exp_f32 v104, v104
v_mfma_f32_32x32x16_bf16 v[128:143], a[220:223], v[52:55], v[128:143]
buffer_load_dwordx4 v30, s[12:15], s42 offen offset:2048 sc1 lds
v_exp_f32 v105, v105
v_exp_f32 v106, v106
v_exp_f32 v107, v107
v_mfma_f32_16x16x32_bf16 v[44:47], v[36:39], v[48:51], v[44:47]
v_exp_f32 v108, v108
v_exp_f32 v109, v109
v_mfma_f32_16x16x32_bf16 v[44:47], v[36:39], v[52:55], v[44:47]
s_bfe_i64 exec, s[96:97], 0x10004
v_exp_f32 v110, v110
v_exp_f32 v111, v111
v_cvt_pk_bf16_f32 v56, v96, v97
v_cvt_pk_bf16_f32 v57, v98, v99
v_cvt_pk_bf16_f32 v58, v100, v101
v_cvt_pk_bf16_f32 v59, v102, v103
v_cvt_pk_bf16_f32 v60, v104, v105
v_cvt_pk_bf16_f32 v61, v106, v107
v_cvt_pk_bf16_f32 v62, v108, v109
v_cvt_pk_bf16_f32 v63, v110, v111
v_mfma_f32_32x32x16_bf16 v[96:111], a[176:179], v[248:251], 0
s_mov_b64 exec, -1
v_mov_b32 v25, 0
buffer_atomic_add v25, v11, s[4:7], s76 offen offset:12 sc0 sc1
v_exp_f32 v80, v80
v_exp_f32 v81, v81
v_exp_f32 v82, v82
v_mfma_f32_32x32x16_bf16 v[96:111], a[180:183], v[252:255], v[96:111]
buffer_load_dwordx4 v31, s[12:15], s42 offen offset:3072 sc1 lds
v_exp_f32 v83, v83
v_exp_f32 v84, v84
v_exp_f32 v85, v85
v_mfma_f32_32x32x16_bf16 v[128:143], a[224:227], v[56:59], v[128:143]
s_add_u32 m0, s41, 81920
s_mul_i32 s42, s57, 64
buffer_load_dwordx4 v28, s[12:15], s42 offen sc1 lds
v_exp_f32 v86, v86
v_exp_f32 v87, v87
v_exp_f32 v88, v88
v_mfma_f32_32x32x16_bf16 v[128:143], a[228:231], v[60:63], v[128:143]
buffer_load_dwordx4 v29, s[12:15], s42 offen offset:1024 sc1 lds
v_exp_f32 v89, v89
v_exp_f32 v90, v90
v_exp_f32 v91, v91
v_mfma_f32_16x16x32_bf16 v[44:47], v[36:39], v[56:59], v[44:47]
s_mul_i32 s45, s0, 7168
s_add_u32 s45, s45, s1
buffer_load_dword v3, v22, s[16:19], s45 offen
v_exp_f32 v92, v92
v_exp_f32 v93, v93
v_mfma_f32_16x16x32_bf16 v[44:47], v[36:39], v[60:63], v[44:47]
s_bfe_i64 exec, s[96:97], 0x10005
v_exp_f32 v94, v94
v_exp_f32 v95, v95
v_cvt_pk_bf16_f32 v48, v80, v81
v_cvt_pk_bf16_f32 v49, v82, v83
v_cvt_pk_bf16_f32 v50, v84, v85
v_cvt_pk_bf16_f32 v51, v86, v87
v_cvt_pk_bf16_f32 v52, v88, v89
v_cvt_pk_bf16_f32 v53, v90, v91
v_cvt_pk_bf16_f32 v54, v92, v93
v_cvt_pk_bf16_f32 v55, v94, v95
v_mfma_f32_32x32x16_bf16 v[80:95], a[184:187], v[248:251], 0
s_mov_b64 exec, -1
buffer_load_dwordx4 v30, s[12:15], s42 offen offset:2048 sc1 lds
v_exp_f32 v96, v96
v_exp_f32 v97, v97
v_exp_f32 v98, v98
v_mfma_f32_32x32x16_bf16 v[80:95], a[188:191], v[252:255], v[80:95]
v_exp_f32 v99, v99
v_exp_f32 v100, v100
v_exp_f32 v101, v101
v_mfma_f32_32x32x16_bf16 v[128:143], a[232:235], v[48:51], v[128:143]
buffer_load_dwordx4 v31, s[12:15], s42 offen offset:3072 sc1 lds
v_exp_f32 v102, v102
v_exp_f32 v103, v103
v_exp_f32 v104, v104
v_mfma_f32_32x32x16_bf16 v[128:143], a[236:239], v[52:55], v[128:143]
v_exp_f32 v105, v105
v_exp_f32 v106, v106
v_exp_f32 v107, v107
v_mfma_f32_16x16x32_bf16 v[44:47], v[36:39], v[48:51], v[44:47]
v_exp_f32 v108, v108
v_exp_f32 v109, v109
v_mfma_f32_16x16x32_bf16 v[44:47], v[36:39], v[52:55], v[44:47]
s_bfe_i64 exec, s[96:97], 0x10006
v_exp_f32 v110, v110
v_exp_f32 v111, v111
v_cvt_pk_bf16_f32 v56, v96, v97
v_cvt_pk_bf16_f32 v57, v98, v99
v_cvt_pk_bf16_f32 v58, v100, v101
v_cvt_pk_bf16_f32 v59, v102, v103
v_cvt_pk_bf16_f32 v60, v104, v105
v_cvt_pk_bf16_f32 v61, v106, v107
v_cvt_pk_bf16_f32 v62, v108, v109
v_cvt_pk_bf16_f32 v63, v110, v111
v_mfma_f32_32x32x16_bf16 v[96:111], v[216:219], v[248:251], v[144:159]
s_mov_b64 exec, -1
v_exp_f32 v80, v80
v_exp_f32 v81, v81
v_exp_f32 v82, v82
v_mfma_f32_32x32x16_bf16 v[96:111], v[220:223], v[252:255], v[96:111]
v_exp_f32 v83, v83
v_exp_f32 v84, v84
v_exp_f32 v85, v85
v_mfma_f32_32x32x16_bf16 v[128:143], a[240:243], v[56:59], v[128:143]
v_exp_f32 v86, v86
v_exp_f32 v87, v87
v_exp_f32 v88, v88
v_mfma_f32_32x32x16_bf16 v[128:143], a[244:247], v[60:63], v[128:143]
v_exp_f32 v89, v89
v_exp_f32 v90, v90
v_exp_f32 v91, v91
v_mfma_f32_16x16x32_bf16 v[44:47], v[36:39], v[56:59], v[44:47]
v_exp_f32 v92, v92
v_exp_f32 v93, v93
v_mfma_f32_16x16x32_bf16 v[44:47], v[36:39], v[60:63], v[44:47]
s_bfe_i64 exec, s[96:97], 0x10007
v_exp_f32 v94, v94
v_exp_f32 v95, v95
v_cvt_pk_bf16_f32 v48, v80, v81
v_cvt_pk_bf16_f32 v49, v82, v83
v_cvt_pk_bf16_f32 v50, v84, v85
v_cvt_pk_bf16_f32 v51, v86, v87
v_cvt_pk_bf16_f32 v52, v88, v89
v_cvt_pk_bf16_f32 v53, v90, v91
v_cvt_pk_bf16_f32 v54, v92, v93
v_cvt_pk_bf16_f32 v55, v94, v95
v_mfma_f32_32x32x16_bf16 v[128:143], a[248:251], v[48:51], v[128:143]
s_mov_b64 exec, -1
s_waitcnt vmcnt(6)
v_readfirstlane_b32 s45, v25
s_nop 0
s_cmp_lt_u32 s45, 16
s_cbranch_scc0 Lpok4030
Lpw4029:
v_mov_b32 v25, 0
buffer_atomic_add v25, v11, s[4:7], s76 offen offset:12 sc0 sc1
s_add_u32 s47, s47, 1
s_cmp_ge_u32 s47, 0x40000
s_cbranch_scc1 Lend
s_waitcnt vmcnt(0)
v_readfirstlane_b32 s45, v25
s_nop 0
s_cmp_lt_u32 s45, 16
s_cbranch_scc1 Lpw4029
Lpok4030:
s_add_u32 s43, s56, s70
buffer_load_dwordx4 a[0:3], v10, s[4:7], s43 offen sc1
v_exp_f32 v96, v96
v_exp_f32 v97, v97
v_exp_f32 v98, v98
v_mfma_f32_32x32x16_bf16 v[128:143], a[252:255], v[52:55], v[128:143]
buffer_load_dwordx4 a[4:7], v10, s[4:7], s43 offen offset:1024 sc1
v_exp_f32 v99, v99
v_exp_f32 v100, v100
v_exp_f32 v101, v101
v_mfma_f32_16x16x32_bf16 v[44:47], v[36:39], v[48:51], v[44:47]
buffer_load_dwordx4 a[8:11], v10, s[4:7], s43 offen offset:2048 sc1
v_exp_f32 v102, v102
v_exp_f32 v103, v103
v_mfma_f32_16x16x32_bf16 v[44:47], v[36:39], v[52:55], v[44:47]
v_exp_f32 v104, v104
v_cvt_pk_bf16_f32 v56, v96, v97
v_cvt_pk_bf16_f32 v57, v98, v99
v_cvt_pk_bf16_f32 v58, v100, v101
v_cvt_pk_bf16_f32 v59, v102, v103
v_exp_f32 v105, v105
s_nop 0
v_mfma_f32_16x16x32_bf16 v[44:47], v[36:39], v[56:59], v[44:47]
v_exp_f32 v106, v106
v_mfma_f32_32x32x16_bf16 v[128:143], v[232:235], v[56:59], v[128:143]
v_exp_f32 v107, v107
v_exp_f32 v108, v108
v_exp_f32 v109, v109
v_exp_f32 v110, v110
v_exp_f32 v111, v111
v_cvt_pk_bf16_f32 v60, v104, v105
v_cvt_pk_bf16_f32 v61, v106, v107
v_cvt_pk_bf16_f32 v62, v108, v109
v_cvt_pk_bf16_f32 v63, v110, v111
s_nop 1
v_mfma_f32_16x16x32_bf16 v[44:47], v[36:39], v[60:63], v[44:47]
s_lshl_b32 s3, s38, 11
s_add_u32 s3, s3, s79
v_mfma_f32_32x32x16_bf16 v[128:143], v[236:239], v[60:63], v[128:143]
buffer_load_dwordx4 a[12:15], v10, s[4:7], s43 offen offset:3072 sc1
buffer_load_dwordx4 a[16:19], v2, s[4:7], s43 offen sc1
buffer_load_dwordx4 a[20:23], v2, s[4:7], s43 offen offset:1024 sc1
s_nop 1
v_lshrrev_b32 v0, 23, v44
v_subrev_u32 v0, 67, v0
v_cmp_lt_u32 vcc, 119, v0
s_cbranch_vccnz Lfb1
Lfbr1:
v_rcp_f32 v27, v44
s_nop 1
v_mul_f32 v128, v27, v128
v_mul_f32 v129, v27, v129
v_mul_f32 v130, v27, v130
v_mul_f32 v131, v27, v131
v_mul_f32 v132, v27, v132
v_mul_f32 v133, v27, v133
v_mul_f32 v134, v27, v134
v_mul_f32 v135, v27, v135
v_mul_f32 v136, v27, v136
v_mul_f32 v137, v27, v137
v_mul_f32 v138, v27, v138
v_mul_f32 v139, v27, v139
v_mul_f32 v140, v27, v140
v_mul_f32 v141, v27, v141
v_mul_f32 v142, v27, v142
v_mul_f32 v143, v27, v143
v_cvt_pk_bf16_f32 v128, v128, v129
v_cvt_pk_bf16_f32 v129, v130, v131
v_cvt_pk_bf16_f32 v130, v132, v133
v_cvt_pk_bf16_f32 v131, v134, v135
v_cvt_pk_bf16_f32 v132, v136, v137
v_cvt_pk_bf16_f32 v133, v138, v139
v_cvt_pk_bf16_f32 v134, v140, v141
v_cvt_pk_bf16_f32 v135, v142, v143
v_permlane16_swap_b32 v128, v132
v_permlane16_swap_b32 v129, v133
v_permlane16_swap_b32 v130, v134
v_permlane16_swap_b32 v131, v135
buffer_store_dwordx4 v[128:131], v10, s[4:7], s3 offen sc1
buffer_store_dwordx4 v[132:135], v10, s[4:7], s3 offen offset:1024 sc1
s_barrier
ds_read_b64_tr_b16 v[64:65], v12 offset:0
ds_read_b64_tr_b16 v[66:67], v12 offset:2048
ds_read_b64_tr_b16 v[68:69], v13 offset:0
ds_read_b64_tr_b16 v[70:71], v13 offset:2048
ds_read_b64_tr_b16 v[72:73], v14 offset:0
ds_read_b64_tr_b16 v[74:75], v14 offset:2048
ds_read_b64_tr_b16 v[76:77], v15 offset:0
ds_read_b64_tr_b16 v[78:79], v15 offset:2048
ds_read_b64_tr_b16 v[80:81], v12 offset:4096
ds_read_b64_tr_b16 v[82:83], v12 offset:6144
ds_read_b64_tr_b16 v[84:85], v13 offset:4096
ds_read_b64_tr_b16 v[86:87], v13 offset:6144
ds_read_b64_tr_b16 v[88:89], v14 offset:4096
ds_read_b64_tr_b16 v[90:91], v14 offset:6144
ds_read_b64_tr_b16 v[92:93], v15 offset:4096
ds_read_b64_tr_b16 v[94:95], v15 offset:6144
buffer_load_dwordx4 a[24:27], v2, s[4:7], s43 offen offset:2048 sc1
buffer_load_dwordx4 a[28:31], v2, s[4:7], s43 offen offset:3072 sc1
s_add_u32 s43, s57, s70
buffer_load_dwordx4 a[32:35], v10, s[4:7], s43 offen sc1
buffer_load_dwordx4 a[36:39], v10, s[4:7], s43 offen offset:1024 sc1
buffer_load_dwordx4 a[40:43], v10, s[4:7], s43 offen offset:2048 sc1
buffer_load_dwordx4 a[44:47], v10, s[4:7], s43 offen offset:3072 sc1
buffer_load_dwordx4 a[48:51], v2, s[4:7], s43 offen sc1
buffer_load_dwordx4 a[52:55], v2, s[4:7], s43 offen offset:1024 sc1
buffer_load_dwordx4 a[56:59], v2, s[4:7], s43 offen offset:2048 sc1
buffer_load_dwordx4 a[60:63], v2, s[4:7], s43 offen offset:3072 sc1
s_cmp_lg_u32 s40, 0
s_cbranch_scc1 Lc04031
v_add_u32 v175, s87, v1
ds_read_b128 v[144:147], v175 offset:0
ds_read_b128 v[148:151], v175 offset:1024
ds_read_b128 v[152:155], v175 offset:2048
ds_read_b128 v[156:159], v175 offset:3072
ds_read_b128 v[160:163], v175 offset:4096
ds_read_b128 v[164:167], v175 offset:5120
ds_read_b128 v[168:171], v175 offset:6144
v_bfe_u32 v0, v1, 4, 3
v_cmp_eq_u32 vcc, 0, v0
v_mov_b32 v52, 0x3f80
s_nop 0
v_cndmask_b32 v48, 0, v52, vcc
v_cmp_eq_u32 vcc, 1, v0
v_mov_b32 v52, 0x3f800000
s_nop 0
v_cndmask_b32 v48, v48, v52, vcc
v_cmp_eq_u32 vcc, 2, v0
v_mov_b32 v52, 0x3f80
s_nop 0
v_cndmask_b32 v49, 0, v52, vcc
v_cmp_eq_u32 vcc, 3, v0
v_mov_b32 v52, 0x3f800000
s_nop 0
v_cndmask_b32 v49, v49, v52, vcc
v_cmp_eq_u32 vcc, 4, v0
v_mov_b32 v52, 0x3f80
s_nop 0
v_cndmask_b32 v50, 0, v52, vcc
v_cmp_eq_u32 vcc, 5, v0
v_mov_b32 v52, 0x3f800000
s_nop 0
v_cndmask_b32 v50, v50, v52, vcc
v_cmp_eq_u32 vcc, 6, v0
v_mov_b32 v52, 0x3f80
s_nop 0
v_cndmask_b32 v51, 0, v52, vcc
v_cmp_eq_u32 vcc, 7, v0
v_mov_b32 v52, 0x3f800000
s_nop 0
v_cndmask_b32 v51, v51, v52, vcc
s_waitcnt lgkmcnt(0)
s_nop 0
v_mfma_f32_16x16x32_bf16 v[112:115], v[48:51], v[144:147], 0
v_mfma_f32_16x16x32_bf16 v[112:115], v[48:51], v[148:151], v[112:115]
v_mfma_f32_16x16x32_bf16 v[116:119], v[48:51], v[152:155], 0
v_mfma_f32_16x16x32_bf16 v[116:119], v[48:51], v[156:159], v[116:119]
v_mfma_f32_16x16x32_bf16 v[120:123], v[48:51], v[160:163], 0
v_mfma_f32_16x16x32_bf16 v[120:123], v[48:51], v[164:167], v[120:123]
v_mfma_f32_16x16x32_bf16 v[124:127], v[48:51], v[168:171], 0
v_bfe_u32 v172, v1, 7, 1
v_lshlrev_b32 v172, 10, v172
v_bfe_u32 v173, v1, 4, 3
v_lshl_add_u32 v172, v173, 5, v172
v_bfe_u32 v173, v1, 8, 1
v_lshl_add_u32 v172, v173, 4, v172
v_add_u32 v172, s87, v172
ds_write_b128 v172, v[112:115] offset:0
ds_write_b128 v172, v[116:119] offset:256
ds_write_b128 v172, v[120:123] offset:512
ds_write_b128 v172, v[124:127] offset:768
Lc04031:
s_waitcnt vmcnt(16) lgkmcnt(8)
v_mfma_f32_16x16x32_bf16 v[176:179], v[64:67], a[0:3], v[176:179]
s_waitcnt vmcnt(10)
ds_read_b64_tr_b16 v[96:97], v12 offset:8192
buffer_atomic_add v26, v11, s[4:7], s76 offen offset:16 sc1
v_mfma_f32_16x16x32_bf16 v[180:183], v[64:67], a[4:7], v[180:183]
s_add_u32 s43, s58, s70
ds_read_b64_tr_b16 v[98:99], v12 offset:10240
v_mfma_f32_16x16x32_bf16 v[184:187], v[68:71], a[0:3], v[184:187]
ds_read_b64_tr_b16 v[100:101], v13 offset:8192
buffer_load_dwordx4 a[64:67], v10, s[4:7], s43 offen sc1
v_mfma_f32_16x16x32_bf16 v[188:191], v[68:71], a[4:7], v[188:191]
ds_read_b64_tr_b16 v[102:103], v13 offset:10240
v_mfma_f32_16x16x32_bf16 v[192:195], v[72:75], a[0:3], v[192:195]
ds_read_b64_tr_b16 v[104:105], v14 offset:8192
v_mfma_f32_16x16x32_bf16 v[196:199], v[72:75], a[4:7], v[196:199]
ds_read_b64_tr_b16 v[106:107], v14 offset:10240
buffer_load_dwordx4 a[68:71], v10, s[4:7], s43 offen offset:1024 sc1
v_mfma_f32_16x16x32_bf16 v[200:203], v[76:79], a[0:3], v[200:203]
ds_read_b64_tr_b16 v[108:109], v15 offset:8192
s_cmp_lg_u32 s40, 0
s_cbranch_scc1 Lc05032
v_bfe_u32 v0, v1, 6, 4
v_bfe_u32 v33, v1, 4, 2
v_lshlrev_b32 v33, 3, v33
s_lshr_b32 s45, s36, 1
s_mul_i32 s45, s45, 14336
s_add_u32 s45, s45, 135168
s_and_b32 s46, s36, 1
s_lshl_b32 s46, s46, 5
s_add_u32 s45, s45, s46
v_add_u32 v33, s45, v33
v_lshl_add_u32 v128, v0, 6, v33
v_add_u32 v33, s46, v33
v_lshl_add_u32 v129, v0, 7, v33
ds_read_b64_tr_b16 v[156:157], v129 offset:2048
ds_read_b64_tr_b16 v[158:159], v129 offset:9216
ds_read_b64_tr_b16 v[160:161], v129 offset:2080
ds_read_b64_tr_b16 v[162:163], v129 offset:9248
ds_read_b64_tr_b16 v[164:165], v129 offset:4096
ds_read_b64_tr_b16 v[166:167], v129 offset:11264
ds_read_b64_tr_b16 v[168:169], v129 offset:4128
ds_read_b64_tr_b16 v[170:171], v129 offset:11296
ds_read_b64_tr_b16 v[172:173], v128 offset:6144
ds_read_b64_tr_b16 v[174:175], v128 offset:13312
Lc05032:
v_mfma_f32_16x16x32_bf16 v[204:207], v[76:79], a[4:7], v[204:207]
s_waitcnt lgkmcnt(7)
ds_read_b64_tr_b16 v[110:111], v15 offset:10240
v_mfma_f32_16x16x32_bf16 v[176:179], v[80:83], a[8:11], v[176:179]
ds_read_b64_tr_b16 v[64:65], v12 offset:12288
buffer_load_dwordx4 a[72:75], v10, s[4:7], s43 offen offset:2048 sc1
v_mfma_f32_16x16x32_bf16 v[180:183], v[80:83], a[12:15], v[180:183]
ds_read_b64_tr_b16 v[66:67], v12 offset:14336
v_mfma_f32_16x16x32_bf16 v[184:187], v[84:87], a[8:11], v[184:187]
ds_read_b64_tr_b16 v[68:69], v13 offset:12288
v_mfma_f32_16x16x32_bf16 v[188:191], v[84:87], a[12:15], v[188:191]
ds_read_b64_tr_b16 v[70:71], v13 offset:14336
v_mfma_f32_16x16x32_bf16 v[192:195], v[88:91], a[8:11], v[192:195]
ds_read_b64_tr_b16 v[72:73], v14 offset:12288
buffer_load_dwordx4 a[76:79], v10, s[4:7], s43 offen offset:3072 sc1
v_mfma_f32_16x16x32_bf16 v[196:199], v[88:91], a[12:15], v[196:199]
ds_read_b64_tr_b16 v[74:75], v14 offset:14336
v_mfma_f32_16x16x32_bf16 v[200:203], v[92:95], a[8:11], v[200:203]
ds_read_b64_tr_b16 v[76:77], v15 offset:12288
v_mfma_f32_16x16x32_bf16 v[204:207], v[92:95], a[12:15], v[204:207]
s_waitcnt lgkmcnt(7)
ds_read_b64_tr_b16 v[78:79], v15 offset:14336
v_mfma_f32_16x16x32_bf16 v[176:179], v[96:99], a[16:19], v[176:179]
ds_read_b64_tr_b16 v[80:81], v12 offset:16384
buffer_load_dwordx4 a[80:83], v2, s[4:7], s43 offen sc1
v_mfma_f32_16x16x32_bf16 v[180:183], v[96:99], a[20:23], v[180:183]
ds_read_b64_tr_b16 v[82:83], v12 offset:18432
v_mfma_f32_16x16x32_bf16 v[184:187], v[100:103], a[16:19], v[184:187]
ds_read_b64_tr_b16 v[84:85], v12 offset:20480
v_mfma_f32_16x16x32_bf16 v[188:191], v[100:103], a[20:23], v[188:191]
ds_read_b64_tr_b16 v[86:87], v12 offset:22528
v_mfma_f32_16x16x32_bf16 v[192:195], v[104:107], a[16:19], v[192:195]
ds_read_b64_tr_b16 v[88:89], v12 offset:24576
buffer_load_dwordx4 a[84:87], v2, s[4:7], s43 offen offset:1024 sc1
v_mfma_f32_16x16x32_bf16 v[196:199], v[104:107], a[20:23], v[196:199]
ds_read_b64_tr_b16 v[90:91], v12 offset:26624
s_cmp_lg_u32 s40, 0
s_cbranch_scc1 Lc06033
s_mul_i32 s45, s38, 327680
s_add_u32 s45, s45, 125829120
s_lshl_b32 s46, s39, 10
s_add_u32 s45, s45, s46
s_add_u32 s46, s45, s46
buffer_store_dwordx4 v[156:159], v1, s[4:7], s46 offen sc1
buffer_store_dwordx4 v[160:163], v1, s[4:7], s46 offen offset:1024 sc1
s_add_u32 s46, s46, 131072
s_add_u32 s45, s45, 262144
buffer_store_dwordx4 v[164:167], v1, s[4:7], s46 offen sc1
buffer_store_dwordx4 v[168:171], v1, s[4:7], s46 offen offset:1024 sc1
buffer_store_dwordx4 v[172:175], v1, s[4:7], s45 offen sc1
Lc06033:
v_mfma_f32_16x16x32_bf16 v[200:203], v[108:111], a[16:19], v[200:203]
ds_read_b64_tr_b16 v[92:93], v12 offset:28672
v_mfma_f32_16x16x32_bf16 v[204:207], v[108:111], a[20:23], v[204:207]
s_waitcnt vmcnt(15) lgkmcnt(7)
ds_read_b64_tr_b16 v[94:95], v12 offset:30720
v_mfma_f32_16x16x32_bf16 v[176:179], v[64:67], a[24:27], v[176:179]
ds_read_b64_tr_b16 v[96:97], v13 offset:16384
buffer_load_dwordx4 a[88:91], v2, s[4:7], s43 offen offset:2048 sc1
v_mfma_f32_16x16x32_bf16 v[180:183], v[64:67], a[28:31], v[180:183]
ds_read_b64_tr_b16 v[98:99], v13 offset:18432
v_mfma_f32_16x16x32_bf16 v[184:187], v[68:71], a[24:27], v[184:187]
ds_read_b64_tr_b16 v[100:101], v13 offset:20480
v_mfma_f32_16x16x32_bf16 v[188:191], v[68:71], a[28:31], v[188:191]
ds_read_b64_tr_b16 v[102:103], v13 offset:22528
v_mfma_f32_16x16x32_bf16 v[192:195], v[72:75], a[24:27], v[192:195]
ds_read_b64_tr_b16 v[104:105], v13 offset:24576
buffer_load_dwordx4 a[92:95], v2, s[4:7], s43 offen offset:3072 sc1
v_mfma_f32_16x16x32_bf16 v[196:199], v[72:75], a[28:31], v[196:199]
ds_read_b64_tr_b16 v[106:107], v13 offset:26624
v_mfma_f32_16x16x32_bf16 v[200:203], v[76:79], a[24:27], v[200:203]
ds_read_b64_tr_b16 v[108:109], v13 offset:28672
v_mfma_f32_16x16x32_bf16 v[204:207], v[76:79], a[28:31], v[204:207]
s_waitcnt vmcnt(9) lgkmcnt(7)
ds_read_b64_tr_b16 v[110:111], v13 offset:30720
v_mfma_f32_16x16x32_bf16 v[176:179], v[80:83], a[32:35], v[176:179]
s_add_u32 s43, s59, s70
ds_read_b64_tr_b16 v[64:65], v14 offset:16384
buffer_load_dwordx4 a[96:99], v10, s[4:7], s43 offen sc1
v_mfma_f32_16x16x32_bf16 v[176:179], v[84:87], a[40:43], v[176:179]
ds_read_b64_tr_b16 v[66:67], v14 offset:18432
v_mfma_f32_16x16x32_bf16 v[176:179], v[88:91], a[48:51], v[176:179]
ds_read_b64_tr_b16 v[68:69], v14 offset:20480
v_mfma_f32_16x16x32_bf16 v[176:179], v[92:95], a[56:59], v[176:179]
ds_read_b64_tr_b16 v[70:71], v14 offset:22528
v_mfma_f32_16x16x32_bf16 v[180:183], v[92:95], a[60:63], v[180:183]
ds_read_b64_tr_b16 v[72:73], v14 offset:24576
buffer_load_dwordx4 a[100:103], v10, s[4:7], s43 offen offset:1024 sc1
v_mfma_f32_16x16x32_bf16 v[180:183], v[88:91], a[52:55], v[180:183]
ds_read_b64_tr_b16 v[74:75], v14 offset:26624
v_mfma_f32_16x16x32_bf16 v[180:183], v[84:87], a[44:47], v[180:183]
ds_read_b64_tr_b16 v[76:77], v14 offset:28672
v_mfma_f32_16x16x32_bf16 v[180:183], v[80:83], a[36:39], v[180:183]
s_waitcnt lgkmcnt(7)
ds_read_b64_tr_b16 v[78:79], v14 offset:30720
v_mfma_f32_16x16x32_bf16 v[188:191], v[96:99], a[36:39], v[188:191]
ds_read_b64_tr_b16 v[80:81], v15 offset:16384
buffer_load_dwordx4 a[104:107], v10, s[4:7], s43 offen offset:2048 sc1
v_mfma_f32_16x16x32_bf16 v[188:191], v[100:103], a[44:47], v[188:191]
ds_read_b64_tr_b16 v[82:83], v15 offset:18432
v_mfma_f32_16x16x32_bf16 v[188:191], v[104:107], a[52:55], v[188:191]
ds_read_b64_tr_b16 v[84:85], v15 offset:20480
buffer_load_dwordx4 a[108:111], v10, s[4:7], s43 offen offset:3072 sc1
v_mfma_f32_16x16x32_bf16 v[188:191], v[108:111], a[60:63], v[188:191]
ds_read_b64_tr_b16 v[86:87], v15 offset:22528
v_mov_b32 v25, 0
v_mfma_f32_16x16x32_bf16 v[184:187], v[108:111], a[56:59], v[184:187]
ds_read_b64_tr_b16 v[88:89], v15 offset:24576
v_mfma_f32_16x16x32_bf16 v[184:187], v[104:107], a[48:51], v[184:187]
ds_read_b64_tr_b16 v[90:91], v15 offset:26624
buffer_atomic_add v25, v11, s[4:7], s76 offen offset:16 sc0 sc1
v_mfma_f32_16x16x32_bf16 v[184:187], v[100:103], a[40:43], v[184:187]
ds_read_b64_tr_b16 v[92:93], v15 offset:28672
v_mfma_f32_16x16x32_bf16 v[184:187], v[96:99], a[32:35], v[184:187]
s_waitcnt lgkmcnt(7)
s_barrier
ds_read_b64_tr_b16 v[94:95], v15 offset:30720
v_mfma_f32_16x16x32_bf16 v[192:195], v[64:67], a[32:35], v[192:195]
ds_read_b64_tr_b16 v[96:97], v12 offset:32768
buffer_load_dwordx4 a[112:115], v2, s[4:7], s43 offen sc1
v_mfma_f32_16x16x32_bf16 v[192:195], v[68:71], a[40:43], v[192:195]
ds_read_b64_tr_b16 v[98:99], v12 offset:34816
v_mfma_f32_16x16x32_bf16 v[192:195], v[72:75], a[48:51], v[192:195]
ds_read_b64_tr_b16 v[100:101], v12 offset:36864
v_mfma_f32_16x16x32_bf16 v[192:195], v[76:79], a[56:59], v[192:195]
ds_read_b64_tr_b16 v[102:103], v12 offset:38912
v_mfma_f32_16x16x32_bf16 v[196:199], v[76:79], a[60:63], v[196:199]
ds_read_b64_tr_b16 v[104:105], v12 offset:40960
buffer_load_dwordx4 a[116:119], v2, s[4:7], s43 offen offset:1024 sc1
v_mfma_f32_16x16x32_bf16 v[196:199], v[72:75], a[52:55], v[196:199]
ds_read_b64_tr_b16 v[106:107], v12 offset:43008
v_mfma_f32_16x16x32_bf16 v[196:199], v[68:71], a[44:47], v[196:199]
ds_read_b64_tr_b16 v[108:109], v12 offset:45056
v_mfma_f32_16x16x32_bf16 v[196:199], v[64:67], a[36:39], v[196:199]
s_waitcnt lgkmcnt(7)
ds_read_b64_tr_b16 v[110:111], v12 offset:47104
v_mfma_f32_16x16x32_bf16 v[204:207], v[80:83], a[36:39], v[204:207]
ds_read_b64_tr_b16 v[64:65], v13 offset:32768
buffer_load_dwordx4 a[120:123], v2, s[4:7], s43 offen offset:2048 sc1
v_mfma_f32_16x16x32_bf16 v[204:207], v[84:87], a[44:47], v[204:207]
ds_read_b64_tr_b16 v[66:67], v13 offset:34816
v_mfma_f32_16x16x32_bf16 v[204:207], v[88:91], a[52:55], v[204:207]
ds_read_b64_tr_b16 v[68:69], v13 offset:36864
v_mfma_f32_16x16x32_bf16 v[204:207], v[92:95], a[60:63], v[204:207]
ds_read_b64_tr_b16 v[70:71], v13 offset:38912
v_mfma_f32_16x16x32_bf16 v[200:203], v[92:95], a[56:59], v[200:203]
ds_read_b64_tr_b16 v[72:73], v13 offset:40960
buffer_load_dwordx4 a[124:127], v2, s[4:7], s43 offen offset:3072 sc1
v_mfma_f32_16x16x32_bf16 v[200:203], v[88:91], a[48:51], v[200:203]
ds_read_b64_tr_b16 v[74:75], v13 offset:43008
s_cmp_lg_u32 s40, 0
s_cbranch_scc1 Lc07034
s_min_u32 s45, s36, 3
s_lshl_b32 s46, s38, 3
s_add_u32 s46, s46, s45
s_add_u32 s46, s46, 3
s_lshl_b32 s46, s46, 4
s_add_u32 s46, s46, s37
s_lshl_b32 s46, s46, 8
s_add_u32 s46, s46, 131072
s_lshl_b32 s45, s45, 8
s_add_u32 s45, s45, 135168
v_lshrrev_b32 v152, 8, v1
v_mul_u32_u24 v152, 7168, v152
v_and_b32 v153, 0xf0, v1
v_add3_u32 v152, v152, v153, s45
ds_read_b128 v[144:147], v152 offset:0
ds_read_b128 v[148:151], v152 offset:1024
s_waitcnt lgkmcnt(0)
v_add_f32 v144, v144, v148
v_add_f32 v145, v145, v149
v_add_f32 v146, v146, v150
v_add_f32 v147, v147, v151
v_mov_b32 v148, v144
v_mov_b32 v149, v145
v_mov_b32 v150, v146
v_mov_b32 v151, v147
v_permlane32_swap_b32 v144, v148
v_permlane32_swap_b32 v145, v149
v_permlane32_swap_b32 v146, v150
v_permlane32_swap_b32 v147, v151
v_add_f32 v144, v144, v148
v_add_f32 v145, v145, v149
v_add_f32 v146, v146, v150
v_add_f32 v147, v147, v151
v_mov_b32 v148, v144
v_mov_b32 v149, v145
v_mov_b32 v150, v146
v_mov_b32 v151, v147
v_permlane16_swap_b32 v144, v148
v_permlane16_swap_b32 v145, v149
v_permlane16_swap_b32 v146, v150
v_permlane16_swap_b32 v147, v151
v_add_f32 v144, v144, v148
v_add_f32 v145, v145, v149
v_add_f32 v146, v146, v150
v_add_f32 v147, v147, v151
buffer_store_dwordx4 v[144:147], v9, s[4:7], s46 offen sc1
Lc07034:
v_mfma_f32_16x16x32_bf16 v[200:203], v[84:87], a[40:43], v[200:203]
ds_read_b64_tr_b16 v[76:77], v13 offset:45056
v_mfma_f32_16x16x32_bf16 v[200:203], v[80:83], a[32:35], v[200:203]
s_waitcnt vmcnt(9) lgkmcnt(7)
ds_read_b64_tr_b16 v[78:79], v13 offset:47104
v_mfma_f32_16x16x32_bf16 v[176:179], v[96:99], a[64:67], v[176:179]
ds_read_b64_tr_b16 v[80:81], v14 offset:32768
buffer_load_dword v3, v4, s[28:31], 0 offen
v_mfma_f32_16x16x32_bf16 v[176:179], v[100:103], a[72:75], v[176:179]
ds_read_b64_tr_b16 v[82:83], v14 offset:34816
v_mfma_f32_16x16x32_bf16 v[176:179], v[104:107], a[80:83], v[176:179]
ds_read_b64_tr_b16 v[84:85], v14 offset:36864
v_mfma_f32_16x16x32_bf16 v[176:179], v[108:111], a[88:91], v[176:179]
ds_read_b64_tr_b16 v[86:87], v14 offset:38912
v_mfma_f32_16x16x32_bf16 v[180:183], v[108:111], a[92:95], v[180:183]
ds_read_b64_tr_b16 v[88:89], v14 offset:40960
v_mfma_f32_16x16x32_bf16 v[180:183], v[104:107], a[84:87], v[180:183]
ds_read_b64_tr_b16 v[90:91], v14 offset:43008
v_mfma_f32_16x16x32_bf16 v[180:183], v[100:103], a[76:79], v[180:183]
s_branch Lso10
Lst10:
s_setpc_b64 s[42:43]
Lso10:
ds_read_b64_tr_b16 v[92:93], v14 offset:45056
v_mfma_f32_16x16x32_bf16 v[180:183], v[96:99], a[68:71], v[180:183]
s_waitcnt lgkmcnt(7)
ds_read_b64_tr_b16 v[94:95], v14 offset:47104
v_mfma_f32_16x16x32_bf16 v[188:191], v[64:67], a[68:71], v[188:191]
ds_read_b64_tr_b16 v[96:97], v15 offset:32768
s_waitcnt vmcnt(5)
v_readfirstlane_b32 s45, v25
s_nop 0
s_cmp_lt_u32 s45, 16
s_cbranch_scc1 Lslow8035
Lback8036:
v_mfma_f32_16x16x32_bf16 v[188:191], v[68:71], a[76:79], v[188:191]
s_add_u32 s43, s56, s79
ds_read_b64_tr_b16 v[98:99], v15 offset:34816
buffer_load_dwordx4 a[128:131], v10, s[4:7], s43 offen sc1
v_mfma_f32_16x16x32_bf16 v[188:191], v[72:75], a[84:87], v[188:191]
ds_read_b64_tr_b16 v[100:101], v15 offset:36864
buffer_load_dwordx4 a[132:135], v10, s[4:7], s43 offen offset:1024 sc1
v_mfma_f32_16x16x32_bf16 v[188:191], v[76:79], a[92:95], v[188:191]
ds_read_b64_tr_b16 v[102:103], v15 offset:38912
v_mfma_f32_16x16x32_bf16 v[184:187], v[76:79], a[88:91], v[184:187]
ds_read_b64_tr_b16 v[104:105], v15 offset:40960
v_mfma_f32_16x16x32_bf16 v[184:187], v[72:75], a[80:83], v[184:187]
ds_read_b64_tr_b16 v[106:107], v15 offset:43008
buffer_load_dwordx4 a[136:139], v10, s[4:7], s43 offen offset:2048 sc1
v_mfma_f32_16x16x32_bf16 v[184:187], v[68:71], a[72:75], v[184:187]
ds_read_b64_tr_b16 v[108:109], v15 offset:45056
v_mfma_f32_16x16x32_bf16 v[184:187], v[64:67], a[64:67], v[184:187]
s_waitcnt lgkmcnt(7)
ds_read_b64_tr_b16 v[110:111], v15 offset:47104
v_mfma_f32_16x16x32_bf16 v[192:195], v[80:83], a[64:67], v[192:195]
ds_read_b64_tr_b16 v[64:65], v12 offset:49152
buffer_load_dwordx4 a[140:143], v10, s[4:7], s43 offen offset:3072 sc1
v_mfma_f32_16x16x32_bf16 v[192:195], v[84:87], a[72:75], v[192:195]
ds_read_b64_tr_b16 v[66:67], v12 offset:51200
v_mfma_f32_16x16x32_bf16 v[192:195], v[88:91], a[80:83], v[192:195]
ds_read_b64_tr_b16 v[68:69], v12 offset:53248
v_mfma_f32_16x16x32_bf16 v[192:195], v[92:95], a[88:91], v[192:195]
ds_read_b64_tr_b16 v[70:71], v12 offset:55296
v_mfma_f32_16x16x32_bf16 v[196:199], v[92:95], a[92:95], v[196:199]
ds_read_b64_tr_b16 v[72:73], v12 offset:57344
buffer_load_dwordx4 a[144:147], v2, s[4:7], s43 offen sc1
v_mfma_f32_16x16x32_bf16 v[196:199], v[88:91], a[84:87], v[196:199]
ds_read_b64_tr_b16 v[74:75], v12 offset:59392
v_mfma_f32_16x16x32_bf16 v[196:199], v[84:87], a[76:79], v[196:199]
ds_read_b64_tr_b16 v[76:77], v12 offset:61440
v_mfma_f32_16x16x32_bf16 v[196:199], v[80:83], a[68:71], v[196:199]
s_waitcnt lgkmcnt(7)
ds_read_b64_tr_b16 v[78:79], v12 offset:63488
v_mfma_f32_16x16x32_bf16 v[204:207], v[96:99], a[68:71], v[204:207]
ds_read_b64_tr_b16 v[80:81], v13 offset:49152
buffer_load_dwordx4 a[148:151], v2, s[4:7], s43 offen offset:1024 sc1
v_mfma_f32_16x16x32_bf16 v[204:207], v[100:103], a[76:79], v[204:207]
ds_read_b64_tr_b16 v[82:83], v13 offset:51200
v_mfma_f32_16x16x32_bf16 v[204:207], v[104:107], a[84:87], v[204:207]
ds_read_b64_tr_b16 v[84:85], v13 offset:53248
v_mfma_f32_16x16x32_bf16 v[204:207], v[108:111], a[92:95], v[204:207]
ds_read_b64_tr_b16 v[86:87], v13 offset:55296
v_mfma_f32_16x16x32_bf16 v[200:203], v[108:111], a[88:91], v[200:203]
ds_read_b64_tr_b16 v[88:89], v13 offset:57344
buffer_load_dwordx4 a[152:155], v2, s[4:7], s43 offen offset:2048 sc1
v_mfma_f32_16x16x32_bf16 v[200:203], v[104:107], a[80:83], v[200:203]
ds_read_b64_tr_b16 v[90:91], v13 offset:59392
v_mfma_f32_16x16x32_bf16 v[200:203], v[100:103], a[72:75], v[200:203]
ds_read_b64_tr_b16 v[92:93], v13 offset:61440
v_mfma_f32_16x16x32_bf16 v[200:203], v[96:99], a[64:67], v[200:203]
s_waitcnt vmcnt(8) lgkmcnt(7)
ds_read_b64_tr_b16 v[94:95], v13 offset:63488
v_mfma_f32_16x16x32_bf16 v[176:179], v[64:67], a[96:99], v[176:179]
ds_read_b64_tr_b16 v[96:97], v14 offset:49152
buffer_load_dwordx4 a[156:159], v2, s[4:7], s43 offen offset:3072 sc1
v_mfma_f32_16x16x32_bf16 v[176:179], v[68:71], a[104:107], v[176:179]
s_add_u32 s43, s57, s79
ds_read_b64_tr_b16 v[98:99], v14 offset:51200
v_mfma_f32_16x16x32_bf16 v[176:179], v[72:75], a[112:115], v[176:179]
ds_read_b64_tr_b16 v[100:101], v14 offset:53248
buffer_load_dwordx4 a[160:163], v10, s[4:7], s43 offen sc1
v_mfma_f32_16x16x32_bf16 v[176:179], v[76:79], a[120:123], v[176:179]
ds_read_b64_tr_b16 v[102:103], v14 offset:55296
v_mfma_f32_16x16x32_bf16 v[180:183], v[76:79], a[124:127], v[180:183]
ds_read_b64_tr_b16 v[104:105], v14 offset:57344
v_mfma_f32_16x16x32_bf16 v[180:183], v[72:75], a[116:119], v[180:183]
ds_read_b64_tr_b16 v[106:107], v14 offset:59392
buffer_load_dwordx4 a[164:167], v10, s[4:7], s43 offen offset:1024 sc1
v_mfma_f32_16x16x32_bf16 v[180:183], v[68:71], a[108:111], v[180:183]
ds_read_b64_tr_b16 v[108:109], v14 offset:61440
v_mfma_f32_16x16x32_bf16 v[180:183], v[64:67], a[100:103], v[180:183]
s_waitcnt lgkmcnt(7)
ds_read_b64_tr_b16 v[110:111], v14 offset:63488
v_mfma_f32_16x16x32_bf16 v[188:191], v[80:83], a[100:103], v[188:191]
ds_read_b64_tr_b16 v[64:65], v15 offset:49152
buffer_load_dwordx4 a[168:171], v10, s[4:7], s43 offen offset:2048 sc1
v_mfma_f32_16x16x32_bf16 v[188:191], v[84:87], a[108:111], v[188:191]
ds_read_b64_tr_b16 v[66:67], v15 offset:51200
v_mfma_f32_16x16x32_bf16 v[188:191], v[88:91], a[116:119], v[188:191]
ds_read_b64_tr_b16 v[68:69], v15 offset:53248
v_mfma_f32_16x16x32_bf16 v[188:191], v[92:95], a[124:127], v[188:191]
ds_read_b64_tr_b16 v[70:71], v15 offset:55296
v_mfma_f32_16x16x32_bf16 v[184:187], v[92:95], a[120:123], v[184:187]
ds_read_b64_tr_b16 v[72:73], v15 offset:57344
buffer_load_dwordx4 a[172:175], v10, s[4:7], s43 offen offset:3072 sc1
v_mfma_f32_16x16x32_bf16 v[184:187], v[88:91], a[112:115], v[184:187]
ds_read_b64_tr_b16 v[74:75], v15 offset:59392
v_mfma_f32_16x16x32_bf16 v[184:187], v[84:87], a[104:107], v[184:187]
ds_read_b64_tr_b16 v[76:77], v15 offset:61440
v_mfma_f32_16x16x32_bf16 v[184:187], v[80:83], a[96:99], v[184:187]
s_waitcnt lgkmcnt(7)
ds_read_b64_tr_b16 v[78:79], v15 offset:63488
v_mfma_f32_16x16x32_bf16 v[192:195], v[96:99], a[96:99], v[192:195]
ds_read_b64_tr_b16 v[80:81], v16 offset:0
buffer_load_dwordx4 a[176:179], v2, s[4:7], s43 offen sc1
v_mfma_f32_16x16x32_bf16 v[192:195], v[100:103], a[104:107], v[192:195]
ds_read_b64_tr_b16 v[82:83], v16 offset:2048
v_mfma_f32_16x16x32_bf16 v[192:195], v[104:107], a[112:115], v[192:195]
ds_read_b64_tr_b16 v[84:85], v17 offset:0
v_mfma_f32_16x16x32_bf16 v[192:195], v[108:111], a[120:123], v[192:195]
ds_read_b64_tr_b16 v[86:87], v17 offset:2048
v_mfma_f32_16x16x32_bf16 v[196:199], v[108:111], a[124:127], v[196:199]
ds_read_b64_tr_b16 v[88:89], v18 offset:0
buffer_load_dwordx4 a[180:183], v2, s[4:7], s43 offen offset:1024 sc1
v_mfma_f32_16x16x32_bf16 v[196:199], v[104:107], a[116:119], v[196:199]
ds_read_b64_tr_b16 v[90:91], v18 offset:2048
v_mfma_f32_16x16x32_bf16 v[196:199], v[100:103], a[108:111], v[196:199]
ds_read_b64_tr_b16 v[92:93], v19 offset:0
v_mfma_f32_16x16x32_bf16 v[196:199], v[96:99], a[100:103], v[196:199]
s_waitcnt lgkmcnt(7)
ds_read_b64_tr_b16 v[94:95], v19 offset:2048
v_mfma_f32_16x16x32_bf16 v[204:207], v[64:67], a[100:103], v[204:207]
ds_read_b64_tr_b16 v[96:97], v16 offset:4096
buffer_load_dwordx4 a[184:187], v2, s[4:7], s43 offen offset:2048 sc1
v_mfma_f32_16x16x32_bf16 v[204:207], v[68:71], a[108:111], v[204:207]
ds_read_b64_tr_b16 v[98:99], v16 offset:6144
v_mfma_f32_16x16x32_bf16 v[204:207], v[72:75], a[116:119], v[204:207]
ds_read_b64_tr_b16 v[100:101], v17 offset:4096
v_mfma_f32_16x16x32_bf16 v[204:207], v[76:79], a[124:127], v[204:207]
ds_read_b64_tr_b16 v[102:103], v17 offset:6144
v_mfma_f32_16x16x32_bf16 v[200:203], v[76:79], a[120:123], v[200:203]
ds_read_b64_tr_b16 v[104:105], v18 offset:4096
buffer_load_dwordx4 a[188:191], v2, s[4:7], s43 offen offset:3072 sc1
v_mfma_f32_16x16x32_bf16 v[200:203], v[72:75], a[112:115], v[200:203]
ds_read_b64_tr_b16 v[106:107], v18 offset:6144
v_mfma_f32_16x16x32_bf16 v[200:203], v[68:71], a[104:107], v[200:203]
ds_read_b64_tr_b16 v[108:109], v19 offset:4096
v_mfma_f32_16x16x32_bf16 v[200:203], v[64:67], a[96:99], v[200:203]
s_waitcnt vmcnt(14) lgkmcnt(7)
ds_read_b64_tr_b16 v[110:111], v19 offset:6144
v_mfma_f32_16x16x32_bf16 v[176:179], v[80:83], a[128:131], v[176:179]
s_add_u32 s43, s58, s79
ds_read_b64_tr_b16 v[64:65], v16 offset:8192
buffer_load_dwordx4 a[192:195], v10, s[4:7], s43 offen sc1
v_mfma_f32_16x16x32_bf16 v[180:183], v[80:83], a[132:135], v[180:183]
ds_read_b64_tr_b16 v[66:67], v16 offset:10240
v_mfma_f32_16x16x32_bf16 v[184:187], v[84:87], a[128:131], v[184:187]
ds_read_b64_tr_b16 v[68:69], v17 offset:8192
v_mfma_f32_16x16x32_bf16 v[188:191], v[84:87], a[132:135], v[188:191]
ds_read_b64_tr_b16 v[70:71], v17 offset:10240
v_mfma_f32_16x16x32_bf16 v[192:195], v[88:91], a[128:131], v[192:195]
ds_read_b64_tr_b16 v[72:73], v18 offset:8192
buffer_load_dwordx4 a[196:199], v10, s[4:7], s43 offen offset:1024 sc1
v_mfma_f32_16x16x32_bf16 v[196:199], v[88:91], a[132:135], v[196:199]
ds_read_b64_tr_b16 v[74:75], v18 offset:10240
v_mfma_f32_16x16x32_bf16 v[200:203], v[92:95], a[128:131], v[200:203]
ds_read_b64_tr_b16 v[76:77], v19 offset:8192
v_mfma_f32_16x16x32_bf16 v[204:207], v[92:95], a[132:135], v[204:207]
s_waitcnt vmcnt(14) lgkmcnt(7)
ds_read_b64_tr_b16 v[78:79], v19 offset:10240
v_mfma_f32_16x16x32_bf16 v[176:179], v[96:99], a[136:139], v[176:179]
ds_read_b64_tr_b16 v[80:81], v16 offset:12288
buffer_load_dwordx4 a[200:203], v10, s[4:7], s43 offen offset:2048 sc1
v_mfma_f32_16x16x32_bf16 v[180:183], v[96:99], a[140:143], v[180:183]
ds_read_b64_tr_b16 v[82:83], v16 offset:14336
v_mfma_f32_16x16x32_bf16 v[184:187], v[100:103], a[136:139], v[184:187]
ds_read_b64_tr_b16 v[84:85], v17 offset:12288
v_mfma_f32_16x16x32_bf16 v[188:191], v[100:103], a[140:143], v[188:191]
ds_read_b64_tr_b16 v[86:87], v17 offset:14336
v_mfma_f32_16x16x32_bf16 v[192:195], v[104:107], a[136:139], v[192:195]
ds_read_b64_tr_b16 v[88:89], v18 offset:12288
buffer_load_dwordx4 a[204:207], v10, s[4:7], s43 offen offset:3072 sc1
v_mfma_f32_16x16x32_bf16 v[196:199], v[104:107], a[140:143], v[196:199]
ds_read_b64_tr_b16 v[90:91], v18 offset:14336
v_mov_b32 v56, 0x3f803f80
v_mfma_f32_16x16x32_bf16 v[200:203], v[108:111], a[136:139], v[200:203]
ds_read_b64_tr_b16 v[92:93], v19 offset:12288
v_mov_b32 v57, 0x3f803f80
v_mov_b32 v58, 0x3f803f80
v_mfma_f32_16x16x32_bf16 v[204:207], v[108:111], a[140:143], v[204:207]
s_waitcnt vmcnt(14) lgkmcnt(7)
ds_read_b64_tr_b16 v[94:95], v19 offset:14336
v_mov_b32 v59, 0x3f803f80
v_mfma_f32_16x16x32_bf16 v[176:179], v[64:67], a[144:147], v[176:179]
ds_read_b64_tr_b16 v[96:97], v16 offset:16384
buffer_load_dwordx4 a[208:211], v2, s[4:7], s43 offen sc1
v_mfma_f32_16x16x32_bf16 v[180:183], v[64:67], a[148:151], v[180:183]
ds_read_b64_tr_b16 v[98:99], v16 offset:18432
v_mfma_f32_16x16x32_bf16 v[184:187], v[68:71], a[144:147], v[184:187]
ds_read_b64_tr_b16 v[100:101], v16 offset:20480
v_mfma_f32_16x16x32_bf16 v[188:191], v[68:71], a[148:151], v[188:191]
ds_read_b64_tr_b16 v[102:103], v16 offset:22528
v_mfma_f32_16x16x32_bf16 v[192:195], v[72:75], a[144:147], v[192:195]
ds_read_b64_tr_b16 v[104:105], v16 offset:24576
buffer_load_dwordx4 a[212:215], v2, s[4:7], s43 offen offset:1024 sc1
v_mfma_f32_16x16x32_bf16 v[196:199], v[72:75], a[148:151], v[196:199]
ds_read_b64_tr_b16 v[106:107], v16 offset:26624
v_mfma_f32_16x16x32_bf16 v[200:203], v[76:79], a[144:147], v[200:203]
ds_read_b64_tr_b16 v[108:109], v16 offset:28672
v_mfma_f32_16x16x32_bf16 v[204:207], v[76:79], a[148:151], v[204:207]
s_waitcnt vmcnt(14) lgkmcnt(7)
ds_read_b64_tr_b16 v[110:111], v16 offset:30720
v_mfma_f32_16x16x32_bf16 v[176:179], v[80:83], a[152:155], v[176:179]
ds_read_b64_tr_b16 v[64:65], v17 offset:16384
buffer_load_dwordx4 a[216:219], v2, s[4:7], s43 offen offset:2048 sc1
v_mfma_f32_16x16x32_bf16 v[180:183], v[80:83], a[156:159], v[180:183]
ds_read_b64_tr_b16 v[66:67], v17 offset:18432
v_mfma_f32_16x16x32_bf16 v[184:187], v[84:87], a[152:155], v[184:187]
ds_read_b64_tr_b16 v[68:69], v17 offset:20480
v_mfma_f32_16x16x32_bf16 v[188:191], v[84:87], a[156:159], v[188:191]
ds_read_b64_tr_b16 v[70:71], v17 offset:22528
v_mfma_f32_16x16x32_bf16 v[192:195], v[88:91], a[152:155], v[192:195]
ds_read_b64_tr_b16 v[72:73], v17 offset:24576
buffer_load_dwordx4 a[220:223], v2, s[4:7], s43 offen offset:3072 sc1
v_mfma_f32_16x16x32_bf16 v[196:199], v[88:91], a[156:159], v[196:199]
ds_read_b64_tr_b16 v[74:75], v17 offset:26624
v_mfma_f32_16x16x32_bf16 v[200:203], v[92:95], a[152:155], v[200:203]
ds_read_b64_tr_b16 v[76:77], v17 offset:28672
v_mfma_f32_16x16x32_bf16 v[204:207], v[92:95], a[156:159], v[204:207]
s_waitcnt vmcnt(8) lgkmcnt(7)
ds_read_b64_tr_b16 v[78:79], v17 offset:30720
v_mfma_f32_16x16x32_bf16 v[176:179], v[96:99], a[160:163], v[176:179]
s_add_u32 s43, s59, s79
ds_read_b64_tr_b16 v[80:81], v18 offset:16384
buffer_load_dwordx4 a[224:227], v10, s[4:7], s43 offen sc1
v_mfma_f32_16x16x32_bf16 v[176:179], v[100:103], a[168:171], v[176:179]
ds_read_b64_tr_b16 v[82:83], v18 offset:18432
v_mfma_f32_16x16x32_bf16 v[176:179], v[104:107], a[176:179], v[176:179]
ds_read_b64_tr_b16 v[84:85], v18 offset:20480
buffer_load_dwordx4 a[228:231], v10, s[4:7], s43 offen offset:1024 sc1
v_mfma_f32_16x16x32_bf16 v[176:179], v[108:111], a[184:187], v[176:179]
ds_read_b64_tr_b16 v[86:87], v18 offset:22528
v_mfma_f32_16x16x32_bf16 v[180:183], v[108:111], a[188:191], v[180:183]
ds_read_b64_tr_b16 v[88:89], v18 offset:24576
v_mfma_f32_16x16x32_bf16 v[180:183], v[104:107], a[180:183], v[180:183]
ds_read_b64_tr_b16 v[90:91], v18 offset:26624
buffer_atomic_add v26, v11, s[4:7], s35 offen offset:20 sc1
v_mfma_f32_16x16x32_bf16 v[180:183], v[100:103], a[172:175], v[180:183]
ds_read_b64_tr_b16 v[92:93], v18 offset:28672
v_mfma_f32_16x16x32_bf16 v[180:183], v[96:99], a[164:167], v[180:183]
s_waitcnt lgkmcnt(7)
ds_read_b64_tr_b16 v[94:95], v18 offset:30720
v_mfma_f32_16x16x32_bf16 v[188:191], v[64:67], a[164:167], v[188:191]
ds_read_b64_tr_b16 v[96:97], v19 offset:16384
buffer_load_dwordx4 a[232:235], v10, s[4:7], s43 offen offset:2048 sc1
v_mfma_f32_16x16x32_bf16 v[188:191], v[68:71], a[172:175], v[188:191]
ds_read_b64_tr_b16 v[98:99], v19 offset:18432
v_mfma_f32_16x16x32_bf16 v[188:191], v[72:75], a[180:183], v[188:191]
ds_read_b64_tr_b16 v[100:101], v19 offset:20480
v_mfma_f32_16x16x32_bf16 v[188:191], v[76:79], a[188:191], v[188:191]
ds_read_b64_tr_b16 v[102:103], v19 offset:22528
v_mfma_f32_16x16x32_bf16 v[184:187], v[76:79], a[184:187], v[184:187]
ds_read_b64_tr_b16 v[104:105], v19 offset:24576
buffer_load_dwordx4 a[236:239], v10, s[4:7], s43 offen offset:3072 sc1
v_mfma_f32_16x16x32_bf16 v[184:187], v[72:75], a[176:179], v[184:187]
ds_read_b64_tr_b16 v[106:107], v19 offset:26624
v_mfma_f32_16x16x32_bf16 v[184:187], v[68:71], a[168:171], v[184:187]
ds_read_b64_tr_b16 v[108:109], v19 offset:28672
v_mfma_f32_16x16x32_bf16 v[184:187], v[64:67], a[160:163], v[184:187]
s_waitcnt lgkmcnt(7)
s_barrier
ds_read_b64_tr_b16 v[110:111], v19 offset:30720
v_mfma_f32_16x16x32_bf16 v[192:195], v[80:83], a[160:163], v[192:195]
ds_read_b64_tr_b16 v[64:65], v16 offset:32768
buffer_load_dwordx4 a[240:243], v2, s[4:7], s43 offen sc1
v_mfma_f32_16x16x32_bf16 v[192:195], v[84:87], a[168:171], v[192:195]
ds_read_b64_tr_b16 v[66:67], v16 offset:34816
v_mfma_f32_16x16x32_bf16 v[192:195], v[88:91], a[176:179], v[192:195]
ds_read_b64_tr_b16 v[68:69], v16 offset:36864
v_mfma_f32_16x16x32_bf16 v[192:195], v[92:95], a[184:187], v[192:195]
ds_read_b64_tr_b16 v[70:71], v16 offset:38912
v_mfma_f32_16x16x32_bf16 v[196:199], v[92:95], a[188:191], v[196:199]
ds_read_b64_tr_b16 v[72:73], v16 offset:40960
buffer_load_dwordx4 a[244:247], v2, s[4:7], s43 offen offset:1024 sc1
v_mfma_f32_16x16x32_bf16 v[196:199], v[88:91], a[180:183], v[196:199]
ds_read_b64_tr_b16 v[74:75], v16 offset:43008
v_mfma_f32_16x16x32_bf16 v[196:199], v[84:87], a[172:175], v[196:199]
ds_read_b64_tr_b16 v[76:77], v16 offset:45056
v_mfma_f32_16x16x32_bf16 v[196:199], v[80:83], a[164:167], v[196:199]
s_waitcnt lgkmcnt(7)
ds_read_b64_tr_b16 v[78:79], v16 offset:47104
v_mfma_f32_16x16x32_bf16 v[204:207], v[96:99], a[164:167], v[204:207]
ds_read_b64_tr_b16 v[80:81], v17 offset:32768
buffer_load_dwordx4 a[248:251], v2, s[4:7], s43 offen offset:2048 sc1
v_mfma_f32_16x16x32_bf16 v[204:207], v[100:103], a[172:175], v[204:207]
ds_read_b64_tr_b16 v[82:83], v17 offset:34816
v_mfma_f32_16x16x32_bf16 v[204:207], v[104:107], a[180:183], v[204:207]
ds_read_b64_tr_b16 v[84:85], v17 offset:36864
v_mfma_f32_16x16x32_bf16 v[204:207], v[108:111], a[188:191], v[204:207]
ds_read_b64_tr_b16 v[86:87], v17 offset:38912
v_mfma_f32_16x16x32_bf16 v[200:203], v[108:111], a[184:187], v[200:203]
ds_read_b64_tr_b16 v[88:89], v17 offset:40960
buffer_load_dwordx4 a[252:255], v2, s[4:7], s43 offen offset:3072 sc1
v_mfma_f32_16x16x32_bf16 v[200:203], v[104:107], a[176:179], v[200:203]
ds_read_b64_tr_b16 v[90:91], v17 offset:43008
v_mfma_f32_16x16x32_bf16 v[200:203], v[100:103], a[168:171], v[200:203]
ds_read_b64_tr_b16 v[92:93], v17 offset:45056
v_mfma_f32_16x16x32_bf16 v[200:203], v[96:99], a[160:163], v[200:203]
s_waitcnt vmcnt(9) lgkmcnt(7)
ds_read_b64_tr_b16 v[94:95], v17 offset:47104
v_mfma_f32_16x16x32_bf16 v[176:179], v[64:67], a[192:195], v[176:179]
ds_read_b64_tr_b16 v[96:97], v18 offset:32768
v_mov_b32 v28, v22
v_mfma_f32_16x16x32_bf16 v[176:179], v[68:71], a[200:203], v[176:179]
ds_read_b64_tr_b16 v[98:99], v18 offset:34816
v_add_u32 v29, 56320, v22
v_mfma_f32_16x16x32_bf16 v[176:179], v[72:75], a[208:211], v[176:179]
ds_read_b64_tr_b16 v[100:101], v18 offset:36864
v_add_u32 v30, 112640, v22
v_mfma_f32_16x16x32_bf16 v[176:179], v[76:79], a[216:219], v[176:179]
ds_read_b64_tr_b16 v[102:103], v18 offset:38912
v_add_u32 v31, 168960, v22
v_mfma_f32_16x16x32_bf16 v[180:183], v[76:79], a[220:223], v[180:183]
s_add_u32 m0, s41, 0
ds_read_b64_tr_b16 v[104:105], v18 offset:40960
s_mul_i32 s42, s48, 112
v_mfma_f32_16x16x32_bf16 v[180:183], v[72:75], a[212:215], v[180:183]
ds_read_b64_tr_b16 v[106:107], v18 offset:43008
buffer_load_dwordx4 v28, s[16:19], s42 offen sc1 lds
v_mfma_f32_16x16x32_bf16 v[180:183], v[68:71], a[204:207], v[180:183]
ds_read_b64_tr_b16 v[108:109], v18 offset:45056
buffer_load_dwordx4 v29, s[16:19], s42 offen offset:1024 sc1 lds
v_mfma_f32_16x16x32_bf16 v[180:183], v[64:67], a[196:199], v[180:183]
s_waitcnt lgkmcnt(7)
ds_read_b64_tr_b16 v[110:111], v18 offset:47104
v_mfma_f32_16x16x32_bf16 v[188:191], v[80:83], a[196:199], v[188:191]
ds_read_b64_tr_b16 v[64:65], v19 offset:32768
buffer_load_dwordx4 v30, s[16:19], s42 offen offset:2048 sc1 lds
v_mfma_f32_16x16x32_bf16 v[188:191], v[84:87], a[204:207], v[188:191]
ds_read_b64_tr_b16 v[66:67], v19 offset:34816
v_mfma_f32_16x16x32_bf16 v[188:191], v[88:91], a[212:215], v[188:191]
ds_read_b64_tr_b16 v[68:69], v19 offset:36864
v_mfma_f32_16x16x32_bf16 v[188:191], v[92:95], a[220:223], v[188:191]
ds_read_b64_tr_b16 v[70:71], v19 offset:38912
v_mfma_f32_16x16x32_bf16 v[184:187], v[92:95], a[216:219], v[184:187]
ds_read_b64_tr_b16 v[72:73], v19 offset:40960
buffer_load_dwordx4 v31, s[16:19], s42 offen offset:3072 sc1 lds
v_mfma_f32_16x16x32_bf16 v[184:187], v[88:91], a[208:211], v[184:187]
ds_read_b64_tr_b16 v[74:75], v19 offset:43008
v_mfma_f32_16x16x32_bf16 v[184:187], v[84:87], a[200:203], v[184:187]
ds_read_b64_tr_b16 v[76:77], v19 offset:45056
v_mfma_f32_16x16x32_bf16 v[184:187], v[80:83], a[192:195], v[184:187]
s_waitcnt lgkmcnt(7)
ds_read_b64_tr_b16 v[78:79], v19 offset:47104
v_mfma_f32_16x16x32_bf16 v[192:195], v[96:99], a[192:195], v[192:195]
s_add_u32 m0, s41, 16384
ds_read_b64_tr_b16 v[80:81], v16 offset:49152
s_mul_i32 s42, s49, 112
v_mfma_f32_16x16x32_bf16 v[192:195], v[100:103], a[200:203], v[192:195]
ds_read_b64_tr_b16 v[82:83], v16 offset:51200
buffer_load_dwordx4 v28, s[16:19], s42 offen sc1 lds
v_mfma_f32_16x16x32_bf16 v[192:195], v[104:107], a[208:211], v[192:195]
ds_read_b64_tr_b16 v[84:85], v16 offset:53248
v_mfma_f32_16x16x32_bf16 v[192:195], v[108:111], a[216:219], v[192:195]
ds_read_b64_tr_b16 v[86:87], v16 offset:55296
v_mfma_f32_16x16x32_bf16 v[196:199], v[108:111], a[220:223], v[196:199]
ds_read_b64_tr_b16 v[88:89], v16 offset:57344
buffer_load_dwordx4 v29, s[16:19], s42 offen offset:1024 sc1 lds
v_mfma_f32_16x16x32_bf16 v[196:199], v[104:107], a[212:215], v[196:199]
s_lshl_b32 s79, s38, 12
ds_read_b64_tr_b16 v[90:91], v16 offset:59392
s_add_u32 s79, s79, s69
v_mfma_f32_16x16x32_bf16 v[196:199], v[100:103], a[204:207], v[196:199]
s_lshl_b32 s3, s38, 8
ds_read_b64_tr_b16 v[92:93], v16 offset:61440
s_add_u32 s3, s3, s74
v_mfma_f32_16x16x32_bf16 v[196:199], v[96:99], a[196:199], v[196:199]
s_waitcnt lgkmcnt(7)
ds_read_b64_tr_b16 v[94:95], v16 offset:63488
v_mfma_f32_16x16x32_bf16 v[204:207], v[64:67], a[196:199], v[204:207]
ds_read_b64_tr_b16 v[96:97], v17 offset:49152
buffer_load_dwordx4 v30, s[16:19], s42 offen offset:2048 sc1 lds
v_mfma_f32_16x16x32_bf16 v[204:207], v[68:71], a[204:207], v[204:207]
ds_read_b64_tr_b16 v[98:99], v17 offset:51200
v_mfma_f32_16x16x32_bf16 v[204:207], v[72:75], a[212:215], v[204:207]
ds_read_b64_tr_b16 v[100:101], v17 offset:53248
v_mfma_f32_16x16x32_bf16 v[204:207], v[76:79], a[220:223], v[204:207]
ds_read_b64_tr_b16 v[102:103], v17 offset:55296
v_mfma_f32_16x16x32_bf16 v[200:203], v[76:79], a[216:219], v[200:203]
ds_read_b64_tr_b16 v[104:105], v17 offset:57344
buffer_load_dwordx4 v31, s[16:19], s42 offen offset:3072 sc1 lds
v_mfma_f32_16x16x32_bf16 v[200:203], v[72:75], a[208:211], v[200:203]
ds_read_b64_tr_b16 v[106:107], v17 offset:59392
v_mfma_f32_16x16x32_bf16 v[200:203], v[68:71], a[200:203], v[200:203]
ds_read_b64_tr_b16 v[108:109], v17 offset:61440
v_mfma_f32_16x16x32_bf16 v[200:203], v[64:67], a[192:195], v[200:203]
s_waitcnt vmcnt(8) lgkmcnt(7)
ds_read_b64_tr_b16 v[110:111], v17 offset:63488
v_mfma_f32_16x16x32_bf16 v[176:179], v[80:83], a[224:227], v[176:179]
s_add_u32 m0, s41, 32768
ds_read_b64_tr_b16 v[64:65], v18 offset:49152
s_mul_i32 s42, s50, 112
v_mfma_f32_16x16x32_bf16 v[176:179], v[84:87], a[232:235], v[176:179]
ds_read_b64_tr_b16 v[66:67], v18 offset:51200
buffer_load_dwordx4 v28, s[16:19], s42 offen sc1 lds
v_mfma_f32_16x16x32_bf16 v[176:179], v[88:91], a[240:243], v[176:179]
ds_read_b64_tr_b16 v[68:69], v18 offset:53248
v_mfma_f32_16x16x32_bf16 v[176:179], v[92:95], a[248:251], v[176:179]
ds_read_b64_tr_b16 v[70:71], v18 offset:55296
v_mfma_f32_16x16x32_bf16 v[180:183], v[92:95], a[252:255], v[180:183]
ds_read_b64_tr_b16 v[72:73], v18 offset:57344
buffer_load_dwordx4 v29, s[16:19], s42 offen offset:1024 sc1 lds
v_mfma_f32_16x16x32_bf16 v[180:183], v[88:91], a[244:247], v[180:183]
ds_read_b64_tr_b16 v[74:75], v18 offset:59392
v_mfma_f32_16x16x32_bf16 v[180:183], v[84:87], a[236:239], v[180:183]
ds_read_b64_tr_b16 v[76:77], v18 offset:61440
v_mfma_f32_16x16x32_bf16 v[180:183], v[80:83], a[228:231], v[180:183]
s_waitcnt lgkmcnt(7)
ds_read_b64_tr_b16 v[78:79], v18 offset:63488
v_mfma_f32_16x16x32_bf16 v[188:191], v[96:99], a[228:231], v[188:191]
ds_read_b64_tr_b16 v[80:81], v19 offset:49152
buffer_load_dwordx4 v30, s[16:19], s42 offen offset:2048 sc1 lds
v_mfma_f32_16x16x32_bf16 v[188:191], v[100:103], a[236:239], v[188:191]
ds_read_b64_tr_b16 v[82:83], v19 offset:51200
v_mfma_f32_16x16x32_bf16 v[188:191], v[104:107], a[244:247], v[188:191]
ds_read_b64_tr_b16 v[84:85], v19 offset:53248
v_mfma_f32_16x16x32_bf16 v[188:191], v[108:111], a[252:255], v[188:191]
ds_read_b64_tr_b16 v[86:87], v19 offset:55296
v_mfma_f32_16x16x32_bf16 v[184:187], v[108:111], a[248:251], v[184:187]
ds_read_b64_tr_b16 v[88:89], v19 offset:57344
buffer_load_dwordx4 v31, s[16:19], s42 offen offset:3072 sc1 lds
v_mfma_f32_16x16x32_bf16 v[184:187], v[104:107], a[240:243], v[184:187]
ds_read_b64_tr_b16 v[90:91], v19 offset:59392
v_mfma_f32_16x16x32_bf16 v[184:187], v[100:103], a[232:235], v[184:187]
ds_read_b64_tr_b16 v[92:93], v19 offset:61440
v_mfma_f32_16x16x32_bf16 v[184:187], v[96:99], a[224:227], v[184:187]
s_waitcnt lgkmcnt(7)
ds_read_b64_tr_b16 v[94:95], v19 offset:63488
v_mfma_f32_16x16x32_bf16 v[192:195], v[64:67], a[224:227], v[192:195]
s_cmp_lg_u32 s40, 0
s_cbranch_scc1 Lc08037
v_mov_b32 v25, 0
buffer_atomic_add v25, v11, s[4:7], s35 offen offset:20 sc0 sc1
Lc08037:
v_mfma_f32_16x16x32_bf16 v[192:195], v[68:71], a[232:235], v[192:195]
v_cvt_pk_bf16_f32 v208, v176, v177
v_cvt_pk_bf16_f32 v209, v178, v179
v_mfma_f32_16x16x32_bf16 v[192:195], v[72:75], a[240:243], v[192:195]
v_cvt_pk_bf16_f32 v210, v184, v185
v_cvt_pk_bf16_f32 v211, v186, v187
v_mfma_f32_16x16x32_bf16 v[192:195], v[76:79], a[248:251], v[192:195]
buffer_store_dwordx4 v[208:211], v10, s[4:7], s79 offen sc1
v_mfma_f32_16x16x32_bf16 v[196:199], v[76:79], a[252:255], v[196:199]
v_mfma_f32_16x16x32_bf16 v[196:199], v[72:75], a[244:247], v[196:199]
v_mfma_f32_16x16x32_bf16 v[196:199], v[68:71], a[236:239], v[196:199]
v_mfma_f32_16x16x32_bf16 v[196:199], v[64:67], a[228:231], v[196:199]
s_waitcnt lgkmcnt(0)
v_mfma_f32_16x16x32_bf16 v[204:207], v[80:83], a[228:231], v[204:207]
v_cvt_pk_bf16_f32 v212, v180, v181
v_cvt_pk_bf16_f32 v213, v182, v183
v_cvt_pk_bf16_f32 v214, v188, v189
v_mfma_f32_16x16x32_bf16 v[204:207], v[84:87], a[236:239], v[204:207]
v_cvt_pk_bf16_f32 v215, v190, v191
v_mfma_f32_16x16x32_bf16 v[204:207], v[88:91], a[244:247], v[204:207]
buffer_store_dwordx4 v[212:215], v10, s[4:7], s79 offen offset:1024 sc1
v_mfma_f32_16x16x32_bf16 v[204:207], v[92:95], a[252:255], v[204:207]
v_mfma_f32_16x16x32_bf16 v[228:231], v[208:211], v[208:211], 0
v_mfma_f32_16x16x32_bf16 v[200:203], v[92:95], a[248:251], v[200:203]
v_mfma_f32_16x16x32_bf16 v[224:227], v[56:59], v[208:211], 0
v_mfma_f32_16x16x32_bf16 v[200:203], v[88:91], a[240:243], v[200:203]
v_mfma_f32_16x16x32_bf16 v[236:239], v[212:215], v[212:215], 0
v_mfma_f32_16x16x32_bf16 v[200:203], v[84:87], a[232:235], v[200:203]
v_mfma_f32_16x16x32_bf16 v[232:235], v[56:59], v[212:215], 0
v_mfma_f32_16x16x32_bf16 v[200:203], v[80:83], a[224:227], v[200:203]
v_cvt_pk_bf16_f32 v216, v192, v193
v_cvt_pk_bf16_f32 v217, v194, v195
s_nop 5
v_cvt_pk_bf16_f32 v218, v200, v201
v_cvt_pk_bf16_f32 v219, v202, v203
buffer_store_dwordx4 v[216:219], v10, s[4:7], s79 offen offset:2048 sc1
s_nop 0
v_mfma_f32_16x16x32_bf16 v[228:231], v[216:219], v[216:219], v[228:231]
v_mfma_f32_16x16x32_bf16 v[224:227], v[56:59], v[216:219], v[224:227]
v_cvt_pk_bf16_f32 v220, v196, v197
v_cvt_pk_bf16_f32 v221, v198, v199
v_cvt_pk_bf16_f32 v222, v204, v205
v_cvt_pk_bf16_f32 v223, v206, v207
buffer_store_dwordx4 v[220:223], v10, s[4:7], s79 offen offset:3072 sc1
s_nop 0
v_mfma_f32_16x16x32_bf16 v[236:239], v[220:223], v[220:223], v[236:239]
v_mfma_f32_16x16x32_bf16 v[232:235], v[56:59], v[220:223], v[232:235]
v_cndmask_b32 v241, v228, v229, s[80:81]
v_cndmask_b32 v241, v241, v230, s[82:83]
v_cndmask_b32 v241, v241, v231, s[84:85]
v_mov_b32 v240, v224
s_nop 2
v_cndmask_b32 v243, v236, v237, s[80:81]
v_cndmask_b32 v243, v243, v238, s[82:83]
v_cndmask_b32 v243, v243, v239, s[84:85]
v_mov_b32 v242, v232
buffer_store_dwordx4 v[240:243], v9, s[4:7], s3 offen sc1
s_waitcnt vmcnt(9) lgkmcnt(0)
s_barrier
s_cmp_lg_u32 s40, 0
s_cbranch_scc1 Lc09038
s_waitcnt vmcnt(5)
v_readfirstlane_b32 s45, v25
s_nop 0
s_cmp_lt_u32 s45, 16
s_cbranch_scc0 Lpok10040
Lpw10039:
v_mov_b32 v25, 0
buffer_atomic_add v25, v11, s[4:7], s35 offen offset:20 sc0 sc1
s_add_u32 s47, s47, 1
s_cmp_ge_u32 s47, 0x40000
s_cbranch_scc1 Lend
s_waitcnt vmcnt(0)
v_readfirstlane_b32 s45, v25
s_nop 0
s_cmp_lt_u32 s45, 16
s_cbranch_scc1 Lpw10039
Lpok10040:
s_min_u32 s45, s36, 3
s_lshl_b32 s46, s38, 3
s_add_u32 s46, s46, s45
s_add_u32 s46, s46, 3
s_lshl_b32 s46, s46, 12
s_add_u32 s46, s46, 131072
buffer_load_dwordx4 v[144:147], v1, s[4:7], s46 offen sc1
buffer_load_dwordx4 v[148:151], v1, s[4:7], s46 offen offset:1024 sc1
buffer_load_dwordx4 v[152:155], v1, s[4:7], s46 offen offset:2048 sc1
buffer_load_dwordx4 v[156:159], v1, s[4:7], s46 offen offset:3072 sc1
Lc09038:
s_add_u32 m0, s41, 49152
s_mul_i32 s42, s51, 112
buffer_load_dwordx4 v28, s[16:19], s42 offen sc1 lds
buffer_load_dwordx4 v29, s[16:19], s42 offen offset:1024 sc1 lds
buffer_load_dwordx4 v30, s[16:19], s42 offen offset:2048 sc1 lds
buffer_load_dwordx4 v31, s[16:19], s42 offen offset:3072 sc1 lds
ds_read_b64_tr_b16 v[64:65], v12 offset:0
ds_read_b64_tr_b16 v[66:67], v12 offset:2048
ds_read_b64_tr_b16 v[68:69], v13 offset:0
ds_read_b64_tr_b16 v[70:71], v13 offset:2048
ds_read_b64_tr_b16 v[72:73], v14 offset:0
ds_read_b64_tr_b16 v[74:75], v14 offset:2048
ds_read_b64_tr_b16 v[76:77], v15 offset:0
ds_read_b64_tr_b16 v[78:79], v15 offset:2048
ds_read_b64_tr_b16 v[80:81], v12 offset:4096
ds_read_b64_tr_b16 v[82:83], v12 offset:6144
ds_read_b64_tr_b16 v[84:85], v13 offset:4096
ds_read_b64_tr_b16 v[86:87], v13 offset:6144
ds_read_b64_tr_b16 v[88:89], v14 offset:4096
ds_read_b64_tr_b16 v[90:91], v14 offset:6144
ds_read_b64_tr_b16 v[92:93], v15 offset:4096
ds_read_b64_tr_b16 v[94:95], v15 offset:6144
s_cmp_lg_u32 s36, 0
s_cbranch_scc1 Ltw10042
s_call_b64 s[42:43], Lst11
s_branch Ltd10041
Ltw10042:
s_cmp_lg_u32 s36, 1
s_branch Lso11
Lst11:
s_branch Lst15
Lso11:
s_cbranch_scc1 Ltw10043
s_call_b64 s[42:43], Lst12
s_branch Ltd10041
Ltw10043:
s_cmp_lg_u32 s36, 2
s_cbranch_scc1 Ltw10044
s_call_b64 s[42:43], Lst13
s_branch Ltd10041
Ltw10044:
s_call_b64 s[42:43], Lst14
Ltd10041:
v_mov_b32 v25, 1
s_waitcnt vmcnt(4)
buffer_atomic_add v25, v11, s[4:7], s76 offen offset:24 sc0 sc1
s_cmp_lg_u32 s40, 0
s_cbranch_scc1 Lc010046
s_waitcnt vmcnt(5)
v_add_f32 v144, v144, v152
v_add_f32 v145, v145, v153
v_add_f32 v146, v146, v154
v_add_f32 v147, v147, v155
v_add_f32 v148, v148, v156
v_add_f32 v149, v149, v157
v_add_f32 v150, v150, v158
v_add_f32 v151, v151, v159
v_add_f32 v144, v144, v148
v_add_f32 v145, v145, v149
v_add_f32 v146, v146, v150
v_add_f32 v147, v147, v151
v_mov_b32 v148, v144
v_mov_b32 v149, v145
v_mov_b32 v150, v146
v_mov_b32 v151, v147
v_permlane32_swap_b32 v144, v148
v_permlane32_swap_b32 v145, v149
v_permlane32_swap_b32 v146, v150
v_permlane32_swap_b32 v147, v151
v_add_f32 v144, v144, v148
v_add_f32 v145, v145, v149
v_add_f32 v146, v146, v150
v_add_f32 v147, v147, v151
v_mov_b32 v148, v144
v_mov_b32 v149, v145
v_mov_b32 v150, v146
v_mov_b32 v151, v147
v_permlane16_swap_b32 v144, v148
v_permlane16_swap_b32 v145, v149
v_permlane16_swap_b32 v146, v150
v_permlane16_swap_b32 v147, v151
v_add_f32 v144, v144, v148
v_add_f32 v145, v145, v149
v_add_f32 v146, v146, v150
v_add_f32 v147, v147, v151
s_min_u32 s45, s36, 3
s_lshl_b32 s45, s45, 8
s_add_u32 s45, s45, 131840
v_and_b32 v152, 0xf0, v1
v_add_u32 v152, s45, v152
ds_write_b128 v152, v[144:147]
Lc010046:
s_add_u32 m0, s41, 65536
s_mul_i32 s42, s52, 112
buffer_load_dwordx4 v28, s[16:19], s42 offen sc1 lds
buffer_load_dwordx4 v29, s[16:19], s42 offen offset:1024 sc1 lds
buffer_load_dwordx4 v30, s[16:19], s42 offen offset:2048 sc1 lds
buffer_load_dwordx4 v31, s[16:19], s42 offen offset:3072 sc1 lds
s_add_u32 m0, s41, 81920
s_mul_i32 s42, s53, 112
buffer_load_dwordx4 v28, s[16:19], s42 offen sc1 lds
buffer_load_dwordx4 v29, s[16:19], s42 offen offset:1024 sc1 lds
buffer_load_dwordx4 v30, s[16:19], s42 offen offset:2048 sc1 lds
buffer_load_dwordx4 v31, s[16:19], s42 offen offset:3072 sc1 lds
v_mov_b32 v33, 0
buffer_atomic_add v33, v11, s[4:7], s76 offen offset:24 sc0 sc1
s_add_u32 m0, s41, 98304
s_mul_i32 s42, s54, 112
buffer_load_dwordx4 v28, s[16:19], s42 offen sc1 lds
buffer_load_dwordx4 v29, s[16:19], s42 offen offset:1024 sc1 lds
buffer_load_dwordx4 v30, s[16:19], s42 offen offset:2048 sc1 lds
buffer_load_dwordx4 v31, s[16:19], s42 offen offset:3072 sc1 lds
s_add_u32 m0, s41, 114688
s_mul_i32 s42, s55, 112
buffer_load_dwordx4 v28, s[16:19], s42 offen sc1 lds
buffer_load_dwordx4 v29, s[16:19], s42 offen offset:1024 sc1 lds
buffer_load_dwordx4 v30, s[16:19], s42 offen offset:2048 sc1 lds
buffer_load_dwordx4 v31, s[16:19], s42 offen offset:3072 sc1 lds
s_waitcnt vmcnt(17)
v_readfirstlane_b32 s45, v25
s_nop 0
s_cmp_lt_u32 s45, 15
s_cbranch_scc0 Lpok11048
s_waitcnt vmcnt(8)
v_readfirstlane_b32 s45, v33
s_nop 0
s_cmp_lt_u32 s45, 16
s_cbranch_scc0 Lpok11048
Lpw11047:
v_mov_b32 v25, 0
buffer_atomic_add v25, v11, s[4:7], s76 offen offset:24 sc0 sc1
s_add_u32 s47, s47, 1
s_cmp_ge_u32 s47, 0x40000
s_cbranch_scc1 Lend
s_waitcnt vmcnt(0)
v_readfirstlane_b32 s45, v25
s_nop 0
s_cmp_lt_u32 s45, 16
s_cbranch_scc1 Lpw11047
Lpok11048:
s_add_u32 s43, s48, s69
buffer_load_dwordx4 a[0:3], v10, s[4:7], s43 offen sc1
buffer_load_dwordx4 a[4:7], v10, s[4:7], s43 offen offset:1024 sc1
buffer_load_dwordx4 a[8:11], v10, s[4:7], s43 offen offset:2048 sc1
buffer_load_dwordx4 a[12:15], v10, s[4:7], s43 offen offset:3072 sc1
buffer_load_dwordx4 a[16:19], v2, s[4:7], s43 offen sc1
buffer_load_dwordx4 a[20:23], v2, s[4:7], s43 offen offset:1024 sc1
buffer_load_dwordx4 a[24:27], v2, s[4:7], s43 offen offset:2048 sc1
buffer_load_dwordx4 a[28:31], v2, s[4:7], s43 offen offset:3072 sc1
s_add_u32 s43, s49, s69
buffer_load_dwordx4 a[32:35], v10, s[4:7], s43 offen sc1
buffer_load_dwordx4 a[36:39], v10, s[4:7], s43 offen offset:1024 sc1
buffer_load_dwordx4 a[40:43], v10, s[4:7], s43 offen offset:2048 sc1
buffer_load_dwordx4 a[44:47], v10, s[4:7], s43 offen offset:3072 sc1
buffer_load_dwordx4 a[48:51], v2, s[4:7], s43 offen sc1
buffer_load_dwordx4 a[52:55], v2, s[4:7], s43 offen offset:1024 sc1
buffer_load_dwordx4 a[56:59], v2, s[4:7], s43 offen offset:2048 sc1
buffer_load_dwordx4 a[60:63], v2, s[4:7], s43 offen offset:3072 sc1
s_cmp_lg_u32 s40, 0
s_cbranch_scc1 Lc011049
s_add_u32 s42, s4, 100663424
s_addc_u32 s43, s5, 0
s_and_b32 s45, s38, 7
s_cmp_eq_u32 s45, 3
s_cselect_b64 s[8:9], s[42:43], s[8:9]
s_add_u32 s42, s4, 107020416
s_addc_u32 s43, s5, 0
s_and_b32 s45, s38, 7
s_cmp_eq_u32 s45, 3
s_cselect_b64 s[12:13], s[42:43], s[12:13]
s_add_u32 s42, s4, 109183104
s_addc_u32 s43, s5, 0
s_and_b32 s45, s38, 7
s_cmp_eq_u32 s45, 3
s_cselect_b64 s[16:17], s[42:43], s[16:17]
s_add_u32 s42, s4, 116588672
s_addc_u32 s43, s5, 0
s_xor_b64 s[66:67], s[42:43], s[20:21]
s_and_b32 s45, s38, 7
s_cmp_eq_u32 s45, 3
s_cselect_b64 s[26:27], s[66:67], 0
s_bitcmp1_b32 0x8888, s38
s_cselect_b64 s[66:67], s[66:67], 0
Lc011049:
s_waitcnt vmcnt(14) lgkmcnt(8)
v_mfma_f32_16x16x32_bf16 v[112:115], v[64:67], a[0:3], 0
s_add_u32 s43, s50, s69
ds_read_b64_tr_b16 v[96:97], v12 offset:8192
buffer_load_dwordx4 a[64:67], v10, s[4:7], s43 offen sc1
v_mfma_f32_16x16x32_bf16 v[116:119], v[64:67], a[4:7], 0
ds_read_b64_tr_b16 v[98:99], v12 offset:10240
v_mfma_f32_16x16x32_bf16 v[120:123], v[68:71], a[0:3], 0
ds_read_b64_tr_b16 v[100:101], v13 offset:8192
v_mfma_f32_16x16x32_bf16 v[124:127], v[68:71], a[4:7], 0
ds_read_b64_tr_b16 v[102:103], v13 offset:10240
v_mfma_f32_16x16x32_bf16 v[128:131], v[72:75], a[0:3], 0
ds_read_b64_tr_b16 v[104:105], v14 offset:8192
buffer_load_dwordx4 a[68:71], v10, s[4:7], s43 offen offset:1024 sc1
v_mfma_f32_16x16x32_bf16 v[132:135], v[72:75], a[4:7], 0
s_cmp_eq_u32 s40, 0
ds_read_b64_tr_b16 v[106:107], v14 offset:10240
s_cselect_b32 s10, 6291456, 0
v_mfma_f32_16x16x32_bf16 v[136:139], v[76:79], a[0:3], 0
ds_read_b64_tr_b16 v[108:109], v15 offset:8192
v_mfma_f32_16x16x32_bf16 v[140:143], v[76:79], a[4:7], 0
s_waitcnt vmcnt(14) lgkmcnt(7)
ds_read_b64_tr_b16 v[110:111], v15 offset:10240
v_mfma_f32_16x16x32_bf16 v[112:115], v[80:83], a[8:11], v[112:115]
ds_read_b64_tr_b16 v[64:65], v12 offset:12288
buffer_load_dwordx4 a[72:75], v10, s[4:7], s43 offen offset:2048 sc1
v_mfma_f32_16x16x32_bf16 v[116:119], v[80:83], a[12:15], v[116:119]
ds_read_b64_tr_b16 v[66:67], v12 offset:14336
v_mfma_f32_16x16x32_bf16 v[120:123], v[84:87], a[8:11], v[120:123]
ds_read_b64_tr_b16 v[68:69], v13 offset:12288
v_mfma_f32_16x16x32_bf16 v[124:127], v[84:87], a[12:15], v[124:127]
ds_read_b64_tr_b16 v[70:71], v13 offset:14336
v_mfma_f32_16x16x32_bf16 v[128:131], v[88:91], a[8:11], v[128:131]
ds_read_b64_tr_b16 v[72:73], v14 offset:12288
buffer_load_dwordx4 a[76:79], v10, s[4:7], s43 offen offset:3072 sc1
v_mfma_f32_16x16x32_bf16 v[132:135], v[88:91], a[12:15], v[132:135]
ds_read_b64_tr_b16 v[74:75], v14 offset:14336
v_mfma_f32_16x16x32_bf16 v[136:139], v[92:95], a[8:11], v[136:139]
ds_read_b64_tr_b16 v[76:77], v15 offset:12288
v_mfma_f32_16x16x32_bf16 v[140:143], v[92:95], a[12:15], v[140:143]
s_waitcnt vmcnt(14) lgkmcnt(7)
ds_read_b64_tr_b16 v[78:79], v15 offset:14336
v_mfma_f32_16x16x32_bf16 v[112:115], v[96:99], a[16:19], v[112:115]
ds_read_b64_tr_b16 v[80:81], v12 offset:16384
buffer_load_dwordx4 a[80:83], v2, s[4:7], s43 offen sc1
v_mfma_f32_16x16x32_bf16 v[116:119], v[96:99], a[20:23], v[116:119]
ds_read_b64_tr_b16 v[82:83], v12 offset:18432
v_mfma_f32_16x16x32_bf16 v[120:123], v[100:103], a[16:19], v[120:123]
ds_read_b64_tr_b16 v[84:85], v12 offset:20480
v_mfma_f32_16x16x32_bf16 v[124:127], v[100:103], a[20:23], v[124:127]
ds_read_b64_tr_b16 v[86:87], v12 offset:22528
v_mfma_f32_16x16x32_bf16 v[128:131], v[104:107], a[16:19], v[128:131]
ds_read_b64_tr_b16 v[88:89], v12 offset:24576
buffer_load_dwordx4 a[84:87], v2, s[4:7], s43 offen offset:1024 sc1
v_mfma_f32_16x16x32_bf16 v[132:135], v[104:107], a[20:23], v[132:135]
ds_read_b64_tr_b16 v[90:91], v12 offset:26624
v_mfma_f32_16x16x32_bf16 v[136:139], v[108:111], a[16:19], v[136:139]
ds_read_b64_tr_b16 v[92:93], v12 offset:28672
v_mfma_f32_16x16x32_bf16 v[140:143], v[108:111], a[20:23], v[140:143]
s_waitcnt vmcnt(14) lgkmcnt(7)
ds_read_b64_tr_b16 v[94:95], v12 offset:30720
v_mfma_f32_16x16x32_bf16 v[112:115], v[64:67], a[24:27], v[112:115]
ds_read_b64_tr_b16 v[96:97], v13 offset:16384
buffer_load_dwordx4 a[88:91], v2, s[4:7], s43 offen offset:2048 sc1
v_mfma_f32_16x16x32_bf16 v[116:119], v[64:67], a[28:31], v[116:119]
ds_read_b64_tr_b16 v[98:99], v13 offset:18432
v_mfma_f32_16x16x32_bf16 v[120:123], v[68:71], a[24:27], v[120:123]
ds_read_b64_tr_b16 v[100:101], v13 offset:20480
buffer_load_dwordx4 a[92:95], v2, s[4:7], s43 offen offset:3072 sc1
v_mfma_f32_16x16x32_bf16 v[124:127], v[68:71], a[28:31], v[124:127]
ds_read_b64_tr_b16 v[102:103], v13 offset:22528
v_mfma_f32_16x16x32_bf16 v[128:131], v[72:75], a[24:27], v[128:131]
ds_read_b64_tr_b16 v[104:105], v13 offset:24576
v_mfma_f32_16x16x32_bf16 v[132:135], v[72:75], a[28:31], v[132:135]
ds_read_b64_tr_b16 v[106:107], v13 offset:26624
buffer_load_dwordx4 v[208:211], v1, s[4:7], s74 offen sc1
v_mfma_f32_16x16x32_bf16 v[136:139], v[76:79], a[24:27], v[136:139]
ds_read_b64_tr_b16 v[108:109], v13 offset:28672
v_mfma_f32_16x16x32_bf16 v[140:143], v[76:79], a[28:31], v[140:143]
s_waitcnt vmcnt(9) lgkmcnt(7)
ds_read_b64_tr_b16 v[110:111], v13 offset:30720
v_mfma_f32_16x16x32_bf16 v[112:115], v[80:83], a[32:35], v[112:115]
s_add_u32 s43, s51, s69
ds_read_b64_tr_b16 v[64:65], v14 offset:16384
buffer_load_dwordx4 a[96:99], v10, s[4:7], s43 offen sc1
v_mfma_f32_16x16x32_bf16 v[112:115], v[84:87], a[40:43], v[112:115]
ds_read_b64_tr_b16 v[66:67], v14 offset:18432
v_mfma_f32_16x16x32_bf16 v[112:115], v[88:91], a[48:51], v[112:115]
ds_read_b64_tr_b16 v[68:69], v14 offset:20480
buffer_load_dwordx4 a[100:103], v10, s[4:7], s43 offen offset:1024 sc1
v_mfma_f32_16x16x32_bf16 v[112:115], v[92:95], a[56:59], v[112:115]
ds_read_b64_tr_b16 v[70:71], v14 offset:22528
v_mfma_f32_16x16x32_bf16 v[116:119], v[92:95], a[60:63], v[116:119]
ds_read_b64_tr_b16 v[72:73], v14 offset:24576
v_mfma_f32_16x16x32_bf16 v[116:119], v[88:91], a[52:55], v[116:119]
ds_read_b64_tr_b16 v[74:75], v14 offset:26624
buffer_load_dwordx4 v[212:215], v1, s[4:7], s74 offen offset:1024 sc1
v_mfma_f32_16x16x32_bf16 v[116:119], v[84:87], a[44:47], v[116:119]
ds_read_b64_tr_b16 v[76:77], v14 offset:28672
v_mfma_f32_16x16x32_bf16 v[116:119], v[80:83], a[36:39], v[116:119]
s_waitcnt lgkmcnt(7)
ds_read_b64_tr_b16 v[78:79], v14 offset:30720
v_mfma_f32_16x16x32_bf16 v[124:127], v[96:99], a[36:39], v[124:127]
ds_read_b64_tr_b16 v[80:81], v15 offset:16384
buffer_load_dwordx4 a[104:107], v10, s[4:7], s43 offen offset:2048 sc1
v_mfma_f32_16x16x32_bf16 v[124:127], v[100:103], a[44:47], v[124:127]
ds_read_b64_tr_b16 v[82:83], v15 offset:18432
v_mfma_f32_16x16x32_bf16 v[124:127], v[104:107], a[52:55], v[124:127]
ds_read_b64_tr_b16 v[84:85], v15 offset:20480
buffer_load_dwordx4 a[108:111], v10, s[4:7], s43 offen offset:3072 sc1
v_mfma_f32_16x16x32_bf16 v[124:127], v[108:111], a[60:63], v[124:127]
ds_read_b64_tr_b16 v[86:87], v15 offset:22528
v_mfma_f32_16x16x32_bf16 v[120:123], v[108:111], a[56:59], v[120:123]
ds_read_b64_tr_b16 v[88:89], v15 offset:24576
v_mfma_f32_16x16x32_bf16 v[120:123], v[104:107], a[48:51], v[120:123]
ds_read_b64_tr_b16 v[90:91], v15 offset:26624
buffer_load_dwordx4 v[216:219], v1, s[4:7], s74 offen offset:2048 sc1
v_mfma_f32_16x16x32_bf16 v[120:123], v[100:103], a[40:43], v[120:123]
ds_read_b64_tr_b16 v[92:93], v15 offset:28672
v_mfma_f32_16x16x32_bf16 v[120:123], v[96:99], a[32:35], v[120:123]
s_waitcnt lgkmcnt(7)
s_barrier
ds_read_b64_tr_b16 v[94:95], v15 offset:30720
v_mfma_f32_16x16x32_bf16 v[128:131], v[64:67], a[32:35], v[128:131]
ds_read_b64_tr_b16 v[96:97], v12 offset:32768
buffer_load_dwordx4 a[112:115], v2, s[4:7], s43 offen sc1
v_mfma_f32_16x16x32_bf16 v[128:131], v[68:71], a[40:43], v[128:131]
ds_read_b64_tr_b16 v[98:99], v12 offset:34816
v_mfma_f32_16x16x32_bf16 v[128:131], v[72:75], a[48:51], v[128:131]
ds_read_b64_tr_b16 v[100:101], v12 offset:36864
buffer_load_dwordx4 a[116:119], v2, s[4:7], s43 offen offset:1024 sc1
v_mfma_f32_16x16x32_bf16 v[128:131], v[76:79], a[56:59], v[128:131]
ds_read_b64_tr_b16 v[102:103], v12 offset:38912
v_mfma_f32_16x16x32_bf16 v[132:135], v[76:79], a[60:63], v[132:135]
ds_read_b64_tr_b16 v[104:105], v12 offset:40960
v_mfma_f32_16x16x32_bf16 v[132:135], v[72:75], a[52:55], v[132:135]
ds_read_b64_tr_b16 v[106:107], v12 offset:43008
buffer_load_dwordx4 v[220:223], v1, s[4:7], s74 offen offset:3072 sc1
v_mfma_f32_16x16x32_bf16 v[132:135], v[68:71], a[44:47], v[132:135]
ds_read_b64_tr_b16 v[108:109], v12 offset:45056
v_mfma_f32_16x16x32_bf16 v[132:135], v[64:67], a[36:39], v[132:135]
s_waitcnt lgkmcnt(7)
ds_read_b64_tr_b16 v[110:111], v12 offset:47104
v_mfma_f32_16x16x32_bf16 v[140:143], v[80:83], a[36:39], v[140:143]
ds_read_b64_tr_b16 v[64:65], v13 offset:32768
buffer_load_dwordx4 a[120:123], v2, s[4:7], s43 offen offset:2048 sc1
v_mfma_f32_16x16x32_bf16 v[140:143], v[84:87], a[44:47], v[140:143]
ds_read_b64_tr_b16 v[66:67], v13 offset:34816
v_mfma_f32_16x16x32_bf16 v[140:143], v[88:91], a[52:55], v[140:143]
ds_read_b64_tr_b16 v[68:69], v13 offset:36864
v_mfma_f32_16x16x32_bf16 v[140:143], v[92:95], a[60:63], v[140:143]
ds_read_b64_tr_b16 v[70:71], v13 offset:38912
v_mfma_f32_16x16x32_bf16 v[136:139], v[92:95], a[56:59], v[136:139]
ds_read_b64_tr_b16 v[72:73], v13 offset:40960
buffer_load_dwordx4 a[124:127], v2, s[4:7], s43 offen offset:3072 sc1
v_mfma_f32_16x16x32_bf16 v[136:139], v[88:91], a[48:51], v[136:139]
ds_read_b64_tr_b16 v[74:75], v13 offset:43008
v_mfma_f32_16x16x32_bf16 v[136:139], v[84:87], a[40:43], v[136:139]
ds_read_b64_tr_b16 v[76:77], v13 offset:45056
v_mfma_f32_16x16x32_bf16 v[136:139], v[80:83], a[32:35], v[136:139]
s_waitcnt vmcnt(12) lgkmcnt(7)
ds_read_b64_tr_b16 v[78:79], v13 offset:47104
v_mfma_f32_16x16x32_bf16 v[112:115], v[96:99], a[64:67], v[112:115]
s_add_u32 s43, s52, s69
ds_read_b64_tr_b16 v[80:81], v14 offset:32768
buffer_load_dwordx4 a[128:131], v10, s[4:7], s43 offen sc1
v_mfma_f32_16x16x32_bf16 v[112:115], v[100:103], a[72:75], v[112:115]
ds_read_b64_tr_b16 v[82:83], v14 offset:34816
v_mfma_f32_16x16x32_bf16 v[112:115], v[104:107], a[80:83], v[112:115]
ds_read_b64_tr_b16 v[84:85], v14 offset:36864
v_mfma_f32_16x16x32_bf16 v[112:115], v[108:111], a[88:91], v[112:115]
ds_read_b64_tr_b16 v[86:87], v14 offset:38912
v_mfma_f32_16x16x32_bf16 v[116:119], v[108:111], a[92:95], v[116:119]
ds_read_b64_tr_b16 v[88:89], v14 offset:40960
buffer_load_dwordx4 a[132:135], v10, s[4:7], s43 offen offset:1024 sc1
v_mfma_f32_16x16x32_bf16 v[116:119], v[104:107], a[84:87], v[116:119]
ds_read_b64_tr_b16 v[90:91], v14 offset:43008
v_mfma_f32_16x16x32_bf16 v[116:119], v[100:103], a[76:79], v[116:119]
ds_read_b64_tr_b16 v[92:93], v14 offset:45056
v_mfma_f32_16x16x32_bf16 v[116:119], v[96:99], a[68:71], v[116:119]
s_waitcnt lgkmcnt(7)
ds_read_b64_tr_b16 v[94:95], v14 offset:47104
v_mfma_f32_16x16x32_bf16 v[124:127], v[64:67], a[68:71], v[124:127]
ds_read_b64_tr_b16 v[96:97], v15 offset:32768
buffer_load_dwordx4 a[136:139], v10, s[4:7], s43 offen offset:2048 sc1
v_mfma_f32_16x16x32_bf16 v[124:127], v[68:71], a[76:79], v[124:127]
ds_read_b64_tr_b16 v[98:99], v15 offset:34816
v_mfma_f32_16x16x32_bf16 v[124:127], v[72:75], a[84:87], v[124:127]
ds_read_b64_tr_b16 v[100:101], v15 offset:36864
v_mfma_f32_16x16x32_bf16 v[124:127], v[76:79], a[92:95], v[124:127]
ds_read_b64_tr_b16 v[102:103], v15 offset:38912
v_mfma_f32_16x16x32_bf16 v[120:123], v[76:79], a[88:91], v[120:123]
ds_read_b64_tr_b16 v[104:105], v15 offset:40960
buffer_load_dwordx4 a[140:143], v10, s[4:7], s43 offen offset:3072 sc1
v_mfma_f32_16x16x32_bf16 v[120:123], v[72:75], a[80:83], v[120:123]
ds_read_b64_tr_b16 v[106:107], v15 offset:43008
v_mfma_f32_16x16x32_bf16 v[120:123], v[68:71], a[72:75], v[120:123]
ds_read_b64_tr_b16 v[108:109], v15 offset:45056
v_mfma_f32_16x16x32_bf16 v[120:123], v[64:67], a[64:67], v[120:123]
s_waitcnt lgkmcnt(7)
ds_read_b64_tr_b16 v[110:111], v15 offset:47104
v_mfma_f32_16x16x32_bf16 v[128:131], v[80:83], a[64:67], v[128:131]
ds_read_b64_tr_b16 v[64:65], v12 offset:49152
buffer_load_dwordx4 a[144:147], v2, s[4:7], s43 offen sc1
v_mfma_f32_16x16x32_bf16 v[128:131], v[84:87], a[72:75], v[128:131]
ds_read_b64_tr_b16 v[66:67], v12 offset:51200
v_mfma_f32_16x16x32_bf16 v[128:131], v[88:91], a[80:83], v[128:131]
ds_read_b64_tr_b16 v[68:69], v12 offset:53248
v_mfma_f32_16x16x32_bf16 v[128:131], v[92:95], a[88:91], v[128:131]
ds_read_b64_tr_b16 v[70:71], v12 offset:55296
v_mfma_f32_16x16x32_bf16 v[132:135], v[92:95], a[92:95], v[132:135]
ds_read_b64_tr_b16 v[72:73], v12 offset:57344
buffer_load_dwordx4 a[148:151], v2, s[4:7], s43 offen offset:1024 sc1
v_mfma_f32_16x16x32_bf16 v[132:135], v[88:91], a[84:87], v[132:135]
ds_read_b64_tr_b16 v[74:75], v12 offset:59392
v_mfma_f32_16x16x32_bf16 v[132:135], v[84:87], a[76:79], v[132:135]
ds_read_b64_tr_b16 v[76:77], v12 offset:61440
v_mfma_f32_16x16x32_bf16 v[132:135], v[80:83], a[68:71], v[132:135]
s_waitcnt lgkmcnt(7)
ds_read_b64_tr_b16 v[78:79], v12 offset:63488
v_mfma_f32_16x16x32_bf16 v[140:143], v[96:99], a[68:71], v[140:143]
ds_read_b64_tr_b16 v[80:81], v13 offset:49152
buffer_load_dwordx4 a[152:155], v2, s[4:7], s43 offen offset:2048 sc1
v_mfma_f32_16x16x32_bf16 v[140:143], v[100:103], a[76:79], v[140:143]
s_waitcnt vmcnt(9)
ds_read_b64_tr_b16 v[82:83], v13 offset:51200
v_add_f32 v208, v208, v212
v_mfma_f32_16x16x32_bf16 v[140:143], v[104:107], a[84:87], v[140:143]
ds_read_b64_tr_b16 v[84:85], v13 offset:53248
v_add_f32 v209, v209, v213
v_mfma_f32_16x16x32_bf16 v[140:143], v[108:111], a[92:95], v[140:143]
ds_read_b64_tr_b16 v[86:87], v13 offset:55296
v_add_f32 v210, v210, v214
v_mfma_f32_16x16x32_bf16 v[136:139], v[108:111], a[88:91], v[136:139]
ds_read_b64_tr_b16 v[88:89], v13 offset:57344
buffer_load_dwordx4 a[156:159], v2, s[4:7], s43 offen offset:3072 sc1
v_mfma_f32_16x16x32_bf16 v[136:139], v[104:107], a[80:83], v[136:139]
ds_read_b64_tr_b16 v[90:91], v13 offset:59392
v_add_f32 v211, v211, v215
v_mfma_f32_16x16x32_bf16 v[136:139], v[100:103], a[72:75], v[136:139]
ds_read_b64_tr_b16 v[92:93], v13 offset:61440
v_add_f32 v216, v216, v220
v_add_f32 v217, v217, v221
v_mfma_f32_16x16x32_bf16 v[136:139], v[96:99], a[64:67], v[136:139]
s_waitcnt vmcnt(8) lgkmcnt(7)
ds_read_b64_tr_b16 v[94:95], v13 offset:63488
v_add_f32 v218, v218, v222
v_mfma_f32_16x16x32_bf16 v[112:115], v[64:67], a[96:99], v[112:115]
s_add_u32 s43, s53, s69
ds_read_b64_tr_b16 v[96:97], v14 offset:49152
buffer_load_dwordx4 a[160:163], v10, s[4:7], s43 offen sc1
v_mfma_f32_16x16x32_bf16 v[112:115], v[68:71], a[104:107], v[112:115]
ds_read_b64_tr_b16 v[98:99], v14 offset:51200
v_add_f32 v219, v219, v223
v_mfma_f32_16x16x32_bf16 v[112:115], v[72:75], a[112:115], v[112:115]
ds_read_b64_tr_b16 v[100:101], v14 offset:53248
v_add_f32 v208, v208, v216
v_mfma_f32_16x16x32_bf16 v[112:115], v[76:79], a[120:123], v[112:115]
ds_read_b64_tr_b16 v[102:103], v14 offset:55296
v_add_f32 v209, v209, v217
v_mfma_f32_16x16x32_bf16 v[116:119], v[76:79], a[124:127], v[116:119]
ds_read_b64_tr_b16 v[104:105], v14 offset:57344
buffer_load_dwordx4 a[164:167], v10, s[4:7], s43 offen offset:1024 sc1
v_mfma_f32_16x16x32_bf16 v[116:119], v[72:75], a[116:119], v[116:119]
ds_read_b64_tr_b16 v[106:107], v14 offset:59392
v_add_f32 v210, v210, v218
v_mfma_f32_16x16x32_bf16 v[116:119], v[68:71], a[108:111], v[116:119]
ds_read_b64_tr_b16 v[108:109], v14 offset:61440
v_add_f32 v211, v211, v219
v_mfma_f32_16x16x32_bf16 v[116:119], v[64:67], a[100:103], v[116:119]
s_waitcnt lgkmcnt(7)
ds_read_b64_tr_b16 v[110:111], v14 offset:63488
v_mov_b32 v212, v208
v_mfma_f32_16x16x32_bf16 v[124:127], v[80:83], a[100:103], v[124:127]
ds_read_b64_tr_b16 v[64:65], v15 offset:49152
buffer_load_dwordx4 a[168:171], v10, s[4:7], s43 offen offset:2048 sc1
v_mfma_f32_16x16x32_bf16 v[124:127], v[84:87], a[108:111], v[124:127]
ds_read_b64_tr_b16 v[66:67], v15 offset:51200
v_mov_b32 v213, v209
v_mfma_f32_16x16x32_bf16 v[124:127], v[88:91], a[116:119], v[124:127]
ds_read_b64_tr_b16 v[68:69], v15 offset:53248
v_mfma_f32_16x16x32_bf16 v[124:127], v[92:95], a[124:127], v[124:127]
ds_read_b64_tr_b16 v[70:71], v15 offset:55296
v_mfma_f32_16x16x32_bf16 v[120:123], v[92:95], a[120:123], v[120:123]
ds_read_b64_tr_b16 v[72:73], v15 offset:57344
buffer_load_dwordx4 a[172:175], v10, s[4:7], s43 offen offset:3072 sc1
v_mfma_f32_16x16x32_bf16 v[120:123], v[88:91], a[112:115], v[120:123]
ds_read_b64_tr_b16 v[74:75], v15 offset:59392
ds_read_b128 v[48:51], v5 offset:1536
v_mov_b32 v214, v210
v_mfma_f32_16x16x32_bf16 v[120:123], v[84:87], a[104:107], v[120:123]
ds_read_b64_tr_b16 v[76:77], v15 offset:61440
ds_read_b128 v[52:55], v5 offset:1600
ds_read_b128 v[56:59], v5 offset:1664
v_mov_b32 v215, v211
ds_read_b128 v[60:63], v5 offset:1728
v_mfma_f32_16x16x32_bf16 v[120:123], v[80:83], a[96:99], v[120:123]
s_waitcnt lgkmcnt(11)
ds_read_b64_tr_b16 v[78:79], v15 offset:63488
v_mfma_f32_16x16x32_bf16 v[128:131], v[96:99], a[96:99], v[128:131]
ds_read_b64_tr_b16 v[80:81], v16 offset:0
buffer_load_dwordx4 a[176:179], v2, s[4:7], s43 offen sc1
v_mfma_f32_16x16x32_bf16 v[128:131], v[100:103], a[104:107], v[128:131]
ds_read_b64_tr_b16 v[82:83], v16 offset:2048
v_permlane32_swap_b32 v208, v212
v_mfma_f32_16x16x32_bf16 v[128:131], v[104:107], a[112:115], v[128:131]
ds_read_b64_tr_b16 v[84:85], v16 offset:4096
v_permlane32_swap_b32 v209, v213
v_mfma_f32_16x16x32_bf16 v[128:131], v[108:111], a[120:123], v[128:131]
ds_read_b64_tr_b16 v[86:87], v16 offset:6144
v_permlane32_swap_b32 v210, v214
v_mfma_f32_16x16x32_bf16 v[132:135], v[108:111], a[124:127], v[132:135]
ds_read_b64_tr_b16 v[88:89], v16 offset:8192
v_permlane32_swap_b32 v211, v215
v_mfma_f32_16x16x32_bf16 v[132:135], v[104:107], a[116:119], v[132:135]
ds_read_b64_tr_b16 v[90:91], v16 offset:10240
buffer_load_dwordx4 a[180:183], v2, s[4:7], s43 offen offset:1024 sc1
v_mfma_f32_16x16x32_bf16 v[132:135], v[100:103], a[108:111], v[132:135]
ds_read_b64_tr_b16 v[92:93], v16 offset:12288
v_add_f32 v208, v208, v212
v_add_f32 v209, v209, v213
v_mfma_f32_16x16x32_bf16 v[132:135], v[96:99], a[100:103], v[132:135]
s_waitcnt lgkmcnt(7)
ds_read_b64_tr_b16 v[94:95], v16 offset:14336
v_add_f32 v210, v210, v214
v_mfma_f32_16x16x32_bf16 v[140:143], v[64:67], a[100:103], v[140:143]
ds_read_b64_tr_b16 v[96:97], v17 offset:0
buffer_load_dwordx4 a[184:187], v2, s[4:7], s43 offen offset:2048 sc1
v_mfma_f32_16x16x32_bf16 v[140:143], v[68:71], a[108:111], v[140:143]
ds_read_b64_tr_b16 v[98:99], v17 offset:2048
v_add_f32 v211, v211, v215
v_mfma_f32_16x16x32_bf16 v[140:143], v[72:75], a[116:119], v[140:143]
ds_read_b64_tr_b16 v[100:101], v17 offset:4096
v_mov_b32 v212, v208
v_mfma_f32_16x16x32_bf16 v[140:143], v[76:79], a[124:127], v[140:143]
ds_read_b64_tr_b16 v[102:103], v17 offset:6144
v_mov_b32 v213, v209
v_mfma_f32_16x16x32_bf16 v[136:139], v[76:79], a[120:123], v[136:139]
ds_read_b64_tr_b16 v[104:105], v17 offset:8192
buffer_load_dwordx4 a[188:191], v2, s[4:7], s43 offen offset:3072 sc1
v_mfma_f32_16x16x32_bf16 v[136:139], v[72:75], a[112:115], v[136:139]
ds_read_b64_tr_b16 v[106:107], v17 offset:10240
v_mov_b32 v214, v210
v_mfma_f32_16x16x32_bf16 v[136:139], v[68:71], a[104:107], v[136:139]
ds_read_b64_tr_b16 v[108:109], v17 offset:12288
v_mov_b32 v215, v211
v_mfma_f32_16x16x32_bf16 v[136:139], v[64:67], a[96:99], v[136:139]
s_waitcnt vmcnt(8) lgkmcnt(7)
ds_read_b64_tr_b16 v[110:111], v17 offset:14336
v_permlane16_swap_b32 v208, v212
v_mfma_f32_16x16x32_bf16 v[112:115], v[80:83], a[128:131], v[112:115]
s_add_u32 s43, s54, s69
ds_read_b64_tr_b16 v[64:65], v18 offset:0
buffer_load_dwordx4 a[192:195], v10, s[4:7], s43 offen sc1
v_mfma_f32_16x16x32_bf16 v[112:115], v[84:87], a[136:139], v[112:115]
ds_read_b64_tr_b16 v[66:67], v18 offset:2048
v_permlane16_swap_b32 v209, v213
v_mfma_f32_16x16x32_bf16 v[112:115], v[88:91], a[144:147], v[112:115]
ds_read_b64_tr_b16 v[68:69], v18 offset:4096
v_permlane16_swap_b32 v210, v214
v_mfma_f32_16x16x32_bf16 v[112:115], v[92:95], a[152:155], v[112:115]
ds_read_b64_tr_b16 v[70:71], v18 offset:6144
v_permlane16_swap_b32 v211, v215
v_mfma_f32_16x16x32_bf16 v[116:119], v[92:95], a[156:159], v[116:119]
ds_read_b64_tr_b16 v[72:73], v18 offset:8192
v_add_f32 v208, v208, v212
v_mfma_f32_16x16x32_bf16 v[116:119], v[88:91], a[148:151], v[116:119]
ds_read_b64_tr_b16 v[74:75], v18 offset:10240
buffer_load_dwordx4 a[196:199], v10, s[4:7], s43 offen offset:1024 sc1
v_mfma_f32_16x16x32_bf16 v[116:119], v[84:87], a[140:143], v[116:119]
ds_read_b64_tr_b16 v[76:77], v18 offset:12288
v_add_f32 v209, v209, v213
v_add_f32 v210, v210, v214
v_mfma_f32_16x16x32_bf16 v[116:119], v[80:83], a[132:135], v[116:119]
s_waitcnt lgkmcnt(7)
ds_read_b64_tr_b16 v[78:79], v18 offset:14336
v_add_f32 v211, v211, v215
v_mfma_f32_16x16x32_bf16 v[124:127], v[96:99], a[132:135], v[124:127]
ds_read_b64_tr_b16 v[80:81], v19 offset:0
buffer_load_dwordx4 a[200:203], v10, s[4:7], s43 offen offset:2048 sc1
v_mfma_f32_16x16x32_bf16 v[124:127], v[100:103], a[140:143], v[124:127]
ds_read_b64_tr_b16 v[82:83], v19 offset:2048
v_mul_f32 v42, 0xba800000, v208
v_mfma_f32_16x16x32_bf16 v[124:127], v[104:107], a[148:151], v[124:127]
ds_read_b64_tr_b16 v[84:85], v19 offset:4096
v_mul_f32 v43, 0xba800000, v210
v_mfma_f32_16x16x32_bf16 v[124:127], v[108:111], a[156:159], v[124:127]
ds_read_b64_tr_b16 v[86:87], v19 offset:6144
v_mul_f32 v209, 0x3a800000, v209
v_mfma_f32_16x16x32_bf16 v[120:123], v[108:111], a[152:155], v[120:123]
ds_read_b64_tr_b16 v[88:89], v19 offset:8192
v_mul_f32 v211, 0x3a800000, v211
v_mfma_f32_16x16x32_bf16 v[120:123], v[104:107], a[144:147], v[120:123]
ds_read_b64_tr_b16 v[90:91], v19 offset:10240
buffer_load_dwordx4 a[204:207], v10, s[4:7], s43 offen offset:3072 sc1
v_mfma_f32_16x16x32_bf16 v[120:123], v[100:103], a[136:139], v[120:123]
ds_read_b64_tr_b16 v[92:93], v19 offset:12288
v_fma_f32 v209, -v42, v42, v209
v_fma_f32 v211, -v43, v43, v211
v_mfma_f32_16x16x32_bf16 v[120:123], v[96:99], a[128:131], v[120:123]
s_waitcnt lgkmcnt(7)
ds_read_b64_tr_b16 v[94:95], v19 offset:14336
v_max_f32 v209, 0, v209
v_mfma_f32_16x16x32_bf16 v[128:131], v[64:67], a[128:131], v[128:131]
ds_read_b64_tr_b16 v[96:97], v16 offset:16384
buffer_load_dwordx4 a[208:211], v2, s[4:7], s43 offen sc1
v_mfma_f32_16x16x32_bf16 v[128:131], v[68:71], a[136:139], v[128:131]
ds_read_b64_tr_b16 v[98:99], v16 offset:18432
v_max_f32 v211, 0, v211
v_mfma_f32_16x16x32_bf16 v[128:131], v[72:75], a[144:147], v[128:131]
ds_read_b64_tr_b16 v[100:101], v16 offset:20480
v_add_f32 v209, 0x3727c5ac, v209
v_mfma_f32_16x16x32_bf16 v[128:131], v[76:79], a[152:155], v[128:131]
ds_read_b64_tr_b16 v[102:103], v16 offset:22528
v_add_f32 v211, 0x3727c5ac, v211
v_mfma_f32_16x16x32_bf16 v[132:135], v[76:79], a[156:159], v[132:135]
ds_read_b64_tr_b16 v[104:105], v16 offset:24576
buffer_load_dwordx4 a[212:215], v2, s[4:7], s43 offen offset:1024 sc1
v_mfma_f32_16x16x32_bf16 v[132:135], v[72:75], a[148:151], v[132:135]
ds_read_b64_tr_b16 v[106:107], v16 offset:26624
v_rsq_f32 v40, v209
v_mfma_f32_16x16x32_bf16 v[132:135], v[68:71], a[140:143], v[132:135]
ds_read_b64_tr_b16 v[108:109], v16 offset:28672
v_rsq_f32 v41, v211
v_mfma_f32_16x16x32_bf16 v[132:135], v[64:67], a[132:135], v[132:135]
s_waitcnt lgkmcnt(7)
ds_read_b64_tr_b16 v[110:111], v16 offset:30720
v_mfma_f32_16x16x32_bf16 v[140:143], v[80:83], a[132:135], v[140:143]
ds_read_b64_tr_b16 v[64:65], v17 offset:16384
buffer_load_dwordx4 a[216:219], v2, s[4:7], s43 offen offset:2048 sc1
v_mfma_f32_16x16x32_bf16 v[140:143], v[84:87], a[140:143], v[140:143]
s_nop 0
ds_read_b64_tr_b16 v[66:67], v17 offset:18432
v_mul_f32 v40, 0xbfb8aa3b, v40
v_mfma_f32_16x16x32_bf16 v[140:143], v[88:91], a[148:151], v[140:143]
ds_read_b64_tr_b16 v[68:69], v17 offset:20480
v_mul_f32 v41, 0xbfb8aa3b, v41
v_mfma_f32_16x16x32_bf16 v[140:143], v[92:95], a[156:159], v[140:143]
ds_read_b64_tr_b16 v[70:71], v17 offset:22528
v_mfma_f32_16x16x32_bf16 v[136:139], v[92:95], a[152:155], v[136:139]
ds_read_b64_tr_b16 v[72:73], v17 offset:24576
buffer_load_dwordx4 a[220:223], v2, s[4:7], s43 offen offset:3072 sc1
v_mfma_f32_16x16x32_bf16 v[136:139], v[88:91], a[144:147], v[136:139]
s_branch Lso12
Lst12:
s_branch Lst16
Lso12:
ds_read_b64_tr_b16 v[74:75], v17 offset:26624
v_add_f32 v48, v48, v56
v_mfma_f32_16x16x32_bf16 v[136:139], v[84:87], a[136:139], v[136:139]
ds_read_b64_tr_b16 v[76:77], v17 offset:28672
v_add_f32 v49, v49, v57
v_add_f32 v50, v50, v58
v_mfma_f32_16x16x32_bf16 v[136:139], v[80:83], a[128:131], v[136:139]
s_waitcnt vmcnt(8) lgkmcnt(7)
ds_read_b64_tr_b16 v[78:79], v17 offset:30720
v_add_f32 v51, v51, v59
v_mfma_f32_16x16x32_bf16 v[112:115], v[96:99], a[160:163], v[112:115]
s_add_u32 s43, s55, s69
ds_read_b64_tr_b16 v[80:81], v18 offset:16384
buffer_load_dwordx4 a[224:227], v10, s[4:7], s43 offen sc1
v_mfma_f32_16x16x32_bf16 v[112:115], v[100:103], a[168:171], v[112:115]
ds_read_b64_tr_b16 v[82:83], v18 offset:18432
v_add_f32 v52, v52, v60
v_mfma_f32_16x16x32_bf16 v[112:115], v[104:107], a[176:179], v[112:115]
ds_read_b64_tr_b16 v[84:85], v18 offset:20480
v_add_f32 v53, v53, v61
v_mfma_f32_16x16x32_bf16 v[112:115], v[108:111], a[184:187], v[112:115]
ds_read_b64_tr_b16 v[86:87], v18 offset:22528
v_add_f32 v54, v54, v62
v_mfma_f32_16x16x32_bf16 v[116:119], v[108:111], a[188:191], v[116:119]
ds_read_b64_tr_b16 v[88:89], v18 offset:24576
buffer_load_dwordx4 a[228:231], v10, s[4:7], s43 offen offset:1024 sc1
v_mfma_f32_16x16x32_bf16 v[116:119], v[104:107], a[180:183], v[116:119]
ds_read_b64_tr_b16 v[90:91], v18 offset:26624
v_add_f32 v55, v55, v63
v_mfma_f32_16x16x32_bf16 v[116:119], v[100:103], a[172:175], v[116:119]
ds_read_b64_tr_b16 v[92:93], v18 offset:28672
v_mul_f32 v240, v48, v42
v_mfma_f32_16x16x32_bf16 v[116:119], v[96:99], a[164:167], v[116:119]
s_waitcnt lgkmcnt(7)
ds_read_b64_tr_b16 v[94:95], v18 offset:30720
v_mul_f32 v241, v49, v42
v_mfma_f32_16x16x32_bf16 v[124:127], v[64:67], a[164:167], v[124:127]
ds_read_b64_tr_b16 v[96:97], v19 offset:16384
buffer_load_dwordx4 a[232:235], v10, s[4:7], s43 offen offset:2048 sc1
v_mfma_f32_16x16x32_bf16 v[124:127], v[68:71], a[172:175], v[124:127]
ds_read_b64_tr_b16 v[98:99], v19 offset:18432
v_mul_f32 v242, v50, v42
v_mfma_f32_16x16x32_bf16 v[124:127], v[72:75], a[180:183], v[124:127]
ds_read_b64_tr_b16 v[100:101], v19 offset:20480
v_mul_f32 v243, v51, v42
v_mfma_f32_16x16x32_bf16 v[124:127], v[76:79], a[188:191], v[124:127]
ds_read_b64_tr_b16 v[102:103], v19 offset:22528
v_mul_f32 v244, v48, v43
v_mfma_f32_16x16x32_bf16 v[120:123], v[76:79], a[184:187], v[120:123]
ds_read_b64_tr_b16 v[104:105], v19 offset:24576
v_mul_f32 v245, v49, v43
v_mfma_f32_16x16x32_bf16 v[120:123], v[72:75], a[176:179], v[120:123]
ds_read_b64_tr_b16 v[106:107], v19 offset:26624
buffer_load_dwordx4 a[236:239], v10, s[4:7], s43 offen offset:3072 sc1
v_mfma_f32_16x16x32_bf16 v[120:123], v[68:71], a[168:171], v[120:123]
ds_read_b64_tr_b16 v[108:109], v19 offset:28672
v_mul_f32 v246, v50, v43
v_mul_f32 v247, v51, v43
v_mfma_f32_16x16x32_bf16 v[120:123], v[64:67], a[160:163], v[120:123]
s_waitcnt lgkmcnt(7)
s_barrier
ds_read_b64_tr_b16 v[110:111], v19 offset:30720
v_mul_f32 v248, v52, v42
v_mfma_f32_16x16x32_bf16 v[128:131], v[80:83], a[160:163], v[128:131]
ds_read_b64_tr_b16 v[64:65], v16 offset:32768
buffer_load_dwordx4 a[240:243], v2, s[4:7], s43 offen sc1
v_mfma_f32_16x16x32_bf16 v[128:131], v[84:87], a[168:171], v[128:131]
ds_read_b64_tr_b16 v[66:67], v16 offset:34816
v_mul_f32 v249, v53, v42
v_mfma_f32_16x16x32_bf16 v[128:131], v[88:91], a[176:179], v[128:131]
ds_read_b64_tr_b16 v[68:69], v16 offset:36864
v_mul_f32 v250, v54, v42
v_mfma_f32_16x16x32_bf16 v[128:131], v[92:95], a[184:187], v[128:131]
ds_read_b64_tr_b16 v[70:71], v16 offset:38912
v_mul_f32 v251, v55, v42
v_mfma_f32_16x16x32_bf16 v[132:135], v[92:95], a[188:191], v[132:135]
ds_read_b64_tr_b16 v[72:73], v16 offset:40960
v_mul_f32 v252, v52, v43
v_mfma_f32_16x16x32_bf16 v[132:135], v[88:91], a[180:183], v[132:135]
ds_read_b64_tr_b16 v[74:75], v16 offset:43008
buffer_load_dwordx4 a[244:247], v2, s[4:7], s43 offen offset:1024 sc1
v_mfma_f32_16x16x32_bf16 v[132:135], v[84:87], a[172:175], v[132:135]
ds_read_b64_tr_b16 v[76:77], v16 offset:45056
v_mul_f32 v253, v53, v43
v_mul_f32 v254, v54, v43
v_mfma_f32_16x16x32_bf16 v[132:135], v[80:83], a[164:167], v[132:135]
s_waitcnt lgkmcnt(7)
ds_read_b64_tr_b16 v[78:79], v16 offset:47104
v_mul_f32 v255, v55, v43
v_mfma_f32_16x16x32_bf16 v[140:143], v[96:99], a[164:167], v[140:143]
ds_read_b64_tr_b16 v[80:81], v17 offset:32768
buffer_load_dwordx4 a[248:251], v2, s[4:7], s43 offen offset:2048 sc1
v_mfma_f32_16x16x32_bf16 v[140:143], v[100:103], a[172:175], v[140:143]
ds_read_b64_tr_b16 v[82:83], v17 offset:34816
v_mfma_f32_16x16x32_bf16 v[140:143], v[104:107], a[180:183], v[140:143]
ds_read_b64_tr_b16 v[84:85], v17 offset:36864
buffer_load_dwordx4 a[252:255], v2, s[4:7], s43 offen offset:3072 sc1
v_mfma_f32_16x16x32_bf16 v[140:143], v[108:111], a[188:191], v[140:143]
s_add_u32 m0, s41, 0
ds_read_b64_tr_b16 v[86:87], v17 offset:38912
s_lshl1_add_u32 s42, s48, s64
v_mfma_f32_16x16x32_bf16 v[136:139], v[108:111], a[184:187], v[136:139]
ds_read_b64_tr_b16 v[88:89], v17 offset:40960
buffer_load_dwordx4 v1, s[4:7], s42 offen sc1 lds
v_mfma_f32_16x16x32_bf16 v[136:139], v[104:107], a[176:179], v[136:139]
ds_read_b64_tr_b16 v[90:91], v17 offset:43008
buffer_load_dwordx4 v1, s[4:7], s42 offen offset:1024 sc1 lds
v_mfma_f32_16x16x32_bf16 v[136:139], v[100:103], a[168:171], v[136:139]
ds_read_b64_tr_b16 v[92:93], v17 offset:45056
ds_read_b128 v[48:51], v5 offset:1024
ds_read_b128 v[52:55], v5 offset:1088
ds_read_b128 v[56:59], v5 offset:1152
ds_read_b128 v[60:63], v5 offset:1216
v_mfma_f32_16x16x32_bf16 v[136:139], v[96:99], a[160:163], v[136:139]
s_waitcnt vmcnt(10) lgkmcnt(11)
ds_read_b64_tr_b16 v[94:95], v17 offset:47104
v_mfma_f32_16x16x32_bf16 v[112:115], v[64:67], a[192:195], v[112:115]
ds_read_b64_tr_b16 v[96:97], v18 offset:32768
buffer_load_dwordx4 v1, s[4:7], s42 offen offset:2048 sc1 lds
v_mfma_f32_16x16x32_bf16 v[112:115], v[68:71], a[200:203], v[112:115]
ds_read_b64_tr_b16 v[98:99], v18 offset:34816
v_mfma_f32_16x16x32_bf16 v[112:115], v[72:75], a[208:211], v[112:115]
ds_read_b64_tr_b16 v[100:101], v18 offset:36864
v_mfma_f32_16x16x32_bf16 v[112:115], v[76:79], a[216:219], v[112:115]
ds_read_b64_tr_b16 v[102:103], v18 offset:38912
v_mfma_f32_16x16x32_bf16 v[116:119], v[76:79], a[220:223], v[116:119]
ds_read_b64_tr_b16 v[104:105], v18 offset:40960
v_mfma_f32_16x16x32_bf16 v[116:119], v[72:75], a[212:215], v[116:119]
ds_read_b64_tr_b16 v[106:107], v18 offset:43008
v_mfma_f32_16x16x32_bf16 v[116:119], v[68:71], a[204:207], v[116:119]
ds_read_b64_tr_b16 v[108:109], v18 offset:45056
v_mfma_f32_16x16x32_bf16 v[116:119], v[64:67], a[196:199], v[116:119]
s_waitcnt lgkmcnt(7)
ds_read_b64_tr_b16 v[110:111], v18 offset:47104
v_mfma_f32_16x16x32_bf16 v[124:127], v[80:83], a[196:199], v[124:127]
ds_read_b64_tr_b16 v[64:65], v19 offset:32768
buffer_load_dwordx4 v1, s[4:7], s42 offen offset:3072 sc1 lds
v_mfma_f32_16x16x32_bf16 v[124:127], v[84:87], a[204:207], v[124:127]
ds_read_b64_tr_b16 v[66:67], v19 offset:34816
v_mul_f32 v144, v48, v42
v_mfma_f32_16x16x32_bf16 v[124:127], v[88:91], a[212:215], v[124:127]
ds_read_b64_tr_b16 v[68:69], v19 offset:36864
v_mul_f32 v145, v49, v42
v_mfma_f32_16x16x32_bf16 v[124:127], v[92:95], a[220:223], v[124:127]
ds_read_b64_tr_b16 v[70:71], v19 offset:38912
v_mul_f32 v146, v50, v42
v_mfma_f32_16x16x32_bf16 v[120:123], v[92:95], a[216:219], v[120:123]
ds_read_b64_tr_b16 v[72:73], v19 offset:40960
v_mul_f32 v147, v51, v42
v_mfma_f32_16x16x32_bf16 v[120:123], v[88:91], a[208:211], v[120:123]
ds_read_b64_tr_b16 v[74:75], v19 offset:43008
v_mul_f32 v148, v48, v43
v_mfma_f32_16x16x32_bf16 v[120:123], v[84:87], a[200:203], v[120:123]
ds_read_b64_tr_b16 v[76:77], v19 offset:45056
v_mul_f32 v149, v49, v43
v_mfma_f32_16x16x32_bf16 v[120:123], v[80:83], a[192:195], v[120:123]
s_waitcnt lgkmcnt(7)
ds_read_b64_tr_b16 v[78:79], v19 offset:47104
v_mfma_f32_16x16x32_bf16 v[128:131], v[96:99], a[192:195], v[128:131]
ds_read_b64_tr_b16 v[80:81], v16 offset:49152
v_mul_f32 v150, v50, v43
v_mfma_f32_16x16x32_bf16 v[128:131], v[100:103], a[200:203], v[128:131]
ds_read_b64_tr_b16 v[82:83], v16 offset:51200
v_mul_f32 v151, v51, v43
v_mfma_f32_16x16x32_bf16 v[128:131], v[104:107], a[208:211], v[128:131]
ds_read_b64_tr_b16 v[84:85], v16 offset:53248
v_mul_f32 v152, v52, v42
v_mfma_f32_16x16x32_bf16 v[128:131], v[108:111], a[216:219], v[128:131]
ds_read_b64_tr_b16 v[86:87], v16 offset:55296
v_mul_f32 v153, v53, v42
v_mfma_f32_16x16x32_bf16 v[132:135], v[108:111], a[220:223], v[132:135]
ds_read_b64_tr_b16 v[88:89], v16 offset:57344
v_mul_f32 v154, v54, v42
v_mfma_f32_16x16x32_bf16 v[132:135], v[104:107], a[212:215], v[132:135]
ds_read_b64_tr_b16 v[90:91], v16 offset:59392
v_mul_f32 v155, v55, v42
v_mfma_f32_16x16x32_bf16 v[132:135], v[100:103], a[204:207], v[132:135]
ds_read_b64_tr_b16 v[92:93], v16 offset:61440
v_mul_f32 v156, v52, v43
v_mfma_f32_16x16x32_bf16 v[132:135], v[96:99], a[196:199], v[132:135]
s_waitcnt lgkmcnt(7)
ds_read_b64_tr_b16 v[94:95], v16 offset:63488
v_mul_f32 v157, v53, v43
v_mfma_f32_16x16x32_bf16 v[140:143], v[64:67], a[196:199], v[140:143]
ds_read_b64_tr_b16 v[96:97], v17 offset:49152
v_mul_f32 v158, v54, v43
v_mfma_f32_16x16x32_bf16 v[140:143], v[68:71], a[204:207], v[140:143]
ds_read_b64_tr_b16 v[98:99], v17 offset:51200
v_mul_f32 v159, v55, v43
v_mfma_f32_16x16x32_bf16 v[140:143], v[72:75], a[212:215], v[140:143]
ds_read_b64_tr_b16 v[100:101], v17 offset:53248
v_mul_f32 v160, v56, v42
v_mfma_f32_16x16x32_bf16 v[140:143], v[76:79], a[220:223], v[140:143]
ds_read_b64_tr_b16 v[102:103], v17 offset:55296
v_mul_f32 v161, v57, v42
v_mfma_f32_16x16x32_bf16 v[136:139], v[76:79], a[216:219], v[136:139]
ds_read_b64_tr_b16 v[104:105], v17 offset:57344
v_mul_f32 v162, v58, v42
v_mfma_f32_16x16x32_bf16 v[136:139], v[72:75], a[208:211], v[136:139]
ds_read_b64_tr_b16 v[106:107], v17 offset:59392
v_mul_f32 v163, v59, v42
v_mfma_f32_16x16x32_bf16 v[136:139], v[68:71], a[200:203], v[136:139]
ds_read_b64_tr_b16 v[108:109], v17 offset:61440
v_mul_f32 v164, v56, v43
v_mfma_f32_16x16x32_bf16 v[136:139], v[64:67], a[192:195], v[136:139]
s_waitcnt vmcnt(4) lgkmcnt(7)
ds_read_b64_tr_b16 v[110:111], v17 offset:63488
v_mfma_f32_16x16x32_bf16 v[112:115], v[80:83], a[224:227], v[112:115]
s_add_u32 m0, s41, 16384
ds_read_b64_tr_b16 v[64:65], v18 offset:49152
s_lshl1_add_u32 s42, s49, s64
v_mfma_f32_16x16x32_bf16 v[112:115], v[84:87], a[232:235], v[112:115]
ds_read_b64_tr_b16 v[66:67], v18 offset:51200
buffer_load_dwordx4 v1, s[4:7], s42 offen sc1 lds
v_mfma_f32_16x16x32_bf16 v[112:115], v[88:91], a[240:243], v[112:115]
ds_read_b64_tr_b16 v[68:69], v18 offset:53248
v_mul_f32 v165, v57, v43
v_mfma_f32_16x16x32_bf16 v[112:115], v[92:95], a[248:251], v[112:115]
ds_read_b64_tr_b16 v[70:71], v18 offset:55296
v_mul_f32 v166, v58, v43
v_mfma_f32_16x16x32_bf16 v[116:119], v[92:95], a[252:255], v[116:119]
ds_read_b64_tr_b16 v[72:73], v18 offset:57344
buffer_load_dwordx4 v1, s[4:7], s42 offen offset:1024 sc1 lds
v_mfma_f32_16x16x32_bf16 v[116:119], v[88:91], a[244:247], v[116:119]
ds_read_b64_tr_b16 v[74:75], v18 offset:59392
v_mul_f32 v167, v59, v43
v_mfma_f32_16x16x32_bf16 v[116:119], v[84:87], a[236:239], v[116:119]
ds_read_b64_tr_b16 v[76:77], v18 offset:61440
v_mul_f32 v168, v60, v42
v_mfma_f32_16x16x32_bf16 v[116:119], v[80:83], a[228:231], v[116:119]
s_waitcnt lgkmcnt(7)
ds_read_b64_tr_b16 v[78:79], v18 offset:63488
v_mfma_f32_16x16x32_bf16 v[124:127], v[96:99], a[228:231], v[124:127]
ds_read_b64_tr_b16 v[80:81], v19 offset:49152
buffer_load_dwordx4 v1, s[4:7], s42 offen offset:2048 sc1 lds
v_mfma_f32_16x16x32_bf16 v[124:127], v[100:103], a[236:239], v[124:127]
ds_read_b64_tr_b16 v[82:83], v19 offset:51200
v_mul_f32 v169, v61, v42
v_mfma_f32_16x16x32_bf16 v[124:127], v[104:107], a[244:247], v[124:127]
ds_read_b64_tr_b16 v[84:85], v19 offset:53248
v_mul_f32 v170, v62, v42
v_mfma_f32_16x16x32_bf16 v[124:127], v[108:111], a[252:255], v[124:127]
ds_read_b64_tr_b16 v[86:87], v19 offset:55296
v_mfma_f32_16x16x32_bf16 v[120:123], v[108:111], a[248:251], v[120:123]
ds_read_b64_tr_b16 v[88:89], v19 offset:57344
buffer_load_dwordx4 v1, s[4:7], s42 offen offset:3072 sc1 lds
v_mfma_f32_16x16x32_bf16 v[120:123], v[104:107], a[240:243], v[120:123]
ds_read_b64_tr_b16 v[90:91], v19 offset:59392
v_mul_f32 v171, v63, v42
v_mfma_f32_16x16x32_bf16 v[120:123], v[100:103], a[232:235], v[120:123]
ds_read_b64_tr_b16 v[92:93], v19 offset:61440
v_mul_f32 v172, v60, v43
v_mfma_f32_16x16x32_bf16 v[120:123], v[96:99], a[224:227], v[120:123]
s_waitcnt vmcnt(4) lgkmcnt(7)
s_barrier
ds_read_b64_tr_b16 v[94:95], v19 offset:63488
v_mfma_f32_16x16x32_bf16 v[128:131], v[64:67], a[224:227], v[128:131]
s_add_u32 m0, s41, 32768
s_lshl1_add_u32 s42, s50, s64
buffer_load_dwordx4 v1, s[4:7], s42 offen sc1 lds
v_mfma_f32_16x16x32_bf16 v[128:131], v[68:71], a[232:235], v[128:131]
ds_read_b128 v[96:99], v1 offset:0
v_mul_f32 v173, v61, v43
v_mfma_f32_16x16x32_bf16 v[128:131], v[72:75], a[240:243], v[128:131]
ds_read_b128 v[100:103], v1 offset:4096
v_mul_f32 v174, v62, v43
v_mfma_f32_16x16x32_bf16 v[128:131], v[76:79], a[248:251], v[128:131]
v_mfma_f32_16x16x32_bf16 v[132:135], v[76:79], a[252:255], v[132:135]
buffer_load_dwordx4 v1, s[4:7], s42 offen offset:1024 sc1 lds
v_mfma_f32_16x16x32_bf16 v[132:135], v[72:75], a[244:247], v[132:135]
ds_read_b128 v[104:107], v1 offset:8192
v_mul_f32 v175, v63, v43
v_mfma_f32_16x16x32_bf16 v[132:135], v[68:71], a[236:239], v[132:135]
ds_read_b128 v[108:111], v1 offset:12288
v_mfma_f32_16x16x32_bf16 v[132:135], v[64:67], a[228:231], v[132:135]
s_waitcnt lgkmcnt(4)
v_mfma_f32_16x16x32_bf16 v[140:143], v[80:83], a[228:231], v[140:143]
buffer_load_dwordx4 v1, s[4:7], s42 offen offset:2048 sc1 lds
v_mfma_f32_16x16x32_bf16 v[140:143], v[84:87], a[236:239], v[140:143]
ds_read_b128 v[64:67], v1 offset:1024
v_mfma_f32_16x16x32_bf16 v[140:143], v[88:91], a[244:247], v[140:143]
ds_read_b128 v[68:71], v1 offset:5120
v_mfma_f32_16x16x32_bf16 v[140:143], v[92:95], a[252:255], v[140:143]
v_mfma_f32_16x16x32_bf16 v[136:139], v[92:95], a[248:251], v[136:139]
buffer_load_dwordx4 v1, s[4:7], s42 offen offset:3072 sc1 lds
v_mfma_f32_16x16x32_bf16 v[136:139], v[88:91], a[240:243], v[136:139]
ds_read_b128 v[72:75], v1 offset:9216
ds_read_b128 v[48:51], v5 offset:768
v_mfma_f32_16x16x32_bf16 v[136:139], v[84:87], a[232:235], v[136:139]
ds_read_b128 v[76:79], v1 offset:13312
ds_read_b128 v[52:55], v5 offset:832
ds_read_b128 v[56:59], v5 offset:896
ds_read_b128 v[60:63], v5 offset:960
v_mfma_f32_16x16x32_bf16 v[136:139], v[80:83], a[224:227], v[136:139]
s_waitcnt lgkmcnt(8)
v_mfma_f32_16x16x32_bf16 v[144:147], v[96:99], a[0:3], v[144:147]
s_add_u32 m0, s41, 49152
s_lshl1_add_u32 s42, s51, s64
buffer_load_dwordx4 v1, s[4:7], s42 offen sc1 lds
v_mfma_f32_16x16x32_bf16 v[144:147], v[100:103], a[8:11], v[144:147]
ds_read_b128 v[80:83], v1 offset:2048
v_mfma_f32_16x16x32_bf16 v[144:147], v[104:107], a[16:19], v[144:147]
ds_read_b128 v[84:87], v1 offset:6144
v_mfma_f32_16x16x32_bf16 v[144:147], v[108:111], a[24:27], v[144:147]
v_mfma_f32_16x16x32_bf16 v[148:151], v[108:111], a[28:31], v[148:151]
buffer_load_dwordx4 v1, s[4:7], s42 offen offset:1024 sc1 lds
v_mfma_f32_16x16x32_bf16 v[148:151], v[104:107], a[20:23], v[148:151]
ds_read_b128 v[88:91], v1 offset:10240
v_mfma_f32_16x16x32_bf16 v[148:151], v[100:103], a[12:15], v[148:151]
ds_read_b128 v[92:95], v1 offset:14336
v_mfma_f32_16x16x32_bf16 v[148:151], v[96:99], a[4:7], v[148:151]
s_waitcnt lgkmcnt(7)
v_mfma_f32_16x16x32_bf16 v[156:159], v[64:67], a[4:7], v[156:159]
buffer_load_dwordx4 v1, s[4:7], s42 offen offset:2048 sc1 lds
v_mfma_f32_16x16x32_bf16 v[156:159], v[68:71], a[12:15], v[156:159]
s_waitcnt lgkmcnt(4)
ds_read_b128 v[96:99], v1 offset:3072
v_fmac_f32 v112, v48, v42
v_mfma_f32_16x16x32_bf16 v[156:159], v[72:75], a[20:23], v[156:159]
ds_read_b128 v[100:103], v1 offset:7168
v_fmac_f32 v113, v49, v42
v_mfma_f32_16x16x32_bf16 v[156:159], v[76:79], a[28:31], v[156:159]
v_fmac_f32 v114, v50, v42
v_fmac_f32 v115, v51, v42
v_mfma_f32_16x16x32_bf16 v[152:155], v[76:79], a[24:27], v[152:155]
buffer_load_dwordx4 v1, s[4:7], s42 offen offset:3072 sc1 lds
v_mfma_f32_16x16x32_bf16 v[152:155], v[72:75], a[16:19], v[152:155]
ds_read_b128 v[104:107], v1 offset:11264
v_mul_f32 v112, v40, v112
v_mfma_f32_16x16x32_bf16 v[152:155], v[68:71], a[8:11], v[152:155]
ds_read_b128 v[108:111], v1 offset:15360
v_mul_f32 v113, v40, v113
v_mfma_f32_16x16x32_bf16 v[152:155], v[64:67], a[0:3], v[152:155]
s_waitcnt vmcnt(8) lgkmcnt(4)
s_barrier
v_mul_f32 v114, v40, v114
v_mul_f32 v115, v40, v115
v_mfma_f32_16x16x32_bf16 v[160:163], v[80:83], a[0:3], v[160:163]
s_add_u32 m0, s41, 65536
s_lshl1_add_u32 s42, s52, s64
buffer_load_dwordx4 v1, s[4:7], s42 offen sc1 lds
v_mfma_f32_16x16x32_bf16 v[160:163], v[84:87], a[8:11], v[160:163]
v_exp_f32 v224, v112
v_mfma_f32_16x16x32_bf16 v[160:163], v[88:91], a[16:19], v[160:163]
v_exp_f32 v225, v113
v_mfma_f32_16x16x32_bf16 v[160:163], v[92:95], a[24:27], v[160:163]
v_exp_f32 v226, v114
v_mfma_f32_16x16x32_bf16 v[164:167], v[92:95], a[28:31], v[164:167]
ds_read_b128 v[64:67], v1 offset:16384
buffer_load_dwordx4 v1, s[4:7], s42 offen offset:1024 sc1 lds
v_mfma_f32_16x16x32_bf16 v[164:167], v[88:91], a[20:23], v[164:167]
ds_read_b128 v[68:71], v1 offset:20480
v_exp_f32 v227, v115
v_mfma_f32_16x16x32_bf16 v[164:167], v[84:87], a[12:15], v[164:167]
ds_read_b128 v[72:75], v1 offset:24576
v_fma_f32 v224, v224, s78, s78
v_mfma_f32_16x16x32_bf16 v[164:167], v[80:83], a[4:7], v[164:167]
s_waitcnt lgkmcnt(3)
ds_read_b128 v[76:79], v1 offset:28672
v_mfma_f32_16x16x32_bf16 v[172:175], v[96:99], a[4:7], v[172:175]
buffer_load_dwordx4 v1, s[4:7], s42 offen offset:2048 sc1 lds
v_mfma_f32_16x16x32_bf16 v[172:175], v[100:103], a[12:15], v[172:175]
ds_read_b128 v[80:83], v1 offset:17408
v_fma_f32 v225, v225, s78, s78
v_mfma_f32_16x16x32_bf16 v[172:175], v[104:107], a[20:23], v[172:175]
ds_read_b128 v[84:87], v1 offset:21504
v_fma_f32 v226, v226, s78, s78
v_mfma_f32_16x16x32_bf16 v[172:175], v[108:111], a[28:31], v[172:175]
ds_read_b128 v[88:91], v1 offset:25600
v_fma_f32 v227, v227, s78, s78
v_mfma_f32_16x16x32_bf16 v[168:171], v[108:111], a[24:27], v[168:171]
buffer_load_dwordx4 v1, s[4:7], s42 offen offset:3072 sc1 lds
v_mfma_f32_16x16x32_bf16 v[168:171], v[104:107], a[16:19], v[168:171]
v_rcp_f32 v224, v224
v_mfma_f32_16x16x32_bf16 v[168:171], v[100:103], a[8:11], v[168:171]
v_rcp_f32 v225, v225
v_mfma_f32_16x16x32_bf16 v[168:171], v[96:99], a[0:3], v[168:171]
s_waitcnt lgkmcnt(3)
ds_read_b128 v[92:95], v1 offset:29696
v_rcp_f32 v226, v226
v_mfma_f32_16x16x32_bf16 v[144:147], v[64:67], a[32:35], v[144:147]
s_add_u32 m0, s41, 81920
s_lshl1_add_u32 s42, s53, s64
buffer_load_dwordx4 v1, s[4:7], s42 offen sc1 lds
v_mfma_f32_16x16x32_bf16 v[144:147], v[68:71], a[40:43], v[144:147]
v_rcp_f32 v227, v227
v_mfma_f32_16x16x32_bf16 v[144:147], v[72:75], a[48:51], v[144:147]
ds_read_b128 v[96:99], v1 offset:18432
v_mul_f32 v112, v224, v112
v_mfma_f32_16x16x32_bf16 v[144:147], v[76:79], a[56:59], v[144:147]
ds_read_b128 v[100:103], v1 offset:22528
v_mul_f32 v113, v225, v113
v_mfma_f32_16x16x32_bf16 v[148:151], v[76:79], a[60:63], v[148:151]
ds_read_b128 v[104:107], v1 offset:26624
v_mul_f32 v114, v226, v114
v_mfma_f32_16x16x32_bf16 v[148:151], v[72:75], a[52:55], v[148:151]
buffer_load_dwordx4 v1, s[4:7], s42 offen offset:1024 sc1 lds
v_mfma_f32_16x16x32_bf16 v[148:151], v[68:71], a[44:47], v[148:151]
ds_read_b128 v[108:111], v1 offset:30720
v_mul_f32 v115, v227, v115
v_mfma_f32_16x16x32_bf16 v[148:151], v[64:67], a[36:39], v[148:151]
s_waitcnt lgkmcnt(4)
v_cvt_pk_bf16_f32 v208, v112, v113
v_cvt_pk_bf16_f32 v209, v114, v115
v_mfma_f32_16x16x32_bf16 v[156:159], v[80:83], a[36:39], v[156:159]
buffer_load_dwordx4 v1, s[4:7], s42 offen offset:2048 sc1 lds
v_mfma_f32_16x16x32_bf16 v[156:159], v[84:87], a[44:47], v[156:159]
ds_read_b128 v[64:67], v1 offset:19456
v_fmac_f32 v120, v52, v42
v_mfma_f32_16x16x32_bf16 v[156:159], v[88:91], a[52:55], v[156:159]
ds_read_b128 v[68:71], v1 offset:23552
v_fmac_f32 v121, v53, v42
v_mfma_f32_16x16x32_bf16 v[156:159], v[92:95], a[60:63], v[156:159]
v_fmac_f32 v122, v54, v42
v_fmac_f32 v123, v55, v42
v_mfma_f32_16x16x32_bf16 v[152:155], v[92:95], a[56:59], v[152:155]
ds_read_b128 v[72:75], v1 offset:27648
v_mul_f32 v120, v40, v120
v_mfma_f32_16x16x32_bf16 v[152:155], v[88:91], a[48:51], v[152:155]
buffer_load_dwordx4 v1, s[4:7], s42 offen offset:3072 sc1 lds
v_mul_f32 v121, v40, v121
v_mfma_f32_16x16x32_bf16 v[152:155], v[84:87], a[40:43], v[152:155]
ds_read_b128 v[76:79], v1 offset:31744
v_mul_f32 v122, v40, v122
v_mul_f32 v123, v40, v123
v_mfma_f32_16x16x32_bf16 v[152:155], v[80:83], a[32:35], v[152:155]
s_waitcnt vmcnt(8) lgkmcnt(4)
s_barrier
v_exp_f32 v228, v120
v_mfma_f32_16x16x32_bf16 v[160:163], v[96:99], a[32:35], v[160:163]
s_lshl4_add_u32 s46, s39, s38
ds_read_b128 v[80:83], v1 offset:32768
s_mul_i32 s46, s46, 7168
v_mfma_f32_16x16x32_bf16 v[160:163], v[100:103], a[40:43], v[160:163]
s_and_b32 s45, s38, 7
ds_read_b128 v[84:87], v1 offset:36864
s_lshl3_add_u32 s45, s40, s45
v_mfma_f32_16x16x32_bf16 v[160:163], v[104:107], a[48:51], v[160:163]
s_cmp_eq_u32 s45, 0
ds_read_b128 v[88:91], v1 offset:40960
s_cselect_b32 s45, s46, 1073741824
v_mfma_f32_16x16x32_bf16 v[160:163], v[108:111], a[56:59], v[160:163]
ds_read_b128 v[92:95], v1 offset:45056
v_min_u32 v0, 7040, v34
v_mfma_f32_16x16x32_bf16 v[164:167], v[108:111], a[60:63], v[164:167]
buffer_load_dword v3, v0, s[20:23], s45 offen
v_mfma_f32_16x16x32_bf16 v[164:167], v[104:107], a[52:55], v[164:167]
v_exp_f32 v229, v121
v_mfma_f32_16x16x32_bf16 v[164:167], v[100:103], a[44:47], v[164:167]
s_add_u32 m0, s41, 98304
s_lshl1_add_u32 s42, s54, s64
buffer_load_dwordx4 v1, s[4:7], s42 offen sc1 lds
v_mfma_f32_16x16x32_bf16 v[164:167], v[96:99], a[36:39], v[164:167]
s_waitcnt lgkmcnt(4)
v_exp_f32 v230, v122
v_mfma_f32_16x16x32_bf16 v[172:175], v[64:67], a[36:39], v[172:175]
buffer_load_dwordx4 v1, s[4:7], s42 offen offset:1024 sc1 lds
v_mfma_f32_16x16x32_bf16 v[172:175], v[68:71], a[44:47], v[172:175]
v_exp_f32 v231, v123
v_mfma_f32_16x16x32_bf16 v[172:175], v[72:75], a[52:55], v[172:175]
ds_read_b128 v[96:99], v1 offset:33792
v_fma_f32 v228, v228, s78, s78
v_mfma_f32_16x16x32_bf16 v[172:175], v[76:79], a[60:63], v[172:175]
ds_read_b128 v[100:103], v1 offset:37888
v_fma_f32 v229, v229, s78, s78
v_mfma_f32_16x16x32_bf16 v[168:171], v[76:79], a[56:59], v[168:171]
ds_read_b128 v[104:107], v1 offset:41984
v_fma_f32 v230, v230, s78, s78
v_fma_f32 v231, v231, s78, s78
v_mfma_f32_16x16x32_bf16 v[168:171], v[72:75], a[48:51], v[168:171]
v_rcp_f32 v228, v228
v_mfma_f32_16x16x32_bf16 v[168:171], v[68:71], a[40:43], v[168:171]
v_rcp_f32 v229, v229
v_mfma_f32_16x16x32_bf16 v[168:171], v[64:67], a[32:35], v[168:171]
s_waitcnt lgkmcnt(3)
ds_read_b128 v[108:111], v1 offset:46080
v_rcp_f32 v230, v230
v_mfma_f32_16x16x32_bf16 v[144:147], v[80:83], a[64:67], v[144:147]
buffer_load_dwordx4 v1, s[4:7], s42 offen offset:2048 sc1 lds
v_mfma_f32_16x16x32_bf16 v[144:147], v[84:87], a[72:75], v[144:147]
v_rcp_f32 v231, v231
v_mfma_f32_16x16x32_bf16 v[144:147], v[88:91], a[80:83], v[144:147]
ds_read_b128 v[64:67], v1 offset:34816
v_mul_f32 v120, v228, v120
v_mfma_f32_16x16x32_bf16 v[144:147], v[92:95], a[88:91], v[144:147]
ds_read_b128 v[68:71], v1 offset:38912
v_mul_f32 v121, v229, v121
v_mfma_f32_16x16x32_bf16 v[148:151], v[92:95], a[92:95], v[148:151]
ds_read_b128 v[72:75], v1 offset:43008
v_mul_f32 v122, v230, v122
v_mfma_f32_16x16x32_bf16 v[148:151], v[88:91], a[84:87], v[148:151]
v_mul_f32 v123, v231, v123
v_cvt_pk_bf16_f32 v210, v120, v121
v_mfma_f32_16x16x32_bf16 v[148:151], v[84:87], a[76:79], v[148:151]
ds_read_b128 v[76:79], v1 offset:47104
v_cvt_pk_bf16_f32 v211, v122, v123
v_mfma_f32_16x16x32_bf16 v[148:151], v[80:83], a[68:71], v[148:151]
s_waitcnt lgkmcnt(4)
v_mfma_f32_16x16x32_bf16 v[156:159], v[96:99], a[68:71], v[156:159]
buffer_load_dwordx4 v1, s[4:7], s42 offen offset:3072 sc1 lds
v_mfma_f32_16x16x32_bf16 v[156:159], v[100:103], a[76:79], v[156:159]
s_lshl_b32 s46, s38, 12
s_add_u32 s46, s46, s71
v_mfma_f32_16x16x32_bf16 v[156:159], v[104:107], a[84:87], v[156:159]
buffer_store_dwordx4 v[208:211], v10, s[4:7], s46 offen sc1
v_mfma_f32_16x16x32_bf16 v[156:159], v[108:111], a[92:95], v[156:159]
ds_read_b128 v[80:83], v1 offset:35840
v_fmac_f32 v116, v48, v43
v_mfma_f32_16x16x32_bf16 v[152:155], v[108:111], a[88:91], v[152:155]
ds_read_b128 v[84:87], v1 offset:39936
v_fmac_f32 v117, v49, v43
v_fmac_f32 v118, v50, v43
v_mfma_f32_16x16x32_bf16 v[152:155], v[104:107], a[80:83], v[152:155]
ds_read_b128 v[88:91], v1 offset:44032
v_fmac_f32 v119, v51, v43
v_mfma_f32_16x16x32_bf16 v[152:155], v[100:103], a[72:75], v[152:155]
ds_read_b128 v[92:95], v1 offset:48128
v_mul_f32 v116, v41, v116
v_mul_f32 v117, v41, v117
v_mfma_f32_16x16x32_bf16 v[152:155], v[96:99], a[64:67], v[152:155]
s_waitcnt lgkmcnt(4)
v_mul_f32 v118, v41, v118
v_mul_f32 v119, v41, v119
v_mfma_f32_16x16x32_bf16 v[160:163], v[64:67], a[64:67], v[160:163]
s_lshl4_add_u32 s46, s39, s38
ds_read_b128 v[96:99], v1 offset:49152
s_mul_i32 s46, s46, 7168
v_mfma_f32_16x16x32_bf16 v[160:163], v[68:71], a[72:75], v[160:163]
s_and_b32 s45, s38, 7
ds_read_b128 v[100:103], v1 offset:53248
s_lshl3_add_u32 s45, s40, s45
v_mfma_f32_16x16x32_bf16 v[160:163], v[72:75], a[80:83], v[160:163]
s_cmp_eq_u32 s45, 6
ds_read_b128 v[104:107], v1 offset:57344
s_cselect_b32 s45, s46, 1073741824
v_mfma_f32_16x16x32_bf16 v[160:163], v[76:79], a[88:91], v[160:163]
ds_read_b128 v[108:111], v1 offset:61440
v_min_u32 v0, 7040, v34
v_mfma_f32_16x16x32_bf16 v[164:167], v[76:79], a[92:95], v[164:167]
buffer_load_dword v3, v0, s[20:23], s45 offen
v_mfma_f32_16x16x32_bf16 v[164:167], v[72:75], a[84:87], v[164:167]
v_exp_f32 v224, v116
v_mfma_f32_16x16x32_bf16 v[164:167], v[68:71], a[76:79], v[164:167]
v_exp_f32 v225, v117
s_add_u32 m0, s41, 114688
s_lshl1_add_u32 s42, s55, s64
buffer_load_dwordx4 v1, s[4:7], s42 offen sc1 lds
v_mfma_f32_16x16x32_bf16 v[164:167], v[64:67], a[68:71], v[164:167]
s_waitcnt lgkmcnt(4)
v_exp_f32 v226, v118
v_mfma_f32_16x16x32_bf16 v[172:175], v[80:83], a[68:71], v[172:175]
buffer_load_dwordx4 v1, s[4:7], s42 offen offset:1024 sc1 lds
v_mfma_f32_16x16x32_bf16 v[172:175], v[84:87], a[76:79], v[172:175]
v_exp_f32 v227, v119
v_mfma_f32_16x16x32_bf16 v[172:175], v[88:91], a[84:87], v[172:175]
ds_read_b128 v[64:67], v1 offset:50176
v_fma_f32 v224, v224, s78, s78
v_mfma_f32_16x16x32_bf16 v[172:175], v[92:95], a[92:95], v[172:175]
ds_read_b128 v[68:71], v1 offset:54272
v_fma_f32 v225, v225, s78, s78
v_mfma_f32_16x16x32_bf16 v[168:171], v[92:95], a[88:91], v[168:171]
ds_read_b128 v[72:75], v1 offset:58368
v_fma_f32 v226, v226, s78, s78
v_mfma_f32_16x16x32_bf16 v[168:171], v[88:91], a[80:83], v[168:171]
ds_read_b128 v[76:79], v1 offset:62464
v_fma_f32 v227, v227, s78, s78
v_mfma_f32_16x16x32_bf16 v[168:171], v[84:87], a[72:75], v[168:171]
v_rcp_f32 v224, v224
v_mfma_f32_16x16x32_bf16 v[168:171], v[80:83], a[64:67], v[168:171]
s_waitcnt lgkmcnt(4)
v_rcp_f32 v225, v225
v_mfma_f32_16x16x32_bf16 v[144:147], v[96:99], a[96:99], v[144:147]
buffer_load_dwordx4 v1, s[4:7], s42 offen offset:2048 sc1 lds
v_mfma_f32_16x16x32_bf16 v[144:147], v[100:103], a[104:107], v[144:147]
v_rcp_f32 v226, v226
v_mfma_f32_16x16x32_bf16 v[144:147], v[104:107], a[112:115], v[144:147]
v_rcp_f32 v227, v227
v_mfma_f32_16x16x32_bf16 v[144:147], v[108:111], a[120:123], v[144:147]
ds_read_b128 v[80:83], v1 offset:51200
v_mul_f32 v116, v224, v116
v_mfma_f32_16x16x32_bf16 v[148:151], v[108:111], a[124:127], v[148:151]
ds_read_b128 v[84:87], v1 offset:55296
v_mul_f32 v117, v225, v117
v_mul_f32 v118, v226, v118
v_mfma_f32_16x16x32_bf16 v[148:151], v[104:107], a[116:119], v[148:151]
ds_read_b128 v[88:91], v1 offset:59392
v_mul_f32 v119, v227, v119
v_mfma_f32_16x16x32_bf16 v[148:151], v[100:103], a[108:111], v[148:151]
ds_read_b128 v[92:95], v1 offset:63488
v_cvt_pk_bf16_f32 v212, v116, v117
v_cvt_pk_bf16_f32 v213, v118, v119
v_mfma_f32_16x16x32_bf16 v[148:151], v[96:99], a[100:103], v[148:151]
s_waitcnt lgkmcnt(4)
v_fmac_f32 v124, v52, v43
v_fmac_f32 v125, v53, v43
v_mfma_f32_16x16x32_bf16 v[156:159], v[64:67], a[100:103], v[156:159]
s_branch Lso13
Lst13:
s_branch Lst17
Lso13:
buffer_load_dwordx4 v1, s[4:7], s42 offen offset:3072 sc1 lds
v_mfma_f32_16x16x32_bf16 v[156:159], v[68:71], a[108:111], v[156:159]
ds_read_b128 v[96:99], v1 offset:52224
v_fmac_f32 v126, v54, v43
v_mfma_f32_16x16x32_bf16 v[156:159], v[72:75], a[116:119], v[156:159]
ds_read_b128 v[100:103], v1 offset:56320
v_fmac_f32 v127, v55, v43
v_mfma_f32_16x16x32_bf16 v[156:159], v[76:79], a[124:127], v[156:159]
v_mul_f32 v124, v41, v124
v_mul_f32 v125, v41, v125
v_mfma_f32_16x16x32_bf16 v[152:155], v[76:79], a[120:123], v[152:155]
ds_read_b128 v[104:107], v1 offset:60416
v_mul_f32 v126, v41, v126
v_mfma_f32_16x16x32_bf16 v[152:155], v[72:75], a[112:115], v[152:155]
ds_read_b128 v[108:111], v1 offset:64512
v_mul_f32 v127, v41, v127
v_mfma_f32_16x16x32_bf16 v[152:155], v[68:71], a[104:107], v[152:155]
v_exp_f32 v228, v124
v_mfma_f32_16x16x32_bf16 v[152:155], v[64:67], a[96:99], v[152:155]
s_waitcnt vmcnt(11) lgkmcnt(4)
s_barrier
v_exp_f32 v229, v125
v_mfma_f32_16x16x32_bf16 v[160:163], v[80:83], a[96:99], v[160:163]
s_lshl4_add_u32 s46, s39, s38
ds_read_b128 v[64:67], v23 offset:0
s_mul_i32 s46, s46, 7168
v_mfma_f32_16x16x32_bf16 v[160:163], v[84:87], a[104:107], v[160:163]
s_and_b32 s45, s38, 7
ds_read_b128 v[68:71], v23 offset:4096
s_lshl3_add_u32 s45, s40, s45
v_mfma_f32_16x16x32_bf16 v[160:163], v[88:91], a[112:115], v[160:163]
s_cmp_eq_u32 s45, 1
ds_read_b128 v[72:75], v23 offset:8192
s_cselect_b32 s45, s46, 1073741824
v_mfma_f32_16x16x32_bf16 v[160:163], v[92:95], a[120:123], v[160:163]
ds_read_b128 v[76:79], v23 offset:12288
v_min_u32 v0, 7040, v34
v_mfma_f32_16x16x32_bf16 v[164:167], v[92:95], a[124:127], v[164:167]
buffer_load_dword v3, v0, s[20:23], s45 offen
v_mfma_f32_16x16x32_bf16 v[164:167], v[88:91], a[116:119], v[164:167]
v_exp_f32 v230, v126
v_mfma_f32_16x16x32_bf16 v[164:167], v[84:87], a[108:111], v[164:167]
v_exp_f32 v231, v127
s_add_u32 m0, s41, 0
s_lshl1_add_u32 s42, s48, s64
s_add_u32 s42, s42, 131072
buffer_load_dwordx4 v1, s[4:7], s42 offen sc1 lds
v_mfma_f32_16x16x32_bf16 v[164:167], v[80:83], a[100:103], v[164:167]
s_waitcnt lgkmcnt(4)
v_fma_f32 v228, v228, s78, s78
v_fma_f32 v229, v229, s78, s78
v_mfma_f32_16x16x32_bf16 v[172:175], v[96:99], a[100:103], v[172:175]
buffer_load_dwordx4 v1, s[4:7], s42 offen offset:1024 sc1 lds
v_mfma_f32_16x16x32_bf16 v[172:175], v[100:103], a[108:111], v[172:175]
ds_read_b128 v[80:83], v23 offset:1024
v_fma_f32 v230, v230, s78, s78
v_mfma_f32_16x16x32_bf16 v[172:175], v[104:107], a[116:119], v[172:175]
ds_read_b128 v[84:87], v23 offset:5120
v_fma_f32 v231, v231, s78, s78
v_mfma_f32_16x16x32_bf16 v[172:175], v[108:111], a[124:127], v[172:175]
v_rcp_f32 v228, v228
v_mfma_f32_16x16x32_bf16 v[168:171], v[108:111], a[120:123], v[168:171]
v_rcp_f32 v229, v229
v_mfma_f32_16x16x32_bf16 v[168:171], v[104:107], a[112:115], v[168:171]
v_rcp_f32 v230, v230
v_mfma_f32_16x16x32_bf16 v[168:171], v[100:103], a[104:107], v[168:171]
ds_read_b128 v[88:91], v23 offset:9216
v_rcp_f32 v231, v231
v_mfma_f32_16x16x32_bf16 v[168:171], v[96:99], a[96:99], v[168:171]
s_waitcnt lgkmcnt(3)
ds_read_b128 v[92:95], v23 offset:13312
v_mul_f32 v124, v228, v124
v_mfma_f32_16x16x32_bf16 v[144:147], v[64:67], a[128:131], v[144:147]
buffer_load_dwordx4 v1, s[4:7], s42 offen offset:2048 sc1 lds
v_mfma_f32_16x16x32_bf16 v[144:147], v[68:71], a[136:139], v[144:147]
ds_read_b128 v[96:99], v23 offset:2048
v_mul_f32 v125, v229, v125
v_mfma_f32_16x16x32_bf16 v[144:147], v[72:75], a[144:147], v[144:147]
ds_read_b128 v[100:103], v23 offset:6144
v_mul_f32 v126, v230, v126
v_mfma_f32_16x16x32_bf16 v[144:147], v[76:79], a[152:155], v[144:147]
v_mul_f32 v127, v231, v127
v_cvt_pk_bf16_f32 v214, v124, v125
v_mfma_f32_16x16x32_bf16 v[148:151], v[76:79], a[156:159], v[148:151]
ds_read_b128 v[104:107], v23 offset:10240
v_cvt_pk_bf16_f32 v215, v126, v127
v_mfma_f32_16x16x32_bf16 v[148:151], v[72:75], a[148:151], v[148:151]
s_lshl_b32 s46, s38, 12
s_add_u32 s46, s46, s71
v_mfma_f32_16x16x32_bf16 v[148:151], v[68:71], a[140:143], v[148:151]
buffer_store_dwordx4 v[212:215], v10, s[4:7], s46 offen offset:1024 sc1
v_mfma_f32_16x16x32_bf16 v[148:151], v[64:67], a[132:135], v[148:151]
s_waitcnt lgkmcnt(3)
ds_read_b128 v[108:111], v23 offset:14336
v_mfma_f32_16x16x32_bf16 v[156:159], v[80:83], a[132:135], v[156:159]
buffer_load_dwordx4 v1, s[4:7], s42 offen offset:3072 sc1 lds
v_mfma_f32_16x16x32_bf16 v[156:159], v[84:87], a[140:143], v[156:159]
ds_read_b128 v[64:67], v23 offset:3072
v_fmac_f32 v128, v56, v42
v_mfma_f32_16x16x32_bf16 v[156:159], v[88:91], a[148:151], v[156:159]
ds_read_b128 v[68:71], v23 offset:7168
v_fmac_f32 v129, v57, v42
v_mfma_f32_16x16x32_bf16 v[156:159], v[92:95], a[156:159], v[156:159]
v_fmac_f32 v130, v58, v42
v_fmac_f32 v131, v59, v42
v_mfma_f32_16x16x32_bf16 v[152:155], v[92:95], a[152:155], v[152:155]
ds_read_b128 v[72:75], v23 offset:11264
v_mul_f32 v128, v40, v128
v_mul_f32 v129, v40, v129
v_mfma_f32_16x16x32_bf16 v[152:155], v[88:91], a[144:147], v[152:155]
ds_read_b128 v[76:79], v23 offset:15360
v_mul_f32 v130, v40, v130
v_mfma_f32_16x16x32_bf16 v[152:155], v[84:87], a[136:139], v[152:155]
v_mul_f32 v131, v40, v131
v_exp_f32 v224, v128
v_mfma_f32_16x16x32_bf16 v[152:155], v[80:83], a[128:131], v[152:155]
s_waitcnt lgkmcnt(4)
v_exp_f32 v225, v129
v_mfma_f32_16x16x32_bf16 v[160:163], v[96:99], a[128:131], v[160:163]
s_lshl4_add_u32 s46, s39, s38
ds_read_b128 v[80:83], v23 offset:16384
s_mul_i32 s46, s46, 7168
v_mfma_f32_16x16x32_bf16 v[160:163], v[100:103], a[136:139], v[160:163]
s_and_b32 s45, s38, 7
ds_read_b128 v[84:87], v23 offset:20480
s_lshl3_add_u32 s45, s40, s45
v_mfma_f32_16x16x32_bf16 v[160:163], v[104:107], a[144:147], v[160:163]
s_cmp_eq_u32 s45, 7
ds_read_b128 v[88:91], v23 offset:24576
s_cselect_b32 s45, s46, 1073741824
v_mfma_f32_16x16x32_bf16 v[160:163], v[108:111], a[152:155], v[160:163]
ds_read_b128 v[92:95], v23 offset:28672
v_min_u32 v0, 7040, v34
v_mfma_f32_16x16x32_bf16 v[164:167], v[108:111], a[156:159], v[164:167]
buffer_load_dword v3, v0, s[20:23], s45 offen
v_mfma_f32_16x16x32_bf16 v[164:167], v[104:107], a[148:151], v[164:167]
v_exp_f32 v226, v130
v_mfma_f32_16x16x32_bf16 v[164:167], v[100:103], a[140:143], v[164:167]
v_exp_f32 v227, v131
s_add_u32 m0, s41, 16384
s_lshl1_add_u32 s42, s49, s64
s_add_u32 s42, s42, 131072
buffer_load_dwordx4 v1, s[4:7], s42 offen sc1 lds
v_mfma_f32_16x16x32_bf16 v[164:167], v[96:99], a[132:135], v[164:167]
s_waitcnt lgkmcnt(4)
v_fma_f32 v224, v224, s78, s78
v_mfma_f32_16x16x32_bf16 v[172:175], v[64:67], a[132:135], v[172:175]
buffer_load_dwordx4 v1, s[4:7], s42 offen offset:1024 sc1 lds
v_mfma_f32_16x16x32_bf16 v[172:175], v[68:71], a[140:143], v[172:175]
ds_read_b128 v[96:99], v23 offset:17408
v_fma_f32 v225, v225, s78, s78
v_mfma_f32_16x16x32_bf16 v[172:175], v[72:75], a[148:151], v[172:175]
ds_read_b128 v[100:103], v23 offset:21504
v_fma_f32 v226, v226, s78, s78
v_mfma_f32_16x16x32_bf16 v[172:175], v[76:79], a[156:159], v[172:175]
ds_read_b128 v[104:107], v23 offset:25600
v_fma_f32 v227, v227, s78, s78
v_mfma_f32_16x16x32_bf16 v[168:171], v[76:79], a[152:155], v[168:171]
v_rcp_f32 v224, v224
v_mfma_f32_16x16x32_bf16 v[168:171], v[72:75], a[144:147], v[168:171]
v_rcp_f32 v225, v225
v_mfma_f32_16x16x32_bf16 v[168:171], v[68:71], a[136:139], v[168:171]
v_rcp_f32 v226, v226
v_mfma_f32_16x16x32_bf16 v[168:171], v[64:67], a[128:131], v[168:171]
s_waitcnt lgkmcnt(3)
ds_read_b128 v[108:111], v23 offset:29696
v_rcp_f32 v227, v227
v_mfma_f32_16x16x32_bf16 v[144:147], v[80:83], a[160:163], v[144:147]
buffer_load_dwordx4 v1, s[4:7], s42 offen offset:2048 sc1 lds
v_mfma_f32_16x16x32_bf16 v[144:147], v[84:87], a[168:171], v[144:147]
ds_read_b128 v[64:67], v23 offset:18432
v_mul_f32 v128, v224, v128
v_mfma_f32_16x16x32_bf16 v[144:147], v[88:91], a[176:179], v[144:147]
ds_read_b128 v[68:71], v23 offset:22528
v_mul_f32 v129, v225, v129
v_mfma_f32_16x16x32_bf16 v[144:147], v[92:95], a[184:187], v[144:147]
v_mul_f32 v130, v226, v130
v_mul_f32 v131, v227, v131
v_mfma_f32_16x16x32_bf16 v[148:151], v[92:95], a[188:191], v[148:151]
ds_read_b128 v[72:75], v23 offset:26624
v_cvt_pk_bf16_f32 v216, v128, v129
v_mfma_f32_16x16x32_bf16 v[148:151], v[88:91], a[180:183], v[148:151]
v_cvt_pk_bf16_f32 v217, v130, v131
v_fmac_f32 v136, v60, v42
v_mfma_f32_16x16x32_bf16 v[148:151], v[84:87], a[172:175], v[148:151]
ds_read_b128 v[76:79], v23 offset:30720
v_fmac_f32 v137, v61, v42
v_fmac_f32 v138, v62, v42
v_mfma_f32_16x16x32_bf16 v[148:151], v[80:83], a[164:167], v[148:151]
s_waitcnt lgkmcnt(4)
v_fmac_f32 v139, v63, v42
v_mul_f32 v136, v40, v136
v_mfma_f32_16x16x32_bf16 v[156:159], v[96:99], a[164:167], v[156:159]
buffer_load_dwordx4 v1, s[4:7], s42 offen offset:3072 sc1 lds
v_mfma_f32_16x16x32_bf16 v[156:159], v[100:103], a[172:175], v[156:159]
ds_read_b128 v[80:83], v23 offset:19456
v_mul_f32 v137, v40, v137
v_mfma_f32_16x16x32_bf16 v[156:159], v[104:107], a[180:183], v[156:159]
ds_read_b128 v[84:87], v23 offset:23552
v_mul_f32 v138, v40, v138
v_mfma_f32_16x16x32_bf16 v[156:159], v[108:111], a[188:191], v[156:159]
ds_read_b128 v[88:91], v23 offset:27648
v_mul_f32 v139, v40, v139
v_mfma_f32_16x16x32_bf16 v[152:155], v[108:111], a[184:187], v[152:155]
v_exp_f32 v228, v136
v_mfma_f32_16x16x32_bf16 v[152:155], v[104:107], a[176:179], v[152:155]
v_exp_f32 v229, v137
v_mfma_f32_16x16x32_bf16 v[152:155], v[100:103], a[168:171], v[152:155]
v_exp_f32 v230, v138
v_mfma_f32_16x16x32_bf16 v[152:155], v[96:99], a[160:163], v[152:155]
s_waitcnt vmcnt(11) lgkmcnt(3)
s_barrier
ds_read_b128 v[92:95], v23 offset:31744
v_exp_f32 v231, v139
v_mfma_f32_16x16x32_bf16 v[160:163], v[64:67], a[160:163], v[160:163]
s_lshl4_add_u32 s46, s39, s38
ds_read_b128 v[96:99], v23 offset:32768
s_mul_i32 s46, s46, 7168
v_mfma_f32_16x16x32_bf16 v[160:163], v[68:71], a[168:171], v[160:163]
s_and_b32 s45, s38, 7
s_lshl3_add_u32 s45, s40, s45
s_cmp_eq_u32 s45, 2
v_mfma_f32_16x16x32_bf16 v[160:163], v[72:75], a[176:179], v[160:163]
s_cselect_b32 s45, s46, 1073741824
ds_read_b128 v[100:103], v23 offset:36864
v_min_u32 v0, 7040, v34
v_mfma_f32_16x16x32_bf16 v[160:163], v[76:79], a[184:187], v[160:163]
buffer_load_dword v3, v0, s[20:23], s45 offen
v_mfma_f32_16x16x32_bf16 v[164:167], v[76:79], a[188:191], v[164:167]
ds_read_b128 v[104:107], v23 offset:40960
v_fma_f32 v228, v228, s78, s78
v_fma_f32 v229, v229, s78, s78
v_mfma_f32_16x16x32_bf16 v[164:167], v[72:75], a[180:183], v[164:167]
ds_read_b128 v[108:111], v23 offset:45056
v_fma_f32 v230, v230, s78, s78
v_mfma_f32_16x16x32_bf16 v[164:167], v[68:71], a[172:175], v[164:167]
s_add_u32 m0, s41, 32768
s_lshl1_add_u32 s42, s50, s64
s_add_u32 s42, s42, 131072
buffer_load_dwordx4 v1, s[4:7], s42 offen sc1 lds
v_mfma_f32_16x16x32_bf16 v[164:167], v[64:67], a[164:167], v[164:167]
s_waitcnt lgkmcnt(4)
v_fma_f32 v231, v231, s78, s78
v_rcp_f32 v228, v228
v_mfma_f32_16x16x32_bf16 v[172:175], v[80:83], a[164:167], v[172:175]
buffer_load_dwordx4 v1, s[4:7], s42 offen offset:1024 sc1 lds
v_mfma_f32_16x16x32_bf16 v[172:175], v[84:87], a[172:175], v[172:175]
v_rcp_f32 v229, v229
v_mfma_f32_16x16x32_bf16 v[172:175], v[88:91], a[180:183], v[172:175]
v_rcp_f32 v230, v230
v_mfma_f32_16x16x32_bf16 v[172:175], v[92:95], a[188:191], v[172:175]
v_rcp_f32 v231, v231
v_mfma_f32_16x16x32_bf16 v[168:171], v[92:95], a[184:187], v[168:171]
ds_read_b128 v[64:67], v23 offset:33792
v_mul_f32 v136, v228, v136
v_mfma_f32_16x16x32_bf16 v[168:171], v[88:91], a[176:179], v[168:171]
ds_read_b128 v[68:71], v23 offset:37888
v_mul_f32 v137, v229, v137
v_mfma_f32_16x16x32_bf16 v[168:171], v[84:87], a[168:171], v[168:171]
ds_read_b128 v[72:75], v23 offset:41984
v_mul_f32 v138, v230, v138
v_mfma_f32_16x16x32_bf16 v[168:171], v[80:83], a[160:163], v[168:171]
s_waitcnt lgkmcnt(3)
ds_read_b128 v[76:79], v23 offset:46080
v_mul_f32 v139, v231, v139
v_mfma_f32_16x16x32_bf16 v[144:147], v[96:99], a[192:195], v[144:147]
buffer_load_dwordx4 v1, s[4:7], s42 offen offset:2048 sc1 lds
v_mfma_f32_16x16x32_bf16 v[144:147], v[100:103], a[200:203], v[144:147]
ds_read_b128 v[80:83], v23 offset:34816
v_cvt_pk_bf16_f32 v218, v136, v137
v_mfma_f32_16x16x32_bf16 v[144:147], v[104:107], a[208:211], v[144:147]
ds_read_b128 v[84:87], v23 offset:38912
v_cvt_pk_bf16_f32 v219, v138, v139
v_mfma_f32_16x16x32_bf16 v[144:147], v[108:111], a[216:219], v[144:147]
s_lshl_b32 s46, s38, 12
s_add_u32 s46, s46, s71
v_mfma_f32_16x16x32_bf16 v[148:151], v[108:111], a[220:223], v[148:151]
buffer_store_dwordx4 v[216:219], v10, s[4:7], s46 offen offset:2048 sc1
v_mfma_f32_16x16x32_bf16 v[148:151], v[104:107], a[212:215], v[148:151]
ds_read_b128 v[88:91], v23 offset:43008
v_fmac_f32 v132, v56, v43
v_mfma_f32_16x16x32_bf16 v[148:151], v[100:103], a[204:207], v[148:151]
ds_read_b128 v[92:95], v23 offset:47104
v_fmac_f32 v133, v57, v43
v_mfma_f32_16x16x32_bf16 v[148:151], v[96:99], a[196:199], v[148:151]
s_waitcnt lgkmcnt(4)
v_fmac_f32 v134, v58, v43
v_mfma_f32_16x16x32_bf16 v[156:159], v[64:67], a[196:199], v[156:159]
buffer_load_dwordx4 v1, s[4:7], s42 offen offset:3072 sc1 lds
v_mfma_f32_16x16x32_bf16 v[156:159], v[68:71], a[204:207], v[156:159]
ds_read_b128 v[96:99], v23 offset:35840
v_fmac_f32 v135, v59, v43
v_mfma_f32_16x16x32_bf16 v[156:159], v[72:75], a[212:215], v[156:159]
ds_read_b128 v[100:103], v23 offset:39936
v_mul_f32 v132, v41, v132
v_mfma_f32_16x16x32_bf16 v[156:159], v[76:79], a[220:223], v[156:159]
ds_read_b128 v[104:107], v23 offset:44032
v_mul_f32 v133, v41, v133
v_mfma_f32_16x16x32_bf16 v[152:155], v[76:79], a[216:219], v[152:155]
ds_read_b128 v[108:111], v23 offset:48128
v_mul_f32 v134, v41, v134
v_mfma_f32_16x16x32_bf16 v[152:155], v[72:75], a[208:211], v[152:155]
v_mul_f32 v135, v41, v135
v_exp_f32 v224, v132
v_mfma_f32_16x16x32_bf16 v[152:155], v[68:71], a[200:203], v[152:155]
v_exp_f32 v225, v133
v_mfma_f32_16x16x32_bf16 v[152:155], v[64:67], a[192:195], v[152:155]
s_waitcnt lgkmcnt(4)
v_exp_f32 v226, v134
v_mfma_f32_16x16x32_bf16 v[160:163], v[80:83], a[192:195], v[160:163]
s_add_u32 m0, s41, 49152
s_lshl1_add_u32 s42, s51, s64
v_mfma_f32_16x16x32_bf16 v[160:163], v[84:87], a[200:203], v[160:163]
s_add_u32 s42, s42, 131072
buffer_load_dwordx4 v1, s[4:7], s42 offen sc1 lds
v_mfma_f32_16x16x32_bf16 v[160:163], v[88:91], a[208:211], v[160:163]
v_exp_f32 v227, v135
v_mfma_f32_16x16x32_bf16 v[160:163], v[92:95], a[216:219], v[160:163]
ds_read_b128 v[64:67], v23 offset:49152
v_fma_f32 v224, v224, s78, s78
v_mfma_f32_16x16x32_bf16 v[164:167], v[92:95], a[220:223], v[164:167]
ds_read_b128 v[68:71], v23 offset:53248
v_fma_f32 v225, v225, s78, s78
v_fma_f32 v226, v226, s78, s78
v_mfma_f32_16x16x32_bf16 v[164:167], v[88:91], a[212:215], v[164:167]
ds_read_b128 v[72:75], v23 offset:57344
v_fma_f32 v227, v227, s78, s78
v_mfma_f32_16x16x32_bf16 v[164:167], v[84:87], a[204:207], v[164:167]
v_rcp_f32 v224, v224
v_mfma_f32_16x16x32_bf16 v[164:167], v[80:83], a[196:199], v[164:167]
s_waitcnt lgkmcnt(3)
ds_read_b128 v[76:79], v23 offset:61440
v_rcp_f32 v225, v225
v_mfma_f32_16x16x32_bf16 v[172:175], v[96:99], a[196:199], v[172:175]
buffer_load_dwordx4 v1, s[4:7], s42 offen offset:1024 sc1 lds
v_mfma_f32_16x16x32_bf16 v[172:175], v[100:103], a[204:207], v[172:175]
v_rcp_f32 v226, v226
v_mfma_f32_16x16x32_bf16 v[172:175], v[104:107], a[212:215], v[172:175]
v_rcp_f32 v227, v227
v_mfma_f32_16x16x32_bf16 v[172:175], v[108:111], a[220:223], v[172:175]
ds_read_b128 v[80:83], v23 offset:50176
v_mul_f32 v132, v224, v132
v_mfma_f32_16x16x32_bf16 v[168:171], v[108:111], a[216:219], v[168:171]
ds_read_b128 v[84:87], v23 offset:54272
v_mul_f32 v133, v225, v133
v_mfma_f32_16x16x32_bf16 v[168:171], v[104:107], a[208:211], v[168:171]
ds_read_b128 v[88:91], v23 offset:58368
v_mul_f32 v134, v226, v134
v_mfma_f32_16x16x32_bf16 v[168:171], v[100:103], a[200:203], v[168:171]
ds_read_b128 v[92:95], v23 offset:62464
v_mul_f32 v135, v227, v135
v_cvt_pk_bf16_f32 v220, v132, v133
v_mfma_f32_16x16x32_bf16 v[168:171], v[96:99], a[192:195], v[168:171]
s_waitcnt lgkmcnt(4)
v_cvt_pk_bf16_f32 v221, v134, v135
v_fmac_f32 v140, v60, v43
v_mfma_f32_16x16x32_bf16 v[144:147], v[64:67], a[224:227], v[144:147]
buffer_load_dwordx4 v1, s[4:7], s42 offen offset:2048 sc1 lds
v_mfma_f32_16x16x32_bf16 v[144:147], v[68:71], a[232:235], v[144:147]
ds_read_b128 v[96:99], v23 offset:51200
v_fmac_f32 v141, v61, v43
v_mfma_f32_16x16x32_bf16 v[144:147], v[72:75], a[240:243], v[144:147]
ds_read_b128 v[100:103], v23 offset:55296
v_fmac_f32 v142, v62, v43
v_mfma_f32_16x16x32_bf16 v[144:147], v[76:79], a[248:251], v[144:147]
v_fmac_f32 v143, v63, v43
v_mul_f32 v140, v41, v140
v_mfma_f32_16x16x32_bf16 v[148:151], v[76:79], a[252:255], v[148:151]
ds_read_b128 v[104:107], v23 offset:59392
v_mul_f32 v141, v41, v141
v_mfma_f32_16x16x32_bf16 v[148:151], v[72:75], a[244:247], v[148:151]
ds_read_b128 v[108:111], v23 offset:63488
v_mul_f32 v142, v41, v142
v_mfma_f32_16x16x32_bf16 v[148:151], v[68:71], a[236:239], v[148:151]
v_mul_f32 v143, v41, v143
v_exp_f32 v228, v140
v_mfma_f32_16x16x32_bf16 v[148:151], v[64:67], a[228:231], v[148:151]
s_waitcnt lgkmcnt(4)
v_exp_f32 v229, v141
v_mfma_f32_16x16x32_bf16 v[156:159], v[80:83], a[228:231], v[156:159]
buffer_load_dwordx4 v1, s[4:7], s42 offen offset:3072 sc1 lds
v_mfma_f32_16x16x32_bf16 v[156:159], v[84:87], a[236:239], v[156:159]
v_exp_f32 v230, v142
v_mfma_f32_16x16x32_bf16 v[156:159], v[88:91], a[244:247], v[156:159]
v_exp_f32 v231, v143
v_mfma_f32_16x16x32_bf16 v[156:159], v[92:95], a[252:255], v[156:159]
ds_read_b128 v[64:67], v23 offset:52224
v_fma_f32 v228, v228, s78, s78
v_mfma_f32_16x16x32_bf16 v[152:155], v[92:95], a[248:251], v[152:155]
ds_read_b128 v[68:71], v23 offset:56320
v_fma_f32 v229, v229, s78, s78
v_fma_f32 v230, v230, s78, s78
v_mfma_f32_16x16x32_bf16 v[152:155], v[88:91], a[240:243], v[152:155]
ds_read_b128 v[72:75], v23 offset:60416
v_fma_f32 v231, v231, s78, s78
v_mfma_f32_16x16x32_bf16 v[152:155], v[84:87], a[232:235], v[152:155]
v_rcp_f32 v228, v228
v_mfma_f32_16x16x32_bf16 v[152:155], v[80:83], a[224:227], v[152:155]
s_waitcnt vmcnt(10) lgkmcnt(3)
s_barrier
ds_read_b128 v[76:79], v23 offset:64512
v_rcp_f32 v229, v229
v_mfma_f32_16x16x32_bf16 v[160:163], v[96:99], a[224:227], v[160:163]
s_lshl4_add_u32 s46, s39, s38
ds_read_b128 v[80:83], v1 offset:0
s_mul_i32 s46, s46, 7168
v_mfma_f32_16x16x32_bf16 v[160:163], v[100:103], a[232:235], v[160:163]
s_and_b32 s45, s38, 7
ds_read_b128 v[84:87], v1 offset:4096
s_lshl3_add_u32 s45, s40, s45
v_mfma_f32_16x16x32_bf16 v[160:163], v[104:107], a[240:243], v[160:163]
s_cmp_eq_u32 s45, 3
ds_read_b128 v[88:91], v1 offset:8192
s_cselect_b32 s45, s46, 1073741824
v_mfma_f32_16x16x32_bf16 v[160:163], v[108:111], a[248:251], v[160:163]
ds_read_b128 v[92:95], v1 offset:12288
v_min_u32 v0, 7040, v34
v_mfma_f32_16x16x32_bf16 v[164:167], v[108:111], a[252:255], v[164:167]
buffer_load_dword v3, v0, s[20:23], s45 offen
v_mfma_f32_16x16x32_bf16 v[164:167], v[104:107], a[244:247], v[164:167]
v_rcp_f32 v230, v230
v_mfma_f32_16x16x32_bf16 v[164:167], v[100:103], a[236:239], v[164:167]
v_rcp_f32 v231, v231
s_add_u32 m0, s41, 65536
s_lshl1_add_u32 s42, s52, s64
s_add_u32 s42, s42, 131072
buffer_load_dwordx4 v1, s[4:7], s42 offen sc1 lds
v_mfma_f32_16x16x32_bf16 v[164:167], v[96:99], a[228:231], v[164:167]
s_waitcnt lgkmcnt(4)
v_mul_f32 v140, v228, v140
v_mfma_f32_16x16x32_bf16 v[172:175], v[64:67], a[228:231], v[172:175]
buffer_load_dwordx4 v1, s[4:7], s42 offen offset:1024 sc1 lds
v_mfma_f32_16x16x32_bf16 v[172:175], v[68:71], a[236:239], v[172:175]
ds_read_b128 v[96:99], v1 offset:1024
v_mul_f32 v141, v229, v141
v_mfma_f32_16x16x32_bf16 v[172:175], v[72:75], a[244:247], v[172:175]
ds_read_b128 v[100:103], v1 offset:5120
v_mul_f32 v142, v230, v142
v_mfma_f32_16x16x32_bf16 v[172:175], v[76:79], a[252:255], v[172:175]
v_mul_f32 v143, v231, v143
v_cvt_pk_bf16_f32 v222, v140, v141
v_mfma_f32_16x16x32_bf16 v[168:171], v[76:79], a[248:251], v[168:171]
ds_read_b128 v[104:107], v1 offset:9216
v_cvt_pk_bf16_f32 v223, v142, v143
v_mfma_f32_16x16x32_bf16 v[168:171], v[72:75], a[240:243], v[168:171]
s_lshl_b32 s46, s38, 12
s_add_u32 s46, s46, s71
v_mfma_f32_16x16x32_bf16 v[168:171], v[68:71], a[232:235], v[168:171]
buffer_store_dwordx4 v[220:223], v10, s[4:7], s46 offen offset:3072 sc1
v_mfma_f32_16x16x32_bf16 v[168:171], v[64:67], a[224:227], v[168:171]
s_waitcnt lgkmcnt(3)
ds_read_b128 v[108:111], v1 offset:13312
v_mfma_f32_16x16x32_bf16 v[112:115], v[80:83], a[0:3], 0
buffer_load_dwordx4 v1, s[4:7], s42 offen offset:2048 sc1 lds
v_mfma_f32_16x16x32_bf16 v[112:115], v[84:87], a[8:11], v[112:115]
ds_read_b128 v[64:67], v1 offset:2048
v_mul_f32 v144, v40, v144
v_mfma_f32_16x16x32_bf16 v[112:115], v[88:91], a[16:19], v[112:115]
ds_read_b128 v[68:71], v1 offset:6144
v_mul_f32 v145, v40, v145
v_mfma_f32_16x16x32_bf16 v[112:115], v[92:95], a[24:27], v[112:115]
ds_read_b128 v[72:75], v1 offset:10240
v_mul_f32 v146, v40, v146
v_mfma_f32_16x16x32_bf16 v[116:119], v[92:95], a[28:31], 0
ds_read_b128 v[76:79], v1 offset:14336
v_mul_f32 v147, v40, v147
v_mfma_f32_16x16x32_bf16 v[116:119], v[88:91], a[20:23], v[116:119]
v_exp_f32 v224, v144
v_mfma_f32_16x16x32_bf16 v[116:119], v[84:87], a[12:15], v[116:119]
v_exp_f32 v225, v145
v_mfma_f32_16x16x32_bf16 v[116:119], v[80:83], a[4:7], v[116:119]
s_waitcnt lgkmcnt(4)
v_exp_f32 v226, v146
v_mfma_f32_16x16x32_bf16 v[124:127], v[96:99], a[4:7], 0
buffer_load_dwordx4 v1, s[4:7], s42 offen offset:3072 sc1 lds
v_mfma_f32_16x16x32_bf16 v[124:127], v[100:103], a[12:15], v[124:127]
v_exp_f32 v227, v147
v_mfma_f32_16x16x32_bf16 v[124:127], v[104:107], a[20:23], v[124:127]
ds_read_b128 v[80:83], v1 offset:3072
v_fma_f32 v224, v224, s78, s78
v_mfma_f32_16x16x32_bf16 v[124:127], v[108:111], a[28:31], v[124:127]
ds_read_b128 v[84:87], v1 offset:7168
v_fma_f32 v225, v225, s78, s78
v_mfma_f32_16x16x32_bf16 v[120:123], v[108:111], a[24:27], 0
ds_read_b128 v[88:91], v1 offset:11264
v_fma_f32 v226, v226, s78, s78
v_mfma_f32_16x16x32_bf16 v[120:123], v[104:107], a[16:19], v[120:123]
ds_read_b128 v[92:95], v1 offset:15360
v_fma_f32 v227, v227, s78, s78
v_mfma_f32_16x16x32_bf16 v[120:123], v[100:103], a[8:11], v[120:123]
v_rcp_f32 v224, v224
v_mfma_f32_16x16x32_bf16 v[120:123], v[96:99], a[0:3], v[120:123]
s_waitcnt lgkmcnt(4)
v_rcp_f32 v225, v225
v_mfma_f32_16x16x32_bf16 v[128:131], v[64:67], a[0:3], 0
s_add_u32 m0, s41, 81920
s_lshl1_add_u32 s42, s53, s64
v_mfma_f32_16x16x32_bf16 v[128:131], v[68:71], a[8:11], v[128:131]
s_add_u32 s42, s42, 131072
buffer_load_dwordx4 v1, s[4:7], s42 offen sc1 lds
v_mfma_f32_16x16x32_bf16 v[128:131], v[72:75], a[16:19], v[128:131]
v_rcp_f32 v226, v226
v_mfma_f32_16x16x32_bf16 v[128:131], v[76:79], a[24:27], v[128:131]
v_rcp_f32 v227, v227
v_mfma_f32_16x16x32_bf16 v[132:135], v[76:79], a[28:31], 0
ds_read_b128 v[96:99], v1 offset:16384
v_mul_f32 v144, v224, v144
v_mfma_f32_16x16x32_bf16 v[132:135], v[72:75], a[20:23], v[132:135]
ds_read_b128 v[100:103], v1 offset:20480
v_mul_f32 v145, v225, v145
v_mfma_f32_16x16x32_bf16 v[132:135], v[68:71], a[12:15], v[132:135]
ds_read_b128 v[104:107], v1 offset:24576
v_mul_f32 v146, v226, v146
v_mul_f32 v147, v227, v147
v_mfma_f32_16x16x32_bf16 v[132:135], v[64:67], a[4:7], v[132:135]
s_waitcnt lgkmcnt(3)
ds_read_b128 v[108:111], v1 offset:28672
v_cvt_pk_bf16_f32 v208, v144, v145
v_mfma_f32_16x16x32_bf16 v[140:143], v[80:83], a[4:7], 0
buffer_load_dwordx4 v1, s[4:7], s42 offen offset:1024 sc1 lds
v_mfma_f32_16x16x32_bf16 v[140:143], v[84:87], a[12:15], v[140:143]
ds_read_b128 v[64:67], v1 offset:17408
v_cvt_pk_bf16_f32 v209, v146, v147
v_mfma_f32_16x16x32_bf16 v[140:143], v[88:91], a[20:23], v[140:143]
ds_read_b128 v[68:71], v1 offset:21504
v_mul_f32 v152, v40, v152
v_mfma_f32_16x16x32_bf16 v[140:143], v[92:95], a[28:31], v[140:143]
ds_read_b128 v[72:75], v1 offset:25600
v_mul_f32 v153, v40, v153
v_mfma_f32_16x16x32_bf16 v[136:139], v[92:95], a[24:27], 0
ds_read_b128 v[76:79], v1 offset:29696
v_mul_f32 v154, v40, v154
v_mfma_f32_16x16x32_bf16 v[136:139], v[88:91], a[16:19], v[136:139]
v_mul_f32 v155, v40, v155
v_exp_f32 v228, v152
v_mfma_f32_16x16x32_bf16 v[136:139], v[84:87], a[8:11], v[136:139]
v_exp_f32 v229, v153
v_mfma_f32_16x16x32_bf16 v[136:139], v[80:83], a[0:3], v[136:139]
s_waitcnt lgkmcnt(4)
v_exp_f32 v230, v154
v_mfma_f32_16x16x32_bf16 v[112:115], v[96:99], a[32:35], v[112:115]
buffer_load_dwordx4 v1, s[4:7], s42 offen offset:2048 sc1 lds
v_mfma_f32_16x16x32_bf16 v[112:115], v[100:103], a[40:43], v[112:115]
v_exp_f32 v231, v155
v_mfma_f32_16x16x32_bf16 v[112:115], v[104:107], a[48:51], v[112:115]
ds_read_b128 v[80:83], v1 offset:18432
v_fma_f32 v228, v228, s78, s78
v_mfma_f32_16x16x32_bf16 v[112:115], v[108:111], a[56:59], v[112:115]
ds_read_b128 v[84:87], v1 offset:22528
v_fma_f32 v229, v229, s78, s78
v_mfma_f32_16x16x32_bf16 v[116:119], v[108:111], a[60:63], v[116:119]
ds_read_b128 v[88:91], v1 offset:26624
v_fma_f32 v230, v230, s78, s78
v_mfma_f32_16x16x32_bf16 v[116:119], v[104:107], a[52:55], v[116:119]
v_fma_f32 v231, v231, s78, s78
v_rcp_f32 v228, v228
v_mfma_f32_16x16x32_bf16 v[116:119], v[100:103], a[44:47], v[116:119]
ds_read_b128 v[92:95], v1 offset:30720
v_mfma_f32_16x16x32_bf16 v[116:119], v[96:99], a[36:39], v[116:119]
s_waitcnt lgkmcnt(4)
v_mfma_f32_16x16x32_bf16 v[124:127], v[64:67], a[36:39], v[124:127]
buffer_load_dwordx4 v1, s[4:7], s42 offen offset:3072 sc1 lds
v_mfma_f32_16x16x32_bf16 v[124:127], v[68:71], a[44:47], v[124:127]
v_rcp_f32 v229, v229
v_mfma_f32_16x16x32_bf16 v[124:127], v[72:75], a[52:55], v[124:127]
v_rcp_f32 v230, v230
v_mfma_f32_16x16x32_bf16 v[124:127], v[76:79], a[60:63], v[124:127]
v_rcp_f32 v231, v231
v_mfma_f32_16x16x32_bf16 v[120:123], v[76:79], a[56:59], v[120:123]
ds_read_b128 v[96:99], v1 offset:19456
v_mul_f32 v152, v228, v152
v_mfma_f32_16x16x32_bf16 v[120:123], v[72:75], a[48:51], v[120:123]
ds_read_b128 v[100:103], v1 offset:23552
v_mul_f32 v153, v229, v153
v_mfma_f32_16x16x32_bf16 v[120:123], v[68:71], a[40:43], v[120:123]
ds_read_b128 v[104:107], v1 offset:27648
v_mul_f32 v154, v230, v154
v_mul_f32 v155, v231, v155
v_mfma_f32_16x16x32_bf16 v[120:123], v[64:67], a[32:35], v[120:123]
s_waitcnt vmcnt(10) lgkmcnt(3)
s_barrier
ds_read_b128 v[108:111], v1 offset:31744
v_cvt_pk_bf16_f32 v210, v152, v153
v_mfma_f32_16x16x32_bf16 v[128:131], v[80:83], a[32:35], v[128:131]
s_lshl4_add_u32 s46, s39, s38
ds_read_b128 v[64:67], v1 offset:32768
s_mul_i32 s46, s46, 7168
v_mfma_f32_16x16x32_bf16 v[128:131], v[84:87], a[40:43], v[128:131]
s_and_b32 s45, s38, 7
s_lshl3_add_u32 s45, s40, s45
s_cmp_eq_u32 s45, 4
v_mfma_f32_16x16x32_bf16 v[128:131], v[88:91], a[48:51], v[128:131]
s_cselect_b32 s45, s46, 1073741824
ds_read_b128 v[68:71], v1 offset:36864
v_min_u32 v0, 7040, v34
v_mfma_f32_16x16x32_bf16 v[128:131], v[92:95], a[56:59], v[128:131]
buffer_load_dword v3, v0, s[20:23], s45 offen
v_mfma_f32_16x16x32_bf16 v[132:135], v[92:95], a[60:63], v[132:135]
ds_read_b128 v[72:75], v1 offset:40960
v_cvt_pk_bf16_f32 v211, v154, v155
s_add_u32 m0, s41, 98304
v_mfma_f32_16x16x32_bf16 v[132:135], v[88:91], a[52:55], v[132:135]
s_lshl1_add_u32 s42, s54, s64
s_add_u32 s42, s42, 131072
buffer_load_dwordx4 v1, s[4:7], s42 offen sc1 lds
v_mfma_f32_16x16x32_bf16 v[132:135], v[84:87], a[44:47], v[132:135]
s_lshl_b32 s46, s38, 12
s_add_u32 s46, s46, s71
s_add_u32 s46, s46, 65536
buffer_store_dwordx4 v[208:211], v10, s[4:7], s46 offen sc1
v_mfma_f32_16x16x32_bf16 v[132:135], v[80:83], a[36:39], v[132:135]
s_branch Lso14
Lst14:
s_branch Lst18
Lso14:
s_waitcnt lgkmcnt(3)
ds_read_b128 v[76:79], v1 offset:45056
v_mfma_f32_16x16x32_bf16 v[140:143], v[96:99], a[36:39], v[140:143]
buffer_load_dwordx4 v1, s[4:7], s42 offen offset:1024 sc1 lds
v_mfma_f32_16x16x32_bf16 v[140:143], v[100:103], a[44:47], v[140:143]
ds_read_b128 v[80:83], v1 offset:33792
v_mul_f32 v148, v41, v148
v_mfma_f32_16x16x32_bf16 v[140:143], v[104:107], a[52:55], v[140:143]
ds_read_b128 v[84:87], v1 offset:37888
v_mul_f32 v149, v41, v149
v_mfma_f32_16x16x32_bf16 v[140:143], v[108:111], a[60:63], v[140:143]
v_mul_f32 v150, v41, v150
v_mul_f32 v151, v41, v151
v_mfma_f32_16x16x32_bf16 v[136:139], v[108:111], a[56:59], v[136:139]
v_exp_f32 v224, v148
v_mfma_f32_16x16x32_bf16 v[136:139], v[104:107], a[48:51], v[136:139]
v_exp_f32 v225, v149
v_mfma_f32_16x16x32_bf16 v[136:139], v[100:103], a[40:43], v[136:139]
ds_read_b128 v[88:91], v1 offset:41984
v_mfma_f32_16x16x32_bf16 v[136:139], v[96:99], a[32:35], v[136:139]
s_waitcnt lgkmcnt(3)
ds_read_b128 v[92:95], v1 offset:46080
v_mfma_f32_16x16x32_bf16 v[112:115], v[64:67], a[64:67], v[112:115]
buffer_load_dwordx4 v1, s[4:7], s42 offen offset:2048 sc1 lds
v_mfma_f32_16x16x32_bf16 v[112:115], v[68:71], a[72:75], v[112:115]
v_exp_f32 v226, v150
v_mfma_f32_16x16x32_bf16 v[112:115], v[72:75], a[80:83], v[112:115]
v_exp_f32 v227, v151
v_mfma_f32_16x16x32_bf16 v[112:115], v[76:79], a[88:91], v[112:115]
ds_read_b128 v[96:99], v1 offset:34816
v_fma_f32 v224, v224, s78, s78
v_mfma_f32_16x16x32_bf16 v[116:119], v[76:79], a[92:95], v[116:119]
ds_read_b128 v[100:103], v1 offset:38912
v_fma_f32 v225, v225, s78, s78
v_mfma_f32_16x16x32_bf16 v[116:119], v[72:75], a[84:87], v[116:119]
ds_read_b128 v[104:107], v1 offset:43008
v_fma_f32 v226, v226, s78, s78
v_mfma_f32_16x16x32_bf16 v[116:119], v[68:71], a[76:79], v[116:119]
ds_read_b128 v[108:111], v1 offset:47104
v_fma_f32 v227, v227, s78, s78
v_mfma_f32_16x16x32_bf16 v[116:119], v[64:67], a[68:71], v[116:119]
s_waitcnt lgkmcnt(4)
v_rcp_f32 v224, v224
v_mfma_f32_16x16x32_bf16 v[124:127], v[80:83], a[68:71], v[124:127]
buffer_load_dwordx4 v1, s[4:7], s42 offen offset:3072 sc1 lds
v_mfma_f32_16x16x32_bf16 v[124:127], v[84:87], a[76:79], v[124:127]
v_rcp_f32 v225, v225
v_mfma_f32_16x16x32_bf16 v[124:127], v[88:91], a[84:87], v[124:127]
v_rcp_f32 v226, v226
v_mfma_f32_16x16x32_bf16 v[124:127], v[92:95], a[92:95], v[124:127]
s_waitcnt vmcnt(12)
v_rcp_f32 v227, v227
v_mfma_f32_16x16x32_bf16 v[120:123], v[92:95], a[88:91], v[120:123]
ds_read_b128 v[64:67], v1 offset:35840
buffer_atomic_add v26, v11, s[4:7], s32 offen offset:28 sc1
v_mfma_f32_16x16x32_bf16 v[120:123], v[88:91], a[80:83], v[120:123]
ds_read_b128 v[68:71], v1 offset:39936
v_mul_f32 v148, v224, v148
v_mfma_f32_16x16x32_bf16 v[120:123], v[84:87], a[72:75], v[120:123]
ds_read_b128 v[72:75], v1 offset:44032
v_mfma_f32_16x16x32_bf16 v[120:123], v[80:83], a[64:67], v[120:123]
s_waitcnt lgkmcnt(3)
ds_read_b128 v[76:79], v1 offset:48128
v_mfma_f32_16x16x32_bf16 v[128:131], v[96:99], a[64:67], v[128:131]
s_add_u32 m0, s41, 114688
s_lshl1_add_u32 s42, s55, s64
v_mfma_f32_16x16x32_bf16 v[128:131], v[100:103], a[72:75], v[128:131]
s_add_u32 s42, s42, 131072
buffer_load_dwordx4 v1, s[4:7], s42 offen sc1 lds
v_mfma_f32_16x16x32_bf16 v[128:131], v[104:107], a[80:83], v[128:131]
ds_read_b128 v[80:83], v1 offset:49152
v_mul_f32 v149, v225, v149
v_mfma_f32_16x16x32_bf16 v[128:131], v[108:111], a[88:91], v[128:131]
ds_read_b128 v[84:87], v1 offset:53248
v_mul_f32 v150, v226, v150
v_mfma_f32_16x16x32_bf16 v[132:135], v[108:111], a[92:95], v[132:135]
ds_read_b128 v[88:91], v1 offset:57344
v_mul_f32 v151, v227, v151
v_mfma_f32_16x16x32_bf16 v[132:135], v[104:107], a[84:87], v[132:135]
v_cvt_pk_bf16_f32 v212, v148, v149
v_cvt_pk_bf16_f32 v213, v150, v151
v_mfma_f32_16x16x32_bf16 v[132:135], v[100:103], a[76:79], v[132:135]
ds_read_b128 v[92:95], v1 offset:61440
v_mul_f32 v156, v41, v156
v_mul_f32 v157, v41, v157
v_mfma_f32_16x16x32_bf16 v[132:135], v[96:99], a[68:71], v[132:135]
s_waitcnt lgkmcnt(4)
v_mul_f32 v158, v41, v158
v_mul_f32 v159, v41, v159
v_mfma_f32_16x16x32_bf16 v[140:143], v[64:67], a[68:71], v[140:143]
buffer_load_dwordx4 v1, s[4:7], s42 offen offset:1024 sc1 lds
v_mfma_f32_16x16x32_bf16 v[140:143], v[68:71], a[76:79], v[140:143]
v_exp_f32 v228, v156
v_mfma_f32_16x16x32_bf16 v[140:143], v[72:75], a[84:87], v[140:143]
v_exp_f32 v229, v157
v_mfma_f32_16x16x32_bf16 v[140:143], v[76:79], a[92:95], v[140:143]
v_exp_f32 v230, v158
v_mfma_f32_16x16x32_bf16 v[136:139], v[76:79], a[88:91], v[136:139]
ds_read_b128 v[96:99], v1 offset:50176
v_exp_f32 v231, v159
v_mfma_f32_16x16x32_bf16 v[136:139], v[72:75], a[80:83], v[136:139]
ds_read_b128 v[100:103], v1 offset:54272
v_fma_f32 v228, v228, s78, s78
v_mfma_f32_16x16x32_bf16 v[136:139], v[68:71], a[72:75], v[136:139]
ds_read_b128 v[104:107], v1 offset:58368
v_fma_f32 v229, v229, s78, s78
v_mfma_f32_16x16x32_bf16 v[136:139], v[64:67], a[64:67], v[136:139]
s_waitcnt lgkmcnt(3)
ds_read_b128 v[108:111], v1 offset:62464
v_fma_f32 v230, v230, s78, s78
v_mfma_f32_16x16x32_bf16 v[112:115], v[80:83], a[96:99], v[112:115]
buffer_load_dwordx4 v1, s[4:7], s42 offen offset:2048 sc1 lds
v_mfma_f32_16x16x32_bf16 v[112:115], v[84:87], a[104:107], v[112:115]
ds_read_b128 v[64:67], v1 offset:51200
v_fma_f32 v231, v231, s78, s78
v_mfma_f32_16x16x32_bf16 v[112:115], v[88:91], a[112:115], v[112:115]
v_rcp_f32 v228, v228
v_mfma_f32_16x16x32_bf16 v[112:115], v[92:95], a[120:123], v[112:115]
v_rcp_f32 v229, v229
v_mfma_f32_16x16x32_bf16 v[116:119], v[92:95], a[124:127], v[116:119]
v_rcp_f32 v230, v230
v_mfma_f32_16x16x32_bf16 v[116:119], v[88:91], a[116:119], v[116:119]
ds_read_b128 v[68:71], v1 offset:55296
v_rcp_f32 v231, v231
v_mfma_f32_16x16x32_bf16 v[116:119], v[84:87], a[108:111], v[116:119]
ds_read_b128 v[72:75], v1 offset:59392
v_mul_f32 v156, v228, v156
v_mfma_f32_16x16x32_bf16 v[116:119], v[80:83], a[100:103], v[116:119]
s_waitcnt lgkmcnt(3)
ds_read_b128 v[76:79], v1 offset:63488
v_mfma_f32_16x16x32_bf16 v[124:127], v[96:99], a[100:103], v[124:127]
buffer_load_dwordx4 v1, s[4:7], s42 offen offset:3072 sc1 lds
v_mfma_f32_16x16x32_bf16 v[124:127], v[100:103], a[108:111], v[124:127]
ds_read_b128 v[80:83], v1 offset:52224
v_mul_f32 v157, v229, v157
v_mfma_f32_16x16x32_bf16 v[124:127], v[104:107], a[116:119], v[124:127]
ds_read_b128 v[84:87], v1 offset:56320
v_mul_f32 v158, v230, v158
v_mfma_f32_16x16x32_bf16 v[124:127], v[108:111], a[124:127], v[124:127]
v_mul_f32 v159, v231, v159
v_cvt_pk_bf16_f32 v214, v156, v157
v_mfma_f32_16x16x32_bf16 v[120:123], v[108:111], a[120:123], v[120:123]
ds_read_b128 v[88:91], v1 offset:60416
v_cvt_pk_bf16_f32 v215, v158, v159
v_mfma_f32_16x16x32_bf16 v[120:123], v[104:107], a[112:115], v[120:123]
s_lshl_b32 s46, s38, 12
s_add_u32 s46, s46, s71
v_mfma_f32_16x16x32_bf16 v[120:123], v[100:103], a[104:107], v[120:123]
s_add_u32 s46, s46, 65536
buffer_store_dwordx4 v[212:215], v10, s[4:7], s46 offen offset:1024 sc1
v_mfma_f32_16x16x32_bf16 v[120:123], v[96:99], a[96:99], v[120:123]
s_waitcnt vmcnt(12) lgkmcnt(3)
s_barrier
ds_read_b128 v[92:95], v1 offset:64512
v_mfma_f32_16x16x32_bf16 v[128:131], v[64:67], a[96:99], v[128:131]
s_lshl4_add_u32 s46, s39, s38
ds_read_b128 v[96:99], v23 offset:0
s_mul_i32 s46, s46, 7168
v_mfma_f32_16x16x32_bf16 v[128:131], v[68:71], a[104:107], v[128:131]
s_and_b32 s45, s38, 7
s_lshl3_add_u32 s45, s40, s45
s_cmp_eq_u32 s45, 5
v_mfma_f32_16x16x32_bf16 v[128:131], v[72:75], a[112:115], v[128:131]
s_cselect_b32 s45, s46, 1073741824
ds_read_b128 v[100:103], v23 offset:4096
v_min_u32 v0, 7040, v34
v_mfma_f32_16x16x32_bf16 v[128:131], v[76:79], a[120:123], v[128:131]
buffer_load_dword v3, v0, s[20:23], s45 offen
v_mfma_f32_16x16x32_bf16 v[132:135], v[76:79], a[124:127], v[132:135]
ds_read_b128 v[104:107], v23 offset:8192
v_mul_f32 v160, v40, v160
v_mfma_f32_16x16x32_bf16 v[132:135], v[72:75], a[116:119], v[132:135]
v_mul_f32 v161, v40, v161
s_add_u32 m0, s41, 0
v_mfma_f32_16x16x32_bf16 v[132:135], v[68:71], a[108:111], v[132:135]
s_add_u32 s42, s65, 0
buffer_load_dwordx4 v1, s[4:7], s42 offen sc1 lds
v_mul_f32 v162, v40, v162
v_mfma_f32_16x16x32_bf16 v[132:135], v[64:67], a[100:103], v[132:135]
s_waitcnt lgkmcnt(3)
ds_read_b128 v[108:111], v23 offset:12288
v_mul_f32 v163, v40, v163
v_mfma_f32_16x16x32_bf16 v[140:143], v[80:83], a[100:103], v[140:143]
buffer_load_dwordx4 v1, s[4:7], s42 offen offset:1024 sc1 lds
v_mfma_f32_16x16x32_bf16 v[140:143], v[84:87], a[108:111], v[140:143]
v_exp_f32 v224, v160
v_mfma_f32_16x16x32_bf16 v[140:143], v[88:91], a[116:119], v[140:143]
v_exp_f32 v225, v161
v_mfma_f32_16x16x32_bf16 v[140:143], v[92:95], a[124:127], v[140:143]
v_exp_f32 v226, v162
v_mfma_f32_16x16x32_bf16 v[136:139], v[92:95], a[120:123], v[136:139]
ds_read_b128 v[64:67], v23 offset:1024
v_exp_f32 v227, v163
v_mfma_f32_16x16x32_bf16 v[136:139], v[88:91], a[112:115], v[136:139]
ds_read_b128 v[68:71], v23 offset:5120
v_fma_f32 v224, v224, s78, s78
v_mfma_f32_16x16x32_bf16 v[136:139], v[84:87], a[104:107], v[136:139]
ds_read_b128 v[72:75], v23 offset:9216
v_fma_f32 v225, v225, s78, s78
v_mfma_f32_16x16x32_bf16 v[136:139], v[80:83], a[96:99], v[136:139]
s_waitcnt lgkmcnt(3)
ds_read_b128 v[76:79], v23 offset:13312
v_mfma_f32_16x16x32_bf16 v[112:115], v[96:99], a[128:131], v[112:115]
buffer_load_dwordx4 v1, s[4:7], s42 offen offset:2048 sc1 lds
v_mfma_f32_16x16x32_bf16 v[112:115], v[100:103], a[136:139], v[112:115]
ds_read_b128 v[80:83], v23 offset:2048
v_fma_f32 v226, v226, s78, s78
v_mfma_f32_16x16x32_bf16 v[112:115], v[104:107], a[144:147], v[112:115]
ds_read_b128 v[84:87], v23 offset:6144
v_fma_f32 v227, v227, s78, s78
v_mfma_f32_16x16x32_bf16 v[112:115], v[108:111], a[152:155], v[112:115]
v_rcp_f32 v224, v224
v_mfma_f32_16x16x32_bf16 v[116:119], v[108:111], a[156:159], v[116:119]
v_rcp_f32 v225, v225
v_mfma_f32_16x16x32_bf16 v[116:119], v[104:107], a[148:151], v[116:119]
v_rcp_f32 v226, v226
v_mfma_f32_16x16x32_bf16 v[116:119], v[100:103], a[140:143], v[116:119]
ds_read_b128 v[88:91], v23 offset:10240
v_rcp_f32 v227, v227
v_mfma_f32_16x16x32_bf16 v[116:119], v[96:99], a[132:135], v[116:119]
s_waitcnt lgkmcnt(3)
ds_read_b128 v[92:95], v23 offset:14336
v_mfma_f32_16x16x32_bf16 v[124:127], v[64:67], a[132:135], v[124:127]
buffer_load_dwordx4 v1, s[4:7], s42 offen offset:3072 sc1 lds
v_mfma_f32_16x16x32_bf16 v[124:127], v[68:71], a[140:143], v[124:127]
ds_read_b128 v[96:99], v23 offset:3072
v_mul_f32 v160, v224, v160
v_mfma_f32_16x16x32_bf16 v[124:127], v[72:75], a[148:151], v[124:127]
ds_read_b128 v[100:103], v23 offset:7168
v_mul_f32 v161, v225, v161
v_mfma_f32_16x16x32_bf16 v[124:127], v[76:79], a[156:159], v[124:127]
v_mul_f32 v162, v226, v162
v_mul_f32 v163, v227, v163
v_mfma_f32_16x16x32_bf16 v[120:123], v[76:79], a[152:155], v[120:123]
ds_read_b128 v[104:107], v23 offset:11264
v_cvt_pk_bf16_f32 v216, v160, v161
v_mfma_f32_16x16x32_bf16 v[120:123], v[72:75], a[144:147], v[120:123]
v_cvt_pk_bf16_f32 v217, v162, v163
v_mul_f32 v168, v40, v168
v_mfma_f32_16x16x32_bf16 v[120:123], v[68:71], a[136:139], v[120:123]
ds_read_b128 v[108:111], v23 offset:15360
v_mul_f32 v169, v40, v169
v_mfma_f32_16x16x32_bf16 v[120:123], v[64:67], a[128:131], v[120:123]
s_waitcnt lgkmcnt(4)
v_mul_f32 v170, v40, v170
v_mul_f32 v171, v40, v171
v_mfma_f32_16x16x32_bf16 v[128:131], v[80:83], a[128:131], v[128:131]
s_add_u32 m0, s41, 16384
s_add_u32 s42, s65, 16384
buffer_load_dwordx4 v1, s[4:7], s42 offen sc1 lds
v_mfma_f32_16x16x32_bf16 v[128:131], v[84:87], a[136:139], v[128:131]
v_exp_f32 v228, v168
v_mfma_f32_16x16x32_bf16 v[128:131], v[88:91], a[144:147], v[128:131]
v_exp_f32 v229, v169
v_mfma_f32_16x16x32_bf16 v[128:131], v[92:95], a[152:155], v[128:131]
v_exp_f32 v230, v170
v_mfma_f32_16x16x32_bf16 v[132:135], v[92:95], a[156:159], v[132:135]
ds_read_b128 v[64:67], v23 offset:16384
v_exp_f32 v231, v171
v_mfma_f32_16x16x32_bf16 v[132:135], v[88:91], a[148:151], v[132:135]
ds_read_b128 v[68:71], v23 offset:20480
v_fma_f32 v228, v228, s78, s78
v_mfma_f32_16x16x32_bf16 v[132:135], v[84:87], a[140:143], v[132:135]
ds_read_b128 v[72:75], v23 offset:24576
v_mfma_f32_16x16x32_bf16 v[132:135], v[80:83], a[132:135], v[132:135]
s_waitcnt lgkmcnt(3)
ds_read_b128 v[76:79], v23 offset:28672
v_mfma_f32_16x16x32_bf16 v[140:143], v[96:99], a[132:135], v[140:143]
buffer_load_dwordx4 v1, s[4:7], s42 offen offset:1024 sc1 lds
v_mfma_f32_16x16x32_bf16 v[140:143], v[100:103], a[140:143], v[140:143]
ds_read_b128 v[80:83], v23 offset:17408
v_fma_f32 v229, v229, s78, s78
v_mfma_f32_16x16x32_bf16 v[140:143], v[104:107], a[148:151], v[140:143]
ds_read_b128 v[84:87], v23 offset:21504
v_fma_f32 v230, v230, s78, s78
v_mfma_f32_16x16x32_bf16 v[140:143], v[108:111], a[156:159], v[140:143]
ds_read_b128 v[88:91], v23 offset:25600
v_fma_f32 v231, v231, s78, s78
v_mfma_f32_16x16x32_bf16 v[136:139], v[108:111], a[152:155], v[136:139]
v_rcp_f32 v228, v228
v_mfma_f32_16x16x32_bf16 v[136:139], v[104:107], a[144:147], v[136:139]
v_rcp_f32 v229, v229
v_mfma_f32_16x16x32_bf16 v[136:139], v[100:103], a[136:139], v[136:139]
v_rcp_f32 v230, v230
v_mfma_f32_16x16x32_bf16 v[136:139], v[96:99], a[128:131], v[136:139]
s_waitcnt lgkmcnt(3)
ds_read_b128 v[92:95], v23 offset:29696
v_mfma_f32_16x16x32_bf16 v[112:115], v[64:67], a[160:163], v[112:115]
buffer_load_dwordx4 v1, s[4:7], s42 offen offset:2048 sc1 lds
v_mfma_f32_16x16x32_bf16 v[112:115], v[68:71], a[168:171], v[112:115]
v_rcp_f32 v231, v231
v_mfma_f32_16x16x32_bf16 v[112:115], v[72:75], a[176:179], v[112:115]
ds_read_b128 v[96:99], v23 offset:18432
v_mul_f32 v168, v228, v168
v_mul_f32 v169, v229, v169
v_mfma_f32_16x16x32_bf16 v[112:115], v[76:79], a[184:187], v[112:115]
ds_read_b128 v[100:103], v23 offset:22528
v_mul_f32 v170, v230, v170
v_mfma_f32_16x16x32_bf16 v[116:119], v[76:79], a[188:191], v[116:119]
ds_read_b128 v[104:107], v23 offset:26624
v_mul_f32 v171, v231, v171
v_cvt_pk_bf16_f32 v218, v168, v169
v_mfma_f32_16x16x32_bf16 v[116:119], v[72:75], a[180:183], v[116:119]
v_cvt_pk_bf16_f32 v219, v170, v171
s_lshl_b32 s46, s38, 12
v_mfma_f32_16x16x32_bf16 v[116:119], v[68:71], a[172:175], v[116:119]
s_add_u32 s46, s46, s71
s_add_u32 s46, s46, 65536
buffer_store_dwordx4 v[216:219], v10, s[4:7], s46 offen offset:2048 sc1
v_mfma_f32_16x16x32_bf16 v[116:119], v[64:67], a[164:167], v[116:119]
s_waitcnt lgkmcnt(3)
ds_read_b128 v[108:111], v23 offset:30720
v_mfma_f32_16x16x32_bf16 v[124:127], v[80:83], a[164:167], v[124:127]
buffer_load_dwordx4 v1, s[4:7], s42 offen offset:3072 sc1 lds
v_mfma_f32_16x16x32_bf16 v[124:127], v[84:87], a[172:175], v[124:127]
ds_read_b128 v[64:67], v23 offset:19456
v_mul_f32 v164, v41, v164
v_mfma_f32_16x16x32_bf16 v[124:127], v[88:91], a[180:183], v[124:127]
ds_read_b128 v[68:71], v23 offset:23552
v_mul_f32 v165, v41, v165
v_mfma_f32_16x16x32_bf16 v[124:127], v[92:95], a[188:191], v[124:127]
v_mul_f32 v166, v41, v166
v_mul_f32 v167, v41, v167
v_mfma_f32_16x16x32_bf16 v[120:123], v[92:95], a[184:187], v[120:123]
v_exp_f32 v224, v164
v_mfma_f32_16x16x32_bf16 v[120:123], v[88:91], a[176:179], v[120:123]
v_exp_f32 v225, v165
v_mfma_f32_16x16x32_bf16 v[120:123], v[84:87], a[168:171], v[120:123]
ds_read_b128 v[72:75], v23 offset:27648
v_mfma_f32_16x16x32_bf16 v[120:123], v[80:83], a[160:163], v[120:123]
s_waitcnt vmcnt(11) lgkmcnt(3)
s_barrier
ds_read_b128 v[76:79], v23 offset:31744
v_mfma_f32_16x16x32_bf16 v[128:131], v[96:99], a[160:163], v[128:131]
s_add_u32 m0, s41, 32768
s_add_u32 s42, s65, 32768
buffer_load_dwordx4 v1, s[4:7], s42 offen sc1 lds
v_mfma_f32_16x16x32_bf16 v[128:131], v[100:103], a[168:171], v[128:131]
v_exp_f32 v226, v166
v_mfma_f32_16x16x32_bf16 v[128:131], v[104:107], a[176:179], v[128:131]
v_exp_f32 v227, v167
v_mfma_f32_16x16x32_bf16 v[128:131], v[108:111], a[184:187], v[128:131]
ds_read_b128 v[80:83], v23 offset:32768
v_fma_f32 v224, v224, s78, s78
v_mfma_f32_16x16x32_bf16 v[132:135], v[108:111], a[188:191], v[132:135]
ds_read_b128 v[84:87], v23 offset:36864
v_fma_f32 v225, v225, s78, s78
v_mfma_f32_16x16x32_bf16 v[132:135], v[104:107], a[180:183], v[132:135]
ds_read_b128 v[88:91], v23 offset:40960
v_fma_f32 v226, v226, s78, s78
v_mfma_f32_16x16x32_bf16 v[132:135], v[100:103], a[172:175], v[132:135]
ds_read_b128 v[92:95], v23 offset:45056
v_fma_f32 v227, v227, s78, s78
v_mfma_f32_16x16x32_bf16 v[132:135], v[96:99], a[164:167], v[132:135]
s_waitcnt lgkmcnt(4)
v_mfma_f32_16x16x32_bf16 v[140:143], v[64:67], a[164:167], v[140:143]
buffer_load_dwordx4 v1, s[4:7], s42 offen offset:1024 sc1 lds
v_mfma_f32_16x16x32_bf16 v[140:143], v[68:71], a[172:175], v[140:143]
v_rcp_f32 v224, v224
v_mfma_f32_16x16x32_bf16 v[140:143], v[72:75], a[180:183], v[140:143]
v_rcp_f32 v225, v225
v_mfma_f32_16x16x32_bf16 v[140:143], v[76:79], a[188:191], v[140:143]
v_rcp_f32 v226, v226
v_mfma_f32_16x16x32_bf16 v[136:139], v[76:79], a[184:187], v[136:139]
ds_read_b128 v[96:99], v23 offset:33792
v_rcp_f32 v227, v227
v_mfma_f32_16x16x32_bf16 v[136:139], v[72:75], a[176:179], v[136:139]
ds_read_b128 v[100:103], v23 offset:37888
v_mul_f32 v164, v224, v164
v_mfma_f32_16x16x32_bf16 v[136:139], v[68:71], a[168:171], v[136:139]
ds_read_b128 v[104:107], v23 offset:41984
v_mul_f32 v165, v225, v165
v_mfma_f32_16x16x32_bf16 v[136:139], v[64:67], a[160:163], v[136:139]
s_waitcnt lgkmcnt(3)
ds_read_b128 v[108:111], v23 offset:46080
v_mfma_f32_16x16x32_bf16 v[112:115], v[80:83], a[192:195], v[112:115]
buffer_load_dwordx4 v1, s[4:7], s42 offen offset:2048 sc1 lds
v_mfma_f32_16x16x32_bf16 v[112:115], v[84:87], a[200:203], v[112:115]
ds_read_b128 v[64:67], v23 offset:34816
v_mul_f32 v166, v226, v166
v_mfma_f32_16x16x32_bf16 v[112:115], v[88:91], a[208:211], v[112:115]
ds_read_b128 v[68:71], v23 offset:38912
v_mul_f32 v167, v227, v167
v_mfma_f32_16x16x32_bf16 v[112:115], v[92:95], a[216:219], v[112:115]
v_cvt_pk_bf16_f32 v220, v164, v165
v_cvt_pk_bf16_f32 v221, v166, v167
v_mfma_f32_16x16x32_bf16 v[116:119], v[92:95], a[220:223], v[116:119]
ds_read_b128 v[72:75], v23 offset:43008
v_mul_f32 v172, v41, v172
v_mfma_f32_16x16x32_bf16 v[116:119], v[88:91], a[212:215], v[116:119]
v_mul_f32 v173, v41, v173
v_mul_f32 v174, v41, v174
v_mfma_f32_16x16x32_bf16 v[116:119], v[84:87], a[204:207], v[116:119]
ds_read_b128 v[76:79], v23 offset:47104
v_mul_f32 v175, v41, v175
v_mfma_f32_16x16x32_bf16 v[116:119], v[80:83], a[196:199], v[116:119]
s_waitcnt lgkmcnt(4)
v_exp_f32 v228, v172
v_mfma_f32_16x16x32_bf16 v[124:127], v[96:99], a[196:199], v[124:127]
buffer_load_dwordx4 v1, s[4:7], s42 offen offset:3072 sc1 lds
v_mfma_f32_16x16x32_bf16 v[124:127], v[100:103], a[204:207], v[124:127]
v_exp_f32 v229, v173
v_mfma_f32_16x16x32_bf16 v[124:127], v[104:107], a[212:215], v[124:127]
v_exp_f32 v230, v174
v_mfma_f32_16x16x32_bf16 v[124:127], v[108:111], a[220:223], v[124:127]
v_exp_f32 v231, v175
v_mfma_f32_16x16x32_bf16 v[120:123], v[108:111], a[216:219], v[120:123]
ds_read_b128 v[80:83], v23 offset:35840
v_fma_f32 v228, v228, s78, s78
v_mfma_f32_16x16x32_bf16 v[120:123], v[104:107], a[208:211], v[120:123]
ds_read_b128 v[84:87], v23 offset:39936
v_fma_f32 v229, v229, s78, s78
v_mfma_f32_16x16x32_bf16 v[120:123], v[100:103], a[200:203], v[120:123]
ds_read_b128 v[88:91], v23 offset:44032
v_fma_f32 v230, v230, s78, s78
v_mfma_f32_16x16x32_bf16 v[120:123], v[96:99], a[192:195], v[120:123]
s_waitcnt lgkmcnt(3)
ds_read_b128 v[92:95], v23 offset:48128
v_fma_f32 v231, v231, s78, s78
v_mfma_f32_16x16x32_bf16 v[128:131], v[64:67], a[192:195], v[128:131]
s_add_u32 m0, s41, 49152
s_add_u32 s42, s65, 49152
buffer_load_dwordx4 v1, s[4:7], s42 offen sc1 lds
v_mfma_f32_16x16x32_bf16 v[128:131], v[68:71], a[200:203], v[128:131]
v_rcp_f32 v228, v228
v_mfma_f32_16x16x32_bf16 v[128:131], v[72:75], a[208:211], v[128:131]
v_rcp_f32 v229, v229
v_mfma_f32_16x16x32_bf16 v[128:131], v[76:79], a[216:219], v[128:131]
v_rcp_f32 v230, v230
v_mfma_f32_16x16x32_bf16 v[132:135], v[76:79], a[220:223], v[132:135]
ds_read_b128 v[96:99], v23 offset:49152
v_rcp_f32 v231, v231
v_mfma_f32_16x16x32_bf16 v[132:135], v[72:75], a[212:215], v[132:135]
ds_read_b128 v[100:103], v23 offset:53248
v_mul_f32 v172, v228, v172
v_mfma_f32_16x16x32_bf16 v[132:135], v[68:71], a[204:207], v[132:135]
ds_read_b128 v[104:107], v23 offset:57344
v_mul_f32 v173, v229, v173
v_mfma_f32_16x16x32_bf16 v[132:135], v[64:67], a[196:199], v[132:135]
s_waitcnt lgkmcnt(3)
ds_read_b128 v[108:111], v23 offset:61440
v_mfma_f32_16x16x32_bf16 v[140:143], v[80:83], a[196:199], v[140:143]
buffer_load_dwordx4 v1, s[4:7], s42 offen offset:1024 sc1 lds
v_mfma_f32_16x16x32_bf16 v[140:143], v[84:87], a[204:207], v[140:143]
ds_read_b128 v[64:67], v23 offset:50176
v_mul_f32 v174, v230, v174
v_mfma_f32_16x16x32_bf16 v[140:143], v[88:91], a[212:215], v[140:143]
ds_read_b128 v[68:71], v23 offset:54272
v_mul_f32 v175, v231, v175
v_mfma_f32_16x16x32_bf16 v[140:143], v[92:95], a[220:223], v[140:143]
v_cvt_pk_bf16_f32 v222, v172, v173
v_cvt_pk_bf16_f32 v223, v174, v175
v_mfma_f32_16x16x32_bf16 v[136:139], v[92:95], a[216:219], v[136:139]
s_lshl_b32 s46, s38, 12
s_add_u32 s46, s46, s71
v_mfma_f32_16x16x32_bf16 v[136:139], v[88:91], a[208:211], v[136:139]
s_add_u32 s46, s46, 65536
buffer_store_dwordx4 v[220:223], v10, s[4:7], s46 offen offset:3072 sc1
v_mfma_f32_16x16x32_bf16 v[136:139], v[84:87], a[200:203], v[136:139]
ds_read_b128 v[72:75], v23 offset:58368
v_mfma_f32_16x16x32_bf16 v[136:139], v[80:83], a[192:195], v[136:139]
s_waitcnt lgkmcnt(3)
ds_read_b128 v[76:79], v23 offset:62464
v_mfma_f32_16x16x32_bf16 v[112:115], v[96:99], a[224:227], v[112:115]
buffer_load_dwordx4 v1, s[4:7], s42 offen offset:2048 sc1 lds
v_mfma_f32_16x16x32_bf16 v[112:115], v[100:103], a[232:235], v[112:115]
ds_read_b128 v[80:83], v23 offset:51200
ds_read_b128 v[48:51], v5 offset:1280
v_mfma_f32_16x16x32_bf16 v[112:115], v[104:107], a[240:243], v[112:115]
ds_read_b128 v[84:87], v23 offset:55296
ds_read_b128 v[52:55], v5 offset:1344
v_mfma_f32_16x16x32_bf16 v[112:115], v[108:111], a[248:251], v[112:115]
ds_read_b128 v[56:59], v5 offset:1408
ds_read_b128 v[60:63], v5 offset:1472
v_mfma_f32_16x16x32_bf16 v[116:119], v[108:111], a[252:255], v[116:119]
ds_read_b128 v[88:91], v23 offset:59392
v_mfma_f32_16x16x32_bf16 v[116:119], v[104:107], a[244:247], v[116:119]
v_mfma_f32_16x16x32_bf16 v[116:119], v[100:103], a[236:239], v[116:119]
ds_read_b128 v[92:95], v23 offset:63488
v_mfma_f32_16x16x32_bf16 v[116:119], v[96:99], a[228:231], v[116:119]
s_waitcnt lgkmcnt(8)
v_mfma_f32_16x16x32_bf16 v[124:127], v[64:67], a[228:231], v[124:127]
buffer_load_dwordx4 v1, s[4:7], s42 offen offset:3072 sc1 lds
v_mfma_f32_16x16x32_bf16 v[124:127], v[68:71], a[236:239], v[124:127]
s_lshl_b32 s79, s94, 1
ds_read_b128 v[96:99], v23 offset:52224
s_add_u32 s79, s79, s71
v_mfma_f32_16x16x32_bf16 v[124:127], v[72:75], a[244:247], v[124:127]
ds_read_b128 v[100:103], v23 offset:56320
v_mov_b32 v25, 0
v_mfma_f32_16x16x32_bf16 v[124:127], v[76:79], a[252:255], v[124:127]
v_mfma_f32_16x16x32_bf16 v[120:123], v[76:79], a[248:251], v[120:123]
buffer_atomic_add v25, v11, s[4:7], s32 offen offset:28 sc0 sc1
v_mfma_f32_16x16x32_bf16 v[120:123], v[72:75], a[240:243], v[120:123]
ds_read_b128 v[104:107], v23 offset:60416
v_mfma_f32_16x16x32_bf16 v[120:123], v[68:71], a[232:235], v[120:123]
ds_read_b128 v[108:111], v23 offset:64512
v_mfma_f32_16x16x32_bf16 v[120:123], v[64:67], a[224:227], v[120:123]
s_waitcnt vmcnt(10) lgkmcnt(4)
s_barrier
v_mfma_f32_16x16x32_bf16 v[128:131], v[80:83], a[224:227], v[128:131]
ds_read_b128 v[64:67], v1 offset:0
v_mov_b32 v28, v24
v_add_u32 v29, 15360, v24
v_mfma_f32_16x16x32_bf16 v[128:131], v[84:87], a[232:235], v[128:131]
ds_read_b128 v[68:71], v1 offset:2048
v_add_u32 v30, 30720, v24
v_add_u32 v31, 46080, v24
v_mfma_f32_16x16x32_bf16 v[128:131], v[88:91], a[240:243], v[128:131]
s_xor_b64 s[20:21], s[20:21], s[26:27]
s_mov_b64 s[26:27], 0
s_add_u32 m0, s41, 65536
s_add_u32 s42, s88, s92
v_mfma_f32_16x16x32_bf16 v[128:131], v[92:95], a[248:251], v[128:131]
buffer_load_dwordx4 v28, s[20:23], s42 offen sc1 lds
v_fmac_f32 v112, v48, v42
v_mfma_f32_16x16x32_bf16 v[132:135], v[92:95], a[252:255], v[132:135]
ds_read_b128 v[72:75], v1 offset:4096
v_fmac_f32 v113, v49, v42
v_fmac_f32 v114, v50, v42
v_fmac_f32 v115, v51, v42
v_mfma_f32_16x16x32_bf16 v[132:135], v[88:91], a[244:247], v[132:135]
ds_read_b128 v[76:79], v1 offset:6144
v_mul_f32 v112, v40, v112
v_mul_f32 v113, v40, v113
v_mul_f32 v114, v40, v114
v_mfma_f32_16x16x32_bf16 v[132:135], v[84:87], a[236:239], v[132:135]
v_mul_f32 v115, v40, v115
v_exp_f32 v224, v112
v_exp_f32 v225, v113
v_mfma_f32_16x16x32_bf16 v[132:135], v[80:83], a[228:231], v[132:135]
s_waitcnt lgkmcnt(4)
v_exp_f32 v226, v114
v_exp_f32 v227, v115
v_mfma_f32_16x16x32_bf16 v[140:143], v[96:99], a[228:231], v[140:143]
buffer_load_dwordx4 v29, s[20:23], s42 offen offset:1024 sc1 lds
v_fma_f32 v224, v224, s78, s78
v_mfma_f32_16x16x32_bf16 v[140:143], v[100:103], a[236:239], v[140:143]
ds_read_b128 v[80:83], v1 offset:8192
v_fma_f32 v225, v225, s78, s78
v_fma_f32 v226, v226, s78, s78
v_mfma_f32_16x16x32_bf16 v[140:143], v[104:107], a[244:247], v[140:143]
ds_read_b128 v[84:87], v1 offset:10240
v_fma_f32 v227, v227, s78, s78
v_rcp_f32 v224, v224
v_mfma_f32_16x16x32_bf16 v[140:143], v[108:111], a[252:255], v[140:143]
v_rcp_f32 v225, v225
v_rcp_f32 v226, v226
v_mfma_f32_16x16x32_bf16 v[136:139], v[108:111], a[248:251], v[136:139]
v_rcp_f32 v227, v227
v_mul_f32 v112, v224, v112
v_mfma_f32_16x16x32_bf16 v[136:139], v[104:107], a[240:243], v[136:139]
ds_read_b128 v[88:91], v1 offset:12288
v_mul_f32 v113, v225, v113
v_mul_f32 v114, v226, v114
v_mfma_f32_16x16x32_bf16 v[136:139], v[100:103], a[232:235], v[136:139]
ds_read_b128 v[92:95], v1 offset:14336
v_mul_f32 v115, v227, v115
v_cvt_pk_bf16_f32 v208, v112, v113
v_mfma_f32_16x16x32_bf16 v[136:139], v[96:99], a[224:227], v[136:139]
s_waitcnt lgkmcnt(4)
v_cvt_pk_bf16_f32 v209, v114, v115
v_fmac_f32 v120, v52, v42
v_mfma_f32_16x16x32_bf16 v[240:243], v[64:67], a[0:3], v[240:243]
buffer_load_dwordx4 v30, s[20:23], s42 offen offset:2048 sc1 lds
v_fmac_f32 v121, v53, v42
v_mfma_f32_16x16x32_bf16 v[240:243], v[68:71], a[8:11], v[240:243]
ds_read_b128 v[96:99], v1 offset:9216
v_fmac_f32 v122, v54, v42
v_fmac_f32 v123, v55, v42
v_mfma_f32_16x16x32_bf16 v[240:243], v[72:75], a[16:19], v[240:243]
ds_read_b128 v[100:103], v1 offset:11264
v_mul_f32 v120, v40, v120
v_mul_f32 v121, v40, v121
v_mul_f32 v122, v40, v122
v_mfma_f32_16x16x32_bf16 v[240:243], v[76:79], a[24:27], v[240:243]
ds_read_b128 v[104:107], v1 offset:13312
v_mul_f32 v123, v40, v123
v_exp_f32 v228, v120
v_mfma_f32_16x16x32_bf16 v[244:247], v[76:79], a[28:31], v[244:247]
v_exp_f32 v229, v121
v_exp_f32 v230, v122
v_mfma_f32_16x16x32_bf16 v[244:247], v[72:75], a[20:23], v[244:247]
v_exp_f32 v231, v123
v_fma_f32 v228, v228, s78, s78
v_mfma_f32_16x16x32_bf16 v[244:247], v[68:71], a[12:15], v[244:247]
ds_read_b128 v[108:111], v1 offset:15360
v_fma_f32 v229, v229, s78, s78
v_fma_f32 v230, v230, s78, s78
v_mfma_f32_16x16x32_bf16 v[244:247], v[64:67], a[4:7], v[244:247]
s_waitcnt lgkmcnt(4)
v_fma_f32 v231, v231, s78, s78
v_rcp_f32 v228, v228
v_mfma_f32_16x16x32_bf16 v[244:247], v[80:83], a[36:39], v[244:247]
buffer_load_dwordx4 v31, s[20:23], s42 offen offset:3072 sc1 lds
v_rcp_f32 v229, v229
v_mfma_f32_16x16x32_bf16 v[244:247], v[84:87], a[44:47], v[244:247]
v_rcp_f32 v230, v230
v_rcp_f32 v231, v231
v_mfma_f32_16x16x32_bf16 v[244:247], v[88:91], a[52:55], v[244:247]
ds_read_b128 v[64:67], v1 offset:1024
v_mul_f32 v120, v228, v120
v_mul_f32 v121, v229, v121
v_mfma_f32_16x16x32_bf16 v[244:247], v[92:95], a[60:63], v[244:247]
s_branch Lso15
Lst15:
s_branch Lst19
Lso15:
ds_read_b128 v[68:71], v1 offset:3072
v_mul_f32 v122, v230, v122
v_mul_f32 v123, v231, v123
v_mfma_f32_16x16x32_bf16 v[240:243], v[92:95], a[56:59], v[240:243]
ds_read_b128 v[72:75], v1 offset:5120
v_cvt_pk_bf16_f32 v210, v120, v121
v_cvt_pk_bf16_f32 v211, v122, v123
v_mfma_f32_16x16x32_bf16 v[240:243], v[88:91], a[48:51], v[240:243]
s_lshl_b32 s46, s38, 12
s_add_u32 s46, s46, s71
s_add_u32 s46, s46, 131072
v_mfma_f32_16x16x32_bf16 v[240:243], v[84:87], a[40:43], v[240:243]
buffer_store_dwordx4 v[208:211], v10, s[4:7], s46 offen sc1
v_mfma_f32_16x16x32_bf16 v[240:243], v[80:83], a[32:35], v[240:243]
s_waitcnt lgkmcnt(3)
ds_read_b128 v[76:79], v1 offset:7168
v_fmac_f32 v116, v48, v43
v_fmac_f32 v117, v49, v43
v_mfma_f32_16x16x32_bf16 v[248:251], v[96:99], a[32:35], v[248:251]
s_add_u32 m0, s41, 81920
s_add_u32 s42, s88, s93
buffer_load_dwordx4 v28, s[20:23], s42 offen sc1 lds
v_mfma_f32_16x16x32_bf16 v[248:251], v[100:103], a[40:43], v[248:251]
ds_read_b128 v[80:83], v1 offset:16384
v_fmac_f32 v118, v50, v43
v_fmac_f32 v119, v51, v43
v_mfma_f32_16x16x32_bf16 v[248:251], v[104:107], a[48:51], v[248:251]
ds_read_b128 v[84:87], v1 offset:18432
v_mul_f32 v116, v41, v116
v_mul_f32 v117, v41, v117
v_mul_f32 v118, v41, v118
v_mfma_f32_16x16x32_bf16 v[248:251], v[108:111], a[56:59], v[248:251]
ds_read_b128 v[88:91], v1 offset:20480
v_mul_f32 v119, v41, v119
v_exp_f32 v224, v116
v_mfma_f32_16x16x32_bf16 v[252:255], v[108:111], a[60:63], v[252:255]
v_exp_f32 v225, v117
v_exp_f32 v226, v118
v_mfma_f32_16x16x32_bf16 v[252:255], v[104:107], a[52:55], v[252:255]
v_exp_f32 v227, v119
v_fma_f32 v224, v224, s78, s78
v_mfma_f32_16x16x32_bf16 v[252:255], v[100:103], a[44:47], v[252:255]
ds_read_b128 v[92:95], v1 offset:22528
v_fma_f32 v225, v225, s78, s78
v_fma_f32 v226, v226, s78, s78
v_mfma_f32_16x16x32_bf16 v[252:255], v[96:99], a[36:39], v[252:255]
s_waitcnt lgkmcnt(4)
v_fma_f32 v227, v227, s78, s78
v_rcp_f32 v224, v224
v_mfma_f32_16x16x32_bf16 v[252:255], v[64:67], a[4:7], v[252:255]
buffer_load_dwordx4 v29, s[20:23], s42 offen offset:1024 sc1 lds
v_rcp_f32 v225, v225
v_mfma_f32_16x16x32_bf16 v[252:255], v[68:71], a[12:15], v[252:255]
v_rcp_f32 v226, v226
v_rcp_f32 v227, v227
v_mfma_f32_16x16x32_bf16 v[252:255], v[72:75], a[20:23], v[252:255]
s_waitcnt vmcnt(7)
v_readfirstlane_b32 s45, v25
s_nop 0
s_cmp_lt_u32 s45, 4
s_cbranch_scc1 Lslow12050
Lback12051:
v_mfma_f32_16x16x32_bf16 v[252:255], v[76:79], a[28:31], v[252:255]
ds_read_b128 v[96:99], v1 offset:24576
v_mul_f32 v116, v224, v116
v_mul_f32 v117, v225, v117
v_mfma_f32_16x16x32_bf16 v[248:251], v[76:79], a[24:27], v[248:251]
ds_read_b128 v[100:103], v1 offset:26624
v_mul_f32 v118, v226, v118
v_mfma_f32_16x16x32_bf16 v[248:251], v[72:75], a[16:19], v[248:251]
ds_read_b128 v[104:107], v1 offset:28672
v_mul_f32 v119, v227, v119
v_cvt_pk_bf16_f32 v212, v116, v117
v_mfma_f32_16x16x32_bf16 v[248:251], v[68:71], a[8:11], v[248:251]
ds_read_b128 v[108:111], v1 offset:30720
v_cvt_pk_bf16_f32 v213, v118, v119
buffer_atomic_add v26, v11, s[4:7], s32 offen offset:32 sc1
v_mfma_f32_16x16x32_bf16 v[248:251], v[64:67], a[0:3], v[248:251]
s_waitcnt lgkmcnt(4)
v_fmac_f32 v124, v52, v43
v_fmac_f32 v125, v53, v43
v_mfma_f32_16x16x32_bf16 v[240:243], v[80:83], a[64:67], v[240:243]
buffer_load_dwordx4 v30, s[20:23], s42 offen offset:2048 sc1 lds
v_fmac_f32 v126, v54, v43
v_mfma_f32_16x16x32_bf16 v[240:243], v[84:87], a[72:75], v[240:243]
ds_read_b128 v[64:67], v1 offset:25600
v_fmac_f32 v127, v55, v43
v_mul_f32 v124, v41, v124
v_mfma_f32_16x16x32_bf16 v[240:243], v[88:91], a[80:83], v[240:243]
ds_read_b128 v[68:71], v1 offset:27648
v_mul_f32 v125, v41, v125
s_lshr_b32 s43, s92, 5
v_mfma_f32_16x16x32_bf16 v[240:243], v[92:95], a[88:91], v[240:243]
s_add_u32 s43, s43, s79
buffer_load_dwordx4 a[0:3], v10, s[4:7], s43 offen sc1
v_mul_f32 v126, v41, v126
v_mul_f32 v127, v41, v127
v_mfma_f32_16x16x32_bf16 v[244:247], v[92:95], a[92:95], v[244:247]
v_exp_f32 v228, v124
v_exp_f32 v229, v125
v_mfma_f32_16x16x32_bf16 v[244:247], v[88:91], a[84:87], v[244:247]
buffer_load_dwordx4 a[4:7], v10, s[4:7], s43 offen offset:1024 sc1
v_exp_f32 v230, v126
v_mfma_f32_16x16x32_bf16 v[244:247], v[84:87], a[76:79], v[244:247]
ds_read_b128 v[72:75], v1 offset:29696
v_exp_f32 v231, v127
v_mfma_f32_16x16x32_bf16 v[244:247], v[80:83], a[68:71], v[244:247]
s_waitcnt lgkmcnt(3)
ds_read_b128 v[76:79], v1 offset:31744
v_fma_f32 v228, v228, s78, s78
v_fma_f32 v229, v229, s78, s78
v_mfma_f32_16x16x32_bf16 v[244:247], v[96:99], a[100:103], v[244:247]
buffer_load_dwordx4 v31, s[20:23], s42 offen offset:3072 sc1 lds
v_fma_f32 v230, v230, s78, s78
v_mfma_f32_16x16x32_bf16 v[244:247], v[100:103], a[108:111], v[244:247]
ds_read_b128 v[80:83], v1 offset:17408
v_fma_f32 v231, v231, s78, s78
v_rcp_f32 v228, v228
v_mfma_f32_16x16x32_bf16 v[244:247], v[104:107], a[116:119], v[244:247]
v_rcp_f32 v229, v229
v_mfma_f32_16x16x32_bf16 v[244:247], v[108:111], a[124:127], v[244:247]
buffer_load_dwordx4 a[8:11], v10, s[4:7], s43 offen offset:2048 sc1
v_rcp_f32 v230, v230
v_mfma_f32_16x16x32_bf16 v[240:243], v[108:111], a[120:123], v[240:243]
v_rcp_f32 v231, v231
v_mul_f32 v124, v228, v124
v_mfma_f32_16x16x32_bf16 v[240:243], v[104:107], a[112:115], v[240:243]
ds_read_b128 v[84:87], v1 offset:19456
v_mul_f32 v125, v229, v125
buffer_load_dwordx4 a[12:15], v10, s[4:7], s43 offen offset:3072 sc1
v_mfma_f32_16x16x32_bf16 v[240:243], v[100:103], a[104:107], v[240:243]
ds_read_b128 v[88:91], v1 offset:21504
v_mul_f32 v126, v230, v126
v_mul_f32 v127, v231, v127
v_mfma_f32_16x16x32_bf16 v[240:243], v[96:99], a[96:99], v[240:243]
s_waitcnt lgkmcnt(3)
s_barrier
ds_read_b128 v[92:95], v1 offset:23552
v_cvt_pk_bf16_f32 v214, v124, v125
v_cvt_pk_bf16_f32 v215, v126, v127
v_mfma_f32_16x16x32_bf16 v[248:251], v[64:67], a[96:99], v[248:251]
s_xor_b64 s[20:21], s[20:21], s[66:67]
s_add_u32 m0, s41, 98304
s_add_u32 s42, s89, s92
buffer_load_dwordx4 v28, s[20:23], s42 offen sc1 lds
v_mfma_f32_16x16x32_bf16 v[248:251], v[68:71], a[104:107], v[248:251]
s_lshl_b32 s46, s38, 12
s_add_u32 s46, s46, s71
s_add_u32 s46, s46, 131072
v_mfma_f32_16x16x32_bf16 v[248:251], v[72:75], a[112:115], v[248:251]
buffer_store_dwordx4 v[212:215], v10, s[4:7], s46 offen offset:1024 sc1
v_mfma_f32_16x16x32_bf16 v[248:251], v[76:79], a[120:123], v[248:251]
ds_read_b128 v[96:99], v1 offset:32768
v_fmac_f32 v128, v56, v42
v_fmac_f32 v129, v57, v42
v_fmac_f32 v130, v58, v42
v_mfma_f32_16x16x32_bf16 v[252:255], v[76:79], a[124:127], v[252:255]
ds_read_b128 v[100:103], v1 offset:34816
v_fmac_f32 v131, v59, v42
v_mul_f32 v128, v40, v128
v_mfma_f32_16x16x32_bf16 v[252:255], v[72:75], a[116:119], v[252:255]
buffer_load_dwordx4 a[16:19], v2, s[4:7], s43 offen sc1
v_mul_f32 v129, v40, v129
v_mul_f32 v130, v40, v130
v_mfma_f32_16x16x32_bf16 v[252:255], v[68:71], a[108:111], v[252:255]
ds_read_b128 v[104:107], v1 offset:36864
v_mul_f32 v131, v40, v131
v_exp_f32 v224, v128
v_mfma_f32_16x16x32_bf16 v[252:255], v[64:67], a[100:103], v[252:255]
s_waitcnt lgkmcnt(3)
ds_read_b128 v[108:111], v1 offset:38912
v_exp_f32 v225, v129
v_mfma_f32_16x16x32_bf16 v[252:255], v[80:83], a[68:71], v[252:255]
buffer_load_dwordx4 v29, s[20:23], s42 offen offset:1024 sc1 lds
v_exp_f32 v226, v130
v_mfma_f32_16x16x32_bf16 v[252:255], v[84:87], a[76:79], v[252:255]
v_exp_f32 v227, v131
v_fma_f32 v224, v224, s78, s78
v_mfma_f32_16x16x32_bf16 v[252:255], v[88:91], a[84:87], v[252:255]
ds_read_b128 v[64:67], v1 offset:40960
v_fma_f32 v225, v225, s78, s78
buffer_load_dwordx4 a[20:23], v2, s[4:7], s43 offen offset:1024 sc1
v_mfma_f32_16x16x32_bf16 v[252:255], v[92:95], a[92:95], v[252:255]
ds_read_b128 v[68:71], v1 offset:43008
v_fma_f32 v226, v226, s78, s78
v_fma_f32 v227, v227, s78, s78
v_mfma_f32_16x16x32_bf16 v[248:251], v[92:95], a[88:91], v[248:251]
v_rcp_f32 v224, v224
v_mfma_f32_16x16x32_bf16 v[248:251], v[88:91], a[80:83], v[248:251]
buffer_load_dwordx4 a[24:27], v2, s[4:7], s43 offen offset:2048 sc1
v_rcp_f32 v225, v225
v_mfma_f32_16x16x32_bf16 v[248:251], v[84:87], a[72:75], v[248:251]
ds_read_b128 v[72:75], v1 offset:45056
v_rcp_f32 v226, v226
v_mfma_f32_16x16x32_bf16 v[248:251], v[80:83], a[64:67], v[248:251]
s_waitcnt lgkmcnt(3)
ds_read_b128 v[76:79], v1 offset:47104
v_rcp_f32 v227, v227
v_mfma_f32_16x16x32_bf16 v[240:243], v[96:99], a[128:131], v[240:243]
buffer_load_dwordx4 v30, s[20:23], s42 offen offset:2048 sc1 lds
v_mul_f32 v128, v224, v128
v_mfma_f32_16x16x32_bf16 v[240:243], v[100:103], a[136:139], v[240:243]
ds_read_b128 v[80:83], v1 offset:41984
v_mul_f32 v129, v225, v129
v_mul_f32 v130, v226, v130
v_mfma_f32_16x16x32_bf16 v[240:243], v[104:107], a[144:147], v[240:243]
ds_read_b128 v[84:87], v1 offset:44032
v_mul_f32 v131, v227, v131
v_cvt_pk_bf16_f32 v216, v128, v129
v_mfma_f32_16x16x32_bf16 v[240:243], v[108:111], a[152:155], v[240:243]
ds_read_b128 v[88:91], v1 offset:46080
v_cvt_pk_bf16_f32 v217, v130, v131
v_fmac_f32 v136, v60, v42
v_mfma_f32_16x16x32_bf16 v[244:247], v[108:111], a[156:159], v[244:247]
ds_read_b128 v[92:95], v1 offset:48128
v_fmac_f32 v137, v61, v42
buffer_load_dwordx4 a[28:31], v2, s[4:7], s43 offen offset:3072 sc1
v_mfma_f32_16x16x32_bf16 v[244:247], v[104:107], a[148:151], v[244:247]
v_fmac_f32 v138, v62, v42
v_fmac_f32 v139, v63, v42
v_mul_f32 v136, v40, v136
v_mfma_f32_16x16x32_bf16 v[244:247], v[100:103], a[140:143], v[244:247]
v_mul_f32 v137, v40, v137
v_mul_f32 v138, v40, v138
v_mul_f32 v139, v40, v139
v_mfma_f32_16x16x32_bf16 v[244:247], v[96:99], a[132:135], v[244:247]
s_waitcnt lgkmcnt(4)
v_exp_f32 v228, v136
v_exp_f32 v229, v137
v_mfma_f32_16x16x32_bf16 v[244:247], v[64:67], a[164:167], v[244:247]
buffer_load_dwordx4 v31, s[20:23], s42 offen offset:3072 sc1 lds
v_exp_f32 v230, v138
v_mfma_f32_16x16x32_bf16 v[244:247], v[68:71], a[172:175], v[244:247]
v_exp_f32 v231, v139
v_fma_f32 v228, v228, s78, s78
v_mfma_f32_16x16x32_bf16 v[244:247], v[72:75], a[180:183], v[244:247]
ds_read_b128 v[96:99], v1 offset:33792
v_fma_f32 v229, v229, s78, s78
s_lshr_b32 s43, s93, 5
v_mfma_f32_16x16x32_bf16 v[244:247], v[76:79], a[188:191], v[244:247]
s_add_u32 s43, s43, s79
buffer_load_dwordx4 a[32:35], v10, s[4:7], s43 offen sc1
v_fma_f32 v230, v230, s78, s78
v_mfma_f32_16x16x32_bf16 v[240:243], v[76:79], a[184:187], v[240:243]
ds_read_b128 v[100:103], v1 offset:35840
v_fma_f32 v231, v231, s78, s78
v_rcp_f32 v228, v228
v_mfma_f32_16x16x32_bf16 v[240:243], v[72:75], a[176:179], v[240:243]
buffer_load_dwordx4 a[36:39], v10, s[4:7], s43 offen offset:1024 sc1
v_rcp_f32 v229, v229
v_mfma_f32_16x16x32_bf16 v[240:243], v[68:71], a[168:171], v[240:243]
ds_read_b128 v[104:107], v1 offset:37888
v_rcp_f32 v230, v230
v_mfma_f32_16x16x32_bf16 v[240:243], v[64:67], a[160:163], v[240:243]
s_waitcnt lgkmcnt(3)
ds_read_b128 v[108:111], v1 offset:39936
v_rcp_f32 v231, v231
v_mfma_f32_16x16x32_bf16 v[248:251], v[80:83], a[160:163], v[248:251]
s_add_u32 m0, s41, 114688
s_add_u32 s42, s89, s93
buffer_load_dwordx4 v28, s[20:23], s42 offen sc1 lds
v_mfma_f32_16x16x32_bf16 v[248:251], v[84:87], a[168:171], v[248:251]
ds_read_b128 v[64:67], v1 offset:49152
v_mul_f32 v136, v228, v136
v_mul_f32 v137, v229, v137
v_mfma_f32_16x16x32_bf16 v[248:251], v[88:91], a[176:179], v[248:251]
ds_read_b128 v[68:71], v1 offset:51200
v_mul_f32 v138, v230, v138
v_mul_f32 v139, v231, v139
v_mfma_f32_16x16x32_bf16 v[248:251], v[92:95], a[184:187], v[248:251]
buffer_load_dwordx4 a[40:43], v10, s[4:7], s43 offen offset:2048 sc1
v_cvt_pk_bf16_f32 v218, v136, v137
v_cvt_pk_bf16_f32 v219, v138, v139
v_mfma_f32_16x16x32_bf16 v[252:255], v[92:95], a[188:191], v[252:255]
s_lshl_b32 s46, s38, 12
s_add_u32 s46, s46, s71
s_add_u32 s46, s46, 131072
v_mfma_f32_16x16x32_bf16 v[252:255], v[88:91], a[180:183], v[252:255]
buffer_store_dwordx4 v[216:219], v10, s[4:7], s46 offen offset:2048 sc1
v_mfma_f32_16x16x32_bf16 v[252:255], v[84:87], a[172:175], v[252:255]
ds_read_b128 v[72:75], v1 offset:53248
v_fmac_f32 v132, v56, v43
buffer_load_dwordx4 a[44:47], v10, s[4:7], s43 offen offset:3072 sc1
v_fmac_f32 v133, v57, v43
v_mfma_f32_16x16x32_bf16 v[252:255], v[80:83], a[164:167], v[252:255]
s_waitcnt lgkmcnt(3)
ds_read_b128 v[76:79], v1 offset:55296
v_fmac_f32 v134, v58, v43
v_fmac_f32 v135, v59, v43
v_mul_f32 v132, v41, v132
v_mfma_f32_16x16x32_bf16 v[252:255], v[96:99], a[132:135], v[252:255]
buffer_load_dwordx4 v29, s[20:23], s42 offen offset:1024 sc1 lds
v_mul_f32 v133, v41, v133
v_mfma_f32_16x16x32_bf16 v[252:255], v[100:103], a[140:143], v[252:255]
ds_read_b128 v[80:83], v1 offset:57344
v_mul_f32 v134, v41, v134
v_mul_f32 v135, v41, v135
v_mfma_f32_16x16x32_bf16 v[252:255], v[104:107], a[148:151], v[252:255]
v_exp_f32 v224, v132
v_exp_f32 v225, v133
v_mfma_f32_16x16x32_bf16 v[252:255], v[108:111], a[156:159], v[252:255]
v_exp_f32 v226, v134
v_mfma_f32_16x16x32_bf16 v[248:251], v[108:111], a[152:155], v[248:251]
buffer_load_dwordx4 a[48:51], v2, s[4:7], s43 offen sc1
v_exp_f32 v227, v135
v_mfma_f32_16x16x32_bf16 v[248:251], v[104:107], a[144:147], v[248:251]
ds_read_b128 v[84:87], v1 offset:59392
v_fma_f32 v224, v224, s78, s78
v_fma_f32 v225, v225, s78, s78
v_mfma_f32_16x16x32_bf16 v[248:251], v[100:103], a[136:139], v[248:251]
ds_read_b128 v[88:91], v1 offset:61440
v_fma_f32 v226, v226, s78, s78
v_fma_f32 v227, v227, s78, s78
v_mfma_f32_16x16x32_bf16 v[248:251], v[96:99], a[128:131], v[248:251]
s_waitcnt lgkmcnt(3)
ds_read_b128 v[92:95], v1 offset:63488
v_rcp_f32 v224, v224
v_mfma_f32_16x16x32_bf16 v[240:243], v[64:67], a[192:195], v[240:243]
buffer_load_dwordx4 v30, s[20:23], s42 offen offset:2048 sc1 lds
v_rcp_f32 v225, v225
v_mfma_f32_16x16x32_bf16 v[240:243], v[68:71], a[200:203], v[240:243]
v_rcp_f32 v226, v226
v_rcp_f32 v227, v227
v_mfma_f32_16x16x32_bf16 v[240:243], v[72:75], a[208:211], v[240:243]
buffer_load_dwordx4 a[52:55], v2, s[4:7], s43 offen offset:1024 sc1
v_mul_f32 v132, v224, v132
v_mfma_f32_16x16x32_bf16 v[240:243], v[76:79], a[216:219], v[240:243]
ds_read_b128 v[96:99], v1 offset:58368
v_mul_f32 v133, v225, v133
v_mul_f32 v134, v226, v134
v_mfma_f32_16x16x32_bf16 v[244:247], v[76:79], a[220:223], v[244:247]
buffer_load_dwordx4 a[56:59], v2, s[4:7], s43 offen offset:2048 sc1
v_mul_f32 v135, v227, v135
v_mfma_f32_16x16x32_bf16 v[244:247], v[72:75], a[212:215], v[244:247]
ds_read_b128 v[100:103], v1 offset:60416
v_cvt_pk_bf16_f32 v220, v132, v133
v_cvt_pk_bf16_f32 v221, v134, v135
v_mfma_f32_16x16x32_bf16 v[244:247], v[68:71], a[204:207], v[244:247]
ds_read_b128 v[104:107], v1 offset:62464
v_mov_b32 v25, 0
buffer_atomic_add v25, v11, s[4:7], s32 offen offset:32 sc0 sc1
v_mfma_f32_16x16x32_bf16 v[244:247], v[64:67], a[196:199], v[244:247]
s_waitcnt lgkmcnt(3)
ds_read_b128 v[108:111], v1 offset:64512
v_fmac_f32 v140, v60, v43
v_fmac_f32 v141, v61, v43
v_mfma_f32_16x16x32_bf16 v[244:247], v[80:83], a[228:231], v[244:247]
buffer_load_dwordx4 v31, s[20:23], s42 offen offset:3072 sc1 lds
v_fmac_f32 v142, v62, v43
v_mfma_f32_16x16x32_bf16 v[244:247], v[84:87], a[236:239], v[244:247]
ds_read_b128 v[64:67], v1 offset:50176
v_fmac_f32 v143, v63, v43
v_mul_f32 v140, v41, v140
v_mfma_f32_16x16x32_bf16 v[244:247], v[88:91], a[244:247], v[244:247]
ds_read_b128 v[68:71], v1 offset:52224
v_mul_f32 v141, v41, v141
v_mul_f32 v142, v41, v142
v_mfma_f32_16x16x32_bf16 v[244:247], v[92:95], a[252:255], v[244:247]
ds_read_b128 v[72:75], v1 offset:54272
v_mul_f32 v143, v41, v143
v_exp_f32 v228, v140
v_mfma_f32_16x16x32_bf16 v[240:243], v[92:95], a[248:251], v[240:243]
buffer_load_dwordx4 a[60:63], v2, s[4:7], s43 offen offset:3072 sc1
v_exp_f32 v229, v141
v_mfma_f32_16x16x32_bf16 v[240:243], v[88:91], a[240:243], v[240:243]
v_exp_f32 v230, v142
v_exp_f32 v231, v143
v_mfma_f32_16x16x32_bf16 v[240:243], v[84:87], a[232:235], v[240:243]
ds_read_b128 v[76:79], v1 offset:56320
v_fma_f32 v228, v228, s78, s78
v_fma_f32 v229, v229, s78, s78
v_mfma_f32_16x16x32_bf16 v[240:243], v[80:83], a[224:227], v[240:243]
s_waitcnt vmcnt(25) lgkmcnt(4)
s_barrier
v_fma_f32 v230, v230, s78, s78
v_fma_f32 v231, v231, s78, s78
v_mfma_f32_16x16x32_bf16 v[248:251], v[96:99], a[224:227], v[248:251]
s_xor_b64 s[20:21], s[20:21], s[66:67]
ds_read_b64_tr_b16 v[80:81], v16 offset:0
s_add_u32 s42, s88, s92
s_add_u32 m0, s41, 0
s_add_u32 s42, s42, 2097152
v_mfma_f32_16x16x32_bf16 v[248:251], v[100:103], a[232:235], v[248:251]
ds_read_b64_tr_b16 v[82:83], v16 offset:2048
buffer_load_dwordx4 v28, s[20:23], s42 offen sc1 lds
v_rcp_f32 v228, v228
v_mfma_f32_16x16x32_bf16 v[248:251], v[104:107], a[240:243], v[248:251]
ds_read_b64_tr_b16 v[84:85], v16 offset:4096
v_rcp_f32 v229, v229
v_mfma_f32_16x16x32_bf16 v[248:251], v[108:111], a[248:251], v[248:251]
ds_read_b64_tr_b16 v[86:87], v16 offset:6144
v_rcp_f32 v230, v230
v_rcp_f32 v231, v231
v_mfma_f32_16x16x32_bf16 v[252:255], v[108:111], a[252:255], v[252:255]
ds_read_b64_tr_b16 v[88:89], v16 offset:8192
v_mul_f32 v140, v228, v140
v_mul_f32 v141, v229, v141
v_mul_f32 v142, v230, v142
v_mfma_f32_16x16x32_bf16 v[252:255], v[104:107], a[244:247], v[252:255]
ds_read_b64_tr_b16 v[90:91], v16 offset:10240
v_mul_f32 v143, v231, v143
v_cvt_pk_bf16_f32 v222, v140, v141
v_cvt_pk_bf16_f32 v223, v142, v143
v_mfma_f32_16x16x32_bf16 v[252:255], v[100:103], a[236:239], v[252:255]
s_lshl_b32 s46, s38, 12
ds_read_b64_tr_b16 v[92:93], v16 offset:12288
s_add_u32 s46, s46, s71
s_add_u32 s46, s46, 131072
buffer_store_dwordx4 v[220:223], v10, s[4:7], s46 offen offset:3072 sc1
v_mfma_f32_16x16x32_bf16 v[252:255], v[96:99], a[228:231], v[252:255]
s_waitcnt lgkmcnt(7)
ds_read_b64_tr_b16 v[94:95], v16 offset:14336
v_mfma_f32_16x16x32_bf16 v[252:255], v[64:67], a[196:199], v[252:255]
ds_read_b64_tr_b16 v[96:97], v17 offset:0
buffer_load_dwordx4 v29, s[20:23], s42 offen offset:1024 sc1 lds
v_mfma_f32_16x16x32_bf16 v[252:255], v[68:71], a[204:207], v[252:255]
ds_read_b64_tr_b16 v[98:99], v17 offset:2048
v_mfma_f32_16x16x32_bf16 v[252:255], v[72:75], a[212:215], v[252:255]
ds_read_b64_tr_b16 v[100:101], v17 offset:4096
v_mfma_f32_16x16x32_bf16 v[252:255], v[76:79], a[220:223], v[252:255]
ds_read_b64_tr_b16 v[102:103], v17 offset:6144
v_mfma_f32_16x16x32_bf16 v[248:251], v[76:79], a[216:219], v[248:251]
ds_read_b64_tr_b16 v[104:105], v17 offset:8192
v_mfma_f32_16x16x32_bf16 v[248:251], v[72:75], a[208:211], v[248:251]
ds_read_b64_tr_b16 v[106:107], v17 offset:10240
v_mfma_f32_16x16x32_bf16 v[248:251], v[68:71], a[200:203], v[248:251]
ds_read_b64_tr_b16 v[108:109], v17 offset:12288
v_mfma_f32_16x16x32_bf16 v[248:251], v[64:67], a[192:195], v[248:251]
s_waitcnt vmcnt(18) lgkmcnt(7)
ds_read_b64_tr_b16 v[110:111], v17 offset:14336
v_mfma_f32_16x16x32_bf16 v[144:147], v[80:83], a[0:3], 0
ds_read_b64_tr_b16 v[64:65], v18 offset:0
buffer_load_dwordx4 v30, s[20:23], s42 offen offset:2048 sc1 lds
v_mfma_f32_16x16x32_bf16 v[144:147], v[84:87], a[8:11], v[144:147]
ds_read_b64_tr_b16 v[66:67], v18 offset:2048
v_mfma_f32_16x16x32_bf16 v[144:147], v[88:91], a[16:19], v[144:147]
ds_read_b64_tr_b16 v[68:69], v18 offset:4096
v_mfma_f32_16x16x32_bf16 v[144:147], v[92:95], a[24:27], v[144:147]
ds_read_b64_tr_b16 v[70:71], v18 offset:6144
v_mfma_f32_16x16x32_bf16 v[148:151], v[92:95], a[28:31], 0
ds_read_b64_tr_b16 v[72:73], v18 offset:8192
v_mfma_f32_16x16x32_bf16 v[148:151], v[88:91], a[20:23], v[148:151]
ds_read_b64_tr_b16 v[74:75], v18 offset:10240
v_mfma_f32_16x16x32_bf16 v[148:151], v[84:87], a[12:15], v[148:151]
ds_read_b64_tr_b16 v[76:77], v18 offset:12288
v_mfma_f32_16x16x32_bf16 v[148:151], v[80:83], a[4:7], v[148:151]
s_waitcnt lgkmcnt(7)
ds_read_b64_tr_b16 v[78:79], v18 offset:14336
v_mfma_f32_16x16x32_bf16 v[156:159], v[96:99], a[4:7], 0
ds_read_b64_tr_b16 v[80:81], v19 offset:0
buffer_load_dwordx4 v31, s[20:23], s42 offen offset:3072 sc1 lds
v_mfma_f32_16x16x32_bf16 v[156:159], v[100:103], a[12:15], v[156:159]
ds_read_b64_tr_b16 v[82:83], v19 offset:2048
v_mul_f32 v240, v40, v240
v_mul_f32 v241, v40, v241
v_mfma_f32_16x16x32_bf16 v[156:159], v[104:107], a[20:23], v[156:159]
ds_read_b64_tr_b16 v[84:85], v19 offset:4096
v_mul_f32 v242, v40, v242
v_mul_f32 v243, v40, v243
v_mfma_f32_16x16x32_bf16 v[156:159], v[108:111], a[28:31], v[156:159]
ds_read_b64_tr_b16 v[86:87], v19 offset:6144
v_exp_f32 v224, v240
v_mfma_f32_16x16x32_bf16 v[152:155], v[108:111], a[24:27], 0
ds_read_b64_tr_b16 v[88:89], v19 offset:8192
v_exp_f32 v225, v241
v_mfma_f32_16x16x32_bf16 v[152:155], v[104:107], a[16:19], v[152:155]
ds_read_b64_tr_b16 v[90:91], v19 offset:10240
v_exp_f32 v226, v242
v_mfma_f32_16x16x32_bf16 v[152:155], v[100:103], a[8:11], v[152:155]
ds_read_b64_tr_b16 v[92:93], v19 offset:12288
v_exp_f32 v227, v243
v_mfma_f32_16x16x32_bf16 v[152:155], v[96:99], a[0:3], v[152:155]
s_waitcnt lgkmcnt(7)
ds_read_b64_tr_b16 v[94:95], v19 offset:14336
v_fma_f32 v224, v224, s78, s78
v_fma_f32 v225, v225, s78, s78
v_mfma_f32_16x16x32_bf16 v[160:163], v[64:67], a[0:3], 0
s_add_u32 s42, s88, s93
ds_read_b64_tr_b16 v[96:97], v16 offset:16384
s_add_u32 m0, s41, 16384
v_mfma_f32_16x16x32_bf16 v[160:163], v[68:71], a[8:11], v[160:163]
s_add_u32 s42, s42, 2097152
ds_read_b64_tr_b16 v[98:99], v16 offset:18432
buffer_load_dwordx4 v28, s[20:23], s42 offen sc1 lds
v_mfma_f32_16x16x32_bf16 v[160:163], v[72:75], a[16:19], v[160:163]
ds_read_b64_tr_b16 v[100:101], v16 offset:20480
v_fma_f32 v226, v226, s78, s78
v_mfma_f32_16x16x32_bf16 v[160:163], v[76:79], a[24:27], v[160:163]
ds_read_b64_tr_b16 v[102:103], v16 offset:22528
s_waitcnt vmcnt(8)
v_readfirstlane_b32 s45, v25
s_nop 0
s_cmp_lt_u32 s45, 4
s_cbranch_scc1 Lslow12052
Lback12053:
v_mfma_f32_16x16x32_bf16 v[164:167], v[76:79], a[28:31], 0
ds_read_b64_tr_b16 v[104:105], v16 offset:24576
v_fma_f32 v227, v227, s78, s78
s_lshr_b32 s43, s92, 5
v_mfma_f32_16x16x32_bf16 v[164:167], v[72:75], a[20:23], v[164:167]
s_add_u32 s43, s43, s79
ds_read_b64_tr_b16 v[106:107], v16 offset:26624
s_add_u32 s43, s43, 65536
buffer_load_dwordx4 a[64:67], v10, s[4:7], s43 offen sc1
v_mfma_f32_16x16x32_bf16 v[164:167], v[68:71], a[12:15], v[164:167]
ds_read_b64_tr_b16 v[108:109], v16 offset:28672
v_rcp_f32 v224, v224
buffer_load_dwordx4 a[68:71], v10, s[4:7], s43 offen offset:1024 sc1
v_mfma_f32_16x16x32_bf16 v[164:167], v[64:67], a[4:7], v[164:167]
s_waitcnt lgkmcnt(7)
ds_read_b64_tr_b16 v[110:111], v16 offset:30720
v_mfma_f32_16x16x32_bf16 v[172:175], v[80:83], a[4:7], 0
ds_read_b64_tr_b16 v[64:65], v17 offset:16384
buffer_load_dwordx4 v29, s[20:23], s42 offen offset:1024 sc1 lds
v_mfma_f32_16x16x32_bf16 v[172:175], v[84:87], a[12:15], v[172:175]
ds_read_b64_tr_b16 v[66:67], v17 offset:18432
v_rcp_f32 v225, v225
v_mfma_f32_16x16x32_bf16 v[172:175], v[88:91], a[20:23], v[172:175]
ds_read_b64_tr_b16 v[68:69], v17 offset:20480
v_rcp_f32 v226, v226
v_mfma_f32_16x16x32_bf16 v[172:175], v[92:95], a[28:31], v[172:175]
ds_read_b64_tr_b16 v[70:71], v17 offset:22528
v_rcp_f32 v227, v227
v_mfma_f32_16x16x32_bf16 v[168:171], v[92:95], a[24:27], 0
ds_read_b64_tr_b16 v[72:73], v17 offset:24576
v_mul_f32 v240, v224, v240
v_mfma_f32_16x16x32_bf16 v[168:171], v[88:91], a[16:19], v[168:171]
ds_read_b64_tr_b16 v[74:75], v17 offset:26624
buffer_load_dwordx4 a[72:75], v10, s[4:7], s43 offen offset:2048 sc1
v_mfma_f32_16x16x32_bf16 v[168:171], v[84:87], a[8:11], v[168:171]
ds_read_b64_tr_b16 v[76:77], v17 offset:28672
v_mul_f32 v241, v225, v241
v_mul_f32 v242, v226, v242
v_mfma_f32_16x16x32_bf16 v[168:171], v[80:83], a[0:3], v[168:171]
s_waitcnt vmcnt(10) lgkmcnt(7)
ds_read_b64_tr_b16 v[78:79], v17 offset:30720
v_mul_f32 v243, v227, v243
v_cvt_pk_bf16_f32 v208, v240, v241
v_mfma_f32_16x16x32_bf16 v[144:147], v[96:99], a[32:35], v[144:147]
ds_read_b64_tr_b16 v[80:81], v18 offset:16384
buffer_load_dwordx4 v30, s[20:23], s42 offen offset:2048 sc1 lds
v_mfma_f32_16x16x32_bf16 v[144:147], v[100:103], a[40:43], v[144:147]
ds_read_b64_tr_b16 v[82:83], v18 offset:18432
v_cvt_pk_bf16_f32 v209, v242, v243
v_mul_f32 v248, v40, v248
v_mfma_f32_16x16x32_bf16 v[144:147], v[104:107], a[48:51], v[144:147]
ds_read_b64_tr_b16 v[84:85], v18 offset:20480
v_mul_f32 v249, v40, v249
v_mul_f32 v250, v40, v250
v_mfma_f32_16x16x32_bf16 v[144:147], v[108:111], a[56:59], v[144:147]
ds_read_b64_tr_b16 v[86:87], v18 offset:22528
buffer_load_dwordx4 a[76:79], v10, s[4:7], s43 offen offset:3072 sc1
v_mfma_f32_16x16x32_bf16 v[148:151], v[108:111], a[60:63], v[148:151]
ds_read_b64_tr_b16 v[88:89], v18 offset:24576
v_mul_f32 v251, v40, v251
v_mfma_f32_16x16x32_bf16 v[148:151], v[104:107], a[52:55], v[148:151]
ds_read_b64_tr_b16 v[90:91], v18 offset:26624
v_exp_f32 v228, v248
v_mfma_f32_16x16x32_bf16 v[148:151], v[100:103], a[44:47], v[148:151]
ds_read_b64_tr_b16 v[92:93], v18 offset:28672
v_exp_f32 v229, v249
v_mfma_f32_16x16x32_bf16 v[148:151], v[96:99], a[36:39], v[148:151]
s_waitcnt lgkmcnt(7)
ds_read_b64_tr_b16 v[94:95], v18 offset:30720
v_exp_f32 v230, v250
v_mfma_f32_16x16x32_bf16 v[156:159], v[64:67], a[36:39], v[156:159]
ds_read_b64_tr_b16 v[96:97], v19 offset:16384
buffer_load_dwordx4 v31, s[20:23], s42 offen offset:3072 sc1 lds
v_mfma_f32_16x16x32_bf16 v[156:159], v[68:71], a[44:47], v[156:159]
ds_read_b64_tr_b16 v[98:99], v19 offset:18432
v_exp_f32 v231, v251
v_mfma_f32_16x16x32_bf16 v[156:159], v[72:75], a[52:55], v[156:159]
ds_read_b64_tr_b16 v[100:101], v19 offset:20480
v_fma_f32 v228, v228, s78, s78
v_fma_f32 v229, v229, s78, s78
v_mfma_f32_16x16x32_bf16 v[156:159], v[76:79], a[60:63], v[156:159]
ds_read_b64_tr_b16 v[102:103], v19 offset:22528
buffer_load_dwordx4 a[80:83], v2, s[4:7], s43 offen sc1
v_mfma_f32_16x16x32_bf16 v[152:155], v[76:79], a[56:59], v[152:155]
ds_read_b64_tr_b16 v[104:105], v19 offset:24576
v_fma_f32 v230, v230, s78, s78
v_fma_f32 v231, v231, s78, s78
v_mfma_f32_16x16x32_bf16 v[152:155], v[72:75], a[48:51], v[152:155]
ds_read_b64_tr_b16 v[106:107], v19 offset:26624
buffer_load_dwordx4 a[84:87], v2, s[4:7], s43 offen offset:1024 sc1
v_mfma_f32_16x16x32_bf16 v[152:155], v[68:71], a[40:43], v[152:155]
ds_read_b64_tr_b16 v[108:109], v19 offset:28672
v_rcp_f32 v228, v228
v_mfma_f32_16x16x32_bf16 v[152:155], v[64:67], a[32:35], v[152:155]
s_waitcnt lgkmcnt(7)
s_barrier
ds_read_b64_tr_b16 v[110:111], v19 offset:30720
v_rcp_f32 v229, v229
v_mfma_f32_16x16x32_bf16 v[160:163], v[80:83], a[32:35], v[160:163]
s_xor_b64 s[20:21], s[20:21], s[66:67]
ds_read_b64_tr_b16 v[64:65], v16 offset:32768
s_add_u32 s42, s89, s92
s_add_u32 m0, s41, 32768
v_mfma_f32_16x16x32_bf16 v[160:163], v[84:87], a[40:43], v[160:163]
s_add_u32 s42, s42, 2097152
ds_read_b64_tr_b16 v[66:67], v16 offset:34816
buffer_load_dwordx4 v28, s[20:23], s42 offen sc1 lds
v_mfma_f32_16x16x32_bf16 v[160:163], v[88:91], a[48:51], v[160:163]
ds_read_b64_tr_b16 v[68:69], v16 offset:36864
v_rcp_f32 v230, v230
v_mfma_f32_16x16x32_bf16 v[160:163], v[92:95], a[56:59], v[160:163]
ds_read_b64_tr_b16 v[70:71], v16 offset:38912
v_rcp_f32 v231, v231
v_mfma_f32_16x16x32_bf16 v[164:167], v[92:95], a[60:63], v[164:167]
ds_read_b64_tr_b16 v[72:73], v16 offset:40960
buffer_load_dwordx4 a[88:91], v2, s[4:7], s43 offen offset:2048 sc1
v_mfma_f32_16x16x32_bf16 v[164:167], v[88:91], a[52:55], v[164:167]
ds_read_b64_tr_b16 v[74:75], v16 offset:43008
v_mul_f32 v248, v228, v248
v_mul_f32 v249, v229, v249
v_mfma_f32_16x16x32_bf16 v[164:167], v[84:87], a[44:47], v[164:167]
s_waitcnt vmcnt(15)
ds_read_b64_tr_b16 v[76:77], v16 offset:45056
v_mul_f32 v250, v230, v250
v_mul_f32 v251, v231, v251
buffer_atomic_add v26, v11, s[4:7], s32 offen offset:36 sc1
v_mfma_f32_16x16x32_bf16 v[164:167], v[80:83], a[36:39], v[164:167]
s_branch Lso16
Lst16:
s_branch Lst20
Lso16:
s_waitcnt lgkmcnt(7)
ds_read_b64_tr_b16 v[78:79], v16 offset:47104
v_cvt_pk_bf16_f32 v210, v248, v249
v_mfma_f32_16x16x32_bf16 v[172:175], v[96:99], a[36:39], v[172:175]
ds_read_b64_tr_b16 v[80:81], v17 offset:32768
buffer_load_dwordx4 v29, s[20:23], s42 offen offset:1024 sc1 lds
v_mfma_f32_16x16x32_bf16 v[172:175], v[100:103], a[44:47], v[172:175]
ds_read_b64_tr_b16 v[82:83], v17 offset:34816
v_cvt_pk_bf16_f32 v211, v250, v251
v_mfma_f32_16x16x32_bf16 v[172:175], v[104:107], a[52:55], v[172:175]
s_lshl_b32 s46, s38, 11
ds_read_b64_tr_b16 v[84:85], v17 offset:36864
s_add_u32 s46, s46, s71
v_mfma_f32_16x16x32_bf16 v[172:175], v[108:111], a[60:63], v[172:175]
s_add_u32 s46, s46, 196608
ds_read_b64_tr_b16 v[86:87], v17 offset:38912
buffer_store_dwordx4 v[208:211], v10, s[4:7], s46 offen sc1
v_mfma_f32_16x16x32_bf16 v[168:171], v[108:111], a[56:59], v[168:171]
ds_read_b64_tr_b16 v[88:89], v17 offset:40960
v_mul_f32 v244, v41, v244
v_mfma_f32_16x16x32_bf16 v[168:171], v[104:107], a[48:51], v[168:171]
ds_read_b64_tr_b16 v[90:91], v17 offset:43008
buffer_load_dwordx4 a[92:95], v2, s[4:7], s43 offen offset:3072 sc1
v_mfma_f32_16x16x32_bf16 v[168:171], v[100:103], a[40:43], v[168:171]
ds_read_b64_tr_b16 v[92:93], v17 offset:45056
v_mul_f32 v245, v41, v245
v_mul_f32 v246, v41, v246
v_mfma_f32_16x16x32_bf16 v[168:171], v[96:99], a[32:35], v[168:171]
s_waitcnt lgkmcnt(7)
ds_read_b64_tr_b16 v[94:95], v17 offset:47104
v_mul_f32 v247, v41, v247
v_mfma_f32_16x16x32_bf16 v[112:115], v[64:67], a[0:3], 0
ds_read_b64_tr_b16 v[96:97], v18 offset:32768
buffer_load_dwordx4 v30, s[20:23], s42 offen offset:2048 sc1 lds
v_mfma_f32_16x16x32_bf16 v[112:115], v[68:71], a[8:11], v[112:115]
ds_read_b64_tr_b16 v[98:99], v18 offset:34816
v_exp_f32 v224, v244
v_mfma_f32_16x16x32_bf16 v[112:115], v[72:75], a[16:19], v[112:115]
ds_read_b64_tr_b16 v[100:101], v18 offset:36864
v_exp_f32 v225, v245
v_mfma_f32_16x16x32_bf16 v[112:115], v[76:79], a[24:27], v[112:115]
s_lshr_b32 s43, s93, 5
ds_read_b64_tr_b16 v[102:103], v18 offset:38912
s_add_u32 s43, s43, s79
s_add_u32 s43, s43, 65536
v_mfma_f32_16x16x32_bf16 v[116:119], v[76:79], a[28:31], 0
ds_read_b64_tr_b16 v[104:105], v18 offset:40960
buffer_load_dwordx4 a[96:99], v10, s[4:7], s43 offen sc1
v_mfma_f32_16x16x32_bf16 v[116:119], v[72:75], a[20:23], v[116:119]
ds_read_b64_tr_b16 v[106:107], v18 offset:43008
v_exp_f32 v226, v246
v_mfma_f32_16x16x32_bf16 v[116:119], v[68:71], a[12:15], v[116:119]
ds_read_b64_tr_b16 v[108:109], v18 offset:45056
v_exp_f32 v227, v247
buffer_load_dwordx4 a[100:103], v10, s[4:7], s43 offen offset:1024 sc1
v_mfma_f32_16x16x32_bf16 v[116:119], v[64:67], a[4:7], v[116:119]
s_waitcnt lgkmcnt(7)
ds_read_b64_tr_b16 v[110:111], v18 offset:47104
v_fma_f32 v224, v224, s78, s78
v_fma_f32 v225, v225, s78, s78
v_mfma_f32_16x16x32_bf16 v[124:127], v[80:83], a[4:7], 0
ds_read_b64_tr_b16 v[64:65], v19 offset:32768
buffer_load_dwordx4 v31, s[20:23], s42 offen offset:3072 sc1 lds
v_mfma_f32_16x16x32_bf16 v[124:127], v[84:87], a[12:15], v[124:127]
ds_read_b64_tr_b16 v[66:67], v19 offset:34816
v_fma_f32 v226, v226, s78, s78
v_fma_f32 v227, v227, s78, s78
v_mfma_f32_16x16x32_bf16 v[124:127], v[88:91], a[20:23], v[124:127]
ds_read_b64_tr_b16 v[68:69], v19 offset:36864
v_rcp_f32 v224, v224
v_mfma_f32_16x16x32_bf16 v[124:127], v[92:95], a[28:31], v[124:127]
ds_read_b64_tr_b16 v[70:71], v19 offset:38912
v_rcp_f32 v225, v225
v_mfma_f32_16x16x32_bf16 v[120:123], v[92:95], a[24:27], 0
ds_read_b64_tr_b16 v[72:73], v19 offset:40960
buffer_load_dwordx4 a[104:107], v10, s[4:7], s43 offen offset:2048 sc1
v_mfma_f32_16x16x32_bf16 v[120:123], v[88:91], a[16:19], v[120:123]
ds_read_b64_tr_b16 v[74:75], v19 offset:43008
v_rcp_f32 v226, v226
v_mfma_f32_16x16x32_bf16 v[120:123], v[84:87], a[8:11], v[120:123]
ds_read_b64_tr_b16 v[76:77], v19 offset:45056
v_rcp_f32 v227, v227
v_mfma_f32_16x16x32_bf16 v[120:123], v[80:83], a[0:3], v[120:123]
s_waitcnt lgkmcnt(7)
ds_read_b64_tr_b16 v[78:79], v19 offset:47104
v_mul_f32 v244, v224, v244
v_mfma_f32_16x16x32_bf16 v[128:131], v[96:99], a[0:3], 0
s_add_u32 s42, s89, s93
ds_read_b64_tr_b16 v[80:81], v16 offset:49152
s_add_u32 m0, s41, 49152
s_add_u32 s42, s42, 2097152
v_mfma_f32_16x16x32_bf16 v[128:131], v[100:103], a[8:11], v[128:131]
ds_read_b64_tr_b16 v[82:83], v16 offset:51200
buffer_load_dwordx4 v28, s[20:23], s42 offen sc1 lds
v_mfma_f32_16x16x32_bf16 v[128:131], v[104:107], a[16:19], v[128:131]
ds_read_b64_tr_b16 v[84:85], v16 offset:53248
v_mul_f32 v245, v225, v245
v_mul_f32 v246, v226, v246
v_mfma_f32_16x16x32_bf16 v[128:131], v[108:111], a[24:27], v[128:131]
ds_read_b64_tr_b16 v[86:87], v16 offset:55296
v_mul_f32 v247, v227, v247
v_cvt_pk_bf16_f32 v212, v244, v245
v_mfma_f32_16x16x32_bf16 v[132:135], v[108:111], a[28:31], 0
ds_read_b64_tr_b16 v[88:89], v16 offset:57344
v_cvt_pk_bf16_f32 v213, v246, v247
buffer_load_dwordx4 a[108:111], v10, s[4:7], s43 offen offset:3072 sc1
v_mfma_f32_16x16x32_bf16 v[132:135], v[104:107], a[20:23], v[132:135]
ds_read_b64_tr_b16 v[90:91], v16 offset:59392
v_mul_f32 v252, v41, v252
v_mul_f32 v253, v41, v253
v_mfma_f32_16x16x32_bf16 v[132:135], v[100:103], a[12:15], v[132:135]
ds_read_b64_tr_b16 v[92:93], v16 offset:61440
v_mul_f32 v254, v41, v254
v_mul_f32 v255, v41, v255
v_mfma_f32_16x16x32_bf16 v[132:135], v[96:99], a[4:7], v[132:135]
s_waitcnt lgkmcnt(7)
ds_read_b64_tr_b16 v[94:95], v16 offset:63488
v_exp_f32 v228, v252
v_mfma_f32_16x16x32_bf16 v[140:143], v[64:67], a[4:7], 0
ds_read_b64_tr_b16 v[96:97], v17 offset:49152
buffer_load_dwordx4 v29, s[20:23], s42 offen offset:1024 sc1 lds
v_mfma_f32_16x16x32_bf16 v[140:143], v[68:71], a[12:15], v[140:143]
ds_read_b64_tr_b16 v[98:99], v17 offset:51200
v_exp_f32 v229, v253
v_mfma_f32_16x16x32_bf16 v[140:143], v[72:75], a[20:23], v[140:143]
ds_read_b64_tr_b16 v[100:101], v17 offset:53248
v_exp_f32 v230, v254
v_mfma_f32_16x16x32_bf16 v[140:143], v[76:79], a[28:31], v[140:143]
ds_read_b64_tr_b16 v[102:103], v17 offset:55296
v_exp_f32 v231, v255
v_mfma_f32_16x16x32_bf16 v[136:139], v[76:79], a[24:27], 0
ds_read_b64_tr_b16 v[104:105], v17 offset:57344
buffer_load_dwordx4 a[112:115], v2, s[4:7], s43 offen sc1
v_mfma_f32_16x16x32_bf16 v[136:139], v[72:75], a[16:19], v[136:139]
ds_read_b64_tr_b16 v[106:107], v17 offset:59392
v_fma_f32 v228, v228, s78, s78
v_fma_f32 v229, v229, s78, s78
v_mfma_f32_16x16x32_bf16 v[136:139], v[68:71], a[8:11], v[136:139]
ds_read_b64_tr_b16 v[108:109], v17 offset:61440
buffer_load_dwordx4 a[116:119], v2, s[4:7], s43 offen offset:1024 sc1
v_mfma_f32_16x16x32_bf16 v[136:139], v[64:67], a[0:3], v[136:139]
s_waitcnt lgkmcnt(7)
ds_read_b64_tr_b16 v[110:111], v17 offset:63488
v_fma_f32 v230, v230, s78, s78
v_fma_f32 v231, v231, s78, s78
v_mfma_f32_16x16x32_bf16 v[112:115], v[80:83], a[32:35], v[112:115]
ds_read_b64_tr_b16 v[64:65], v18 offset:49152
buffer_load_dwordx4 v30, s[20:23], s42 offen offset:2048 sc1 lds
v_mfma_f32_16x16x32_bf16 v[112:115], v[84:87], a[40:43], v[112:115]
ds_read_b64_tr_b16 v[66:67], v18 offset:51200
v_rcp_f32 v228, v228
v_mfma_f32_16x16x32_bf16 v[112:115], v[88:91], a[48:51], v[112:115]
ds_read_b64_tr_b16 v[68:69], v18 offset:53248
v_rcp_f32 v229, v229
v_mfma_f32_16x16x32_bf16 v[112:115], v[92:95], a[56:59], v[112:115]
ds_read_b64_tr_b16 v[70:71], v18 offset:55296
buffer_load_dwordx4 a[120:123], v2, s[4:7], s43 offen offset:2048 sc1
v_mfma_f32_16x16x32_bf16 v[116:119], v[92:95], a[60:63], v[116:119]
ds_read_b64_tr_b16 v[72:73], v18 offset:57344
v_rcp_f32 v230, v230
v_mfma_f32_16x16x32_bf16 v[116:119], v[88:91], a[52:55], v[116:119]
ds_read_b64_tr_b16 v[74:75], v18 offset:59392
v_mov_b32 v25, 0
v_mfma_f32_16x16x32_bf16 v[116:119], v[84:87], a[44:47], v[116:119]
ds_read_b64_tr_b16 v[76:77], v18 offset:61440
buffer_atomic_add v25, v11, s[4:7], s32 offen offset:36 sc0 sc1
v_mfma_f32_16x16x32_bf16 v[116:119], v[80:83], a[36:39], v[116:119]
s_waitcnt lgkmcnt(7)
ds_read_b64_tr_b16 v[78:79], v18 offset:63488
v_rcp_f32 v231, v231
v_mfma_f32_16x16x32_bf16 v[124:127], v[96:99], a[36:39], v[124:127]
ds_read_b64_tr_b16 v[80:81], v19 offset:49152
buffer_load_dwordx4 v31, s[20:23], s42 offen offset:3072 sc1 lds
v_mfma_f32_16x16x32_bf16 v[124:127], v[100:103], a[44:47], v[124:127]
ds_read_b64_tr_b16 v[82:83], v19 offset:51200
v_mul_f32 v252, v228, v252
v_mul_f32 v253, v229, v253
v_mfma_f32_16x16x32_bf16 v[124:127], v[104:107], a[52:55], v[124:127]
ds_read_b64_tr_b16 v[84:85], v19 offset:53248
v_mul_f32 v254, v230, v254
v_mul_f32 v255, v231, v255
v_mfma_f32_16x16x32_bf16 v[124:127], v[108:111], a[60:63], v[124:127]
ds_read_b64_tr_b16 v[86:87], v19 offset:55296
buffer_load_dwordx4 a[124:127], v2, s[4:7], s43 offen offset:3072 sc1
v_mfma_f32_16x16x32_bf16 v[120:123], v[108:111], a[56:59], v[120:123]
ds_read_b64_tr_b16 v[88:89], v19 offset:57344
v_cvt_pk_bf16_f32 v214, v252, v253
v_cvt_pk_bf16_f32 v215, v254, v255
v_mfma_f32_16x16x32_bf16 v[120:123], v[104:107], a[48:51], v[120:123]
s_lshl_b32 s46, s38, 11
ds_read_b64_tr_b16 v[90:91], v19 offset:59392
s_add_u32 s46, s46, s71
v_mfma_f32_16x16x32_bf16 v[120:123], v[100:103], a[40:43], v[120:123]
s_add_u32 s46, s46, 196608
ds_read_b64_tr_b16 v[92:93], v19 offset:61440
buffer_store_dwordx4 v[212:215], v10, s[4:7], s46 offen offset:1024 sc1
v_mfma_f32_16x16x32_bf16 v[120:123], v[96:99], a[32:35], v[120:123]
s_waitcnt vmcnt(24) lgkmcnt(7)
s_barrier
ds_read_b64_tr_b16 v[94:95], v19 offset:63488
v_mfma_f32_16x16x32_bf16 v[128:131], v[64:67], a[32:35], v[128:131]
s_xor_b64 s[20:21], s[20:21], s[66:67]
ds_read_b64_tr_b16 v[96:97], v12 offset:0
s_add_u32 s42, s88, s92
v_mfma_f32_16x16x32_bf16 v[128:131], v[68:71], a[40:43], v[128:131]
s_add_u32 m0, s41, 65536
ds_read_b64_tr_b16 v[98:99], v12 offset:2048
s_add_u32 s42, s42, 4194304
v_mfma_f32_16x16x32_bf16 v[128:131], v[72:75], a[48:51], v[128:131]
ds_read_b64_tr_b16 v[100:101], v12 offset:4096
buffer_load_dwordx4 v28, s[20:23], s42 offen sc1 lds
v_mfma_f32_16x16x32_bf16 v[128:131], v[76:79], a[56:59], v[128:131]
ds_read_b64_tr_b16 v[102:103], v12 offset:6144
v_mfma_f32_16x16x32_bf16 v[132:135], v[76:79], a[60:63], v[132:135]
ds_read_b64_tr_b16 v[104:105], v12 offset:8192
v_mfma_f32_16x16x32_bf16 v[132:135], v[72:75], a[52:55], v[132:135]
ds_read_b64_tr_b16 v[106:107], v12 offset:10240
v_mfma_f32_16x16x32_bf16 v[132:135], v[68:71], a[44:47], v[132:135]
ds_read_b64_tr_b16 v[108:109], v12 offset:12288
v_mfma_f32_16x16x32_bf16 v[132:135], v[64:67], a[36:39], v[132:135]
s_waitcnt lgkmcnt(7)
ds_read_b64_tr_b16 v[110:111], v12 offset:14336
v_mfma_f32_16x16x32_bf16 v[140:143], v[80:83], a[36:39], v[140:143]
ds_read_b64_tr_b16 v[64:65], v13 offset:0
buffer_load_dwordx4 v29, s[20:23], s42 offen offset:1024 sc1 lds
v_mfma_f32_16x16x32_bf16 v[140:143], v[84:87], a[44:47], v[140:143]
ds_read_b64_tr_b16 v[66:67], v13 offset:2048
v_mfma_f32_16x16x32_bf16 v[140:143], v[88:91], a[52:55], v[140:143]
ds_read_b64_tr_b16 v[68:69], v13 offset:4096
v_mfma_f32_16x16x32_bf16 v[140:143], v[92:95], a[60:63], v[140:143]
ds_read_b64_tr_b16 v[70:71], v13 offset:6144
v_mfma_f32_16x16x32_bf16 v[136:139], v[92:95], a[56:59], v[136:139]
ds_read_b64_tr_b16 v[72:73], v13 offset:8192
v_mfma_f32_16x16x32_bf16 v[136:139], v[88:91], a[48:51], v[136:139]
ds_read_b64_tr_b16 v[74:75], v13 offset:10240
v_mfma_f32_16x16x32_bf16 v[136:139], v[84:87], a[40:43], v[136:139]
ds_read_b64_tr_b16 v[76:77], v13 offset:12288
v_mfma_f32_16x16x32_bf16 v[136:139], v[80:83], a[32:35], v[136:139]
s_waitcnt vmcnt(18) lgkmcnt(7)
ds_read_b64_tr_b16 v[78:79], v13 offset:14336
v_mfma_f32_16x16x32_bf16 v[144:147], v[96:99], a[64:67], v[144:147]
ds_read_b64_tr_b16 v[80:81], v14 offset:0
buffer_load_dwordx4 v30, s[20:23], s42 offen offset:2048 sc1 lds
v_mfma_f32_16x16x32_bf16 v[144:147], v[100:103], a[72:75], v[144:147]
ds_read_b64_tr_b16 v[82:83], v14 offset:2048
v_mfma_f32_16x16x32_bf16 v[144:147], v[104:107], a[80:83], v[144:147]
ds_read_b64_tr_b16 v[84:85], v14 offset:4096
v_mfma_f32_16x16x32_bf16 v[144:147], v[108:111], a[88:91], v[144:147]
ds_read_b64_tr_b16 v[86:87], v14 offset:6144
v_mfma_f32_16x16x32_bf16 v[148:151], v[108:111], a[92:95], v[148:151]
ds_read_b64_tr_b16 v[88:89], v14 offset:8192
v_mfma_f32_16x16x32_bf16 v[148:151], v[104:107], a[84:87], v[148:151]
ds_read_b64_tr_b16 v[90:91], v14 offset:10240
v_mfma_f32_16x16x32_bf16 v[148:151], v[100:103], a[76:79], v[148:151]
ds_read_b64_tr_b16 v[92:93], v14 offset:12288
v_mfma_f32_16x16x32_bf16 v[148:151], v[96:99], a[68:71], v[148:151]
s_waitcnt lgkmcnt(7)
ds_read_b64_tr_b16 v[94:95], v14 offset:14336
v_mfma_f32_16x16x32_bf16 v[156:159], v[64:67], a[68:71], v[156:159]
ds_read_b64_tr_b16 v[96:97], v15 offset:0
buffer_load_dwordx4 v31, s[20:23], s42 offen offset:3072 sc1 lds
v_mfma_f32_16x16x32_bf16 v[156:159], v[68:71], a[76:79], v[156:159]
ds_read_b64_tr_b16 v[98:99], v15 offset:2048
v_mfma_f32_16x16x32_bf16 v[156:159], v[72:75], a[84:87], v[156:159]
ds_read_b64_tr_b16 v[100:101], v15 offset:4096
v_mfma_f32_16x16x32_bf16 v[156:159], v[76:79], a[92:95], v[156:159]
ds_read_b64_tr_b16 v[102:103], v15 offset:6144
v_mfma_f32_16x16x32_bf16 v[152:155], v[76:79], a[88:91], v[152:155]
ds_read_b64_tr_b16 v[104:105], v15 offset:8192
v_mfma_f32_16x16x32_bf16 v[152:155], v[72:75], a[80:83], v[152:155]
ds_read_b64_tr_b16 v[106:107], v15 offset:10240
v_mfma_f32_16x16x32_bf16 v[152:155], v[68:71], a[72:75], v[152:155]
ds_read_b64_tr_b16 v[108:109], v15 offset:12288
v_mfma_f32_16x16x32_bf16 v[152:155], v[64:67], a[64:67], v[152:155]
s_waitcnt lgkmcnt(7)
ds_read_b64_tr_b16 v[110:111], v15 offset:14336
v_mfma_f32_16x16x32_bf16 v[160:163], v[80:83], a[64:67], v[160:163]
s_add_u32 s42, s88, s93
ds_read_b64_tr_b16 v[64:65], v12 offset:16384
s_add_u32 m0, s41, 81920
v_mfma_f32_16x16x32_bf16 v[160:163], v[84:87], a[72:75], v[160:163]
s_add_u32 s42, s42, 4194304
ds_read_b64_tr_b16 v[66:67], v12 offset:18432
buffer_load_dwordx4 v28, s[20:23], s42 offen sc1 lds
v_mfma_f32_16x16x32_bf16 v[160:163], v[88:91], a[80:83], v[160:163]
ds_read_b64_tr_b16 v[68:69], v12 offset:20480
s_waitcnt vmcnt(8)
v_readfirstlane_b32 s45, v25
s_nop 0
s_cmp_lt_u32 s45, 4
s_cbranch_scc1 Lslow12054
Lback12055:
v_mfma_f32_16x16x32_bf16 v[160:163], v[92:95], a[88:91], v[160:163]
s_lshr_b32 s43, s92, 5
ds_read_b64_tr_b16 v[70:71], v12 offset:22528
s_add_u32 s43, s43, s79
v_mfma_f32_16x16x32_bf16 v[164:167], v[92:95], a[92:95], v[164:167]
s_add_u32 s43, s43, 131072
ds_read_b64_tr_b16 v[72:73], v12 offset:24576
buffer_load_dwordx4 a[128:131], v10, s[4:7], s43 offen sc1
v_mfma_f32_16x16x32_bf16 v[164:167], v[88:91], a[84:87], v[164:167]
ds_read_b64_tr_b16 v[74:75], v12 offset:26624
buffer_load_dwordx4 a[132:135], v10, s[4:7], s43 offen offset:1024 sc1
v_mfma_f32_16x16x32_bf16 v[164:167], v[84:87], a[76:79], v[164:167]
ds_read_b64_tr_b16 v[76:77], v12 offset:28672
v_mfma_f32_16x16x32_bf16 v[164:167], v[80:83], a[68:71], v[164:167]
s_waitcnt lgkmcnt(7)
ds_read_b64_tr_b16 v[78:79], v12 offset:30720
v_mfma_f32_16x16x32_bf16 v[172:175], v[96:99], a[68:71], v[172:175]
ds_read_b64_tr_b16 v[80:81], v13 offset:16384
buffer_load_dwordx4 v29, s[20:23], s42 offen offset:1024 sc1 lds
v_mfma_f32_16x16x32_bf16 v[172:175], v[100:103], a[76:79], v[172:175]
ds_read_b64_tr_b16 v[82:83], v13 offset:18432
v_mfma_f32_16x16x32_bf16 v[172:175], v[104:107], a[84:87], v[172:175]
ds_read_b64_tr_b16 v[84:85], v13 offset:20480
v_mfma_f32_16x16x32_bf16 v[172:175], v[108:111], a[92:95], v[172:175]
ds_read_b64_tr_b16 v[86:87], v13 offset:22528
v_mfma_f32_16x16x32_bf16 v[168:171], v[108:111], a[88:91], v[168:171]
ds_read_b64_tr_b16 v[88:89], v13 offset:24576
buffer_load_dwordx4 a[136:139], v10, s[4:7], s43 offen offset:2048 sc1
v_mfma_f32_16x16x32_bf16 v[168:171], v[104:107], a[80:83], v[168:171]
ds_read_b64_tr_b16 v[90:91], v13 offset:26624
v_mfma_f32_16x16x32_bf16 v[168:171], v[100:103], a[72:75], v[168:171]
ds_read_b64_tr_b16 v[92:93], v13 offset:28672
v_mfma_f32_16x16x32_bf16 v[168:171], v[96:99], a[64:67], v[168:171]
s_waitcnt vmcnt(10) lgkmcnt(7)
ds_read_b64_tr_b16 v[94:95], v13 offset:30720
v_mfma_f32_16x16x32_bf16 v[144:147], v[64:67], a[96:99], v[144:147]
ds_read_b64_tr_b16 v[96:97], v14 offset:16384
buffer_load_dwordx4 v30, s[20:23], s42 offen offset:2048 sc1 lds
v_mfma_f32_16x16x32_bf16 v[144:147], v[68:71], a[104:107], v[144:147]
ds_read_b64_tr_b16 v[98:99], v14 offset:18432
v_mfma_f32_16x16x32_bf16 v[144:147], v[72:75], a[112:115], v[144:147]
ds_read_b64_tr_b16 v[100:101], v14 offset:20480
buffer_load_dwordx4 a[140:143], v10, s[4:7], s43 offen offset:3072 sc1
v_mfma_f32_16x16x32_bf16 v[144:147], v[76:79], a[120:123], v[144:147]
s_waitcnt vmcnt(11)
ds_read_b64_tr_b16 v[102:103], v14 offset:22528
v_mfma_f32_16x16x32_bf16 v[148:151], v[76:79], a[124:127], v[148:151]
ds_read_b64_tr_b16 v[104:105], v14 offset:24576
v_mfma_f32_16x16x32_bf16 v[148:151], v[72:75], a[116:119], v[148:151]
ds_read_b64_tr_b16 v[106:107], v14 offset:26624
buffer_atomic_add v26, v11, s[4:7], s32 offen offset:40 sc1
v_mfma_f32_16x16x32_bf16 v[148:151], v[68:71], a[108:111], v[148:151]
ds_read_b64_tr_b16 v[108:109], v14 offset:28672
v_mfma_f32_16x16x32_bf16 v[148:151], v[64:67], a[100:103], v[148:151]
s_waitcnt lgkmcnt(7)
ds_read_b64_tr_b16 v[110:111], v14 offset:30720
v_mfma_f32_16x16x32_bf16 v[156:159], v[80:83], a[100:103], v[156:159]
ds_read_b64_tr_b16 v[64:65], v15 offset:16384
buffer_load_dwordx4 v31, s[20:23], s42 offen offset:3072 sc1 lds
v_mfma_f32_16x16x32_bf16 v[156:159], v[84:87], a[108:111], v[156:159]
ds_read_b64_tr_b16 v[66:67], v15 offset:18432
v_mfma_f32_16x16x32_bf16 v[156:159], v[88:91], a[116:119], v[156:159]
ds_read_b64_tr_b16 v[68:69], v15 offset:20480
buffer_load_dwordx4 a[144:147], v2, s[4:7], s43 offen sc1
v_mfma_f32_16x16x32_bf16 v[156:159], v[92:95], a[124:127], v[156:159]
ds_read_b64_tr_b16 v[70:71], v15 offset:22528
v_mfma_f32_16x16x32_bf16 v[152:155], v[92:95], a[120:123], v[152:155]
ds_read_b64_tr_b16 v[72:73], v15 offset:24576
v_mfma_f32_16x16x32_bf16 v[152:155], v[88:91], a[112:115], v[152:155]
ds_read_b64_tr_b16 v[74:75], v15 offset:26624
buffer_load_dwordx4 a[148:151], v2, s[4:7], s43 offen offset:1024 sc1
v_mfma_f32_16x16x32_bf16 v[152:155], v[84:87], a[104:107], v[152:155]
ds_read_b64_tr_b16 v[76:77], v15 offset:28672
v_mfma_f32_16x16x32_bf16 v[152:155], v[80:83], a[96:99], v[152:155]
s_waitcnt lgkmcnt(7)
s_barrier
ds_read_b64_tr_b16 v[78:79], v15 offset:30720
v_mfma_f32_16x16x32_bf16 v[160:163], v[96:99], a[96:99], v[160:163]
s_xor_b64 s[20:21], s[20:21], s[66:67]
ds_read_b64_tr_b16 v[80:81], v12 offset:32768
s_add_u32 s42, s89, s92
v_mfma_f32_16x16x32_bf16 v[160:163], v[100:103], a[104:107], v[160:163]
s_add_u32 m0, s41, 98304
ds_read_b64_tr_b16 v[82:83], v12 offset:34816
s_add_u32 s42, s42, 4194304
v_mfma_f32_16x16x32_bf16 v[160:163], v[104:107], a[112:115], v[160:163]
ds_read_b64_tr_b16 v[84:85], v12 offset:36864
buffer_load_dwordx4 v28, s[20:23], s42 offen sc1 lds
v_mfma_f32_16x16x32_bf16 v[160:163], v[108:111], a[120:123], v[160:163]
ds_read_b64_tr_b16 v[86:87], v12 offset:38912
v_mfma_f32_16x16x32_bf16 v[164:167], v[108:111], a[124:127], v[164:167]
ds_read_b64_tr_b16 v[88:89], v12 offset:40960
buffer_load_dwordx4 a[152:155], v2, s[4:7], s43 offen offset:2048 sc1
v_mfma_f32_16x16x32_bf16 v[164:167], v[104:107], a[116:119], v[164:167]
ds_read_b64_tr_b16 v[90:91], v12 offset:43008
v_mfma_f32_16x16x32_bf16 v[164:167], v[100:103], a[108:111], v[164:167]
ds_read_b64_tr_b16 v[92:93], v12 offset:45056
v_mfma_f32_16x16x32_bf16 v[164:167], v[96:99], a[100:103], v[164:167]
s_waitcnt lgkmcnt(7)
ds_read_b64_tr_b16 v[94:95], v12 offset:47104
v_mfma_f32_16x16x32_bf16 v[172:175], v[64:67], a[100:103], v[172:175]
ds_read_b64_tr_b16 v[96:97], v13 offset:32768
buffer_load_dwordx4 v29, s[20:23], s42 offen offset:1024 sc1 lds
v_mfma_f32_16x16x32_bf16 v[172:175], v[68:71], a[108:111], v[172:175]
ds_read_b64_tr_b16 v[98:99], v13 offset:34816
v_mfma_f32_16x16x32_bf16 v[172:175], v[72:75], a[116:119], v[172:175]
ds_read_b64_tr_b16 v[100:101], v13 offset:36864
v_mfma_f32_16x16x32_bf16 v[172:175], v[76:79], a[124:127], v[172:175]
ds_read_b64_tr_b16 v[102:103], v13 offset:38912
v_mfma_f32_16x16x32_bf16 v[168:171], v[76:79], a[120:123], v[168:171]
ds_read_b64_tr_b16 v[104:105], v13 offset:40960
buffer_load_dwordx4 a[156:159], v2, s[4:7], s43 offen offset:3072 sc1
v_mfma_f32_16x16x32_bf16 v[168:171], v[72:75], a[112:115], v[168:171]
ds_read_b64_tr_b16 v[106:107], v13 offset:43008
v_mfma_f32_16x16x32_bf16 v[168:171], v[68:71], a[104:107], v[168:171]
ds_read_b64_tr_b16 v[108:109], v13 offset:45056
v_mfma_f32_16x16x32_bf16 v[168:171], v[64:67], a[96:99], v[168:171]
s_waitcnt lgkmcnt(7)
ds_read_b64_tr_b16 v[110:111], v13 offset:47104
v_mfma_f32_16x16x32_bf16 v[112:115], v[80:83], a[64:67], v[112:115]
ds_read_b64_tr_b16 v[64:65], v14 offset:32768
buffer_load_dwordx4 v30, s[20:23], s42 offen offset:2048 sc1 lds
v_mfma_f32_16x16x32_bf16 v[112:115], v[84:87], a[72:75], v[112:115]
s_lshr_b32 s43, s93, 5
ds_read_b64_tr_b16 v[66:67], v14 offset:34816
s_add_u32 s43, s43, s79
v_mfma_f32_16x16x32_bf16 v[112:115], v[88:91], a[80:83], v[112:115]
s_add_u32 s43, s43, 131072
ds_read_b64_tr_b16 v[68:69], v14 offset:36864
buffer_load_dwordx4 a[160:163], v10, s[4:7], s43 offen sc1
v_mfma_f32_16x16x32_bf16 v[112:115], v[92:95], a[88:91], v[112:115]
ds_read_b64_tr_b16 v[70:71], v14 offset:38912
v_mfma_f32_16x16x32_bf16 v[116:119], v[92:95], a[92:95], v[116:119]
ds_read_b64_tr_b16 v[72:73], v14 offset:40960
v_mfma_f32_16x16x32_bf16 v[116:119], v[88:91], a[84:87], v[116:119]
ds_read_b64_tr_b16 v[74:75], v14 offset:43008
buffer_load_dwordx4 a[164:167], v10, s[4:7], s43 offen offset:1024 sc1
v_mfma_f32_16x16x32_bf16 v[116:119], v[84:87], a[76:79], v[116:119]
ds_read_b64_tr_b16 v[76:77], v14 offset:45056
v_mfma_f32_16x16x32_bf16 v[116:119], v[80:83], a[68:71], v[116:119]
s_waitcnt lgkmcnt(7)
ds_read_b64_tr_b16 v[78:79], v14 offset:47104
v_mfma_f32_16x16x32_bf16 v[124:127], v[96:99], a[68:71], v[124:127]
ds_read_b64_tr_b16 v[80:81], v15 offset:32768
buffer_load_dwordx4 v31, s[20:23], s42 offen offset:3072 sc1 lds
v_mfma_f32_16x16x32_bf16 v[124:127], v[100:103], a[76:79], v[124:127]
ds_read_b64_tr_b16 v[82:83], v15 offset:34816
v_mfma_f32_16x16x32_bf16 v[124:127], v[104:107], a[84:87], v[124:127]
ds_read_b64_tr_b16 v[84:85], v15 offset:36864
v_mfma_f32_16x16x32_bf16 v[124:127], v[108:111], a[92:95], v[124:127]
ds_read_b64_tr_b16 v[86:87], v15 offset:38912
v_mfma_f32_16x16x32_bf16 v[120:123], v[108:111], a[88:91], v[120:123]
ds_read_b64_tr_b16 v[88:89], v15 offset:40960
buffer_load_dwordx4 a[168:171], v10, s[4:7], s43 offen offset:2048 sc1
v_mfma_f32_16x16x32_bf16 v[120:123], v[104:107], a[80:83], v[120:123]
ds_read_b64_tr_b16 v[90:91], v15 offset:43008
v_mfma_f32_16x16x32_bf16 v[120:123], v[100:103], a[72:75], v[120:123]
ds_read_b64_tr_b16 v[92:93], v15 offset:45056
v_mfma_f32_16x16x32_bf16 v[120:123], v[96:99], a[64:67], v[120:123]
s_waitcnt lgkmcnt(7)
ds_read_b64_tr_b16 v[94:95], v15 offset:47104
v_mfma_f32_16x16x32_bf16 v[128:131], v[64:67], a[64:67], v[128:131]
s_add_u32 s42, s89, s93
ds_read_b64_tr_b16 v[96:97], v12 offset:49152
s_add_u32 m0, s41, 114688
v_mfma_f32_16x16x32_bf16 v[128:131], v[68:71], a[72:75], v[128:131]
s_add_u32 s42, s42, 4194304
ds_read_b64_tr_b16 v[98:99], v12 offset:51200
buffer_load_dwordx4 v28, s[20:23], s42 offen sc1 lds
v_mfma_f32_16x16x32_bf16 v[128:131], v[72:75], a[80:83], v[128:131]
ds_read_b64_tr_b16 v[100:101], v12 offset:53248
v_mfma_f32_16x16x32_bf16 v[128:131], v[76:79], a[88:91], v[128:131]
ds_read_b64_tr_b16 v[102:103], v12 offset:55296
v_mfma_f32_16x16x32_bf16 v[132:135], v[76:79], a[92:95], v[132:135]
ds_read_b64_tr_b16 v[104:105], v12 offset:57344
buffer_load_dwordx4 a[172:175], v10, s[4:7], s43 offen offset:3072 sc1
v_mfma_f32_16x16x32_bf16 v[132:135], v[72:75], a[84:87], v[132:135]
ds_read_b64_tr_b16 v[106:107], v12 offset:59392
v_mfma_f32_16x16x32_bf16 v[132:135], v[68:71], a[76:79], v[132:135]
ds_read_b64_tr_b16 v[108:109], v12 offset:61440
v_mfma_f32_16x16x32_bf16 v[132:135], v[64:67], a[68:71], v[132:135]
s_waitcnt lgkmcnt(7)
ds_read_b64_tr_b16 v[110:111], v12 offset:63488
v_mfma_f32_16x16x32_bf16 v[140:143], v[80:83], a[68:71], v[140:143]
ds_read_b64_tr_b16 v[64:65], v13 offset:49152
buffer_load_dwordx4 v29, s[20:23], s42 offen offset:1024 sc1 lds
v_mfma_f32_16x16x32_bf16 v[140:143], v[84:87], a[76:79], v[140:143]
ds_read_b64_tr_b16 v[66:67], v13 offset:51200
v_mfma_f32_16x16x32_bf16 v[140:143], v[88:91], a[84:87], v[140:143]
ds_read_b64_tr_b16 v[68:69], v13 offset:53248
buffer_load_dwordx4 a[176:179], v2, s[4:7], s43 offen sc1
v_mfma_f32_16x16x32_bf16 v[140:143], v[92:95], a[92:95], v[140:143]
ds_read_b64_tr_b16 v[70:71], v13 offset:55296
v_mfma_f32_16x16x32_bf16 v[136:139], v[92:95], a[88:91], v[136:139]
ds_read_b64_tr_b16 v[72:73], v13 offset:57344
v_mfma_f32_16x16x32_bf16 v[136:139], v[88:91], a[80:83], v[136:139]
ds_read_b64_tr_b16 v[74:75], v13 offset:59392
buffer_load_dwordx4 a[180:183], v2, s[4:7], s43 offen offset:1024 sc1
v_mfma_f32_16x16x32_bf16 v[136:139], v[84:87], a[72:75], v[136:139]
ds_read_b64_tr_b16 v[76:77], v13 offset:61440
v_mfma_f32_16x16x32_bf16 v[136:139], v[80:83], a[64:67], v[136:139]
s_waitcnt lgkmcnt(7)
ds_read_b64_tr_b16 v[78:79], v13 offset:63488
v_mfma_f32_16x16x32_bf16 v[112:115], v[96:99], a[96:99], v[112:115]
ds_read_b64_tr_b16 v[80:81], v14 offset:49152
buffer_load_dwordx4 v30, s[20:23], s42 offen offset:2048 sc1 lds
v_mfma_f32_16x16x32_bf16 v[112:115], v[100:103], a[104:107], v[112:115]
ds_read_b64_tr_b16 v[82:83], v14 offset:51200
v_mfma_f32_16x16x32_bf16 v[112:115], v[104:107], a[112:115], v[112:115]
ds_read_b64_tr_b16 v[84:85], v14 offset:53248
v_mfma_f32_16x16x32_bf16 v[112:115], v[108:111], a[120:123], v[112:115]
ds_read_b64_tr_b16 v[86:87], v14 offset:55296
v_mfma_f32_16x16x32_bf16 v[116:119], v[108:111], a[124:127], v[116:119]
ds_read_b64_tr_b16 v[88:89], v14 offset:57344
buffer_load_dwordx4 a[184:187], v2, s[4:7], s43 offen offset:2048 sc1
v_mfma_f32_16x16x32_bf16 v[116:119], v[104:107], a[116:119], v[116:119]
ds_read_b64_tr_b16 v[90:91], v14 offset:59392
v_mfma_f32_16x16x32_bf16 v[116:119], v[100:103], a[108:111], v[116:119]
ds_read_b64_tr_b16 v[92:93], v14 offset:61440
v_mfma_f32_16x16x32_bf16 v[116:119], v[96:99], a[100:103], v[116:119]
s_waitcnt lgkmcnt(7)
ds_read_b64_tr_b16 v[94:95], v14 offset:63488
v_mfma_f32_16x16x32_bf16 v[124:127], v[64:67], a[100:103], v[124:127]
ds_read_b64_tr_b16 v[96:97], v15 offset:49152
buffer_load_dwordx4 v31, s[20:23], s42 offen offset:3072 sc1 lds
v_mfma_f32_16x16x32_bf16 v[124:127], v[68:71], a[108:111], v[124:127]
ds_read_b64_tr_b16 v[98:99], v15 offset:51200
v_mfma_f32_16x16x32_bf16 v[124:127], v[72:75], a[116:119], v[124:127]
ds_read_b64_tr_b16 v[100:101], v15 offset:53248
v_mfma_f32_16x16x32_bf16 v[124:127], v[76:79], a[124:127], v[124:127]
ds_read_b64_tr_b16 v[102:103], v15 offset:55296
v_mfma_f32_16x16x32_bf16 v[120:123], v[76:79], a[120:123], v[120:123]
ds_read_b64_tr_b16 v[104:105], v15 offset:57344
buffer_load_dwordx4 a[188:191], v2, s[4:7], s43 offen offset:3072 sc1
v_mfma_f32_16x16x32_bf16 v[120:123], v[72:75], a[112:115], v[120:123]
ds_read_b64_tr_b16 v[106:107], v15 offset:59392
v_mfma_f32_16x16x32_bf16 v[120:123], v[68:71], a[104:107], v[120:123]
ds_read_b64_tr_b16 v[108:109], v15 offset:61440
v_mfma_f32_16x16x32_bf16 v[120:123], v[64:67], a[96:99], v[120:123]
s_waitcnt vmcnt(20) lgkmcnt(7)
s_barrier
ds_read_b64_tr_b16 v[110:111], v15 offset:63488
v_mfma_f32_16x16x32_bf16 v[128:131], v[80:83], a[96:99], v[128:131]
s_xor_b64 s[20:21], s[20:21], s[66:67]
ds_read_b64_tr_b16 v[64:65], v16 offset:0
s_lshl_b32 s42, s94, 5
v_mfma_f32_16x16x32_bf16 v[128:131], v[84:87], a[104:107], v[128:131]
s_sub_u32 s42, s88, s42
ds_read_b64_tr_b16 v[66:67], v16 offset:2048
s_add_u32 m0, s41, 0
v_mfma_f32_16x16x32_bf16 v[128:131], v[88:91], a[112:115], v[128:131]
s_add_u32 s42, s42, 6291456
ds_read_b64_tr_b16 v[68:69], v16 offset:4096
buffer_load_dwordx4 v28, s[20:23], s42 offen sc1 lds
v_mfma_f32_16x16x32_bf16 v[128:131], v[92:95], a[120:123], v[128:131]
ds_read_b64_tr_b16 v[70:71], v16 offset:6144
v_mfma_f32_16x16x32_bf16 v[132:135], v[92:95], a[124:127], v[132:135]
ds_read_b64_tr_b16 v[72:73], v16 offset:8192
v_mfma_f32_16x16x32_bf16 v[132:135], v[88:91], a[116:119], v[132:135]
ds_read_b64_tr_b16 v[74:75], v16 offset:10240
v_mfma_f32_16x16x32_bf16 v[132:135], v[84:87], a[108:111], v[132:135]
s_branch Lso17
Lst17:
s_branch Lst21
Lso17:
ds_read_b64_tr_b16 v[76:77], v16 offset:12288
v_mfma_f32_16x16x32_bf16 v[132:135], v[80:83], a[100:103], v[132:135]
s_waitcnt lgkmcnt(7)
ds_read_b64_tr_b16 v[78:79], v16 offset:14336
v_mfma_f32_16x16x32_bf16 v[140:143], v[96:99], a[100:103], v[140:143]
ds_read_b64_tr_b16 v[80:81], v17 offset:0
buffer_load_dwordx4 v29, s[20:23], s42 offen offset:1024 sc1 lds
v_mfma_f32_16x16x32_bf16 v[140:143], v[100:103], a[108:111], v[140:143]
ds_read_b64_tr_b16 v[82:83], v17 offset:2048
v_mov_b32 v25, 0
v_mfma_f32_16x16x32_bf16 v[140:143], v[104:107], a[116:119], v[140:143]
ds_read_b64_tr_b16 v[84:85], v17 offset:4096
v_mfma_f32_16x16x32_bf16 v[140:143], v[108:111], a[124:127], v[140:143]
ds_read_b64_tr_b16 v[86:87], v17 offset:6144
v_mfma_f32_16x16x32_bf16 v[136:139], v[108:111], a[120:123], v[136:139]
ds_read_b64_tr_b16 v[88:89], v17 offset:8192
buffer_atomic_add v25, v11, s[4:7], s32 offen offset:40 sc0 sc1
v_mfma_f32_16x16x32_bf16 v[136:139], v[104:107], a[112:115], v[136:139]
ds_read_b64_tr_b16 v[90:91], v17 offset:10240
v_mfma_f32_16x16x32_bf16 v[136:139], v[100:103], a[104:107], v[136:139]
ds_read_b64_tr_b16 v[92:93], v17 offset:12288
v_mfma_f32_16x16x32_bf16 v[136:139], v[96:99], a[96:99], v[136:139]
s_waitcnt vmcnt(17) lgkmcnt(7)
ds_read_b64_tr_b16 v[94:95], v17 offset:14336
v_mfma_f32_16x16x32_bf16 v[144:147], v[64:67], a[128:131], v[144:147]
ds_read_b64_tr_b16 v[96:97], v18 offset:0
buffer_load_dwordx4 v30, s[20:23], s42 offen offset:2048 sc1 lds
v_mfma_f32_16x16x32_bf16 v[144:147], v[68:71], a[136:139], v[144:147]
ds_read_b64_tr_b16 v[98:99], v18 offset:2048
v_mfma_f32_16x16x32_bf16 v[144:147], v[72:75], a[144:147], v[144:147]
ds_read_b64_tr_b16 v[100:101], v18 offset:4096
v_mfma_f32_16x16x32_bf16 v[144:147], v[76:79], a[152:155], v[144:147]
ds_read_b64_tr_b16 v[102:103], v18 offset:6144
v_mfma_f32_16x16x32_bf16 v[148:151], v[76:79], a[156:159], v[148:151]
ds_read_b64_tr_b16 v[104:105], v18 offset:8192
v_mfma_f32_16x16x32_bf16 v[148:151], v[72:75], a[148:151], v[148:151]
ds_read_b64_tr_b16 v[106:107], v18 offset:10240
v_mfma_f32_16x16x32_bf16 v[148:151], v[68:71], a[140:143], v[148:151]
ds_read_b64_tr_b16 v[108:109], v18 offset:12288
v_mfma_f32_16x16x32_bf16 v[148:151], v[64:67], a[132:135], v[148:151]
s_waitcnt lgkmcnt(7)
ds_read_b64_tr_b16 v[110:111], v18 offset:14336
v_mfma_f32_16x16x32_bf16 v[156:159], v[80:83], a[132:135], v[156:159]
ds_read_b64_tr_b16 v[64:65], v19 offset:0
buffer_load_dwordx4 v31, s[20:23], s42 offen offset:3072 sc1 lds
v_mfma_f32_16x16x32_bf16 v[156:159], v[84:87], a[140:143], v[156:159]
ds_read_b64_tr_b16 v[66:67], v19 offset:2048
v_mfma_f32_16x16x32_bf16 v[156:159], v[88:91], a[148:151], v[156:159]
ds_read_b64_tr_b16 v[68:69], v19 offset:4096
v_mfma_f32_16x16x32_bf16 v[156:159], v[92:95], a[156:159], v[156:159]
ds_read_b64_tr_b16 v[70:71], v19 offset:6144
v_mfma_f32_16x16x32_bf16 v[152:155], v[92:95], a[152:155], v[152:155]
ds_read_b64_tr_b16 v[72:73], v19 offset:8192
v_mfma_f32_16x16x32_bf16 v[152:155], v[88:91], a[144:147], v[152:155]
ds_read_b64_tr_b16 v[74:75], v19 offset:10240
v_mfma_f32_16x16x32_bf16 v[152:155], v[84:87], a[136:139], v[152:155]
ds_read_b64_tr_b16 v[76:77], v19 offset:12288
v_mfma_f32_16x16x32_bf16 v[152:155], v[80:83], a[128:131], v[152:155]
s_waitcnt lgkmcnt(7)
ds_read_b64_tr_b16 v[78:79], v19 offset:14336
v_mfma_f32_16x16x32_bf16 v[160:163], v[96:99], a[128:131], v[160:163]
s_xor_b64 s[20:21], s[20:21], s[66:67]
ds_read_b64_tr_b16 v[80:81], v16 offset:16384
s_lshl_b32 s42, s94, 5
v_mfma_f32_16x16x32_bf16 v[160:163], v[100:103], a[136:139], v[160:163]
s_sub_u32 s42, s89, s42
ds_read_b64_tr_b16 v[82:83], v16 offset:18432
s_add_u32 m0, s41, 16384
v_mfma_f32_16x16x32_bf16 v[160:163], v[104:107], a[144:147], v[160:163]
s_add_u32 s42, s42, 6291456
ds_read_b64_tr_b16 v[84:85], v16 offset:20480
buffer_load_dwordx4 v28, s[20:23], s42 offen sc1 lds
v_mfma_f32_16x16x32_bf16 v[160:163], v[108:111], a[152:155], v[160:163]
ds_read_b64_tr_b16 v[86:87], v16 offset:22528
v_mfma_f32_16x16x32_bf16 v[164:167], v[108:111], a[156:159], v[164:167]
ds_read_b64_tr_b16 v[88:89], v16 offset:24576
v_mfma_f32_16x16x32_bf16 v[164:167], v[104:107], a[148:151], v[164:167]
ds_read_b64_tr_b16 v[90:91], v16 offset:26624
v_mfma_f32_16x16x32_bf16 v[164:167], v[100:103], a[140:143], v[164:167]
ds_read_b64_tr_b16 v[92:93], v16 offset:28672
v_mfma_f32_16x16x32_bf16 v[164:167], v[96:99], a[132:135], v[164:167]
s_waitcnt lgkmcnt(7)
ds_read_b64_tr_b16 v[94:95], v16 offset:30720
v_mfma_f32_16x16x32_bf16 v[172:175], v[64:67], a[132:135], v[172:175]
ds_read_b64_tr_b16 v[96:97], v17 offset:16384
buffer_load_dwordx4 v29, s[20:23], s42 offen offset:1024 sc1 lds
v_mfma_f32_16x16x32_bf16 v[172:175], v[68:71], a[140:143], v[172:175]
ds_read_b64_tr_b16 v[98:99], v17 offset:18432
v_mfma_f32_16x16x32_bf16 v[172:175], v[72:75], a[148:151], v[172:175]
ds_read_b64_tr_b16 v[100:101], v17 offset:20480
v_mfma_f32_16x16x32_bf16 v[172:175], v[76:79], a[156:159], v[172:175]
ds_read_b64_tr_b16 v[102:103], v17 offset:22528
v_mfma_f32_16x16x32_bf16 v[168:171], v[76:79], a[152:155], v[168:171]
ds_read_b64_tr_b16 v[104:105], v17 offset:24576
v_mfma_f32_16x16x32_bf16 v[168:171], v[72:75], a[144:147], v[168:171]
ds_read_b64_tr_b16 v[106:107], v17 offset:26624
v_mfma_f32_16x16x32_bf16 v[168:171], v[68:71], a[136:139], v[168:171]
ds_read_b64_tr_b16 v[108:109], v17 offset:28672
v_mfma_f32_16x16x32_bf16 v[168:171], v[64:67], a[128:131], v[168:171]
s_waitcnt vmcnt(7) lgkmcnt(7)
ds_read_b64_tr_b16 v[110:111], v17 offset:30720
v_mfma_f32_16x16x32_bf16 v[144:147], v[80:83], a[160:163], v[144:147]
ds_read_b64_tr_b16 v[64:65], v18 offset:16384
buffer_load_dwordx4 v30, s[20:23], s42 offen offset:2048 sc1 lds
v_mfma_f32_16x16x32_bf16 v[144:147], v[84:87], a[168:171], v[144:147]
ds_read_b64_tr_b16 v[66:67], v18 offset:18432
v_mfma_f32_16x16x32_bf16 v[144:147], v[88:91], a[176:179], v[144:147]
ds_read_b64_tr_b16 v[68:69], v18 offset:20480
v_mfma_f32_16x16x32_bf16 v[144:147], v[92:95], a[184:187], v[144:147]
ds_read_b64_tr_b16 v[70:71], v18 offset:22528
v_mfma_f32_16x16x32_bf16 v[148:151], v[92:95], a[188:191], v[148:151]
ds_read_b64_tr_b16 v[72:73], v18 offset:24576
v_mfma_f32_16x16x32_bf16 v[148:151], v[88:91], a[180:183], v[148:151]
ds_read_b64_tr_b16 v[74:75], v18 offset:26624
v_mfma_f32_16x16x32_bf16 v[148:151], v[84:87], a[172:175], v[148:151]
ds_read_b64_tr_b16 v[76:77], v18 offset:28672
v_mfma_f32_16x16x32_bf16 v[148:151], v[80:83], a[164:167], v[148:151]
s_waitcnt lgkmcnt(7)
ds_read_b64_tr_b16 v[78:79], v18 offset:30720
v_mfma_f32_16x16x32_bf16 v[156:159], v[96:99], a[164:167], v[156:159]
ds_read_b64_tr_b16 v[80:81], v19 offset:16384
buffer_load_dwordx4 v31, s[20:23], s42 offen offset:3072 sc1 lds
v_mfma_f32_16x16x32_bf16 v[156:159], v[100:103], a[172:175], v[156:159]
ds_read_b64_tr_b16 v[82:83], v19 offset:18432
s_waitcnt vmcnt(6)
v_readfirstlane_b32 s45, v25
s_nop 0
s_cmp_lt_u32 s45, 4
s_cbranch_scc1 Lslow12056
Lback12057:
v_mfma_f32_16x16x32_bf16 v[156:159], v[104:107], a[180:183], v[156:159]
s_add_u32 s43, s71, s94
ds_read_b64_tr_b16 v[84:85], v19 offset:20480
s_add_u32 s43, s43, 196608
v_mfma_f32_16x16x32_bf16 v[156:159], v[108:111], a[188:191], v[156:159]
ds_read_b64_tr_b16 v[86:87], v19 offset:22528
buffer_load_dwordx4 a[192:195], v10, s[4:7], s43 offen sc1
v_mfma_f32_16x16x32_bf16 v[152:155], v[108:111], a[184:187], v[152:155]
ds_read_b64_tr_b16 v[88:89], v19 offset:24576
v_mfma_f32_16x16x32_bf16 v[152:155], v[104:107], a[176:179], v[152:155]
ds_read_b64_tr_b16 v[90:91], v19 offset:26624
buffer_load_dwordx4 a[196:199], v10, s[4:7], s43 offen offset:1024 sc1
v_mfma_f32_16x16x32_bf16 v[152:155], v[100:103], a[168:171], v[152:155]
ds_read_b64_tr_b16 v[92:93], v19 offset:28672
v_mfma_f32_16x16x32_bf16 v[152:155], v[96:99], a[160:163], v[152:155]
s_waitcnt lgkmcnt(7)
s_barrier
ds_read_b64_tr_b16 v[94:95], v19 offset:30720
v_mfma_f32_16x16x32_bf16 v[160:163], v[64:67], a[160:163], v[160:163]
s_add_u32 m0, s41, 32768
ds_read_b64_tr_b16 v[96:97], v16 offset:32768
s_add_u32 s42, s90, s92
v_mfma_f32_16x16x32_bf16 v[160:163], v[68:71], a[168:171], v[160:163]
ds_read_b64_tr_b16 v[98:99], v16 offset:34816
buffer_load_dwordx4 v28, s[20:23], s42 offen sc1 lds
v_mfma_f32_16x16x32_bf16 v[160:163], v[72:75], a[176:179], v[160:163]
ds_read_b64_tr_b16 v[100:101], v16 offset:36864
v_mfma_f32_16x16x32_bf16 v[160:163], v[76:79], a[184:187], v[160:163]
ds_read_b64_tr_b16 v[102:103], v16 offset:38912
v_mfma_f32_16x16x32_bf16 v[164:167], v[76:79], a[188:191], v[164:167]
ds_read_b64_tr_b16 v[104:105], v16 offset:40960
buffer_load_dwordx4 a[200:203], v10, s[4:7], s43 offen offset:2048 sc1
v_mfma_f32_16x16x32_bf16 v[164:167], v[72:75], a[180:183], v[164:167]
ds_read_b64_tr_b16 v[106:107], v16 offset:43008
v_mfma_f32_16x16x32_bf16 v[164:167], v[68:71], a[172:175], v[164:167]
ds_read_b64_tr_b16 v[108:109], v16 offset:45056
v_mfma_f32_16x16x32_bf16 v[164:167], v[64:67], a[164:167], v[164:167]
s_waitcnt lgkmcnt(7)
ds_read_b64_tr_b16 v[110:111], v16 offset:47104
v_mfma_f32_16x16x32_bf16 v[172:175], v[80:83], a[164:167], v[172:175]
ds_read_b64_tr_b16 v[64:65], v17 offset:32768
buffer_load_dwordx4 v29, s[20:23], s42 offen offset:1024 sc1 lds
v_mfma_f32_16x16x32_bf16 v[172:175], v[84:87], a[172:175], v[172:175]
ds_read_b64_tr_b16 v[66:67], v17 offset:34816
v_mfma_f32_16x16x32_bf16 v[172:175], v[88:91], a[180:183], v[172:175]
ds_read_b64_tr_b16 v[68:69], v17 offset:36864
v_mfma_f32_16x16x32_bf16 v[172:175], v[92:95], a[188:191], v[172:175]
ds_read_b64_tr_b16 v[70:71], v17 offset:38912
v_mfma_f32_16x16x32_bf16 v[168:171], v[92:95], a[184:187], v[168:171]
ds_read_b64_tr_b16 v[72:73], v17 offset:40960
buffer_load_dwordx4 a[204:207], v10, s[4:7], s43 offen offset:3072 sc1
v_mfma_f32_16x16x32_bf16 v[168:171], v[88:91], a[176:179], v[168:171]
ds_read_b64_tr_b16 v[74:75], v17 offset:43008
v_mfma_f32_16x16x32_bf16 v[168:171], v[84:87], a[168:171], v[168:171]
ds_read_b64_tr_b16 v[76:77], v17 offset:45056
v_mfma_f32_16x16x32_bf16 v[168:171], v[80:83], a[160:163], v[168:171]
s_waitcnt lgkmcnt(7)
ds_read_b64_tr_b16 v[78:79], v17 offset:47104
v_mfma_f32_16x16x32_bf16 v[112:115], v[96:99], a[128:131], v[112:115]
ds_read_b64_tr_b16 v[80:81], v18 offset:32768
buffer_load_dwordx4 v30, s[20:23], s42 offen offset:2048 sc1 lds
v_mfma_f32_16x16x32_bf16 v[112:115], v[100:103], a[136:139], v[112:115]
ds_read_b64_tr_b16 v[82:83], v18 offset:34816
v_mfma_f32_16x16x32_bf16 v[112:115], v[104:107], a[144:147], v[112:115]
ds_read_b64_tr_b16 v[84:85], v18 offset:36864
buffer_load_dwordx4 a[208:211], v2, s[4:7], s43 offen sc1
v_mfma_f32_16x16x32_bf16 v[112:115], v[108:111], a[152:155], v[112:115]
ds_read_b64_tr_b16 v[86:87], v18 offset:38912
v_mfma_f32_16x16x32_bf16 v[116:119], v[108:111], a[156:159], v[116:119]
ds_read_b64_tr_b16 v[88:89], v18 offset:40960
v_mfma_f32_16x16x32_bf16 v[116:119], v[104:107], a[148:151], v[116:119]
ds_read_b64_tr_b16 v[90:91], v18 offset:43008
buffer_load_dwordx4 a[212:215], v2, s[4:7], s43 offen offset:1024 sc1
v_mfma_f32_16x16x32_bf16 v[116:119], v[100:103], a[140:143], v[116:119]
ds_read_b64_tr_b16 v[92:93], v18 offset:45056
v_mfma_f32_16x16x32_bf16 v[116:119], v[96:99], a[132:135], v[116:119]
s_waitcnt lgkmcnt(7)
ds_read_b64_tr_b16 v[94:95], v18 offset:47104
v_mfma_f32_16x16x32_bf16 v[124:127], v[64:67], a[132:135], v[124:127]
ds_read_b64_tr_b16 v[96:97], v19 offset:32768
buffer_load_dwordx4 v31, s[20:23], s42 offen offset:3072 sc1 lds
v_mfma_f32_16x16x32_bf16 v[124:127], v[68:71], a[140:143], v[124:127]
ds_read_b64_tr_b16 v[98:99], v19 offset:34816
v_mfma_f32_16x16x32_bf16 v[124:127], v[72:75], a[148:151], v[124:127]
ds_read_b64_tr_b16 v[100:101], v19 offset:36864
v_mfma_f32_16x16x32_bf16 v[124:127], v[76:79], a[156:159], v[124:127]
ds_read_b64_tr_b16 v[102:103], v19 offset:38912
v_mfma_f32_16x16x32_bf16 v[120:123], v[76:79], a[152:155], v[120:123]
ds_read_b64_tr_b16 v[104:105], v19 offset:40960
buffer_load_dwordx4 a[216:219], v2, s[4:7], s43 offen offset:2048 sc1
v_mfma_f32_16x16x32_bf16 v[120:123], v[72:75], a[144:147], v[120:123]
ds_read_b64_tr_b16 v[106:107], v19 offset:43008
v_mfma_f32_16x16x32_bf16 v[120:123], v[68:71], a[136:139], v[120:123]
ds_read_b64_tr_b16 v[108:109], v19 offset:45056
v_mfma_f32_16x16x32_bf16 v[120:123], v[64:67], a[128:131], v[120:123]
s_waitcnt lgkmcnt(7)
ds_read_b64_tr_b16 v[110:111], v19 offset:47104
v_mfma_f32_16x16x32_bf16 v[128:131], v[80:83], a[128:131], v[128:131]
s_add_u32 m0, s41, 49152
ds_read_b64_tr_b16 v[64:65], v16 offset:49152
s_add_u32 s42, s90, s93
v_mfma_f32_16x16x32_bf16 v[128:131], v[84:87], a[136:139], v[128:131]
ds_read_b64_tr_b16 v[66:67], v16 offset:51200
buffer_load_dwordx4 v28, s[20:23], s42 offen sc1 lds
v_mfma_f32_16x16x32_bf16 v[128:131], v[88:91], a[144:147], v[128:131]
ds_read_b64_tr_b16 v[68:69], v16 offset:53248
v_mfma_f32_16x16x32_bf16 v[128:131], v[92:95], a[152:155], v[128:131]
ds_read_b64_tr_b16 v[70:71], v16 offset:55296
v_mfma_f32_16x16x32_bf16 v[132:135], v[92:95], a[156:159], v[132:135]
ds_read_b64_tr_b16 v[72:73], v16 offset:57344
buffer_load_dwordx4 a[220:223], v2, s[4:7], s43 offen offset:3072 sc1
v_mfma_f32_16x16x32_bf16 v[132:135], v[88:91], a[148:151], v[132:135]
ds_read_b64_tr_b16 v[74:75], v16 offset:59392
v_mfma_f32_16x16x32_bf16 v[132:135], v[84:87], a[140:143], v[132:135]
ds_read_b64_tr_b16 v[76:77], v16 offset:61440
v_mfma_f32_16x16x32_bf16 v[132:135], v[80:83], a[132:135], v[132:135]
s_waitcnt lgkmcnt(7)
ds_read_b64_tr_b16 v[78:79], v16 offset:63488
v_mfma_f32_16x16x32_bf16 v[140:143], v[96:99], a[132:135], v[140:143]
ds_read_b64_tr_b16 v[80:81], v17 offset:49152
buffer_load_dwordx4 v29, s[20:23], s42 offen offset:1024 sc1 lds
v_mfma_f32_16x16x32_bf16 v[140:143], v[100:103], a[140:143], v[140:143]
ds_read_b64_tr_b16 v[82:83], v17 offset:51200
v_mfma_f32_16x16x32_bf16 v[140:143], v[104:107], a[148:151], v[140:143]
ds_read_b64_tr_b16 v[84:85], v17 offset:53248
v_mfma_f32_16x16x32_bf16 v[140:143], v[108:111], a[156:159], v[140:143]
ds_read_b64_tr_b16 v[86:87], v17 offset:55296
v_mfma_f32_16x16x32_bf16 v[136:139], v[108:111], a[152:155], v[136:139]
ds_read_b64_tr_b16 v[88:89], v17 offset:57344
v_mfma_f32_16x16x32_bf16 v[136:139], v[104:107], a[144:147], v[136:139]
ds_read_b64_tr_b16 v[90:91], v17 offset:59392
v_mfma_f32_16x16x32_bf16 v[136:139], v[100:103], a[136:139], v[136:139]
ds_read_b64_tr_b16 v[92:93], v17 offset:61440
v_mfma_f32_16x16x32_bf16 v[136:139], v[96:99], a[128:131], v[136:139]
s_waitcnt lgkmcnt(7)
ds_read_b64_tr_b16 v[94:95], v17 offset:63488
v_mfma_f32_16x16x32_bf16 v[112:115], v[64:67], a[160:163], v[112:115]
ds_read_b64_tr_b16 v[96:97], v18 offset:49152
buffer_load_dwordx4 v30, s[20:23], s42 offen offset:2048 sc1 lds
v_mfma_f32_16x16x32_bf16 v[112:115], v[68:71], a[168:171], v[112:115]
ds_read_b64_tr_b16 v[98:99], v18 offset:51200
v_mfma_f32_16x16x32_bf16 v[112:115], v[72:75], a[176:179], v[112:115]
ds_read_b64_tr_b16 v[100:101], v18 offset:53248
v_mfma_f32_16x16x32_bf16 v[112:115], v[76:79], a[184:187], v[112:115]
ds_read_b64_tr_b16 v[102:103], v18 offset:55296
v_mfma_f32_16x16x32_bf16 v[116:119], v[76:79], a[188:191], v[116:119]
ds_read_b64_tr_b16 v[104:105], v18 offset:57344
v_mfma_f32_16x16x32_bf16 v[116:119], v[72:75], a[180:183], v[116:119]
ds_read_b64_tr_b16 v[106:107], v18 offset:59392
v_mfma_f32_16x16x32_bf16 v[116:119], v[68:71], a[172:175], v[116:119]
ds_read_b64_tr_b16 v[108:109], v18 offset:61440
v_mfma_f32_16x16x32_bf16 v[116:119], v[64:67], a[164:167], v[116:119]
s_waitcnt lgkmcnt(7)
ds_read_b64_tr_b16 v[110:111], v18 offset:63488
v_mfma_f32_16x16x32_bf16 v[124:127], v[80:83], a[164:167], v[124:127]
ds_read_b64_tr_b16 v[64:65], v19 offset:49152
buffer_load_dwordx4 v31, s[20:23], s42 offen offset:3072 sc1 lds
v_mfma_f32_16x16x32_bf16 v[124:127], v[84:87], a[172:175], v[124:127]
ds_read_b64_tr_b16 v[66:67], v19 offset:51200
v_mfma_f32_16x16x32_bf16 v[124:127], v[88:91], a[180:183], v[124:127]
ds_read_b64_tr_b16 v[68:69], v19 offset:53248
v_mfma_f32_16x16x32_bf16 v[124:127], v[92:95], a[188:191], v[124:127]
ds_read_b64_tr_b16 v[70:71], v19 offset:55296
v_mfma_f32_16x16x32_bf16 v[120:123], v[92:95], a[184:187], v[120:123]
ds_read_b64_tr_b16 v[72:73], v19 offset:57344
v_mfma_f32_16x16x32_bf16 v[120:123], v[88:91], a[176:179], v[120:123]
ds_read_b64_tr_b16 v[74:75], v19 offset:59392
v_mfma_f32_16x16x32_bf16 v[120:123], v[84:87], a[168:171], v[120:123]
ds_read_b64_tr_b16 v[76:77], v19 offset:61440
v_mfma_f32_16x16x32_bf16 v[120:123], v[80:83], a[160:163], v[120:123]
s_waitcnt vmcnt(16) lgkmcnt(7)
s_barrier
ds_read_b64_tr_b16 v[78:79], v19 offset:63488
v_mfma_f32_16x16x32_bf16 v[128:131], v[96:99], a[160:163], v[128:131]
s_add_u32 s42, s90, s92
ds_read_b64_tr_b16 v[80:81], v12 offset:0
s_add_u32 m0, s41, 65536
v_mfma_f32_16x16x32_bf16 v[128:131], v[100:103], a[168:171], v[128:131]
s_add_u32 s42, s42, 2097152
ds_read_b64_tr_b16 v[82:83], v12 offset:2048
buffer_load_dwordx4 v28, s[20:23], s42 offen sc1 lds
v_mfma_f32_16x16x32_bf16 v[128:131], v[104:107], a[176:179], v[128:131]
ds_read_b64_tr_b16 v[84:85], v12 offset:4096
v_mfma_f32_16x16x32_bf16 v[128:131], v[108:111], a[184:187], v[128:131]
ds_read_b64_tr_b16 v[86:87], v12 offset:6144
v_mfma_f32_16x16x32_bf16 v[132:135], v[108:111], a[188:191], v[132:135]
ds_read_b64_tr_b16 v[88:89], v12 offset:8192
v_mfma_f32_16x16x32_bf16 v[132:135], v[104:107], a[180:183], v[132:135]
ds_read_b64_tr_b16 v[90:91], v12 offset:10240
v_mfma_f32_16x16x32_bf16 v[132:135], v[100:103], a[172:175], v[132:135]
ds_read_b64_tr_b16 v[92:93], v12 offset:12288
v_mfma_f32_16x16x32_bf16 v[132:135], v[96:99], a[164:167], v[132:135]
s_waitcnt lgkmcnt(7)
ds_read_b64_tr_b16 v[94:95], v12 offset:14336
v_mfma_f32_16x16x32_bf16 v[140:143], v[64:67], a[164:167], v[140:143]
ds_read_b64_tr_b16 v[96:97], v13 offset:0
buffer_load_dwordx4 v29, s[20:23], s42 offen offset:1024 sc1 lds
v_mfma_f32_16x16x32_bf16 v[140:143], v[68:71], a[172:175], v[140:143]
ds_read_b64_tr_b16 v[98:99], v13 offset:2048
v_mfma_f32_16x16x32_bf16 v[140:143], v[72:75], a[180:183], v[140:143]
ds_read_b64_tr_b16 v[100:101], v13 offset:4096
v_mfma_f32_16x16x32_bf16 v[140:143], v[76:79], a[188:191], v[140:143]
ds_read_b64_tr_b16 v[102:103], v13 offset:6144
v_mfma_f32_16x16x32_bf16 v[136:139], v[76:79], a[184:187], v[136:139]
ds_read_b64_tr_b16 v[104:105], v13 offset:8192
v_mfma_f32_16x16x32_bf16 v[136:139], v[72:75], a[176:179], v[136:139]
ds_read_b64_tr_b16 v[106:107], v13 offset:10240
v_mfma_f32_16x16x32_bf16 v[136:139], v[68:71], a[168:171], v[136:139]
ds_read_b64_tr_b16 v[108:109], v13 offset:12288
v_mfma_f32_16x16x32_bf16 v[136:139], v[64:67], a[160:163], v[136:139]
s_waitcnt vmcnt(5) lgkmcnt(7)
ds_read_b64_tr_b16 v[110:111], v13 offset:14336
v_mfma_f32_16x16x32_bf16 v[144:147], v[80:83], a[192:195], v[144:147]
ds_read_b64_tr_b16 v[64:65], v14 offset:0
buffer_load_dwordx4 v30, s[20:23], s42 offen offset:2048 sc1 lds
v_mfma_f32_16x16x32_bf16 v[144:147], v[84:87], a[200:203], v[144:147]
ds_read_b64_tr_b16 v[66:67], v14 offset:2048
v_mfma_f32_16x16x32_bf16 v[144:147], v[88:91], a[208:211], v[144:147]
ds_read_b64_tr_b16 v[68:69], v14 offset:4096
v_mfma_f32_16x16x32_bf16 v[144:147], v[92:95], a[216:219], v[144:147]
ds_read_b64_tr_b16 v[70:71], v14 offset:6144
v_mfma_f32_16x16x32_bf16 v[148:151], v[92:95], a[220:223], v[148:151]
ds_read_b64_tr_b16 v[72:73], v14 offset:8192
v_mfma_f32_16x16x32_bf16 v[148:151], v[88:91], a[212:215], v[148:151]
ds_read_b64_tr_b16 v[74:75], v14 offset:10240
v_mfma_f32_16x16x32_bf16 v[148:151], v[84:87], a[204:207], v[148:151]
ds_read_b64_tr_b16 v[76:77], v14 offset:12288
v_mfma_f32_16x16x32_bf16 v[148:151], v[80:83], a[196:199], v[148:151]
s_waitcnt lgkmcnt(7)
ds_read_b64_tr_b16 v[78:79], v14 offset:14336
v_mfma_f32_16x16x32_bf16 v[156:159], v[96:99], a[196:199], v[156:159]
ds_read_b64_tr_b16 v[80:81], v15 offset:0
buffer_load_dwordx4 v31, s[20:23], s42 offen offset:3072 sc1 lds
v_mfma_f32_16x16x32_bf16 v[156:159], v[100:103], a[204:207], v[156:159]
ds_read_b64_tr_b16 v[82:83], v15 offset:2048
v_mfma_f32_16x16x32_bf16 v[156:159], v[104:107], a[212:215], v[156:159]
ds_read_b64_tr_b16 v[84:85], v15 offset:4096
v_mfma_f32_16x16x32_bf16 v[156:159], v[108:111], a[220:223], v[156:159]
ds_read_b64_tr_b16 v[86:87], v15 offset:6144
v_mfma_f32_16x16x32_bf16 v[152:155], v[108:111], a[216:219], v[152:155]
ds_read_b64_tr_b16 v[88:89], v15 offset:8192
v_mfma_f32_16x16x32_bf16 v[152:155], v[104:107], a[208:211], v[152:155]
ds_read_b64_tr_b16 v[90:91], v15 offset:10240
v_mfma_f32_16x16x32_bf16 v[152:155], v[100:103], a[200:203], v[152:155]
ds_read_b64_tr_b16 v[92:93], v15 offset:12288
v_mfma_f32_16x16x32_bf16 v[152:155], v[96:99], a[192:195], v[152:155]
s_waitcnt lgkmcnt(7)
ds_read_b64_tr_b16 v[94:95], v15 offset:14336
v_mfma_f32_16x16x32_bf16 v[160:163], v[64:67], a[192:195], v[160:163]
s_add_u32 s42, s90, s93
ds_read_b64_tr_b16 v[96:97], v12 offset:16384
s_add_u32 m0, s41, 81920
v_mfma_f32_16x16x32_bf16 v[160:163], v[68:71], a[200:203], v[160:163]
s_add_u32 s42, s42, 2097152
ds_read_b64_tr_b16 v[98:99], v12 offset:18432
buffer_load_dwordx4 v28, s[20:23], s42 offen sc1 lds
v_mfma_f32_16x16x32_bf16 v[160:163], v[72:75], a[208:211], v[160:163]
s_xor_b32 s46, s38, 8
ds_read_b64_tr_b16 v[100:101], v12 offset:20480
s_mul_i32 s46, s46, 12288
v_mfma_f32_16x16x32_bf16 v[160:163], v[76:79], a[216:219], v[160:163]
s_add_u32 s46, s46, s95
ds_read_b64_tr_b16 v[102:103], v12 offset:22528
v_cvt_pk_bf16_f32 v208, v144, v145
v_mfma_f32_16x16x32_bf16 v[164:167], v[76:79], a[220:223], v[164:167]
ds_read_b64_tr_b16 v[104:105], v12 offset:24576
v_cvt_pk_bf16_f32 v209, v146, v147
v_mfma_f32_16x16x32_bf16 v[164:167], v[72:75], a[212:215], v[164:167]
ds_read_b64_tr_b16 v[106:107], v12 offset:26624
v_cvt_pk_bf16_f32 v210, v152, v153
v_mfma_f32_16x16x32_bf16 v[164:167], v[68:71], a[204:207], v[164:167]
ds_read_b64_tr_b16 v[108:109], v12 offset:28672
v_cvt_pk_bf16_f32 v211, v154, v155
v_mfma_f32_16x16x32_bf16 v[164:167], v[64:67], a[196:199], v[164:167]
s_waitcnt lgkmcnt(7)
ds_read_b64_tr_b16 v[110:111], v12 offset:30720
v_mfma_f32_16x16x32_bf16 v[172:175], v[80:83], a[196:199], v[172:175]
ds_read_b64_tr_b16 v[64:65], v13 offset:16384
buffer_load_dwordx4 v29, s[20:23], s42 offen offset:1024 sc1 lds
v_mfma_f32_16x16x32_bf16 v[172:175], v[84:87], a[204:207], v[172:175]
ds_read_b64_tr_b16 v[66:67], v13 offset:18432
buffer_store_dwordx4 v[208:211], v10, s[4:7], s46 offen sc1
v_mfma_f32_16x16x32_bf16 v[172:175], v[88:91], a[212:215], v[172:175]
ds_read_b64_tr_b16 v[68:69], v13 offset:20480
v_cvt_pk_bf16_f32 v212, v148, v149
v_cvt_pk_bf16_f32 v213, v150, v151
v_mfma_f32_16x16x32_bf16 v[172:175], v[92:95], a[220:223], v[172:175]
ds_read_b64_tr_b16 v[70:71], v13 offset:22528
v_cvt_pk_bf16_f32 v214, v156, v157
v_mfma_f32_16x16x32_bf16 v[168:171], v[92:95], a[216:219], v[168:171]
ds_read_b64_tr_b16 v[72:73], v13 offset:24576
v_cvt_pk_bf16_f32 v215, v158, v159
v_mfma_f32_16x16x32_bf16 v[168:171], v[88:91], a[208:211], v[168:171]
ds_read_b64_tr_b16 v[74:75], v13 offset:26624
buffer_store_dwordx4 v[212:215], v10, s[4:7], s46 offen offset:1024 sc1
v_mfma_f32_16x16x32_bf16 v[168:171], v[84:87], a[200:203], v[168:171]
ds_read_b64_tr_b16 v[76:77], v13 offset:28672
v_mfma_f32_16x16x32_bf16 v[168:171], v[80:83], a[192:195], v[168:171]
s_waitcnt lgkmcnt(7)
ds_read_b64_tr_b16 v[78:79], v13 offset:30720
v_mfma_f32_16x16x32_bf16 v[112:115], v[96:99], a[192:195], v[112:115]
ds_read_b64_tr_b16 v[80:81], v14 offset:16384
buffer_load_dwordx4 v30, s[20:23], s42 offen offset:2048 sc1 lds
v_mfma_f32_16x16x32_bf16 v[112:115], v[100:103], a[200:203], v[112:115]
ds_read_b64_tr_b16 v[82:83], v14 offset:18432
v_cvt_pk_bf16_f32 v216, v160, v161
v_mfma_f32_16x16x32_bf16 v[112:115], v[104:107], a[208:211], v[112:115]
ds_read_b64_tr_b16 v[84:85], v14 offset:20480
v_cvt_pk_bf16_f32 v217, v162, v163
v_mfma_f32_16x16x32_bf16 v[112:115], v[108:111], a[216:219], v[112:115]
ds_read_b64_tr_b16 v[86:87], v14 offset:22528
v_cvt_pk_bf16_f32 v218, v168, v169
v_mfma_f32_16x16x32_bf16 v[116:119], v[108:111], a[220:223], v[116:119]
ds_read_b64_tr_b16 v[88:89], v14 offset:24576
v_cvt_pk_bf16_f32 v219, v170, v171
v_mfma_f32_16x16x32_bf16 v[116:119], v[104:107], a[212:215], v[116:119]
ds_read_b64_tr_b16 v[90:91], v14 offset:26624
v_mfma_f32_16x16x32_bf16 v[116:119], v[100:103], a[204:207], v[116:119]
ds_read_b64_tr_b16 v[92:93], v14 offset:28672
v_mfma_f32_16x16x32_bf16 v[116:119], v[96:99], a[196:199], v[116:119]
s_waitcnt lgkmcnt(7)
ds_read_b64_tr_b16 v[94:95], v14 offset:30720
v_mfma_f32_16x16x32_bf16 v[124:127], v[64:67], a[196:199], v[124:127]
ds_read_b64_tr_b16 v[96:97], v15 offset:16384
buffer_load_dwordx4 v31, s[20:23], s42 offen offset:3072 sc1 lds
v_mfma_f32_16x16x32_bf16 v[124:127], v[68:71], a[204:207], v[124:127]
ds_read_b64_tr_b16 v[98:99], v15 offset:18432
v_mfma_f32_16x16x32_bf16 v[124:127], v[72:75], a[212:215], v[124:127]
ds_read_b64_tr_b16 v[100:101], v15 offset:20480
v_mfma_f32_16x16x32_bf16 v[124:127], v[76:79], a[220:223], v[124:127]
ds_read_b64_tr_b16 v[102:103], v15 offset:22528
v_mfma_f32_16x16x32_bf16 v[120:123], v[76:79], a[216:219], v[120:123]
ds_read_b64_tr_b16 v[104:105], v15 offset:24576
buffer_store_dwordx4 v[216:219], v10, s[4:7], s46 offen offset:2048 sc1
v_mfma_f32_16x16x32_bf16 v[120:123], v[72:75], a[208:211], v[120:123]
ds_read_b64_tr_b16 v[106:107], v15 offset:26624
v_cvt_pk_bf16_f32 v220, v164, v165
v_mfma_f32_16x16x32_bf16 v[120:123], v[68:71], a[200:203], v[120:123]
ds_read_b64_tr_b16 v[108:109], v15 offset:28672
v_cvt_pk_bf16_f32 v221, v166, v167
v_mfma_f32_16x16x32_bf16 v[120:123], v[64:67], a[192:195], v[120:123]
s_waitcnt vmcnt(11) lgkmcnt(7)
s_barrier
ds_read_b64_tr_b16 v[110:111], v15 offset:30720
v_mfma_f32_16x16x32_bf16 v[128:131], v[80:83], a[192:195], v[128:131]
s_add_u32 s42, s90, s92
ds_read_b64_tr_b16 v[64:65], v12 offset:32768
s_add_u32 m0, s41, 98304
v_mfma_f32_16x16x32_bf16 v[128:131], v[84:87], a[200:203], v[128:131]
s_add_u32 s42, s42, 4194304
ds_read_b64_tr_b16 v[66:67], v12 offset:34816
buffer_load_dwordx4 v28, s[20:23], s42 offen sc1 lds
v_mfma_f32_16x16x32_bf16 v[128:131], v[88:91], a[208:211], v[128:131]
ds_read_b64_tr_b16 v[68:69], v12 offset:36864
v_cvt_pk_bf16_f32 v222, v172, v173
v_mfma_f32_16x16x32_bf16 v[128:131], v[92:95], a[216:219], v[128:131]
ds_read_b64_tr_b16 v[70:71], v12 offset:38912
v_cvt_pk_bf16_f32 v223, v174, v175
v_mfma_f32_16x16x32_bf16 v[132:135], v[92:95], a[220:223], v[132:135]
ds_read_b64_tr_b16 v[72:73], v12 offset:40960
buffer_store_dwordx4 v[220:223], v10, s[4:7], s46 offen offset:3072 sc1
v_mfma_f32_16x16x32_bf16 v[132:135], v[88:91], a[212:215], v[132:135]
ds_read_b64_tr_b16 v[74:75], v12 offset:43008
v_mfma_f32_16x16x32_bf16 v[132:135], v[84:87], a[204:207], v[132:135]
ds_read_b64_tr_b16 v[76:77], v12 offset:45056
v_mfma_f32_16x16x32_bf16 v[132:135], v[80:83], a[196:199], v[132:135]
s_waitcnt lgkmcnt(7)
ds_read_b64_tr_b16 v[78:79], v12 offset:47104
v_mfma_f32_16x16x32_bf16 v[140:143], v[96:99], a[196:199], v[140:143]
ds_read_b64_tr_b16 v[80:81], v13 offset:32768
buffer_load_dwordx4 v29, s[20:23], s42 offen offset:1024 sc1 lds
v_mfma_f32_16x16x32_bf16 v[140:143], v[100:103], a[204:207], v[140:143]
ds_read_b64_tr_b16 v[82:83], v13 offset:34816
v_mfma_f32_16x16x32_bf16 v[140:143], v[104:107], a[212:215], v[140:143]
ds_read_b64_tr_b16 v[84:85], v13 offset:36864
v_mfma_f32_16x16x32_bf16 v[140:143], v[108:111], a[220:223], v[140:143]
ds_read_b64_tr_b16 v[86:87], v13 offset:38912
v_mfma_f32_16x16x32_bf16 v[136:139], v[108:111], a[216:219], v[136:139]
ds_read_b64_tr_b16 v[88:89], v13 offset:40960
v_mfma_f32_16x16x32_bf16 v[136:139], v[104:107], a[208:211], v[136:139]
ds_read_b64_tr_b16 v[90:91], v13 offset:43008
v_mfma_f32_16x16x32_bf16 v[136:139], v[100:103], a[200:203], v[136:139]
ds_read_b64_tr_b16 v[92:93], v13 offset:45056
v_mfma_f32_16x16x32_bf16 v[136:139], v[96:99], a[192:195], v[136:139]
s_waitcnt lgkmcnt(7)
ds_read_b64_tr_b16 v[94:95], v13 offset:47104
v_mfma_f32_16x16x32_bf16 v[144:147], v[64:67], a[0:3], 0
ds_read_b64_tr_b16 v[96:97], v14 offset:32768
buffer_load_dwordx4 v30, s[20:23], s42 offen offset:2048 sc1 lds
v_mfma_f32_16x16x32_bf16 v[144:147], v[68:71], a[8:11], v[144:147]
s_xor_b32 s46, s38, 12
ds_read_b64_tr_b16 v[98:99], v14 offset:34816
s_mul_i32 s46, s46, 12288
v_mfma_f32_16x16x32_bf16 v[144:147], v[72:75], a[16:19], v[144:147]
s_add_u32 s46, s46, s95
ds_read_b64_tr_b16 v[100:101], v14 offset:36864
s_add_u32 s46, s46, 4096
v_mfma_f32_16x16x32_bf16 v[144:147], v[76:79], a[24:27], v[144:147]
ds_read_b64_tr_b16 v[102:103], v14 offset:38912
v_mfma_f32_16x16x32_bf16 v[148:151], v[76:79], a[28:31], 0
ds_read_b64_tr_b16 v[104:105], v14 offset:40960
v_mfma_f32_16x16x32_bf16 v[148:151], v[72:75], a[20:23], v[148:151]
ds_read_b64_tr_b16 v[106:107], v14 offset:43008
v_mfma_f32_16x16x32_bf16 v[148:151], v[68:71], a[12:15], v[148:151]
ds_read_b64_tr_b16 v[108:109], v14 offset:45056
v_mfma_f32_16x16x32_bf16 v[148:151], v[64:67], a[4:7], v[148:151]
s_branch Lso18
Lst18:
s_setpc_b64 s[42:43]
Lso18:
s_waitcnt lgkmcnt(7)
ds_read_b64_tr_b16 v[110:111], v14 offset:47104
v_mfma_f32_16x16x32_bf16 v[156:159], v[80:83], a[4:7], 0
ds_read_b64_tr_b16 v[64:65], v15 offset:32768
buffer_load_dwordx4 v31, s[20:23], s42 offen offset:3072 sc1 lds
v_mfma_f32_16x16x32_bf16 v[156:159], v[84:87], a[12:15], v[156:159]
ds_read_b64_tr_b16 v[66:67], v15 offset:34816
v_cvt_pk_bf16_f32 v208, v112, v113
v_mfma_f32_16x16x32_bf16 v[156:159], v[88:91], a[20:23], v[156:159]
ds_read_b64_tr_b16 v[68:69], v15 offset:36864
v_cvt_pk_bf16_f32 v209, v114, v115
v_mfma_f32_16x16x32_bf16 v[156:159], v[92:95], a[28:31], v[156:159]
ds_read_b64_tr_b16 v[70:71], v15 offset:38912
v_cvt_pk_bf16_f32 v210, v120, v121
v_mfma_f32_16x16x32_bf16 v[152:155], v[92:95], a[24:27], 0
ds_read_b64_tr_b16 v[72:73], v15 offset:40960
v_cvt_pk_bf16_f32 v211, v122, v123
v_mfma_f32_16x16x32_bf16 v[152:155], v[88:91], a[16:19], v[152:155]
ds_read_b64_tr_b16 v[74:75], v15 offset:43008
v_mfma_f32_16x16x32_bf16 v[152:155], v[84:87], a[8:11], v[152:155]
ds_read_b64_tr_b16 v[76:77], v15 offset:45056
v_mfma_f32_16x16x32_bf16 v[152:155], v[80:83], a[0:3], v[152:155]
s_waitcnt lgkmcnt(7)
ds_read_b64_tr_b16 v[78:79], v15 offset:47104
v_mfma_f32_16x16x32_bf16 v[160:163], v[96:99], a[0:3], 0
s_add_u32 s42, s90, s93
ds_read_b64_tr_b16 v[80:81], v12 offset:49152
s_add_u32 m0, s41, 114688
v_mfma_f32_16x16x32_bf16 v[160:163], v[100:103], a[8:11], v[160:163]
s_add_u32 s42, s42, 4194304
ds_read_b64_tr_b16 v[82:83], v12 offset:51200
buffer_load_dwordx4 v28, s[20:23], s42 offen sc1 lds
v_mfma_f32_16x16x32_bf16 v[160:163], v[104:107], a[16:19], v[160:163]
ds_read_b64_tr_b16 v[84:85], v12 offset:53248
v_mfma_f32_16x16x32_bf16 v[160:163], v[108:111], a[24:27], v[160:163]
ds_read_b64_tr_b16 v[86:87], v12 offset:55296
v_mfma_f32_16x16x32_bf16 v[164:167], v[108:111], a[28:31], 0
ds_read_b64_tr_b16 v[88:89], v12 offset:57344
buffer_store_dwordx4 v[208:211], v10, s[4:7], s46 offen sc1
v_mfma_f32_16x16x32_bf16 v[164:167], v[104:107], a[20:23], v[164:167]
ds_read_b64_tr_b16 v[90:91], v12 offset:59392
v_cvt_pk_bf16_f32 v212, v116, v117
v_mfma_f32_16x16x32_bf16 v[164:167], v[100:103], a[12:15], v[164:167]
ds_read_b64_tr_b16 v[92:93], v12 offset:61440
v_cvt_pk_bf16_f32 v213, v118, v119
v_mfma_f32_16x16x32_bf16 v[164:167], v[96:99], a[4:7], v[164:167]
s_waitcnt lgkmcnt(7)
ds_read_b64_tr_b16 v[94:95], v12 offset:63488
v_cvt_pk_bf16_f32 v214, v124, v125
v_mfma_f32_16x16x32_bf16 v[172:175], v[64:67], a[4:7], 0
ds_read_b64_tr_b16 v[96:97], v13 offset:49152
buffer_load_dwordx4 v29, s[20:23], s42 offen offset:1024 sc1 lds
v_mfma_f32_16x16x32_bf16 v[172:175], v[68:71], a[12:15], v[172:175]
ds_read_b64_tr_b16 v[98:99], v13 offset:51200
v_cvt_pk_bf16_f32 v215, v126, v127
v_mfma_f32_16x16x32_bf16 v[172:175], v[72:75], a[20:23], v[172:175]
ds_read_b64_tr_b16 v[100:101], v13 offset:53248
v_mfma_f32_16x16x32_bf16 v[172:175], v[76:79], a[28:31], v[172:175]
ds_read_b64_tr_b16 v[102:103], v13 offset:55296
v_mfma_f32_16x16x32_bf16 v[168:171], v[76:79], a[24:27], 0
ds_read_b64_tr_b16 v[104:105], v13 offset:57344
buffer_store_dwordx4 v[212:215], v10, s[4:7], s46 offen offset:1024 sc1
v_mfma_f32_16x16x32_bf16 v[168:171], v[72:75], a[16:19], v[168:171]
ds_read_b64_tr_b16 v[106:107], v13 offset:59392
v_cvt_pk_bf16_f32 v216, v128, v129
v_mfma_f32_16x16x32_bf16 v[168:171], v[68:71], a[8:11], v[168:171]
ds_read_b64_tr_b16 v[108:109], v13 offset:61440
v_cvt_pk_bf16_f32 v217, v130, v131
v_mfma_f32_16x16x32_bf16 v[168:171], v[64:67], a[0:3], v[168:171]
s_waitcnt lgkmcnt(7)
ds_read_b64_tr_b16 v[110:111], v13 offset:63488
v_mfma_f32_16x16x32_bf16 v[144:147], v[80:83], a[32:35], v[144:147]
ds_read_b64_tr_b16 v[64:65], v14 offset:49152
buffer_load_dwordx4 v30, s[20:23], s42 offen offset:2048 sc1 lds
v_mfma_f32_16x16x32_bf16 v[144:147], v[84:87], a[40:43], v[144:147]
ds_read_b64_tr_b16 v[66:67], v14 offset:51200
v_cvt_pk_bf16_f32 v218, v136, v137
v_mfma_f32_16x16x32_bf16 v[144:147], v[88:91], a[48:51], v[144:147]
ds_read_b64_tr_b16 v[68:69], v14 offset:53248
v_cvt_pk_bf16_f32 v219, v138, v139
v_mfma_f32_16x16x32_bf16 v[144:147], v[92:95], a[56:59], v[144:147]
ds_read_b64_tr_b16 v[70:71], v14 offset:55296
v_mfma_f32_16x16x32_bf16 v[148:151], v[92:95], a[60:63], v[148:151]
ds_read_b64_tr_b16 v[72:73], v14 offset:57344
buffer_store_dwordx4 v[216:219], v10, s[4:7], s46 offen offset:2048 sc1
v_mfma_f32_16x16x32_bf16 v[148:151], v[88:91], a[52:55], v[148:151]
ds_read_b64_tr_b16 v[74:75], v14 offset:59392
v_cvt_pk_bf16_f32 v220, v132, v133
v_mfma_f32_16x16x32_bf16 v[148:151], v[84:87], a[44:47], v[148:151]
ds_read_b64_tr_b16 v[76:77], v14 offset:61440
v_mfma_f32_16x16x32_bf16 v[148:151], v[80:83], a[36:39], v[148:151]
s_waitcnt lgkmcnt(7)
ds_read_b64_tr_b16 v[78:79], v14 offset:63488
v_mfma_f32_16x16x32_bf16 v[156:159], v[96:99], a[36:39], v[156:159]
ds_read_b64_tr_b16 v[80:81], v15 offset:49152
buffer_load_dwordx4 v31, s[20:23], s42 offen offset:3072 sc1 lds
v_mfma_f32_16x16x32_bf16 v[156:159], v[100:103], a[44:47], v[156:159]
ds_read_b64_tr_b16 v[82:83], v15 offset:51200
v_cvt_pk_bf16_f32 v221, v134, v135
v_mfma_f32_16x16x32_bf16 v[156:159], v[104:107], a[52:55], v[156:159]
ds_read_b64_tr_b16 v[84:85], v15 offset:53248
v_cvt_pk_bf16_f32 v222, v140, v141
v_mfma_f32_16x16x32_bf16 v[156:159], v[108:111], a[60:63], v[156:159]
ds_read_b64_tr_b16 v[86:87], v15 offset:55296
v_cvt_pk_bf16_f32 v223, v142, v143
v_mfma_f32_16x16x32_bf16 v[152:155], v[108:111], a[56:59], v[152:155]
ds_read_b64_tr_b16 v[88:89], v15 offset:57344
buffer_store_dwordx4 v[220:223], v10, s[4:7], s46 offen offset:3072 sc1
v_mfma_f32_16x16x32_bf16 v[152:155], v[104:107], a[48:51], v[152:155]
ds_read_b64_tr_b16 v[90:91], v15 offset:59392
v_mfma_f32_16x16x32_bf16 v[152:155], v[100:103], a[40:43], v[152:155]
ds_read_b64_tr_b16 v[92:93], v15 offset:61440
v_mfma_f32_16x16x32_bf16 v[152:155], v[96:99], a[32:35], v[152:155]
s_waitcnt vmcnt(14) lgkmcnt(7)
s_barrier
ds_read_b64_tr_b16 v[94:95], v15 offset:63488
v_mfma_f32_16x16x32_bf16 v[160:163], v[64:67], a[32:35], v[160:163]
s_lshl_b32 s42, s94, 5
ds_read_b64_tr_b16 v[96:97], v16 offset:0
s_sub_u32 s42, s90, s42
v_mfma_f32_16x16x32_bf16 v[160:163], v[68:71], a[40:43], v[160:163]
s_add_u32 m0, s41, 0
ds_read_b64_tr_b16 v[98:99], v16 offset:2048
s_add_u32 s42, s42, 6291456
v_mfma_f32_16x16x32_bf16 v[160:163], v[72:75], a[48:51], v[160:163]
ds_read_b64_tr_b16 v[100:101], v16 offset:4096
buffer_load_dwordx4 v28, s[20:23], s42 offen sc1 lds
v_mfma_f32_16x16x32_bf16 v[160:163], v[76:79], a[56:59], v[160:163]
ds_read_b64_tr_b16 v[102:103], v16 offset:6144
v_mfma_f32_16x16x32_bf16 v[164:167], v[76:79], a[60:63], v[164:167]
ds_read_b64_tr_b16 v[104:105], v16 offset:8192
v_mfma_f32_16x16x32_bf16 v[164:167], v[72:75], a[52:55], v[164:167]
ds_read_b64_tr_b16 v[106:107], v16 offset:10240
v_mfma_f32_16x16x32_bf16 v[164:167], v[68:71], a[44:47], v[164:167]
ds_read_b64_tr_b16 v[108:109], v16 offset:12288
v_mfma_f32_16x16x32_bf16 v[164:167], v[64:67], a[36:39], v[164:167]
s_waitcnt lgkmcnt(7)
ds_read_b64_tr_b16 v[110:111], v16 offset:14336
v_mfma_f32_16x16x32_bf16 v[172:175], v[80:83], a[36:39], v[172:175]
ds_read_b64_tr_b16 v[64:65], v17 offset:0
buffer_load_dwordx4 v29, s[20:23], s42 offen offset:1024 sc1 lds
v_mfma_f32_16x16x32_bf16 v[172:175], v[84:87], a[44:47], v[172:175]
ds_read_b64_tr_b16 v[66:67], v17 offset:2048
v_mfma_f32_16x16x32_bf16 v[172:175], v[88:91], a[52:55], v[172:175]
ds_read_b64_tr_b16 v[68:69], v17 offset:4096
v_mfma_f32_16x16x32_bf16 v[172:175], v[92:95], a[60:63], v[172:175]
ds_read_b64_tr_b16 v[70:71], v17 offset:6144
v_mfma_f32_16x16x32_bf16 v[168:171], v[92:95], a[56:59], v[168:171]
ds_read_b64_tr_b16 v[72:73], v17 offset:8192
v_mfma_f32_16x16x32_bf16 v[168:171], v[88:91], a[48:51], v[168:171]
ds_read_b64_tr_b16 v[74:75], v17 offset:10240
v_mfma_f32_16x16x32_bf16 v[168:171], v[84:87], a[40:43], v[168:171]
ds_read_b64_tr_b16 v[76:77], v17 offset:12288
v_mfma_f32_16x16x32_bf16 v[168:171], v[80:83], a[32:35], v[168:171]
s_waitcnt lgkmcnt(7)
ds_read_b64_tr_b16 v[78:79], v17 offset:14336
v_mfma_f32_16x16x32_bf16 v[144:147], v[96:99], a[64:67], v[144:147]
ds_read_b64_tr_b16 v[80:81], v18 offset:0
buffer_load_dwordx4 v30, s[20:23], s42 offen offset:2048 sc1 lds
v_mfma_f32_16x16x32_bf16 v[144:147], v[100:103], a[72:75], v[144:147]
ds_read_b64_tr_b16 v[82:83], v18 offset:2048
v_mov_b32 v48, 0
v_mfma_f32_16x16x32_bf16 v[144:147], v[104:107], a[80:83], v[144:147]
ds_read_b64_tr_b16 v[84:85], v18 offset:4096
v_mov_b32 v49, 0
v_mfma_f32_16x16x32_bf16 v[144:147], v[108:111], a[88:91], v[144:147]
ds_read_b64_tr_b16 v[86:87], v18 offset:6144
v_mfma_f32_16x16x32_bf16 v[148:151], v[108:111], a[92:95], v[148:151]
ds_read_b64_tr_b16 v[88:89], v18 offset:8192
v_mfma_f32_16x16x32_bf16 v[148:151], v[104:107], a[84:87], v[148:151]
ds_read_b64_tr_b16 v[90:91], v18 offset:10240
v_mfma_f32_16x16x32_bf16 v[148:151], v[100:103], a[76:79], v[148:151]
ds_read_b64_tr_b16 v[92:93], v18 offset:12288
v_mfma_f32_16x16x32_bf16 v[148:151], v[96:99], a[68:71], v[148:151]
s_waitcnt lgkmcnt(7)
ds_read_b64_tr_b16 v[94:95], v18 offset:14336
v_mfma_f32_16x16x32_bf16 v[156:159], v[64:67], a[68:71], v[156:159]
ds_read_b64_tr_b16 v[96:97], v19 offset:0
buffer_load_dwordx4 v31, s[20:23], s42 offen offset:3072 sc1 lds
v_mfma_f32_16x16x32_bf16 v[156:159], v[68:71], a[76:79], v[156:159]
ds_read_b64_tr_b16 v[98:99], v19 offset:2048
v_mov_b32 v52, 0
v_mfma_f32_16x16x32_bf16 v[156:159], v[72:75], a[84:87], v[156:159]
ds_read_b64_tr_b16 v[100:101], v19 offset:4096
v_mov_b32 v53, 0
v_mfma_f32_16x16x32_bf16 v[156:159], v[76:79], a[92:95], v[156:159]
ds_read_b64_tr_b16 v[102:103], v19 offset:6144
v_mfma_f32_16x16x32_bf16 v[152:155], v[76:79], a[88:91], v[152:155]
ds_read_b64_tr_b16 v[104:105], v19 offset:8192
v_mfma_f32_16x16x32_bf16 v[152:155], v[72:75], a[80:83], v[152:155]
ds_read_b64_tr_b16 v[106:107], v19 offset:10240
v_mfma_f32_16x16x32_bf16 v[152:155], v[68:71], a[72:75], v[152:155]
ds_read_b64_tr_b16 v[108:109], v19 offset:12288
v_mfma_f32_16x16x32_bf16 v[152:155], v[64:67], a[64:67], v[152:155]
s_waitcnt lgkmcnt(7)
ds_read_b64_tr_b16 v[110:111], v19 offset:14336
v_mfma_f32_16x16x32_bf16 v[160:163], v[80:83], a[64:67], v[160:163]
s_xor_b64 s[20:21], s[20:21], s[66:67]
ds_read_b64_tr_b16 v[64:65], v16 offset:16384
s_add_u32 m0, s41, 16384
v_mfma_f32_16x16x32_bf16 v[160:163], v[84:87], a[72:75], v[160:163]
s_add_u32 s42, s91, s92
ds_read_b64_tr_b16 v[66:67], v16 offset:18432
buffer_load_dwordx4 v28, s[20:23], s42 offen sc1 lds
v_mfma_f32_16x16x32_bf16 v[160:163], v[88:91], a[80:83], v[160:163]
ds_read_b64_tr_b16 v[68:69], v16 offset:20480
v_mov_b32 v54, 0x3f80
v_mfma_f32_16x16x32_bf16 v[160:163], v[92:95], a[88:91], v[160:163]
ds_read_b64_tr_b16 v[70:71], v16 offset:22528
v_mov_b32 v55, 0x3f800000
v_mfma_f32_16x16x32_bf16 v[164:167], v[92:95], a[92:95], v[164:167]
ds_read_b64_tr_b16 v[72:73], v16 offset:24576
v_mfma_f32_16x16x32_bf16 v[164:167], v[88:91], a[84:87], v[164:167]
ds_read_b64_tr_b16 v[74:75], v16 offset:26624
v_mfma_f32_16x16x32_bf16 v[164:167], v[84:87], a[76:79], v[164:167]
ds_read_b64_tr_b16 v[76:77], v16 offset:28672
v_mfma_f32_16x16x32_bf16 v[164:167], v[80:83], a[68:71], v[164:167]
s_waitcnt lgkmcnt(7)
ds_read_b64_tr_b16 v[78:79], v16 offset:30720
v_mfma_f32_16x16x32_bf16 v[172:175], v[96:99], a[68:71], v[172:175]
ds_read_b64_tr_b16 v[80:81], v17 offset:16384
buffer_load_dwordx4 v29, s[20:23], s42 offen offset:1024 sc1 lds
v_mfma_f32_16x16x32_bf16 v[172:175], v[100:103], a[76:79], v[172:175]
ds_read_b64_tr_b16 v[82:83], v17 offset:18432
v_cndmask_b32 v50, v54, v55, s[80:81]
v_mfma_f32_16x16x32_bf16 v[172:175], v[104:107], a[84:87], v[172:175]
ds_read_b64_tr_b16 v[84:85], v17 offset:20480
v_cndmask_b32 v51, v48, v54, s[82:83]
v_mfma_f32_16x16x32_bf16 v[172:175], v[108:111], a[92:95], v[172:175]
ds_read_b64_tr_b16 v[86:87], v17 offset:22528
v_mfma_f32_16x16x32_bf16 v[168:171], v[108:111], a[88:91], v[168:171]
ds_read_b64_tr_b16 v[88:89], v17 offset:24576
v_mfma_f32_16x16x32_bf16 v[168:171], v[104:107], a[80:83], v[168:171]
ds_read_b64_tr_b16 v[90:91], v17 offset:26624
v_mfma_f32_16x16x32_bf16 v[168:171], v[100:103], a[72:75], v[168:171]
ds_read_b64_tr_b16 v[92:93], v17 offset:28672
v_mfma_f32_16x16x32_bf16 v[168:171], v[96:99], a[64:67], v[168:171]
s_waitcnt lgkmcnt(7)
ds_read_b64_tr_b16 v[94:95], v17 offset:30720
v_mfma_f32_16x16x32_bf16 v[144:147], v[64:67], a[96:99], v[144:147]
ds_read_b64_tr_b16 v[96:97], v18 offset:16384
buffer_load_dwordx4 v30, s[20:23], s42 offen offset:2048 sc1 lds
v_mfma_f32_16x16x32_bf16 v[144:147], v[68:71], a[104:107], v[144:147]
ds_read_b64_tr_b16 v[98:99], v18 offset:18432
v_cndmask_b32 v50, v50, v48, s[82:83]
v_mfma_f32_16x16x32_bf16 v[144:147], v[72:75], a[112:115], v[144:147]
ds_read_b64_tr_b16 v[100:101], v18 offset:20480
v_cndmask_b32 v51, v51, v55, s[84:85]
v_mfma_f32_16x16x32_bf16 v[144:147], v[76:79], a[120:123], v[144:147]
ds_read_b64_tr_b16 v[102:103], v18 offset:22528
v_mfma_f32_16x16x32_bf16 v[148:151], v[76:79], a[124:127], v[148:151]
ds_read_b64_tr_b16 v[104:105], v18 offset:24576
v_mfma_f32_16x16x32_bf16 v[148:151], v[72:75], a[116:119], v[148:151]
ds_read_b64_tr_b16 v[106:107], v18 offset:26624
v_mfma_f32_16x16x32_bf16 v[148:151], v[68:71], a[108:111], v[148:151]
ds_read_b64_tr_b16 v[108:109], v18 offset:28672
v_mfma_f32_16x16x32_bf16 v[148:151], v[64:67], a[100:103], v[148:151]
s_waitcnt lgkmcnt(7)
ds_read_b64_tr_b16 v[110:111], v18 offset:30720
v_mfma_f32_16x16x32_bf16 v[156:159], v[80:83], a[100:103], v[156:159]
ds_read_b64_tr_b16 v[64:65], v19 offset:16384
buffer_load_dwordx4 v31, s[20:23], s42 offen offset:3072 sc1 lds
v_mfma_f32_16x16x32_bf16 v[156:159], v[84:87], a[108:111], v[156:159]
ds_read_b64_tr_b16 v[66:67], v19 offset:18432
v_cndmask_b32 v50, v50, v48, s[84:85]
v_mfma_f32_16x16x32_bf16 v[156:159], v[88:91], a[116:119], v[156:159]
ds_read_b64_tr_b16 v[68:69], v19 offset:20480
v_cmp_gt_u32 vcc, 0x1000, v9
v_mfma_f32_16x16x32_bf16 v[156:159], v[92:95], a[124:127], v[156:159]
s_nop 1
ds_read_b64_tr_b16 v[70:71], v19 offset:22528
v_cndmask_b32 v50, v48, v50, vcc
v_mfma_f32_16x16x32_bf16 v[152:155], v[92:95], a[120:123], v[152:155]
ds_read_b64_tr_b16 v[72:73], v19 offset:24576
v_cndmask_b32 v51, v48, v51, vcc
v_mfma_f32_16x16x32_bf16 v[152:155], v[88:91], a[112:115], v[152:155]
ds_read_b64_tr_b16 v[74:75], v19 offset:26624
v_mfma_f32_16x16x32_bf16 v[152:155], v[84:87], a[104:107], v[152:155]
ds_read_b64_tr_b16 v[76:77], v19 offset:28672
v_mfma_f32_16x16x32_bf16 v[152:155], v[80:83], a[96:99], v[152:155]
s_waitcnt vmcnt(9) lgkmcnt(7)
s_barrier
ds_read_b64_tr_b16 v[78:79], v19 offset:30720
v_mfma_f32_16x16x32_bf16 v[160:163], v[96:99], a[96:99], v[160:163]
s_add_u32 m0, s41, 32768
ds_read_b64_tr_b16 v[80:81], v16 offset:32768
s_add_u32 s42, s91, s93
v_mfma_f32_16x16x32_bf16 v[160:163], v[100:103], a[104:107], v[160:163]
ds_read_b64_tr_b16 v[82:83], v16 offset:34816
buffer_load_dwordx4 v28, s[20:23], s42 offen sc1 lds
v_mfma_f32_16x16x32_bf16 v[160:163], v[104:107], a[112:115], v[160:163]
ds_read_b64_tr_b16 v[84:85], v16 offset:36864
v_mov_b32 v56, 0x3f803f80
v_mfma_f32_16x16x32_bf16 v[160:163], v[108:111], a[120:123], v[160:163]
ds_read_b64_tr_b16 v[86:87], v16 offset:38912
v_mov_b32 v57, 0x3f803f80
v_mfma_f32_16x16x32_bf16 v[164:167], v[108:111], a[124:127], v[164:167]
ds_read_b64_tr_b16 v[88:89], v16 offset:40960
v_mfma_f32_16x16x32_bf16 v[164:167], v[104:107], a[116:119], v[164:167]
ds_read_b64_tr_b16 v[90:91], v16 offset:43008
v_mfma_f32_16x16x32_bf16 v[164:167], v[100:103], a[108:111], v[164:167]
ds_read_b64_tr_b16 v[92:93], v16 offset:45056
v_mfma_f32_16x16x32_bf16 v[164:167], v[96:99], a[100:103], v[164:167]
s_waitcnt lgkmcnt(7)
ds_read_b64_tr_b16 v[94:95], v16 offset:47104
v_mfma_f32_16x16x32_bf16 v[172:175], v[64:67], a[100:103], v[172:175]
ds_read_b64_tr_b16 v[96:97], v17 offset:32768
buffer_load_dwordx4 v29, s[20:23], s42 offen offset:1024 sc1 lds
v_mfma_f32_16x16x32_bf16 v[172:175], v[68:71], a[108:111], v[172:175]
s_waitcnt vmcnt(10)
ds_read_b64_tr_b16 v[98:99], v17 offset:34816
v_mfma_f32_16x16x32_bf16 v[172:175], v[72:75], a[116:119], v[172:175]
ds_read_b64_tr_b16 v[100:101], v17 offset:36864
buffer_atomic_add v26, v11, s[4:7], s33 offen offset:44 sc1
v_mfma_f32_16x16x32_bf16 v[172:175], v[76:79], a[124:127], v[172:175]
ds_read_b64_tr_b16 v[102:103], v17 offset:38912
v_mov_b32 v58, 0x3f803f80
v_mfma_f32_16x16x32_bf16 v[168:171], v[76:79], a[120:123], v[168:171]
ds_read_b64_tr_b16 v[104:105], v17 offset:40960
v_mov_b32 v59, 0x3f803f80
v_mfma_f32_16x16x32_bf16 v[168:171], v[72:75], a[112:115], v[168:171]
ds_read_b64_tr_b16 v[106:107], v17 offset:43008
buffer_load_dword v3, v4, s[28:31], 0 offen
v_mfma_f32_16x16x32_bf16 v[168:171], v[68:71], a[104:107], v[168:171]
ds_read_b64_tr_b16 v[108:109], v17 offset:45056
v_mfma_f32_16x16x32_bf16 v[168:171], v[64:67], a[96:99], v[168:171]
s_waitcnt lgkmcnt(7)
ds_read_b64_tr_b16 v[110:111], v17 offset:47104
v_mfma_f32_16x16x32_bf16 v[144:147], v[80:83], a[128:131], v[144:147]
ds_read_b64_tr_b16 v[64:65], v18 offset:32768
buffer_load_dwordx4 v30, s[20:23], s42 offen offset:2048 sc1 lds
v_mfma_f32_16x16x32_bf16 v[144:147], v[84:87], a[136:139], v[144:147]
ds_read_b64_tr_b16 v[66:67], v18 offset:34816
v_mfma_f32_16x16x32_bf16 v[144:147], v[88:91], a[144:147], v[144:147]
ds_read_b64_tr_b16 v[68:69], v18 offset:36864
v_mfma_f32_16x16x32_bf16 v[144:147], v[92:95], a[152:155], v[144:147]
ds_read_b64_tr_b16 v[70:71], v18 offset:38912
v_mfma_f32_16x16x32_bf16 v[148:151], v[92:95], a[156:159], v[148:151]
ds_read_b64_tr_b16 v[72:73], v18 offset:40960
v_mfma_f32_16x16x32_bf16 v[148:151], v[88:91], a[148:151], v[148:151]
ds_read_b64_tr_b16 v[74:75], v18 offset:43008
v_mfma_f32_16x16x32_bf16 v[148:151], v[84:87], a[140:143], v[148:151]
ds_read_b64_tr_b16 v[76:77], v18 offset:45056
v_mfma_f32_16x16x32_bf16 v[148:151], v[80:83], a[132:135], v[148:151]
s_waitcnt lgkmcnt(7)
ds_read_b64_tr_b16 v[78:79], v18 offset:47104
v_mfma_f32_16x16x32_bf16 v[156:159], v[96:99], a[132:135], v[156:159]
ds_read_b64_tr_b16 v[80:81], v19 offset:32768
buffer_load_dwordx4 v31, s[20:23], s42 offen offset:3072 sc1 lds
v_mfma_f32_16x16x32_bf16 v[156:159], v[100:103], a[140:143], v[156:159]
ds_read_b64_tr_b16 v[82:83], v19 offset:34816
v_bfe_u32 v120, v1, 4, 4
v_mfma_f32_16x16x32_bf16 v[156:159], v[104:107], a[148:151], v[156:159]
ds_read_b64_tr_b16 v[84:85], v19 offset:36864
v_lshrrev_b32 v121, 9, v1
v_mfma_f32_16x16x32_bf16 v[156:159], v[108:111], a[156:159], v[156:159]
ds_read_b64_tr_b16 v[86:87], v19 offset:38912
v_and_b32 v122, 7, v120
v_mfma_f32_16x16x32_bf16 v[152:155], v[108:111], a[152:155], v[152:155]
ds_read_b64_tr_b16 v[88:89], v19 offset:40960
v_mfma_f32_16x16x32_bf16 v[152:155], v[104:107], a[144:147], v[152:155]
ds_read_b64_tr_b16 v[90:91], v19 offset:43008
v_mfma_f32_16x16x32_bf16 v[152:155], v[100:103], a[136:139], v[152:155]
ds_read_b64_tr_b16 v[92:93], v19 offset:45056
v_mfma_f32_16x16x32_bf16 v[152:155], v[96:99], a[128:131], v[152:155]
s_waitcnt lgkmcnt(7)
ds_read_b64_tr_b16 v[94:95], v19 offset:47104
v_mfma_f32_16x16x32_bf16 v[160:163], v[64:67], a[128:131], v[160:163]
s_add_u32 s42, s91, s92
ds_read_b64_tr_b16 v[96:97], v16 offset:49152
s_add_u32 m0, s41, 49152
v_mfma_f32_16x16x32_bf16 v[160:163], v[68:71], a[136:139], v[160:163]
s_add_u32 s42, s42, 2097152
ds_read_b64_tr_b16 v[98:99], v16 offset:51200
buffer_load_dwordx4 v28, s[20:23], s42 offen sc1 lds
v_mfma_f32_16x16x32_bf16 v[160:163], v[72:75], a[144:147], v[160:163]
ds_read_b64_tr_b16 v[100:101], v16 offset:53248
v_xor_b32 v121, v121, v122
v_mfma_f32_16x16x32_bf16 v[160:163], v[76:79], a[152:155], v[160:163]
ds_read_b64_tr_b16 v[102:103], v16 offset:55296
v_lshlrev_b32 v121, 4, v121
v_mfma_f32_16x16x32_bf16 v[164:167], v[76:79], a[156:159], v[164:167]
ds_read_b64_tr_b16 v[104:105], v16 offset:57344
v_bfe_u32 v122, v1, 8, 1
v_mfma_f32_16x16x32_bf16 v[164:167], v[72:75], a[148:151], v[164:167]
ds_read_b64_tr_b16 v[106:107], v16 offset:59392
v_mfma_f32_16x16x32_bf16 v[164:167], v[68:71], a[140:143], v[164:167]
ds_read_b64_tr_b16 v[108:109], v16 offset:61440
v_mfma_f32_16x16x32_bf16 v[164:167], v[64:67], a[132:135], v[164:167]
s_waitcnt lgkmcnt(7)
ds_read_b64_tr_b16 v[110:111], v16 offset:63488
v_mfma_f32_16x16x32_bf16 v[172:175], v[80:83], a[132:135], v[172:175]
ds_read_b64_tr_b16 v[64:65], v17 offset:49152
buffer_load_dwordx4 v29, s[20:23], s42 offen offset:1024 sc1 lds
v_mfma_f32_16x16x32_bf16 v[172:175], v[84:87], a[140:143], v[172:175]
ds_read_b64_tr_b16 v[66:67], v17 offset:51200
v_lshlrev_b32 v122, 3, v122
v_mfma_f32_16x16x32_bf16 v[172:175], v[88:91], a[148:151], v[172:175]
ds_read_b64_tr_b16 v[68:69], v17 offset:53248
v_lshl_add_u32 v122, v120, 7, v122
v_mfma_f32_16x16x32_bf16 v[172:175], v[92:95], a[156:159], v[172:175]
ds_read_b64_tr_b16 v[70:71], v17 offset:55296
v_add_u32 v122, s87, v122
v_mfma_f32_16x16x32_bf16 v[168:171], v[92:95], a[152:155], v[168:171]
ds_read_b64_tr_b16 v[72:73], v17 offset:57344
v_mfma_f32_16x16x32_bf16 v[168:171], v[88:91], a[144:147], v[168:171]
ds_read_b64_tr_b16 v[74:75], v17 offset:59392
v_mfma_f32_16x16x32_bf16 v[168:171], v[84:87], a[136:139], v[168:171]
ds_read_b64_tr_b16 v[76:77], v17 offset:61440
v_mfma_f32_16x16x32_bf16 v[168:171], v[80:83], a[128:131], v[168:171]
s_waitcnt lgkmcnt(7)
ds_read_b64_tr_b16 v[78:79], v17 offset:63488
v_mfma_f32_16x16x32_bf16 v[144:147], v[96:99], a[160:163], v[144:147]
ds_read_b64_tr_b16 v[80:81], v18 offset:49152
buffer_load_dwordx4 v30, s[20:23], s42 offen offset:2048 sc1 lds
v_mfma_f32_16x16x32_bf16 v[144:147], v[100:103], a[168:171], v[144:147]
ds_read_b64_tr_b16 v[82:83], v18 offset:51200
v_xor_b32 v123, 0, v121
v_mfma_f32_16x16x32_bf16 v[144:147], v[104:107], a[176:179], v[144:147]
ds_read_b64_tr_b16 v[84:85], v18 offset:53248
v_add_u32 v112, v123, v122
v_mfma_f32_16x16x32_bf16 v[144:147], v[108:111], a[184:187], v[144:147]
ds_read_b64_tr_b16 v[86:87], v18 offset:55296
v_xor_b32 v123, 32, v121
v_mfma_f32_16x16x32_bf16 v[148:151], v[108:111], a[188:191], v[148:151]
ds_read_b64_tr_b16 v[88:89], v18 offset:57344
v_mfma_f32_16x16x32_bf16 v[148:151], v[104:107], a[180:183], v[148:151]
ds_read_b64_tr_b16 v[90:91], v18 offset:59392
v_mfma_f32_16x16x32_bf16 v[148:151], v[100:103], a[172:175], v[148:151]
ds_read_b64_tr_b16 v[92:93], v18 offset:61440
v_mfma_f32_16x16x32_bf16 v[148:151], v[96:99], a[164:167], v[148:151]
s_waitcnt lgkmcnt(7)
ds_read_b64_tr_b16 v[94:95], v18 offset:63488
v_mfma_f32_16x16x32_bf16 v[156:159], v[64:67], a[164:167], v[156:159]
ds_read_b64_tr_b16 v[96:97], v19 offset:49152
buffer_load_dwordx4 v31, s[20:23], s42 offen offset:3072 sc1 lds
v_mfma_f32_16x16x32_bf16 v[156:159], v[68:71], a[172:175], v[156:159]
ds_read_b64_tr_b16 v[98:99], v19 offset:51200
v_add_u32 v113, v123, v122
v_mfma_f32_16x16x32_bf16 v[156:159], v[72:75], a[180:183], v[156:159]
ds_read_b64_tr_b16 v[100:101], v19 offset:53248
v_xor_b32 v123, 64, v121
v_mfma_f32_16x16x32_bf16 v[156:159], v[76:79], a[188:191], v[156:159]
ds_read_b64_tr_b16 v[102:103], v19 offset:55296
v_add_u32 v114, v123, v122
v_mfma_f32_16x16x32_bf16 v[152:155], v[76:79], a[184:187], v[152:155]
ds_read_b64_tr_b16 v[104:105], v19 offset:57344
v_mfma_f32_16x16x32_bf16 v[152:155], v[72:75], a[176:179], v[152:155]
ds_read_b64_tr_b16 v[106:107], v19 offset:59392
v_mfma_f32_16x16x32_bf16 v[152:155], v[68:71], a[168:171], v[152:155]
ds_read_b64_tr_b16 v[108:109], v19 offset:61440
v_mfma_f32_16x16x32_bf16 v[152:155], v[64:67], a[160:163], v[152:155]
s_waitcnt vmcnt(10) lgkmcnt(7)
s_barrier
ds_read_b64_tr_b16 v[110:111], v19 offset:63488
v_mfma_f32_16x16x32_bf16 v[160:163], v[80:83], a[160:163], v[160:163]
s_add_u32 s42, s91, s93
ds_read_b64_tr_b16 v[64:65], v12 offset:0
s_add_u32 m0, s41, 65536
v_mfma_f32_16x16x32_bf16 v[160:163], v[84:87], a[168:171], v[160:163]
s_add_u32 s42, s42, 2097152
ds_read_b64_tr_b16 v[66:67], v12 offset:2048
buffer_load_dwordx4 v28, s[20:23], s42 offen sc1 lds
v_mfma_f32_16x16x32_bf16 v[160:163], v[88:91], a[176:179], v[160:163]
ds_read_b64_tr_b16 v[68:69], v12 offset:4096
v_xor_b32 v123, 96, v121
v_mfma_f32_16x16x32_bf16 v[160:163], v[92:95], a[184:187], v[160:163]
ds_read_b64_tr_b16 v[70:71], v12 offset:6144
v_add_u32 v115, v123, v122
v_mfma_f32_16x16x32_bf16 v[164:167], v[92:95], a[188:191], v[164:167]
ds_read_b64_tr_b16 v[72:73], v12 offset:8192
v_add_u32 v116, s87, v1
v_mfma_f32_16x16x32_bf16 v[164:167], v[88:91], a[180:183], v[164:167]
ds_read_b64_tr_b16 v[74:75], v12 offset:10240
v_mfma_f32_16x16x32_bf16 v[164:167], v[84:87], a[172:175], v[164:167]
ds_read_b64_tr_b16 v[76:77], v12 offset:12288
v_mfma_f32_16x16x32_bf16 v[164:167], v[80:83], a[164:167], v[164:167]
s_waitcnt lgkmcnt(7)
ds_read_b64_tr_b16 v[78:79], v12 offset:14336
v_mfma_f32_16x16x32_bf16 v[172:175], v[96:99], a[164:167], v[172:175]
ds_read_b64_tr_b16 v[80:81], v13 offset:0
buffer_load_dwordx4 v29, s[20:23], s42 offen offset:1024 sc1 lds
v_mfma_f32_16x16x32_bf16 v[172:175], v[100:103], a[172:175], v[172:175]
ds_read_b64_tr_b16 v[82:83], v13 offset:2048
v_lshrrev_b32 v120, 7, v1
v_mfma_f32_16x16x32_bf16 v[172:175], v[104:107], a[180:183], v[172:175]
ds_read_b64_tr_b16 v[84:85], v13 offset:4096
v_bfe_u32 v121, v1, 4, 3
v_mfma_f32_16x16x32_bf16 v[172:175], v[108:111], a[188:191], v[172:175]
ds_read_b64_tr_b16 v[86:87], v13 offset:6144
v_xor_b32 v121, v121, v120
v_mfma_f32_16x16x32_bf16 v[168:171], v[108:111], a[184:187], v[168:171]
ds_read_b64_tr_b16 v[88:89], v13 offset:8192
v_mfma_f32_16x16x32_bf16 v[168:171], v[104:107], a[176:179], v[168:171]
ds_read_b64_tr_b16 v[90:91], v13 offset:10240
v_mfma_f32_16x16x32_bf16 v[168:171], v[100:103], a[168:171], v[168:171]
ds_read_b64_tr_b16 v[92:93], v13 offset:12288
v_mfma_f32_16x16x32_bf16 v[168:171], v[96:99], a[160:163], v[168:171]
s_waitcnt lgkmcnt(7)
ds_read_b64_tr_b16 v[94:95], v13 offset:14336
v_mfma_f32_16x16x32_bf16 v[144:147], v[64:67], a[192:195], v[144:147]
ds_read_b64_tr_b16 v[96:97], v14 offset:0
buffer_load_dwordx4 v30, s[20:23], s42 offen offset:2048 sc1 lds
v_mfma_f32_16x16x32_bf16 v[144:147], v[68:71], a[200:203], v[144:147]
ds_read_b64_tr_b16 v[98:99], v14 offset:2048
v_mov_b32 v25, 0
v_mfma_f32_16x16x32_bf16 v[144:147], v[72:75], a[208:211], v[144:147]
ds_read_b64_tr_b16 v[100:101], v14 offset:4096
v_mfma_f32_16x16x32_bf16 v[144:147], v[76:79], a[216:219], v[144:147]
ds_read_b64_tr_b16 v[102:103], v14 offset:6144
v_mfma_f32_16x16x32_bf16 v[148:151], v[76:79], a[220:223], v[148:151]
ds_read_b64_tr_b16 v[104:105], v14 offset:8192
buffer_atomic_add v25, v11, s[4:7], s33 offen offset:44 sc0 sc1
v_mfma_f32_16x16x32_bf16 v[148:151], v[72:75], a[212:215], v[148:151]
ds_read_b64_tr_b16 v[106:107], v14 offset:10240
v_lshlrev_b32 v121, 4, v121
v_mfma_f32_16x16x32_bf16 v[148:151], v[68:71], a[204:207], v[148:151]
ds_read_b64_tr_b16 v[108:109], v14 offset:12288
v_lshl_add_u32 v117, v120, 11, v121
v_mfma_f32_16x16x32_bf16 v[148:151], v[64:67], a[196:199], v[148:151]
s_waitcnt lgkmcnt(7)
ds_read_b64_tr_b16 v[110:111], v14 offset:14336
v_mfma_f32_16x16x32_bf16 v[156:159], v[80:83], a[196:199], v[156:159]
ds_read_b64_tr_b16 v[64:65], v15 offset:0
buffer_load_dwordx4 v31, s[20:23], s42 offen offset:3072 sc1 lds
v_mfma_f32_16x16x32_bf16 v[156:159], v[84:87], a[204:207], v[156:159]
ds_read_b64_tr_b16 v[66:67], v15 offset:2048
v_mfma_f32_16x16x32_bf16 v[156:159], v[88:91], a[212:215], v[156:159]
ds_read_b64_tr_b16 v[68:69], v15 offset:4096
v_mfma_f32_16x16x32_bf16 v[156:159], v[92:95], a[220:223], v[156:159]
ds_read_b64_tr_b16 v[70:71], v15 offset:6144
v_mfma_f32_16x16x32_bf16 v[152:155], v[92:95], a[216:219], v[152:155]
ds_read_b64_tr_b16 v[72:73], v15 offset:8192
v_mfma_f32_16x16x32_bf16 v[152:155], v[88:91], a[208:211], v[152:155]
ds_read_b64_tr_b16 v[74:75], v15 offset:10240
v_mfma_f32_16x16x32_bf16 v[152:155], v[84:87], a[200:203], v[152:155]
ds_read_b64_tr_b16 v[76:77], v15 offset:12288
v_mfma_f32_16x16x32_bf16 v[152:155], v[80:83], a[192:195], v[152:155]
s_waitcnt lgkmcnt(7)
ds_read_b64_tr_b16 v[78:79], v15 offset:14336
v_mfma_f32_16x16x32_bf16 v[160:163], v[96:99], a[192:195], v[160:163]
s_add_u32 s42, s91, s92
ds_read_b64_tr_b16 v[80:81], v12 offset:16384
s_add_u32 m0, s41, 81920
v_mfma_f32_16x16x32_bf16 v[160:163], v[100:103], a[200:203], v[160:163]
s_branch Lso19
Lst19:
s_setpc_b64 s[42:43]
Lso19:
s_add_u32 s42, s42, 4194304
ds_read_b64_tr_b16 v[82:83], v12 offset:18432
buffer_load_dwordx4 v28, s[20:23], s42 offen sc1 lds
v_mfma_f32_16x16x32_bf16 v[160:163], v[104:107], a[208:211], v[160:163]
s_xor_b32 s46, s38, 4
ds_read_b64_tr_b16 v[84:85], v12 offset:20480
s_mul_i32 s46, s46, 12288
v_mfma_f32_16x16x32_bf16 v[160:163], v[108:111], a[216:219], v[160:163]
s_add_u32 s46, s46, s95
ds_read_b64_tr_b16 v[86:87], v12 offset:22528
s_add_u32 s46, s46, 8192
v_mfma_f32_16x16x32_bf16 v[164:167], v[108:111], a[220:223], v[164:167]
ds_read_b64_tr_b16 v[88:89], v12 offset:24576
v_cvt_pk_bf16_f32 v208, v144, v145
v_mfma_f32_16x16x32_bf16 v[164:167], v[104:107], a[212:215], v[164:167]
ds_read_b64_tr_b16 v[90:91], v12 offset:26624
v_cvt_pk_bf16_f32 v209, v146, v147
v_mfma_f32_16x16x32_bf16 v[164:167], v[100:103], a[204:207], v[164:167]
ds_read_b64_tr_b16 v[92:93], v12 offset:28672
v_cvt_pk_bf16_f32 v210, v152, v153
v_mfma_f32_16x16x32_bf16 v[164:167], v[96:99], a[196:199], v[164:167]
s_waitcnt lgkmcnt(7)
ds_read_b64_tr_b16 v[94:95], v12 offset:30720
v_mfma_f32_16x16x32_bf16 v[172:175], v[64:67], a[196:199], v[172:175]
ds_read_b64_tr_b16 v[96:97], v13 offset:16384
buffer_load_dwordx4 v29, s[20:23], s42 offen offset:1024 sc1 lds
v_mfma_f32_16x16x32_bf16 v[172:175], v[68:71], a[204:207], v[172:175]
ds_read_b64_tr_b16 v[98:99], v13 offset:18432
v_cvt_pk_bf16_f32 v211, v154, v155
v_mfma_f32_16x16x32_bf16 v[172:175], v[72:75], a[212:215], v[172:175]
ds_read_b64_tr_b16 v[100:101], v13 offset:20480
buffer_store_dwordx4 v[208:211], v10, s[4:7], s46 offen sc1
v_mfma_f32_16x16x32_bf16 v[172:175], v[76:79], a[220:223], v[172:175]
ds_read_b64_tr_b16 v[102:103], v13 offset:22528
v_cvt_pk_bf16_f32 v212, v148, v149
v_cvt_pk_bf16_f32 v213, v150, v151
v_mfma_f32_16x16x32_bf16 v[168:171], v[76:79], a[216:219], v[168:171]
ds_read_b64_tr_b16 v[104:105], v13 offset:24576
v_cvt_pk_bf16_f32 v214, v156, v157
v_cvt_pk_bf16_f32 v215, v158, v159
v_mfma_f32_16x16x32_bf16 v[168:171], v[72:75], a[208:211], v[168:171]
ds_read_b64_tr_b16 v[106:107], v13 offset:26624
buffer_store_dwordx4 v[212:215], v10, s[4:7], s46 offen offset:1024 sc1
v_mfma_f32_16x16x32_bf16 v[168:171], v[68:71], a[200:203], v[168:171]
ds_read_b64_tr_b16 v[108:109], v13 offset:28672
v_mfma_f32_16x16x32_bf16 v[168:171], v[64:67], a[192:195], v[168:171]
s_waitcnt lgkmcnt(7)
ds_read_b64_tr_b16 v[110:111], v13 offset:30720
v_mfma_f32_16x16x32_bf16 v[176:179], v[80:83], a[0:3], v[176:179]
ds_read_b64_tr_b16 v[64:65], v14 offset:16384
buffer_load_dwordx4 v30, s[20:23], s42 offen offset:2048 sc1 lds
v_mfma_f32_16x16x32_bf16 v[176:179], v[84:87], a[8:11], v[176:179]
ds_read_b64_tr_b16 v[66:67], v14 offset:18432
v_cvt_pk_bf16_f32 v216, v160, v161
v_mfma_f32_16x16x32_bf16 v[176:179], v[88:91], a[16:19], v[176:179]
ds_read_b64_tr_b16 v[68:69], v14 offset:20480
v_cvt_pk_bf16_f32 v217, v162, v163
v_mfma_f32_16x16x32_bf16 v[176:179], v[92:95], a[24:27], v[176:179]
ds_read_b64_tr_b16 v[70:71], v14 offset:22528
v_cvt_pk_bf16_f32 v218, v168, v169
v_mfma_f32_16x16x32_bf16 v[180:183], v[92:95], a[28:31], v[180:183]
ds_read_b64_tr_b16 v[72:73], v14 offset:24576
v_cvt_pk_bf16_f32 v219, v170, v171
v_mfma_f32_16x16x32_bf16 v[180:183], v[88:91], a[20:23], v[180:183]
ds_read_b64_tr_b16 v[74:75], v14 offset:26624
buffer_store_dwordx4 v[216:219], v10, s[4:7], s46 offen offset:2048 sc1
v_mfma_f32_16x16x32_bf16 v[180:183], v[84:87], a[12:15], v[180:183]
ds_read_b64_tr_b16 v[76:77], v14 offset:28672
v_mfma_f32_16x16x32_bf16 v[180:183], v[80:83], a[4:7], v[180:183]
s_waitcnt lgkmcnt(7)
ds_read_b64_tr_b16 v[78:79], v14 offset:30720
v_mfma_f32_16x16x32_bf16 v[188:191], v[96:99], a[4:7], v[188:191]
ds_read_b64_tr_b16 v[80:81], v15 offset:16384
buffer_load_dwordx4 v31, s[20:23], s42 offen offset:3072 sc1 lds
v_mfma_f32_16x16x32_bf16 v[188:191], v[100:103], a[12:15], v[188:191]
ds_read_b64_tr_b16 v[82:83], v15 offset:18432
v_cvt_pk_bf16_f32 v220, v164, v165
v_mfma_f32_16x16x32_bf16 v[188:191], v[104:107], a[20:23], v[188:191]
ds_read_b64_tr_b16 v[84:85], v15 offset:20480
v_cvt_pk_bf16_f32 v221, v166, v167
v_mfma_f32_16x16x32_bf16 v[188:191], v[108:111], a[28:31], v[188:191]
ds_read_b64_tr_b16 v[86:87], v15 offset:22528
v_cvt_pk_bf16_f32 v222, v172, v173
v_mfma_f32_16x16x32_bf16 v[184:187], v[108:111], a[24:27], v[184:187]
ds_read_b64_tr_b16 v[88:89], v15 offset:24576
v_cvt_pk_bf16_f32 v223, v174, v175
v_mfma_f32_16x16x32_bf16 v[184:187], v[104:107], a[16:19], v[184:187]
ds_read_b64_tr_b16 v[90:91], v15 offset:26624
buffer_store_dwordx4 v[220:223], v10, s[4:7], s46 offen offset:3072 sc1
v_mfma_f32_16x16x32_bf16 v[184:187], v[100:103], a[8:11], v[184:187]
ds_read_b64_tr_b16 v[92:93], v15 offset:28672
v_mfma_f32_16x16x32_bf16 v[184:187], v[96:99], a[0:3], v[184:187]
s_waitcnt vmcnt(13) lgkmcnt(7)
s_barrier
ds_read_b64_tr_b16 v[94:95], v15 offset:30720
v_mfma_f32_16x16x32_bf16 v[192:195], v[64:67], a[0:3], v[192:195]
s_add_u32 s42, s91, s93
ds_read_b64_tr_b16 v[96:97], v12 offset:32768
s_add_u32 m0, s41, 98304
v_mfma_f32_16x16x32_bf16 v[192:195], v[68:71], a[8:11], v[192:195]
s_add_u32 s42, s42, 4194304
ds_read_b64_tr_b16 v[98:99], v12 offset:34816
buffer_load_dwordx4 v28, s[20:23], s42 offen sc1 lds
v_mfma_f32_16x16x32_bf16 v[192:195], v[72:75], a[16:19], v[192:195]
ds_read_b64_tr_b16 v[100:101], v12 offset:36864
s_waitcnt vmcnt(10)
v_readfirstlane_b32 s45, v25
s_nop 0
s_cmp_lt_u32 s45, 4
s_cbranch_scc1 Lslow12058
Lback12059:
v_mfma_f32_16x16x32_bf16 v[192:195], v[76:79], a[24:27], v[192:195]
ds_read_b64_tr_b16 v[102:103], v12 offset:38912
v_mfma_f32_16x16x32_bf16 v[196:199], v[76:79], a[28:31], v[196:199]
ds_read_b64_tr_b16 v[104:105], v12 offset:40960
v_mfma_f32_16x16x32_bf16 v[196:199], v[72:75], a[20:23], v[196:199]
ds_read_b64_tr_b16 v[106:107], v12 offset:43008
v_mfma_f32_16x16x32_bf16 v[196:199], v[68:71], a[12:15], v[196:199]
ds_read_b64_tr_b16 v[108:109], v12 offset:45056
v_mfma_f32_16x16x32_bf16 v[196:199], v[64:67], a[4:7], v[196:199]
s_waitcnt lgkmcnt(7)
ds_read_b64_tr_b16 v[110:111], v12 offset:47104
v_mfma_f32_16x16x32_bf16 v[204:207], v[80:83], a[4:7], v[204:207]
ds_read_b64_tr_b16 v[64:65], v13 offset:32768
buffer_load_dwordx4 v29, s[20:23], s42 offen offset:1024 sc1 lds
v_mfma_f32_16x16x32_bf16 v[204:207], v[84:87], a[12:15], v[204:207]
ds_read_b64_tr_b16 v[66:67], v13 offset:34816
v_mfma_f32_16x16x32_bf16 v[204:207], v[88:91], a[20:23], v[204:207]
ds_read_b64_tr_b16 v[68:69], v13 offset:36864
v_mfma_f32_16x16x32_bf16 v[204:207], v[92:95], a[28:31], v[204:207]
ds_read_b64_tr_b16 v[70:71], v13 offset:38912
v_mfma_f32_16x16x32_bf16 v[200:203], v[92:95], a[24:27], v[200:203]
ds_read_b64_tr_b16 v[72:73], v13 offset:40960
v_mfma_f32_16x16x32_bf16 v[200:203], v[88:91], a[16:19], v[200:203]
ds_read_b64_tr_b16 v[74:75], v13 offset:43008
v_mfma_f32_16x16x32_bf16 v[200:203], v[84:87], a[8:11], v[200:203]
ds_read_b64_tr_b16 v[76:77], v13 offset:45056
v_mfma_f32_16x16x32_bf16 v[200:203], v[80:83], a[0:3], v[200:203]
s_waitcnt lgkmcnt(7)
ds_read_b64_tr_b16 v[78:79], v13 offset:47104
v_mfma_f32_16x16x32_bf16 v[176:179], v[96:99], a[32:35], v[176:179]
ds_read_b64_tr_b16 v[80:81], v14 offset:32768
buffer_load_dwordx4 v30, s[20:23], s42 offen offset:2048 sc1 lds
v_mfma_f32_16x16x32_bf16 v[176:179], v[100:103], a[40:43], v[176:179]
s_mul_i32 s43, s38, 12288
ds_read_b64_tr_b16 v[82:83], v14 offset:34816
s_add_u32 s43, s43, s95
v_mfma_f32_16x16x32_bf16 v[176:179], v[104:107], a[48:51], v[176:179]
ds_read_b64_tr_b16 v[84:85], v14 offset:36864
v_mfma_f32_16x16x32_bf16 v[176:179], v[108:111], a[56:59], v[176:179]
ds_read_b64_tr_b16 v[86:87], v14 offset:38912
v_mfma_f32_16x16x32_bf16 v[180:183], v[108:111], a[60:63], v[180:183]
ds_read_b64_tr_b16 v[88:89], v14 offset:40960
buffer_load_dwordx4 a[224:227], v10, s[4:7], s43 offen sc1
v_mfma_f32_16x16x32_bf16 v[180:183], v[104:107], a[52:55], v[180:183]
ds_read_b64_tr_b16 v[90:91], v14 offset:43008
v_mfma_f32_16x16x32_bf16 v[180:183], v[100:103], a[44:47], v[180:183]
ds_read_b64_tr_b16 v[92:93], v14 offset:45056
v_mfma_f32_16x16x32_bf16 v[180:183], v[96:99], a[36:39], v[180:183]
s_waitcnt lgkmcnt(7)
ds_read_b64_tr_b16 v[94:95], v14 offset:47104
v_mfma_f32_16x16x32_bf16 v[188:191], v[64:67], a[36:39], v[188:191]
ds_read_b64_tr_b16 v[96:97], v15 offset:32768
buffer_load_dwordx4 v31, s[20:23], s42 offen offset:3072 sc1 lds
v_mfma_f32_16x16x32_bf16 v[188:191], v[68:71], a[44:47], v[188:191]
ds_read_b64_tr_b16 v[98:99], v15 offset:34816
v_mfma_f32_16x16x32_bf16 v[188:191], v[72:75], a[52:55], v[188:191]
ds_read_b64_tr_b16 v[100:101], v15 offset:36864
buffer_load_dwordx4 a[228:231], v10, s[4:7], s43 offen offset:1024 sc1
v_mfma_f32_16x16x32_bf16 v[188:191], v[76:79], a[60:63], v[188:191]
ds_read_b64_tr_b16 v[102:103], v15 offset:38912
v_mfma_f32_16x16x32_bf16 v[184:187], v[76:79], a[56:59], v[184:187]
ds_read_b64_tr_b16 v[104:105], v15 offset:40960
buffer_load_dwordx4 a[232:235], v10, s[4:7], s43 offen offset:2048 sc1
v_mfma_f32_16x16x32_bf16 v[184:187], v[72:75], a[48:51], v[184:187]
ds_read_b64_tr_b16 v[106:107], v15 offset:43008
v_mfma_f32_16x16x32_bf16 v[184:187], v[68:71], a[40:43], v[184:187]
ds_read_b64_tr_b16 v[108:109], v15 offset:45056
buffer_load_dwordx4 a[236:239], v10, s[4:7], s43 offen offset:3072 sc1
v_mfma_f32_16x16x32_bf16 v[184:187], v[64:67], a[32:35], v[184:187]
s_waitcnt lgkmcnt(7)
ds_read_b64_tr_b16 v[110:111], v15 offset:47104
v_mfma_f32_16x16x32_bf16 v[192:195], v[80:83], a[32:35], v[192:195]
s_lshl_b32 s42, s94, 5
ds_read_b64_tr_b16 v[64:65], v12 offset:49152
s_sub_u32 s42, s91, s42
v_mfma_f32_16x16x32_bf16 v[192:195], v[84:87], a[40:43], v[192:195]
s_add_u32 m0, s41, 114688
ds_read_b64_tr_b16 v[66:67], v12 offset:51200
s_add_u32 s42, s42, 6291456
v_mfma_f32_16x16x32_bf16 v[192:195], v[88:91], a[48:51], v[192:195]
ds_read_b64_tr_b16 v[68:69], v12 offset:53248
buffer_load_dwordx4 v28, s[20:23], s42 offen sc1 lds
v_mfma_f32_16x16x32_bf16 v[192:195], v[92:95], a[56:59], v[192:195]
s_mul_i32 s43, s38, 12288
ds_read_b64_tr_b16 v[70:71], v12 offset:55296
s_add_u32 s43, s43, s95
v_mfma_f32_16x16x32_bf16 v[196:199], v[92:95], a[60:63], v[196:199]
ds_read_b64_tr_b16 v[72:73], v12 offset:57344
v_mfma_f32_16x16x32_bf16 v[196:199], v[88:91], a[52:55], v[196:199]
ds_read_b64_tr_b16 v[74:75], v12 offset:59392
v_mfma_f32_16x16x32_bf16 v[196:199], v[84:87], a[44:47], v[196:199]
ds_read_b64_tr_b16 v[76:77], v12 offset:61440
v_mfma_f32_16x16x32_bf16 v[196:199], v[80:83], a[36:39], v[196:199]
s_waitcnt lgkmcnt(7)
ds_read_b64_tr_b16 v[78:79], v12 offset:63488
v_mfma_f32_16x16x32_bf16 v[204:207], v[96:99], a[36:39], v[204:207]
ds_read_b64_tr_b16 v[80:81], v13 offset:49152
buffer_load_dwordx4 v29, s[20:23], s42 offen offset:1024 sc1 lds
v_mfma_f32_16x16x32_bf16 v[204:207], v[100:103], a[44:47], v[204:207]
s_add_u32 s43, s43, 4096
ds_read_b64_tr_b16 v[82:83], v13 offset:51200
v_mfma_f32_16x16x32_bf16 v[204:207], v[104:107], a[52:55], v[204:207]
ds_read_b64_tr_b16 v[84:85], v13 offset:53248
buffer_load_dwordx4 a[240:243], v10, s[4:7], s43 offen sc1
v_mfma_f32_16x16x32_bf16 v[204:207], v[108:111], a[60:63], v[204:207]
ds_read_b64_tr_b16 v[86:87], v13 offset:55296
v_mfma_f32_16x16x32_bf16 v[200:203], v[108:111], a[56:59], v[200:203]
ds_read_b64_tr_b16 v[88:89], v13 offset:57344
v_mfma_f32_16x16x32_bf16 v[200:203], v[104:107], a[48:51], v[200:203]
ds_read_b64_tr_b16 v[90:91], v13 offset:59392
buffer_load_dwordx4 a[244:247], v10, s[4:7], s43 offen offset:1024 sc1
v_mfma_f32_16x16x32_bf16 v[200:203], v[100:103], a[40:43], v[200:203]
ds_read_b64_tr_b16 v[92:93], v13 offset:61440
v_mfma_f32_16x16x32_bf16 v[200:203], v[96:99], a[32:35], v[200:203]
s_waitcnt lgkmcnt(7)
ds_read_b64_tr_b16 v[94:95], v13 offset:63488
v_mfma_f32_16x16x32_bf16 v[176:179], v[64:67], a[64:67], v[176:179]
ds_read_b64_tr_b16 v[96:97], v14 offset:49152
buffer_load_dwordx4 v30, s[20:23], s42 offen offset:2048 sc1 lds
v_mfma_f32_16x16x32_bf16 v[176:179], v[68:71], a[72:75], v[176:179]
ds_read_b64_tr_b16 v[98:99], v14 offset:51200
v_mfma_f32_16x16x32_bf16 v[176:179], v[72:75], a[80:83], v[176:179]
ds_read_b64_tr_b16 v[100:101], v14 offset:53248
buffer_load_dwordx4 a[248:251], v10, s[4:7], s43 offen offset:2048 sc1
v_mfma_f32_16x16x32_bf16 v[176:179], v[76:79], a[88:91], v[176:179]
ds_read_b64_tr_b16 v[102:103], v14 offset:55296
v_mfma_f32_16x16x32_bf16 v[180:183], v[76:79], a[92:95], v[180:183]
ds_read_b64_tr_b16 v[104:105], v14 offset:57344
v_mfma_f32_16x16x32_bf16 v[180:183], v[72:75], a[84:87], v[180:183]
ds_read_b64_tr_b16 v[106:107], v14 offset:59392
buffer_load_dwordx4 a[252:255], v10, s[4:7], s43 offen offset:3072 sc1
v_mfma_f32_16x16x32_bf16 v[180:183], v[68:71], a[76:79], v[180:183]
ds_read_b64_tr_b16 v[108:109], v14 offset:61440
v_mfma_f32_16x16x32_bf16 v[180:183], v[64:67], a[68:71], v[180:183]
s_waitcnt lgkmcnt(7)
ds_read_b64_tr_b16 v[110:111], v14 offset:63488
v_mfma_f32_16x16x32_bf16 v[188:191], v[80:83], a[68:71], v[188:191]
ds_read_b64_tr_b16 v[64:65], v15 offset:49152
buffer_load_dwordx4 v31, s[20:23], s42 offen offset:3072 sc1 lds
v_mfma_f32_16x16x32_bf16 v[188:191], v[84:87], a[76:79], v[188:191]
s_waitcnt vmcnt(16)
ds_read_b64_tr_b16 v[66:67], v15 offset:51200
v_mfma_f32_16x16x32_bf16 v[188:191], v[88:91], a[84:87], v[188:191]
ds_read_b64_tr_b16 v[68:69], v15 offset:53248
v_mfma_f32_16x16x32_bf16 v[188:191], v[92:95], a[92:95], v[188:191]
ds_read_b64_tr_b16 v[70:71], v15 offset:55296
v_mfma_f32_16x16x32_bf16 v[184:187], v[92:95], a[88:91], v[184:187]
ds_read_b64_tr_b16 v[72:73], v15 offset:57344
buffer_atomic_add v26, v11, s[4:7], s34 offen offset:48 sc1
v_mfma_f32_16x16x32_bf16 v[184:187], v[88:91], a[80:83], v[184:187]
ds_read_b64_tr_b16 v[74:75], v15 offset:59392
v_mfma_f32_16x16x32_bf16 v[184:187], v[84:87], a[72:75], v[184:187]
ds_read_b64_tr_b16 v[76:77], v15 offset:61440
v_mfma_f32_16x16x32_bf16 v[184:187], v[80:83], a[64:67], v[184:187]
s_waitcnt lgkmcnt(7)
s_barrier
ds_read_b64_tr_b16 v[78:79], v15 offset:63488
v_mfma_f32_16x16x32_bf16 v[192:195], v[96:99], a[64:67], v[192:195]
ds_read_b64_tr_b16 v[80:81], v16 offset:0
v_add_u32 v28, 2048, v20
v_mfma_f32_16x16x32_bf16 v[192:195], v[100:103], a[72:75], v[192:195]
ds_read_b64_tr_b16 v[82:83], v16 offset:2048
v_add_u32 v29, 50176, v20
v_mfma_f32_16x16x32_bf16 v[192:195], v[104:107], a[80:83], v[192:195]
ds_read_b64_tr_b16 v[84:85], v16 offset:4096
v_add_u32 v30, 98304, v20
v_mfma_f32_16x16x32_bf16 v[192:195], v[108:111], a[88:91], v[192:195]
ds_read_b64_tr_b16 v[86:87], v16 offset:6144
v_add_u32 v31, 146432, v20
v_mfma_f32_16x16x32_bf16 v[196:199], v[108:111], a[92:95], v[196:199]
s_add_u32 m0, s41, 0
ds_read_b64_tr_b16 v[88:89], v16 offset:8192
s_mul_i32 s42, s48, 96
v_mfma_f32_16x16x32_bf16 v[196:199], v[104:107], a[84:87], v[196:199]
ds_read_b64_tr_b16 v[90:91], v16 offset:10240
buffer_load_dwordx4 v28, s[8:11], s42 offen sc1 lds
v_mfma_f32_16x16x32_bf16 v[196:199], v[100:103], a[76:79], v[196:199]
ds_read_b64_tr_b16 v[92:93], v16 offset:12288
v_mfma_f32_16x16x32_bf16 v[196:199], v[96:99], a[68:71], v[196:199]
s_waitcnt lgkmcnt(7)
ds_read_b64_tr_b16 v[94:95], v16 offset:14336
v_mfma_f32_16x16x32_bf16 v[204:207], v[64:67], a[68:71], v[204:207]
ds_read_b64_tr_b16 v[96:97], v17 offset:0
buffer_load_dwordx4 v29, s[8:11], s42 offen offset:1024 sc1 lds
v_mfma_f32_16x16x32_bf16 v[204:207], v[68:71], a[76:79], v[204:207]
ds_read_b64_tr_b16 v[98:99], v17 offset:2048
v_mfma_f32_16x16x32_bf16 v[204:207], v[72:75], a[84:87], v[204:207]
ds_read_b64_tr_b16 v[100:101], v17 offset:4096
v_mfma_f32_16x16x32_bf16 v[204:207], v[76:79], a[92:95], v[204:207]
ds_read_b64_tr_b16 v[102:103], v17 offset:6144
v_mfma_f32_16x16x32_bf16 v[200:203], v[76:79], a[88:91], v[200:203]
ds_read_b64_tr_b16 v[104:105], v17 offset:8192
v_mfma_f32_16x16x32_bf16 v[200:203], v[72:75], a[80:83], v[200:203]
ds_read_b64_tr_b16 v[106:107], v17 offset:10240
v_mfma_f32_16x16x32_bf16 v[200:203], v[68:71], a[72:75], v[200:203]
ds_read_b64_tr_b16 v[108:109], v17 offset:12288
v_mfma_f32_16x16x32_bf16 v[200:203], v[64:67], a[64:67], v[200:203]
s_waitcnt lgkmcnt(7)
ds_read_b64_tr_b16 v[110:111], v17 offset:14336
v_mfma_f32_16x16x32_bf16 v[176:179], v[80:83], a[96:99], v[176:179]
ds_read_b64_tr_b16 v[64:65], v18 offset:0
buffer_load_dwordx4 v30, s[8:11], s42 offen offset:2048 sc1 lds
v_mfma_f32_16x16x32_bf16 v[176:179], v[84:87], a[104:107], v[176:179]
s_waitcnt vmcnt(12)
ds_read_b64_tr_b16 v[66:67], v18 offset:2048
v_mfma_f32_16x16x32_bf16 v[176:179], v[50:53], a[224:227], v[176:179]
v_mfma_f32_16x16x32_bf16 v[176:179], v[88:91], a[112:115], v[176:179]
ds_read_b64_tr_b16 v[68:69], v18 offset:4096
v_mfma_f32_16x16x32_bf16 v[180:183], v[50:53], a[228:231], v[180:183]
v_mfma_f32_16x16x32_bf16 v[176:179], v[92:95], a[120:123], v[176:179]
ds_read_b64_tr_b16 v[70:71], v18 offset:6144
v_mfma_f32_16x16x32_bf16 v[180:183], v[92:95], a[124:127], v[180:183]
ds_read_b64_tr_b16 v[72:73], v18 offset:8192
v_mfma_f32_16x16x32_bf16 v[180:183], v[88:91], a[116:119], v[180:183]
ds_read_b64_tr_b16 v[74:75], v18 offset:10240
v_mfma_f32_16x16x32_bf16 v[180:183], v[84:87], a[108:111], v[180:183]
ds_read_b64_tr_b16 v[76:77], v18 offset:12288
v_mfma_f32_16x16x32_bf16 v[180:183], v[80:83], a[100:103], v[180:183]
s_waitcnt lgkmcnt(7)
ds_read_b64_tr_b16 v[78:79], v18 offset:14336
v_mfma_f32_16x16x32_bf16 v[188:191], v[96:99], a[100:103], v[188:191]
ds_read_b64_tr_b16 v[80:81], v19 offset:0
buffer_load_dwordx4 v31, s[8:11], s42 offen offset:3072 sc1 lds
v_mfma_f32_16x16x32_bf16 v[188:191], v[100:103], a[108:111], v[188:191]
ds_read_b64_tr_b16 v[82:83], v19 offset:2048
v_mfma_f32_16x16x32_bf16 v[184:187], v[48:51], a[224:227], v[184:187]
v_mfma_f32_16x16x32_bf16 v[188:191], v[104:107], a[116:119], v[188:191]
ds_read_b64_tr_b16 v[84:85], v19 offset:4096
v_mfma_f32_16x16x32_bf16 v[188:191], v[48:51], a[228:231], v[188:191]
v_mfma_f32_16x16x32_bf16 v[188:191], v[108:111], a[124:127], v[188:191]
ds_read_b64_tr_b16 v[86:87], v19 offset:6144
v_mfma_f32_16x16x32_bf16 v[184:187], v[108:111], a[120:123], v[184:187]
ds_read_b64_tr_b16 v[88:89], v19 offset:8192
v_mfma_f32_16x16x32_bf16 v[184:187], v[104:107], a[112:115], v[184:187]
ds_read_b64_tr_b16 v[90:91], v19 offset:10240
v_mfma_f32_16x16x32_bf16 v[184:187], v[100:103], a[104:107], v[184:187]
ds_read_b64_tr_b16 v[92:93], v19 offset:12288
v_mfma_f32_16x16x32_bf16 v[184:187], v[96:99], a[96:99], v[184:187]
s_waitcnt lgkmcnt(7)
ds_read_b64_tr_b16 v[94:95], v19 offset:14336
v_mfma_f32_16x16x32_bf16 v[192:195], v[64:67], a[96:99], v[192:195]
s_add_u32 m0, s41, 16384
ds_read_b64_tr_b16 v[96:97], v16 offset:16384
s_mul_i32 s42, s49, 96
v_mfma_f32_16x16x32_bf16 v[192:195], v[68:71], a[104:107], v[192:195]
ds_read_b64_tr_b16 v[98:99], v16 offset:18432
buffer_load_dwordx4 v28, s[8:11], s42 offen sc1 lds
v_mfma_f32_16x16x32_bf16 v[192:195], v[72:75], a[112:115], v[192:195]
ds_read_b64_tr_b16 v[100:101], v16 offset:20480
v_mov_b32 v25, 0
v_mfma_f32_16x16x32_bf16 v[192:195], v[76:79], a[120:123], v[192:195]
ds_read_b64_tr_b16 v[102:103], v16 offset:22528
buffer_atomic_add v25, v11, s[4:7], s34 offen offset:48 sc0 sc1
v_mfma_f32_16x16x32_bf16 v[196:199], v[76:79], a[124:127], v[196:199]
ds_read_b64_tr_b16 v[104:105], v16 offset:24576
v_mfma_f32_16x16x32_bf16 v[192:195], v[50:53], a[232:235], v[192:195]
v_mfma_f32_16x16x32_bf16 v[196:199], v[72:75], a[116:119], v[196:199]
ds_read_b64_tr_b16 v[106:107], v16 offset:26624
v_mfma_f32_16x16x32_bf16 v[196:199], v[50:53], a[236:239], v[196:199]
v_mfma_f32_16x16x32_bf16 v[196:199], v[68:71], a[108:111], v[196:199]
ds_read_b64_tr_b16 v[108:109], v16 offset:28672
v_mfma_f32_16x16x32_bf16 v[196:199], v[64:67], a[100:103], v[196:199]
s_waitcnt lgkmcnt(7)
ds_read_b64_tr_b16 v[110:111], v16 offset:30720
v_mfma_f32_16x16x32_bf16 v[204:207], v[80:83], a[100:103], v[204:207]
ds_read_b64_tr_b16 v[64:65], v17 offset:16384
buffer_load_dwordx4 v29, s[8:11], s42 offen offset:1024 sc1 lds
v_mfma_f32_16x16x32_bf16 v[204:207], v[84:87], a[108:111], v[204:207]
ds_read_b64_tr_b16 v[66:67], v17 offset:18432
v_mfma_f32_16x16x32_bf16 v[200:203], v[48:51], a[232:235], v[200:203]
v_mfma_f32_16x16x32_bf16 v[204:207], v[88:91], a[116:119], v[204:207]
ds_read_b64_tr_b16 v[68:69], v17 offset:20480
v_mfma_f32_16x16x32_bf16 v[204:207], v[48:51], a[236:239], v[204:207]
v_mfma_f32_16x16x32_bf16 v[204:207], v[92:95], a[124:127], v[204:207]
ds_read_b64_tr_b16 v[70:71], v17 offset:22528
v_mfma_f32_16x16x32_bf16 v[200:203], v[92:95], a[120:123], v[200:203]
ds_read_b64_tr_b16 v[72:73], v17 offset:24576
v_mfma_f32_16x16x32_bf16 v[200:203], v[88:91], a[112:115], v[200:203]
ds_read_b64_tr_b16 v[74:75], v17 offset:26624
v_mfma_f32_16x16x32_bf16 v[200:203], v[84:87], a[104:107], v[200:203]
ds_read_b64_tr_b16 v[76:77], v17 offset:28672
v_mfma_f32_16x16x32_bf16 v[200:203], v[80:83], a[96:99], v[200:203]
s_waitcnt lgkmcnt(7)
ds_read_b64_tr_b16 v[78:79], v17 offset:30720
v_mfma_f32_16x16x32_bf16 v[176:179], v[96:99], a[128:131], v[176:179]
ds_read_b64_tr_b16 v[80:81], v18 offset:16384
buffer_load_dwordx4 v30, s[8:11], s42 offen offset:2048 sc1 lds
v_mfma_f32_16x16x32_bf16 v[176:179], v[100:103], a[136:139], v[176:179]
s_waitcnt vmcnt(10)
ds_read_b64_tr_b16 v[82:83], v18 offset:18432
v_mfma_f32_16x16x32_bf16 v[176:179], v[50:53], a[240:243], v[176:179]
v_mfma_f32_16x16x32_bf16 v[176:179], v[104:107], a[144:147], v[176:179]
ds_read_b64_tr_b16 v[84:85], v18 offset:20480
v_mfma_f32_16x16x32_bf16 v[180:183], v[50:53], a[244:247], v[180:183]
v_mfma_f32_16x16x32_bf16 v[176:179], v[108:111], a[152:155], v[176:179]
ds_read_b64_tr_b16 v[86:87], v18 offset:22528
v_mfma_f32_16x16x32_bf16 v[180:183], v[108:111], a[156:159], v[180:183]
ds_read_b64_tr_b16 v[88:89], v18 offset:24576
v_mfma_f32_16x16x32_bf16 v[180:183], v[104:107], a[148:151], v[180:183]
ds_read_b64_tr_b16 v[90:91], v18 offset:26624
v_mfma_f32_16x16x32_bf16 v[180:183], v[100:103], a[140:143], v[180:183]
ds_read_b64_tr_b16 v[92:93], v18 offset:28672
v_mfma_f32_16x16x32_bf16 v[180:183], v[96:99], a[132:135], v[180:183]
s_waitcnt lgkmcnt(7)
ds_read_b64_tr_b16 v[94:95], v18 offset:30720
v_mfma_f32_16x16x32_bf16 v[188:191], v[64:67], a[132:135], v[188:191]
ds_read_b64_tr_b16 v[96:97], v19 offset:16384
buffer_load_dwordx4 v31, s[8:11], s42 offen offset:3072 sc1 lds
v_mfma_f32_16x16x32_bf16 v[188:191], v[68:71], a[140:143], v[188:191]
ds_read_b64_tr_b16 v[98:99], v19 offset:18432
v_mfma_f32_16x16x32_bf16 v[184:187], v[48:51], a[240:243], v[184:187]
v_mfma_f32_16x16x32_bf16 v[188:191], v[72:75], a[148:151], v[188:191]
ds_read_b64_tr_b16 v[100:101], v19 offset:20480
v_mfma_f32_16x16x32_bf16 v[188:191], v[48:51], a[244:247], v[188:191]
v_mfma_f32_16x16x32_bf16 v[188:191], v[76:79], a[156:159], v[188:191]
ds_read_b64_tr_b16 v[102:103], v19 offset:22528
v_mfma_f32_16x16x32_bf16 v[184:187], v[76:79], a[152:155], v[184:187]
ds_read_b64_tr_b16 v[104:105], v19 offset:24576
v_mfma_f32_16x16x32_bf16 v[184:187], v[72:75], a[144:147], v[184:187]
ds_read_b64_tr_b16 v[106:107], v19 offset:26624
v_mfma_f32_16x16x32_bf16 v[184:187], v[68:71], a[136:139], v[184:187]
ds_read_b64_tr_b16 v[108:109], v19 offset:28672
v_mfma_f32_16x16x32_bf16 v[184:187], v[64:67], a[128:131], v[184:187]
s_waitcnt vmcnt(10) lgkmcnt(7)
s_barrier
ds_read_b64_tr_b16 v[110:111], v19 offset:30720
v_mfma_f32_16x16x32_bf16 v[192:195], v[80:83], a[128:131], v[192:195]
s_add_u32 m0, s41, 32768
ds_read_b64_tr_b16 v[64:65], v16 offset:32768
s_mul_i32 s42, s50, 96
v_mfma_f32_16x16x32_bf16 v[192:195], v[84:87], a[136:139], v[192:195]
ds_read_b64_tr_b16 v[66:67], v16 offset:34816
buffer_load_dwordx4 v28, s[8:11], s42 offen sc1 lds
v_mfma_f32_16x16x32_bf16 v[192:195], v[88:91], a[144:147], v[192:195]
ds_read_b64_tr_b16 v[68:69], v16 offset:36864
v_mfma_f32_16x16x32_bf16 v[192:195], v[50:53], a[248:251], v[192:195]
v_mfma_f32_16x16x32_bf16 v[192:195], v[92:95], a[152:155], v[192:195]
ds_read_b64_tr_b16 v[70:71], v16 offset:38912
v_mfma_f32_16x16x32_bf16 v[196:199], v[50:53], a[252:255], v[196:199]
v_mfma_f32_16x16x32_bf16 v[196:199], v[92:95], a[156:159], v[196:199]
ds_read_b64_tr_b16 v[72:73], v16 offset:40960
v_mfma_f32_16x16x32_bf16 v[196:199], v[88:91], a[148:151], v[196:199]
ds_read_b64_tr_b16 v[74:75], v16 offset:43008
v_mfma_f32_16x16x32_bf16 v[196:199], v[84:87], a[140:143], v[196:199]
ds_read_b64_tr_b16 v[76:77], v16 offset:45056
v_mfma_f32_16x16x32_bf16 v[196:199], v[80:83], a[132:135], v[196:199]
s_waitcnt lgkmcnt(7)
ds_read_b64_tr_b16 v[78:79], v16 offset:47104
v_mfma_f32_16x16x32_bf16 v[204:207], v[96:99], a[132:135], v[204:207]
ds_read_b64_tr_b16 v[80:81], v17 offset:32768
buffer_load_dwordx4 v29, s[8:11], s42 offen offset:1024 sc1 lds
v_mfma_f32_16x16x32_bf16 v[204:207], v[100:103], a[140:143], v[204:207]
ds_read_b64_tr_b16 v[82:83], v17 offset:34816
v_mfma_f32_16x16x32_bf16 v[200:203], v[48:51], a[248:251], v[200:203]
v_mfma_f32_16x16x32_bf16 v[204:207], v[104:107], a[148:151], v[204:207]
ds_read_b64_tr_b16 v[84:85], v17 offset:36864
v_mfma_f32_16x16x32_bf16 v[204:207], v[48:51], a[252:255], v[204:207]
v_mfma_f32_16x16x32_bf16 v[204:207], v[108:111], a[156:159], v[204:207]
ds_read_b64_tr_b16 v[86:87], v17 offset:38912
v_mfma_f32_16x16x32_bf16 v[200:203], v[108:111], a[152:155], v[200:203]
ds_read_b64_tr_b16 v[88:89], v17 offset:40960
v_mfma_f32_16x16x32_bf16 v[200:203], v[104:107], a[144:147], v[200:203]
ds_read_b64_tr_b16 v[90:91], v17 offset:43008
v_mfma_f32_16x16x32_bf16 v[200:203], v[100:103], a[136:139], v[200:203]
ds_read_b64_tr_b16 v[92:93], v17 offset:45056
v_mfma_f32_16x16x32_bf16 v[200:203], v[96:99], a[128:131], v[200:203]
s_waitcnt lgkmcnt(7)
ds_read_b64_tr_b16 v[94:95], v17 offset:47104
v_mfma_f32_16x16x32_bf16 v[176:179], v[64:67], a[160:163], v[176:179]
ds_read_b64_tr_b16 v[96:97], v18 offset:32768
buffer_load_dwordx4 v30, s[8:11], s42 offen offset:2048 sc1 lds
v_mfma_f32_16x16x32_bf16 v[176:179], v[68:71], a[168:171], v[176:179]
ds_read_b64_tr_b16 v[98:99], v18 offset:34816
s_waitcnt vmcnt(6)
v_readfirstlane_b32 s45, v25
s_nop 0
s_cmp_lt_u32 s45, 2
s_cbranch_scc1 Lslow12060
Lback12061:
v_mfma_f32_16x16x32_bf16 v[176:179], v[72:75], a[176:179], v[176:179]
s_mul_i32 s43, s38, 12288
ds_read_b64_tr_b16 v[100:101], v18 offset:36864
s_add_u32 s43, s43, s95
v_mfma_f32_16x16x32_bf16 v[176:179], v[76:79], a[184:187], v[176:179]
s_add_u32 s43, s43, 8192
ds_read_b64_tr_b16 v[102:103], v18 offset:38912
v_mfma_f32_16x16x32_bf16 v[180:183], v[76:79], a[188:191], v[180:183]
ds_read_b64_tr_b16 v[104:105], v18 offset:40960
buffer_load_dwordx4 a[224:227], v10, s[4:7], s43 offen sc1
v_mfma_f32_16x16x32_bf16 v[180:183], v[72:75], a[180:183], v[180:183]
ds_read_b64_tr_b16 v[106:107], v18 offset:43008
v_mfma_f32_16x16x32_bf16 v[180:183], v[68:71], a[172:175], v[180:183]
ds_read_b64_tr_b16 v[108:109], v18 offset:45056
v_mfma_f32_16x16x32_bf16 v[180:183], v[64:67], a[164:167], v[180:183]
s_waitcnt lgkmcnt(7)
ds_read_b64_tr_b16 v[110:111], v18 offset:47104
v_mfma_f32_16x16x32_bf16 v[188:191], v[80:83], a[164:167], v[188:191]
ds_read_b64_tr_b16 v[64:65], v19 offset:32768
buffer_load_dwordx4 v31, s[8:11], s42 offen offset:3072 sc1 lds
v_mfma_f32_16x16x32_bf16 v[188:191], v[84:87], a[172:175], v[188:191]
ds_read_b64_tr_b16 v[66:67], v19 offset:34816
v_mfma_f32_16x16x32_bf16 v[188:191], v[88:91], a[180:183], v[188:191]
ds_read_b64_tr_b16 v[68:69], v19 offset:36864
buffer_load_dwordx4 a[228:231], v10, s[4:7], s43 offen offset:1024 sc1
v_mfma_f32_16x16x32_bf16 v[188:191], v[92:95], a[188:191], v[188:191]
ds_read_b64_tr_b16 v[70:71], v19 offset:38912
v_mfma_f32_16x16x32_bf16 v[184:187], v[92:95], a[184:187], v[184:187]
ds_read_b64_tr_b16 v[72:73], v19 offset:40960
buffer_load_dwordx4 a[232:235], v10, s[4:7], s43 offen offset:2048 sc1
v_mfma_f32_16x16x32_bf16 v[184:187], v[88:91], a[176:179], v[184:187]
ds_read_b64_tr_b16 v[74:75], v19 offset:43008
v_mfma_f32_16x16x32_bf16 v[184:187], v[84:87], a[168:171], v[184:187]
ds_read_b64_tr_b16 v[76:77], v19 offset:45056
buffer_load_dwordx4 a[236:239], v10, s[4:7], s43 offen offset:3072 sc1
v_mfma_f32_16x16x32_bf16 v[184:187], v[80:83], a[160:163], v[184:187]
s_waitcnt lgkmcnt(7)
ds_read_b64_tr_b16 v[78:79], v19 offset:47104
v_mfma_f32_16x16x32_bf16 v[192:195], v[96:99], a[160:163], v[192:195]
s_add_u32 m0, s41, 49152
ds_read_b64_tr_b16 v[80:81], v16 offset:49152
s_mul_i32 s42, s51, 96
v_mfma_f32_16x16x32_bf16 v[192:195], v[100:103], a[168:171], v[192:195]
ds_read_b64_tr_b16 v[82:83], v16 offset:51200
buffer_load_dwordx4 v28, s[8:11], s42 offen sc1 lds
v_mfma_f32_16x16x32_bf16 v[192:195], v[104:107], a[176:179], v[192:195]
ds_read_b64_tr_b16 v[84:85], v16 offset:53248
v_mfma_f32_16x16x32_bf16 v[192:195], v[108:111], a[184:187], v[192:195]
s_branch Lso20
Lst20:
s_setpc_b64 s[42:43]
Lso20:
ds_read_b64_tr_b16 v[86:87], v16 offset:55296
v_mfma_f32_16x16x32_bf16 v[196:199], v[108:111], a[188:191], v[196:199]
ds_read_b64_tr_b16 v[88:89], v16 offset:57344
v_mfma_f32_16x16x32_bf16 v[196:199], v[104:107], a[180:183], v[196:199]
ds_read_b64_tr_b16 v[90:91], v16 offset:59392
v_mfma_f32_16x16x32_bf16 v[196:199], v[100:103], a[172:175], v[196:199]
ds_read_b64_tr_b16 v[92:93], v16 offset:61440
v_mfma_f32_16x16x32_bf16 v[196:199], v[96:99], a[164:167], v[196:199]
s_waitcnt lgkmcnt(7)
ds_read_b64_tr_b16 v[94:95], v16 offset:63488
v_mfma_f32_16x16x32_bf16 v[204:207], v[64:67], a[164:167], v[204:207]
ds_read_b64_tr_b16 v[96:97], v17 offset:49152
buffer_load_dwordx4 v29, s[8:11], s42 offen offset:1024 sc1 lds
v_mfma_f32_16x16x32_bf16 v[204:207], v[68:71], a[172:175], v[204:207]
s_lshl_b32 s79, s38, 12
ds_read_b64_tr_b16 v[98:99], v17 offset:51200
s_add_u32 s79, s79, s68
v_mfma_f32_16x16x32_bf16 v[204:207], v[72:75], a[180:183], v[204:207]
s_add_u32 s79, s79, 49283072
ds_read_b64_tr_b16 v[100:101], v17 offset:53248
s_lshl_b32 s3, s38, 8
v_mfma_f32_16x16x32_bf16 v[204:207], v[76:79], a[188:191], v[204:207]
s_add_u32 s3, s3, s73
ds_read_b64_tr_b16 v[102:103], v17 offset:55296
s_add_u32 s3, s3, 49283072
v_mfma_f32_16x16x32_bf16 v[200:203], v[76:79], a[184:187], v[200:203]
ds_read_b64_tr_b16 v[104:105], v17 offset:57344
v_mfma_f32_16x16x32_bf16 v[200:203], v[72:75], a[176:179], v[200:203]
ds_read_b64_tr_b16 v[106:107], v17 offset:59392
v_mfma_f32_16x16x32_bf16 v[200:203], v[68:71], a[168:171], v[200:203]
ds_read_b64_tr_b16 v[108:109], v17 offset:61440
v_mfma_f32_16x16x32_bf16 v[200:203], v[64:67], a[160:163], v[200:203]
s_waitcnt lgkmcnt(7)
ds_read_b64_tr_b16 v[110:111], v17 offset:63488
v_mfma_f32_16x16x32_bf16 v[176:179], v[80:83], a[192:195], v[176:179]
ds_read_b64_tr_b16 v[64:65], v18 offset:49152
buffer_load_dwordx4 v30, s[8:11], s42 offen offset:2048 sc1 lds
v_mfma_f32_16x16x32_bf16 v[176:179], v[84:87], a[200:203], v[176:179]
ds_read_b64_tr_b16 v[66:67], v18 offset:51200
v_mfma_f32_16x16x32_bf16 v[176:179], v[88:91], a[208:211], v[176:179]
ds_read_b64_tr_b16 v[68:69], v18 offset:53248
v_mfma_f32_16x16x32_bf16 v[176:179], v[92:95], a[216:219], v[176:179]
ds_read_b64_tr_b16 v[70:71], v18 offset:55296
v_mfma_f32_16x16x32_bf16 v[180:183], v[92:95], a[220:223], v[180:183]
ds_read_b64_tr_b16 v[72:73], v18 offset:57344
v_mfma_f32_16x16x32_bf16 v[180:183], v[88:91], a[212:215], v[180:183]
ds_read_b64_tr_b16 v[74:75], v18 offset:59392
v_mfma_f32_16x16x32_bf16 v[180:183], v[84:87], a[204:207], v[180:183]
ds_read_b64_tr_b16 v[76:77], v18 offset:61440
v_mfma_f32_16x16x32_bf16 v[180:183], v[80:83], a[196:199], v[180:183]
s_waitcnt lgkmcnt(7)
ds_read_b64_tr_b16 v[78:79], v18 offset:63488
v_mfma_f32_16x16x32_bf16 v[188:191], v[96:99], a[196:199], v[188:191]
ds_read_b64_tr_b16 v[80:81], v19 offset:49152
buffer_load_dwordx4 v31, s[8:11], s42 offen offset:3072 sc1 lds
v_mfma_f32_16x16x32_bf16 v[188:191], v[100:103], a[204:207], v[188:191]
ds_read_b64_tr_b16 v[82:83], v19 offset:51200
v_mfma_f32_16x16x32_bf16 v[188:191], v[104:107], a[212:215], v[188:191]
ds_read_b64_tr_b16 v[84:85], v19 offset:53248
v_mfma_f32_16x16x32_bf16 v[188:191], v[108:111], a[220:223], v[188:191]
ds_read_b64_tr_b16 v[86:87], v19 offset:55296
v_mfma_f32_16x16x32_bf16 v[184:187], v[108:111], a[216:219], v[184:187]
ds_read_b64_tr_b16 v[88:89], v19 offset:57344
v_mfma_f32_16x16x32_bf16 v[184:187], v[104:107], a[208:211], v[184:187]
ds_read_b64_tr_b16 v[90:91], v19 offset:59392
v_mfma_f32_16x16x32_bf16 v[184:187], v[100:103], a[200:203], v[184:187]
ds_read_b64_tr_b16 v[92:93], v19 offset:61440
v_mfma_f32_16x16x32_bf16 v[184:187], v[96:99], a[192:195], v[184:187]
s_waitcnt lgkmcnt(7)
ds_read_b64_tr_b16 v[94:95], v19 offset:63488
v_mfma_f32_16x16x32_bf16 v[192:195], v[64:67], a[192:195], v[192:195]
v_mfma_f32_16x16x32_bf16 v[192:195], v[68:71], a[200:203], v[192:195]
v_mfma_f32_16x16x32_bf16 v[192:195], v[72:75], a[208:211], v[192:195]
v_mfma_f32_16x16x32_bf16 v[192:195], v[76:79], a[216:219], v[192:195]
v_mfma_f32_16x16x32_bf16 v[196:199], v[76:79], a[220:223], v[196:199]
v_mfma_f32_16x16x32_bf16 v[196:199], v[72:75], a[212:215], v[196:199]
v_mfma_f32_16x16x32_bf16 v[196:199], v[68:71], a[204:207], v[196:199]
v_mfma_f32_16x16x32_bf16 v[196:199], v[64:67], a[196:199], v[196:199]
s_waitcnt lgkmcnt(0)
v_mfma_f32_16x16x32_bf16 v[204:207], v[80:83], a[196:199], v[204:207]
s_waitcnt vmcnt(4)
v_mfma_f32_16x16x32_bf16 v[176:179], v[50:53], a[224:227], v[176:179]
v_mfma_f32_16x16x32_bf16 v[204:207], v[84:87], a[204:207], v[204:207]
v_mfma_f32_16x16x32_bf16 v[180:183], v[50:53], a[228:231], v[180:183]
v_mfma_f32_16x16x32_bf16 v[204:207], v[88:91], a[212:215], v[204:207]
v_mfma_f32_16x16x32_bf16 v[184:187], v[48:51], a[224:227], v[184:187]
v_mfma_f32_16x16x32_bf16 v[204:207], v[92:95], a[220:223], v[204:207]
v_mfma_f32_16x16x32_bf16 v[188:191], v[48:51], a[228:231], v[188:191]
v_mfma_f32_16x16x32_bf16 v[200:203], v[92:95], a[216:219], v[200:203]
v_mfma_f32_16x16x32_bf16 v[192:195], v[50:53], a[232:235], v[192:195]
v_mfma_f32_16x16x32_bf16 v[200:203], v[88:91], a[208:211], v[200:203]
v_mfma_f32_16x16x32_bf16 v[196:199], v[50:53], a[236:239], v[196:199]
v_mfma_f32_16x16x32_bf16 v[200:203], v[84:87], a[200:203], v[200:203]
v_mfma_f32_16x16x32_bf16 v[200:203], v[80:83], a[192:195], v[200:203]
v_mfma_f32_16x16x32_bf16 v[200:203], v[48:51], a[232:235], v[200:203]
v_mfma_f32_16x16x32_bf16 v[204:207], v[48:51], a[236:239], v[204:207]
v_cvt_pk_bf16_f32 v208, v176, v177
v_cvt_pk_bf16_f32 v209, v178, v179
v_cvt_pk_bf16_f32 v210, v184, v185
v_cvt_pk_bf16_f32 v211, v186, v187
v_cvt_pk_bf16_f32 v212, v180, v181
v_cvt_pk_bf16_f32 v213, v182, v183
v_cvt_pk_bf16_f32 v214, v188, v189
v_cvt_pk_bf16_f32 v215, v190, v191
s_cmp_lg_u32 s40, 0
s_cbranch_scc1 Lfinal
buffer_store_dwordx4 v[208:211], v10, s[4:7], s79 offen sc1
buffer_store_dwordx4 v[212:215], v10, s[4:7], s79 offen offset:1024 sc1
v_mfma_f32_16x16x32_bf16 v[228:231], v[208:211], v[208:211], 0
v_mfma_f32_16x16x32_bf16 v[224:227], v[56:59], v[208:211], 0
v_mfma_f32_16x16x32_bf16 v[236:239], v[212:215], v[212:215], 0
v_mfma_f32_16x16x32_bf16 v[232:235], v[56:59], v[212:215], 0
v_cvt_pk_bf16_f32 v216, v192, v193
v_cvt_pk_bf16_f32 v217, v194, v195
v_cvt_pk_bf16_f32 v218, v200, v201
v_cvt_pk_bf16_f32 v219, v202, v203
buffer_store_dwordx4 v[216:219], v10, s[4:7], s79 offen offset:2048 sc1
s_nop 0
v_mfma_f32_16x16x32_bf16 v[228:231], v[216:219], v[216:219], v[228:231]
v_mfma_f32_16x16x32_bf16 v[224:227], v[56:59], v[216:219], v[224:227]
v_cvt_pk_bf16_f32 v220, v196, v197
v_cvt_pk_bf16_f32 v221, v198, v199
v_cvt_pk_bf16_f32 v222, v204, v205
v_cvt_pk_bf16_f32 v223, v206, v207
buffer_store_dwordx4 v[220:223], v10, s[4:7], s79 offen offset:3072 sc1
s_nop 0
v_mfma_f32_16x16x32_bf16 v[236:239], v[220:223], v[220:223], v[236:239]
v_mfma_f32_16x16x32_bf16 v[232:235], v[56:59], v[220:223], v[232:235]
v_cndmask_b32 v241, v228, v229, s[80:81]
v_cndmask_b32 v241, v241, v230, s[82:83]
v_cndmask_b32 v241, v241, v231, s[84:85]
v_mov_b32 v240, v224
s_nop 2
v_cndmask_b32 v243, v236, v237, s[80:81]
v_cndmask_b32 v243, v243, v238, s[82:83]
v_cndmask_b32 v243, v243, v239, s[84:85]
v_mov_b32 v242, v232
buffer_store_dwordx4 v[240:243], v9, s[4:7], s3 offen sc1
s_barrier
s_add_u32 m0, s41, 65536
s_mul_i32 s42, s52, 96
buffer_load_dwordx4 v28, s[8:11], s42 offen sc1 lds
buffer_load_dwordx4 v29, s[8:11], s42 offen offset:1024 sc1 lds
buffer_load_dwordx4 v30, s[8:11], s42 offen offset:2048 sc1 lds
buffer_load_dwordx4 v31, s[8:11], s42 offen offset:3072 sc1 lds
ds_read_b64_tr_b16 v[64:65], v12 offset:0
ds_read_b64_tr_b16 v[66:67], v12 offset:2048
ds_read_b64_tr_b16 v[68:69], v13 offset:0
ds_read_b64_tr_b16 v[70:71], v13 offset:2048
ds_read_b64_tr_b16 v[72:73], v14 offset:0
ds_read_b64_tr_b16 v[74:75], v14 offset:2048
ds_read_b64_tr_b16 v[76:77], v15 offset:0
ds_read_b64_tr_b16 v[78:79], v15 offset:2048
ds_read_b64_tr_b16 v[80:81], v12 offset:4096
ds_read_b64_tr_b16 v[82:83], v12 offset:6144
ds_read_b64_tr_b16 v[84:85], v13 offset:4096
ds_read_b64_tr_b16 v[86:87], v13 offset:6144
ds_read_b64_tr_b16 v[88:89], v14 offset:4096
ds_read_b64_tr_b16 v[90:91], v14 offset:6144
ds_read_b64_tr_b16 v[92:93], v15 offset:4096
ds_read_b64_tr_b16 v[94:95], v15 offset:6144
s_cmp_lg_u32 s36, 0
s_cbranch_scc1 Ltw12063
s_call_b64 s[42:43], Lst3
s_branch Ltd12062
Ltw12063:
s_cmp_lg_u32 s36, 1
s_cbranch_scc1 Ltw12064
s_call_b64 s[42:43], Lst4
s_branch Ltd12062
Ltw12064:
s_cmp_lg_u32 s36, 2
s_cbranch_scc1 Ltw12065
s_call_b64 s[42:43], Lst6
s_branch Ltd12062
Ltw12065:
s_call_b64 s[42:43], Lst7
Ltd12062:
v_mov_b32 v25, 1
s_waitcnt vmcnt(4)
buffer_atomic_add v25, v11, s[4:7], s76 offen offset:52 sc0 sc1
s_add_u32 m0, s41, 81920
s_mul_i32 s42, s53, 96
buffer_load_dwordx4 v28, s[8:11], s42 offen sc1 lds
buffer_load_dwordx4 v29, s[8:11], s42 offen offset:1024 sc1 lds
buffer_load_dwordx4 v30, s[8:11], s42 offen offset:2048 sc1 lds
buffer_load_dwordx4 v31, s[8:11], s42 offen offset:3072 sc1 lds
s_add_u32 m0, s41, 98304
s_mul_i32 s42, s54, 96
buffer_load_dwordx4 v28, s[8:11], s42 offen sc1 lds
buffer_load_dwordx4 v29, s[8:11], s42 offen offset:1024 sc1 lds
buffer_load_dwordx4 v30, s[8:11], s42 offen offset:2048 sc1 lds
buffer_load_dwordx4 v31, s[8:11], s42 offen offset:3072 sc1 lds
s_add_u32 m0, s41, 114688
s_mul_i32 s42, s55, 96
buffer_load_dwordx4 v28, s[8:11], s42 offen sc1 lds
buffer_load_dwordx4 v29, s[8:11], s42 offen offset:1024 sc1 lds
buffer_load_dwordx4 v30, s[8:11], s42 offen offset:2048 sc1 lds
buffer_load_dwordx4 v31, s[8:11], s42 offen offset:3072 sc1 lds
s_add_u32 s68, s68, 49283072
s_add_u32 s69, s69, 49283072
s_add_u32 s70, s70, 49283072
s_add_u32 s71, s71, 49283072
s_add_u32 s72, s72, 49283072
s_add_u32 s73, s73, 49283072
s_add_u32 s74, s74, 49283072
s_add_u32 s95, s95, 49283072
s_add_u32 s60, s60, 49283072
s_add_u32 s61, s61, 49283072
s_add_u32 s75, s75, 64
s_add_u32 s44, s44, 64
s_add_u32 s32, s32, 64
s_add_u32 s33, s33, 64
s_add_u32 s34, s34, 64
s_add_u32 s35, s35, 64
s_waitcnt vmcnt(12)
v_readfirstlane_b32 s45, v25
s_nop 0
s_cmp_lt_u32 s45, 15
s_cbranch_scc0 Lpok12068
Lpw12067:
v_mov_b32 v25, 0
buffer_atomic_add v25, v11, s[4:7], s76 offen offset:52 sc0 sc1
s_add_u32 s47, s47, 1
s_cmp_ge_u32 s47, 0x40000
s_cbranch_scc1 Lend
s_waitcnt vmcnt(0)
v_readfirstlane_b32 s45, v25
s_nop 0
s_cmp_lt_u32 s45, 16
s_cbranch_scc1 Lpw12067
Lpok12068:
s_mov_b32 s40, 1
s_add_u32 s76, s76, 64
s_mov_b32 s24, 9
s_mov_b32 s0, 0x20000
s_branch Llayer
Lst21:
s_setpc_b64 s[42:43]
Lfinal:
ds_write_b64 v112, v[208:209] offset:0
ds_write_b64 v113, v[210:211] offset:0
ds_write_b64 v112, v[212:213] offset:2048
ds_write_b64 v113, v[214:215] offset:2048
v_cvt_pk_bf16_f32 v216, v192, v193
v_cvt_pk_bf16_f32 v217, v194, v195
v_cvt_pk_bf16_f32 v218, v200, v201
v_cvt_pk_bf16_f32 v219, v202, v203
v_cvt_pk_bf16_f32 v220, v196, v197
v_cvt_pk_bf16_f32 v221, v198, v199
v_cvt_pk_bf16_f32 v222, v204, v205
v_cvt_pk_bf16_f32 v223, v206, v207
ds_write_b64 v114, v[216:217] offset:0
ds_write_b64 v115, v[218:219] offset:0
ds_write_b64 v114, v[220:221] offset:2048
ds_write_b64 v115, v[222:223] offset:2048
s_lshl_b32 s45, s39, 16
s_lshl_b32 s46, s38, 7
s_add_u32 s45, s45, s46
s_mov_b32 s28, s98
s_and_b32 s29, s99, 0xffff
s_mov_b32 s30, 4194304
s_mov_b32 s31, 0x00020000
s_waitcnt lgkmcnt(0)
ds_read_b128 v[224:227], v116 offset:0
ds_read_b128 v[228:231], v116 offset:1024
ds_read_b128 v[232:235], v116 offset:2048
ds_read_b128 v[236:239], v116 offset:3072
s_waitcnt lgkmcnt(3)
buffer_store_dwordx4 v[224:227], v117, s[28:31], s45 offen sc1
s_add_u32 s45, s45, 16384
s_waitcnt lgkmcnt(2)
buffer_store_dwordx4 v[228:231], v117, s[28:31], s45 offen sc1
s_add_u32 s45, s45, 16384
s_waitcnt lgkmcnt(1)
buffer_store_dwordx4 v[232:235], v117, s[28:31], s45 offen sc1
s_add_u32 s45, s45, 16384
s_waitcnt lgkmcnt(0)
buffer_store_dwordx4 v[236:239], v117, s[28:31], s45 offen sc1
Lend:
s_endpgm
Lslow2016:
v_mov_b32 v25, 0
buffer_atomic_add v25, v11, s[4:7], s69 offen offset:60 sc0 sc1
s_add_u32 s47, s47, 1
s_cmp_ge_u32 s47, 0x40000
s_cbranch_scc1 Lend
s_waitcnt vmcnt(0)
v_readfirstlane_b32 s45, v25
s_nop 0
s_cmp_lt_u32 s45, 16
s_cbranch_scc1 Lslow2016
s_branch Lback2017
Lslow2018:
v_mov_b32 v25, 0
buffer_atomic_add v25, v11, s[4:7], s76 offen offset:56 sc0 sc1
s_add_u32 s47, s47, 1
s_cmp_ge_u32 s47, 0x40000
s_cbranch_scc1 Lend
s_waitcnt vmcnt(0)
v_readfirstlane_b32 s45, v25
s_nop 0
s_cmp_lt_u32 s45, 16
s_cbranch_scc1 Lslow2018
s_branch Lback2019
Lslow3021:
v_mov_b32 v25, 0
buffer_atomic_add v25, v11, s[4:7], s44 offen offset:4 sc0 sc1
s_add_u32 s47, s47, 1
s_cmp_ge_u32 s47, 0x40000
s_cbranch_scc1 Lend
s_waitcnt vmcnt(0)
v_readfirstlane_b32 s45, v25
s_nop 0
s_cmp_lt_u32 s45, 2
s_cbranch_scc1 Lslow3021
s_branch Lback3022
Lslow3023:
v_mov_b32 v25, 0
buffer_atomic_add v25, v11, s[4:7], s44 offen offset:8 sc0 sc1
s_add_u32 s47, s47, 1
s_cmp_ge_u32 s47, 0x40000
s_cbranch_scc1 Lend
s_waitcnt vmcnt(0)
v_readfirstlane_b32 s45, v25
s_nop 0
s_cmp_lt_u32 s45, 2
s_cbranch_scc1 Lslow3023
s_branch Lback3024
Lfb0:
s_nop 15
v_mov_b32 v42, 0xff800000
v_mfma_f32_32x32x16_bf16 v[64:79], a[0:3], v[240:243], v[160:175]
v_mfma_f32_32x32x16_bf16 v[64:79], a[4:7], v[244:247], v[64:79]
s_bfe_i64 exec, s[96:97], 0x10000
s_nop 10
v_max3_f32 v42, v42, v64, v65
v_max3_f32 v42, v42, v66, v67
v_max3_f32 v42, v42, v68, v69
v_max3_f32 v42, v42, v70, v71
v_max3_f32 v42, v42, v72, v73
v_max3_f32 v42, v42, v74, v75
v_max3_f32 v42, v42, v76, v77
v_max3_f32 v42, v42, v78, v79
s_mov_b64 exec, -1
v_mfma_f32_32x32x16_bf16 v[64:79], a[8:11], v[240:243], 0
v_mfma_f32_32x32x16_bf16 v[64:79], a[12:15], v[244:247], v[64:79]
s_bfe_i64 exec, s[96:97], 0x10001
s_nop 10
v_max3_f32 v42, v42, v64, v65
v_max3_f32 v42, v42, v66, v67
v_max3_f32 v42, v42, v68, v69
v_max3_f32 v42, v42, v70, v71
v_max3_f32 v42, v42, v72, v73
v_max3_f32 v42, v42, v74, v75
v_max3_f32 v42, v42, v76, v77
v_max3_f32 v42, v42, v78, v79
s_mov_b64 exec, -1
v_mfma_f32_32x32x16_bf16 v[64:79], a[16:19], v[240:243], 0
v_mfma_f32_32x32x16_bf16 v[64:79], a[20:23], v[244:247], v[64:79]
s_bfe_i64 exec, s[96:97], 0x10002
s_nop 10
v_max3_f32 v42, v42, v64, v65
v_max3_f32 v42, v42, v66, v67
v_max3_f32 v42, v42, v68, v69
v_max3_f32 v42, v42, v70, v71
v_max3_f32 v42, v42, v72, v73
v_max3_f32 v42, v42, v74, v75
v_max3_f32 v42, v42, v76, v77
v_max3_f32 v42, v42, v78, v79
s_mov_b64 exec, -1
v_mfma_f32_32x32x16_bf16 v[64:79], a[24:27], v[240:243], 0
v_mfma_f32_32x32x16_bf16 v[64:79], a[28:31], v[244:247], v[64:79]
s_bfe_i64 exec, s[96:97], 0x10003
s_nop 10
v_max3_f32 v42, v42, v64, v65
v_max3_f32 v42, v42, v66, v67
v_max3_f32 v42, v42, v68, v69
v_max3_f32 v42, v42, v70, v71
v_max3_f32 v42, v42, v72, v73
v_max3_f32 v42, v42, v74, v75
v_max3_f32 v42, v42, v76, v77
v_max3_f32 v42, v42, v78, v79
s_mov_b64 exec, -1
v_mfma_f32_32x32x16_bf16 v[64:79], a[32:35], v[240:243], 0
v_mfma_f32_32x32x16_bf16 v[64:79], a[36:39], v[244:247], v[64:79]
s_bfe_i64 exec, s[96:97], 0x10004
s_nop 10
v_max3_f32 v42, v42, v64, v65
v_max3_f32 v42, v42, v66, v67
v_max3_f32 v42, v42, v68, v69
v_max3_f32 v42, v42, v70, v71
v_max3_f32 v42, v42, v72, v73
v_max3_f32 v42, v42, v74, v75
v_max3_f32 v42, v42, v76, v77
v_max3_f32 v42, v42, v78, v79
s_mov_b64 exec, -1
v_mfma_f32_32x32x16_bf16 v[64:79], a[40:43], v[240:243], 0
v_mfma_f32_32x32x16_bf16 v[64:79], a[44:47], v[244:247], v[64:79]
s_bfe_i64 exec, s[96:97], 0x10005
s_nop 10
v_max3_f32 v42, v42, v64, v65
v_max3_f32 v42, v42, v66, v67
v_max3_f32 v42, v42, v68, v69
v_max3_f32 v42, v42, v70, v71
v_max3_f32 v42, v42, v72, v73
v_max3_f32 v42, v42, v74, v75
v_max3_f32 v42, v42, v76, v77
v_max3_f32 v42, v42, v78, v79
s_mov_b64 exec, -1
v_mfma_f32_32x32x16_bf16 v[64:79], a[48:51], v[240:243], 0
v_mfma_f32_32x32x16_bf16 v[64:79], a[52:55], v[244:247], v[64:79]
s_bfe_i64 exec, s[96:97], 0x10006
s_nop 10
v_max3_f32 v42, v42, v64, v65
v_max3_f32 v42, v42, v66, v67
v_max3_f32 v42, v42, v68, v69
v_max3_f32 v42, v42, v70, v71
v_max3_f32 v42, v42, v72, v73
v_max3_f32 v42, v42, v74, v75
v_max3_f32 v42, v42, v76, v77
v_max3_f32 v42, v42, v78, v79
s_mov_b64 exec, -1
v_mfma_f32_32x32x16_bf16 v[64:79], a[56:59], v[240:243], 0
v_mfma_f32_32x32x16_bf16 v[64:79], a[60:63], v[244:247], v[64:79]
s_bfe_i64 exec, s[96:97], 0x10007
s_nop 10
v_max3_f32 v42, v42, v64, v65
v_max3_f32 v42, v42, v66, v67
v_max3_f32 v42, v42, v68, v69
v_max3_f32 v42, v42, v70, v71
v_max3_f32 v42, v42, v72, v73
v_max3_f32 v42, v42, v74, v75
v_max3_f32 v42, v42, v76, v77
v_max3_f32 v42, v42, v78, v79
s_mov_b64 exec, -1
v_mfma_f32_32x32x16_bf16 v[64:79], v[208:211], v[240:243], v[144:159]
v_mfma_f32_32x32x16_bf16 v[64:79], v[212:215], v[244:247], v[64:79]
s_nop 11
v_max3_f32 v42, v42, v64, v65
v_max3_f32 v42, v42, v66, v67
v_max3_f32 v42, v42, v68, v69
v_max3_f32 v42, v42, v70, v71
v_max3_f32 v42, v42, v72, v73
v_max3_f32 v42, v42, v74, v75
v_max3_f32 v42, v42, v76, v77
v_max3_f32 v42, v42, v78, v79
v_mov_b32 v0, v42
s_nop 1
v_permlane32_swap_b32 v42, v0
v_max_f32 v42, v42, v0
v_mov_b32 v48, 0
v_mov_b32 v49, 0
v_mov_b32 v50, 0
v_mov_b32 v51, 0
v_mov_b32 v52, 0
v_mov_b32 v53, 0
v_mov_b32 v54, 0
v_mov_b32 v55, 0
v_mfma_f32_32x32x16_bf16 v[64:79], a[0:3], v[240:243], v[160:175]
v_mfma_f32_32x32x16_bf16 v[64:79], a[4:7], v[244:247], v[64:79]
s_nop 11
v_sub_f32 v64, v64, v42
v_sub_f32 v65, v65, v42
v_sub_f32 v66, v66, v42
v_sub_f32 v67, v67, v42
v_sub_f32 v68, v68, v42
v_sub_f32 v69, v69, v42
v_sub_f32 v70, v70, v42
v_sub_f32 v71, v71, v42
v_sub_f32 v72, v72, v42
v_sub_f32 v73, v73, v42
v_sub_f32 v74, v74, v42
v_sub_f32 v75, v75, v42
v_sub_f32 v76, v76, v42
v_sub_f32 v77, v77, v42
v_sub_f32 v78, v78, v42
v_sub_f32 v79, v79, v42
v_exp_f32 v64, v64
v_exp_f32 v65, v65
v_exp_f32 v66, v66
v_exp_f32 v67, v67
v_exp_f32 v68, v68
v_exp_f32 v69, v69
v_exp_f32 v70, v70
v_exp_f32 v71, v71
v_exp_f32 v72, v72
v_exp_f32 v73, v73
v_exp_f32 v74, v74
v_exp_f32 v75, v75
v_exp_f32 v76, v76
v_exp_f32 v77, v77
v_exp_f32 v78, v78
v_exp_f32 v79, v79
s_bfe_i64 exec, s[96:97], 0x10000
v_cvt_pk_bf16_f32 v48, v64, v65
v_cvt_pk_bf16_f32 v49, v66, v67
v_cvt_pk_bf16_f32 v50, v68, v69
v_cvt_pk_bf16_f32 v51, v70, v71
v_cvt_pk_bf16_f32 v52, v72, v73
v_cvt_pk_bf16_f32 v53, v74, v75
v_cvt_pk_bf16_f32 v54, v76, v77
v_cvt_pk_bf16_f32 v55, v78, v79
s_mov_b64 exec, -1
v_mfma_f32_32x32x16_bf16 v[112:127], a[64:67], v[48:51], 0
v_mfma_f32_32x32x16_bf16 v[112:127], a[68:71], v[52:55], v[112:127]
v_mfma_f32_16x16x32_bf16 v[44:47], v[36:39], v[48:51], 0
v_mfma_f32_16x16x32_bf16 v[44:47], v[36:39], v[52:55], v[44:47]
v_mfma_f32_32x32x16_bf16 v[64:79], a[8:11], v[240:243], 0
v_mfma_f32_32x32x16_bf16 v[64:79], a[12:15], v[244:247], v[64:79]
s_nop 11
v_sub_f32 v64, v64, v42
v_sub_f32 v65, v65, v42
v_sub_f32 v66, v66, v42
v_sub_f32 v67, v67, v42
v_sub_f32 v68, v68, v42
v_sub_f32 v69, v69, v42
v_sub_f32 v70, v70, v42
v_sub_f32 v71, v71, v42
v_sub_f32 v72, v72, v42
v_sub_f32 v73, v73, v42
v_sub_f32 v74, v74, v42
v_sub_f32 v75, v75, v42
v_sub_f32 v76, v76, v42
v_sub_f32 v77, v77, v42
v_sub_f32 v78, v78, v42
v_sub_f32 v79, v79, v42
v_exp_f32 v64, v64
v_exp_f32 v65, v65
v_exp_f32 v66, v66
v_exp_f32 v67, v67
v_exp_f32 v68, v68
v_exp_f32 v69, v69
v_exp_f32 v70, v70
v_exp_f32 v71, v71
v_exp_f32 v72, v72
v_exp_f32 v73, v73
v_exp_f32 v74, v74
v_exp_f32 v75, v75
v_exp_f32 v76, v76
v_exp_f32 v77, v77
v_exp_f32 v78, v78
v_exp_f32 v79, v79
s_bfe_i64 exec, s[96:97], 0x10001
v_cvt_pk_bf16_f32 v48, v64, v65
v_cvt_pk_bf16_f32 v49, v66, v67
v_cvt_pk_bf16_f32 v50, v68, v69
v_cvt_pk_bf16_f32 v51, v70, v71
v_cvt_pk_bf16_f32 v52, v72, v73
v_cvt_pk_bf16_f32 v53, v74, v75
v_cvt_pk_bf16_f32 v54, v76, v77
v_cvt_pk_bf16_f32 v55, v78, v79
s_mov_b64 exec, -1
v_mfma_f32_32x32x16_bf16 v[112:127], a[72:75], v[48:51], v[112:127]
v_mfma_f32_32x32x16_bf16 v[112:127], a[76:79], v[52:55], v[112:127]
v_mfma_f32_16x16x32_bf16 v[44:47], v[36:39], v[48:51], v[44:47]
v_mfma_f32_16x16x32_bf16 v[44:47], v[36:39], v[52:55], v[44:47]
v_mfma_f32_32x32x16_bf16 v[64:79], a[16:19], v[240:243], 0
v_mfma_f32_32x32x16_bf16 v[64:79], a[20:23], v[244:247], v[64:79]
s_nop 11
v_sub_f32 v64, v64, v42
v_sub_f32 v65, v65, v42
v_sub_f32 v66, v66, v42
v_sub_f32 v67, v67, v42
v_sub_f32 v68, v68, v42
v_sub_f32 v69, v69, v42
v_sub_f32 v70, v70, v42
v_sub_f32 v71, v71, v42
v_sub_f32 v72, v72, v42
v_sub_f32 v73, v73, v42
v_sub_f32 v74, v74, v42
v_sub_f32 v75, v75, v42
v_sub_f32 v76, v76, v42
v_sub_f32 v77, v77, v42
v_sub_f32 v78, v78, v42
v_sub_f32 v79, v79, v42
v_exp_f32 v64, v64
v_exp_f32 v65, v65
v_exp_f32 v66, v66
v_exp_f32 v67, v67
v_exp_f32 v68, v68
v_exp_f32 v69, v69
v_exp_f32 v70, v70
v_exp_f32 v71, v71
v_exp_f32 v72, v72
v_exp_f32 v73, v73
v_exp_f32 v74, v74
v_exp_f32 v75, v75
v_exp_f32 v76, v76
v_exp_f32 v77, v77
v_exp_f32 v78, v78
v_exp_f32 v79, v79
s_bfe_i64 exec, s[96:97], 0x10002
v_cvt_pk_bf16_f32 v48, v64, v65
v_cvt_pk_bf16_f32 v49, v66, v67
v_cvt_pk_bf16_f32 v50, v68, v69
v_cvt_pk_bf16_f32 v51, v70, v71
v_cvt_pk_bf16_f32 v52, v72, v73
v_cvt_pk_bf16_f32 v53, v74, v75
v_cvt_pk_bf16_f32 v54, v76, v77
v_cvt_pk_bf16_f32 v55, v78, v79
s_mov_b64 exec, -1
v_mfma_f32_32x32x16_bf16 v[112:127], a[80:83], v[48:51], v[112:127]
v_mfma_f32_32x32x16_bf16 v[112:127], a[84:87], v[52:55], v[112:127]
v_mfma_f32_16x16x32_bf16 v[44:47], v[36:39], v[48:51], v[44:47]
v_mfma_f32_16x16x32_bf16 v[44:47], v[36:39], v[52:55], v[44:47]
v_mfma_f32_32x32x16_bf16 v[64:79], a[24:27], v[240:243], 0
v_mfma_f32_32x32x16_bf16 v[64:79], a[28:31], v[244:247], v[64:79]
s_nop 11
v_sub_f32 v64, v64, v42
v_sub_f32 v65, v65, v42
v_sub_f32 v66, v66, v42
v_sub_f32 v67, v67, v42
v_sub_f32 v68, v68, v42
v_sub_f32 v69, v69, v42
v_sub_f32 v70, v70, v42
v_sub_f32 v71, v71, v42
v_sub_f32 v72, v72, v42
v_sub_f32 v73, v73, v42
v_sub_f32 v74, v74, v42
v_sub_f32 v75, v75, v42
v_sub_f32 v76, v76, v42
v_sub_f32 v77, v77, v42
v_sub_f32 v78, v78, v42
v_sub_f32 v79, v79, v42
v_exp_f32 v64, v64
v_exp_f32 v65, v65
v_exp_f32 v66, v66
v_exp_f32 v67, v67
v_exp_f32 v68, v68
v_exp_f32 v69, v69
v_exp_f32 v70, v70
v_exp_f32 v71, v71
v_exp_f32 v72, v72
v_exp_f32 v73, v73
v_exp_f32 v74, v74
v_exp_f32 v75, v75
v_exp_f32 v76, v76
v_exp_f32 v77, v77
v_exp_f32 v78, v78
v_exp_f32 v79, v79
s_bfe_i64 exec, s[96:97], 0x10003
v_cvt_pk_bf16_f32 v48, v64, v65
v_cvt_pk_bf16_f32 v49, v66, v67
v_cvt_pk_bf16_f32 v50, v68, v69
v_cvt_pk_bf16_f32 v51, v70, v71
v_cvt_pk_bf16_f32 v52, v72, v73
v_cvt_pk_bf16_f32 v53, v74, v75
v_cvt_pk_bf16_f32 v54, v76, v77
v_cvt_pk_bf16_f32 v55, v78, v79
s_mov_b64 exec, -1
v_mfma_f32_32x32x16_bf16 v[112:127], a[88:91], v[48:51], v[112:127]
v_mfma_f32_32x32x16_bf16 v[112:127], a[92:95], v[52:55], v[112:127]
v_mfma_f32_16x16x32_bf16 v[44:47], v[36:39], v[48:51], v[44:47]
v_mfma_f32_16x16x32_bf16 v[44:47], v[36:39], v[52:55], v[44:47]
v_mfma_f32_32x32x16_bf16 v[64:79], a[32:35], v[240:243], 0
v_mfma_f32_32x32x16_bf16 v[64:79], a[36:39], v[244:247], v[64:79]
s_nop 11
v_sub_f32 v64, v64, v42
v_sub_f32 v65, v65, v42
v_sub_f32 v66, v66, v42
v_sub_f32 v67, v67, v42
v_sub_f32 v68, v68, v42
v_sub_f32 v69, v69, v42
v_sub_f32 v70, v70, v42
v_sub_f32 v71, v71, v42
v_sub_f32 v72, v72, v42
v_sub_f32 v73, v73, v42
v_sub_f32 v74, v74, v42
v_sub_f32 v75, v75, v42
v_sub_f32 v76, v76, v42
v_sub_f32 v77, v77, v42
v_sub_f32 v78, v78, v42
v_sub_f32 v79, v79, v42
v_exp_f32 v64, v64
v_exp_f32 v65, v65
v_exp_f32 v66, v66
v_exp_f32 v67, v67
v_exp_f32 v68, v68
v_exp_f32 v69, v69
v_exp_f32 v70, v70
v_exp_f32 v71, v71
v_exp_f32 v72, v72
v_exp_f32 v73, v73
v_exp_f32 v74, v74
v_exp_f32 v75, v75
v_exp_f32 v76, v76
v_exp_f32 v77, v77
v_exp_f32 v78, v78
v_exp_f32 v79, v79
s_bfe_i64 exec, s[96:97], 0x10004
v_cvt_pk_bf16_f32 v48, v64, v65
v_cvt_pk_bf16_f32 v49, v66, v67
v_cvt_pk_bf16_f32 v50, v68, v69
v_cvt_pk_bf16_f32 v51, v70, v71
v_cvt_pk_bf16_f32 v52, v72, v73
v_cvt_pk_bf16_f32 v53, v74, v75
v_cvt_pk_bf16_f32 v54, v76, v77
v_cvt_pk_bf16_f32 v55, v78, v79
s_mov_b64 exec, -1
v_mfma_f32_32x32x16_bf16 v[112:127], a[96:99], v[48:51], v[112:127]
v_mfma_f32_32x32x16_bf16 v[112:127], a[100:103], v[52:55], v[112:127]
v_mfma_f32_16x16x32_bf16 v[44:47], v[36:39], v[48:51], v[44:47]
v_mfma_f32_16x16x32_bf16 v[44:47], v[36:39], v[52:55], v[44:47]
v_mfma_f32_32x32x16_bf16 v[64:79], a[40:43], v[240:243], 0
v_mfma_f32_32x32x16_bf16 v[64:79], a[44:47], v[244:247], v[64:79]
s_nop 11
v_sub_f32 v64, v64, v42
v_sub_f32 v65, v65, v42
v_sub_f32 v66, v66, v42
v_sub_f32 v67, v67, v42
v_sub_f32 v68, v68, v42
v_sub_f32 v69, v69, v42
v_sub_f32 v70, v70, v42
v_sub_f32 v71, v71, v42
v_sub_f32 v72, v72, v42
v_sub_f32 v73, v73, v42
v_sub_f32 v74, v74, v42
v_sub_f32 v75, v75, v42
v_sub_f32 v76, v76, v42
v_sub_f32 v77, v77, v42
v_sub_f32 v78, v78, v42
v_sub_f32 v79, v79, v42
v_exp_f32 v64, v64
v_exp_f32 v65, v65
v_exp_f32 v66, v66
v_exp_f32 v67, v67
v_exp_f32 v68, v68
v_exp_f32 v69, v69
v_exp_f32 v70, v70
v_exp_f32 v71, v71
v_exp_f32 v72, v72
v_exp_f32 v73, v73
v_exp_f32 v74, v74
v_exp_f32 v75, v75
v_exp_f32 v76, v76
v_exp_f32 v77, v77
v_exp_f32 v78, v78
v_exp_f32 v79, v79
s_bfe_i64 exec, s[96:97], 0x10005
v_cvt_pk_bf16_f32 v48, v64, v65
v_cvt_pk_bf16_f32 v49, v66, v67
v_cvt_pk_bf16_f32 v50, v68, v69
v_cvt_pk_bf16_f32 v51, v70, v71
v_cvt_pk_bf16_f32 v52, v72, v73
v_cvt_pk_bf16_f32 v53, v74, v75
v_cvt_pk_bf16_f32 v54, v76, v77
v_cvt_pk_bf16_f32 v55, v78, v79
s_mov_b64 exec, -1
v_mfma_f32_32x32x16_bf16 v[112:127], a[104:107], v[48:51], v[112:127]
v_mfma_f32_32x32x16_bf16 v[112:127], a[108:111], v[52:55], v[112:127]
v_mfma_f32_16x16x32_bf16 v[44:47], v[36:39], v[48:51], v[44:47]
v_mfma_f32_16x16x32_bf16 v[44:47], v[36:39], v[52:55], v[44:47]
v_mfma_f32_32x32x16_bf16 v[64:79], a[48:51], v[240:243], 0
v_mfma_f32_32x32x16_bf16 v[64:79], a[52:55], v[244:247], v[64:79]
s_nop 11
v_sub_f32 v64, v64, v42
v_sub_f32 v65, v65, v42
v_sub_f32 v66, v66, v42
v_sub_f32 v67, v67, v42
v_sub_f32 v68, v68, v42
v_sub_f32 v69, v69, v42
v_sub_f32 v70, v70, v42
v_sub_f32 v71, v71, v42
v_sub_f32 v72, v72, v42
v_sub_f32 v73, v73, v42
v_sub_f32 v74, v74, v42
v_sub_f32 v75, v75, v42
v_sub_f32 v76, v76, v42
v_sub_f32 v77, v77, v42
v_sub_f32 v78, v78, v42
v_sub_f32 v79, v79, v42
v_exp_f32 v64, v64
v_exp_f32 v65, v65
v_exp_f32 v66, v66
v_exp_f32 v67, v67
v_exp_f32 v68, v68
v_exp_f32 v69, v69
v_exp_f32 v70, v70
v_exp_f32 v71, v71
v_exp_f32 v72, v72
v_exp_f32 v73, v73
v_exp_f32 v74, v74
v_exp_f32 v75, v75
v_exp_f32 v76, v76
v_exp_f32 v77, v77
v_exp_f32 v78, v78
v_exp_f32 v79, v79
s_bfe_i64 exec, s[96:97], 0x10006
v_cvt_pk_bf16_f32 v48, v64, v65
v_cvt_pk_bf16_f32 v49, v66, v67
v_cvt_pk_bf16_f32 v50, v68, v69
v_cvt_pk_bf16_f32 v51, v70, v71
v_cvt_pk_bf16_f32 v52, v72, v73
v_cvt_pk_bf16_f32 v53, v74, v75
v_cvt_pk_bf16_f32 v54, v76, v77
v_cvt_pk_bf16_f32 v55, v78, v79
s_mov_b64 exec, -1
v_mfma_f32_32x32x16_bf16 v[112:127], a[112:115], v[48:51], v[112:127]
v_mfma_f32_32x32x16_bf16 v[112:127], a[116:119], v[52:55], v[112:127]
v_mfma_f32_16x16x32_bf16 v[44:47], v[36:39], v[48:51], v[44:47]
v_mfma_f32_16x16x32_bf16 v[44:47], v[36:39], v[52:55], v[44:47]
v_mfma_f32_32x32x16_bf16 v[64:79], a[56:59], v[240:243], 0
v_mfma_f32_32x32x16_bf16 v[64:79], a[60:63], v[244:247], v[64:79]
s_nop 11
v_sub_f32 v64, v64, v42
v_sub_f32 v65, v65, v42
v_sub_f32 v66, v66, v42
v_sub_f32 v67, v67, v42
v_sub_f32 v68, v68, v42
v_sub_f32 v69, v69, v42
v_sub_f32 v70, v70, v42
v_sub_f32 v71, v71, v42
v_sub_f32 v72, v72, v42
v_sub_f32 v73, v73, v42
v_sub_f32 v74, v74, v42
v_sub_f32 v75, v75, v42
v_sub_f32 v76, v76, v42
v_sub_f32 v77, v77, v42
v_sub_f32 v78, v78, v42
v_sub_f32 v79, v79, v42
v_exp_f32 v64, v64
v_exp_f32 v65, v65
v_exp_f32 v66, v66
v_exp_f32 v67, v67
v_exp_f32 v68, v68
v_exp_f32 v69, v69
v_exp_f32 v70, v70
v_exp_f32 v71, v71
v_exp_f32 v72, v72
v_exp_f32 v73, v73
v_exp_f32 v74, v74
v_exp_f32 v75, v75
v_exp_f32 v76, v76
v_exp_f32 v77, v77
v_exp_f32 v78, v78
v_exp_f32 v79, v79
s_bfe_i64 exec, s[96:97], 0x10007
v_cvt_pk_bf16_f32 v48, v64, v65
v_cvt_pk_bf16_f32 v49, v66, v67
v_cvt_pk_bf16_f32 v50, v68, v69
v_cvt_pk_bf16_f32 v51, v70, v71
v_cvt_pk_bf16_f32 v52, v72, v73
v_cvt_pk_bf16_f32 v53, v74, v75
v_cvt_pk_bf16_f32 v54, v76, v77
v_cvt_pk_bf16_f32 v55, v78, v79
s_mov_b64 exec, -1
v_mfma_f32_32x32x16_bf16 v[112:127], a[120:123], v[48:51], v[112:127]
v_mfma_f32_32x32x16_bf16 v[112:127], a[124:127], v[52:55], v[112:127]
v_mfma_f32_16x16x32_bf16 v[44:47], v[36:39], v[48:51], v[44:47]
v_mfma_f32_16x16x32_bf16 v[44:47], v[36:39], v[52:55], v[44:47]
v_mfma_f32_32x32x16_bf16 v[64:79], v[208:211], v[240:243], v[144:159]
v_mfma_f32_32x32x16_bf16 v[64:79], v[212:215], v[244:247], v[64:79]
s_nop 11
v_sub_f32 v64, v64, v42
v_sub_f32 v65, v65, v42
v_sub_f32 v66, v66, v42
v_sub_f32 v67, v67, v42
v_sub_f32 v68, v68, v42
v_sub_f32 v69, v69, v42
v_sub_f32 v70, v70, v42
v_sub_f32 v71, v71, v42
v_sub_f32 v72, v72, v42
v_sub_f32 v73, v73, v42
v_sub_f32 v74, v74, v42
v_sub_f32 v75, v75, v42
v_sub_f32 v76, v76, v42
v_sub_f32 v77, v77, v42
v_sub_f32 v78, v78, v42
v_sub_f32 v79, v79, v42
v_exp_f32 v64, v64
v_exp_f32 v65, v65
v_exp_f32 v66, v66
v_exp_f32 v67, v67
v_exp_f32 v68, v68
v_exp_f32 v69, v69
v_exp_f32 v70, v70
v_exp_f32 v71, v71
v_exp_f32 v72, v72
v_exp_f32 v73, v73
v_exp_f32 v74, v74
v_exp_f32 v75, v75
v_exp_f32 v76, v76
v_exp_f32 v77, v77
v_exp_f32 v78, v78
v_exp_f32 v79, v79
v_cvt_pk_bf16_f32 v48, v64, v65
v_cvt_pk_bf16_f32 v49, v66, v67
v_cvt_pk_bf16_f32 v50, v68, v69
v_cvt_pk_bf16_f32 v51, v70, v71
v_cvt_pk_bf16_f32 v52, v72, v73
v_cvt_pk_bf16_f32 v53, v74, v75
v_cvt_pk_bf16_f32 v54, v76, v77
v_cvt_pk_bf16_f32 v55, v78, v79
v_mfma_f32_32x32x16_bf16 v[112:127], v[224:227], v[48:51], v[112:127]
s_nop 0
v_mfma_f32_32x32x16_bf16 v[112:127], v[228:231], v[52:55], v[112:127]
v_mfma_f32_16x16x32_bf16 v[44:47], v[36:39], v[48:51], v[44:47]
v_mfma_f32_16x16x32_bf16 v[44:47], v[36:39], v[52:55], v[44:47]
s_nop 15
s_branch Lfbr0
Lfb1:
s_nop 15
v_mov_b32 v42, 0xff800000
v_mfma_f32_32x32x16_bf16 v[64:79], a[128:131], v[248:251], v[160:175]
v_mfma_f32_32x32x16_bf16 v[64:79], a[132:135], v[252:255], v[64:79]
s_bfe_i64 exec, s[96:97], 0x10000
s_nop 10
v_max3_f32 v42, v42, v64, v65
v_max3_f32 v42, v42, v66, v67
v_max3_f32 v42, v42, v68, v69
v_max3_f32 v42, v42, v70, v71
v_max3_f32 v42, v42, v72, v73
v_max3_f32 v42, v42, v74, v75
v_max3_f32 v42, v42, v76, v77
v_max3_f32 v42, v42, v78, v79
s_mov_b64 exec, -1
v_mfma_f32_32x32x16_bf16 v[64:79], a[136:139], v[248:251], 0
v_mfma_f32_32x32x16_bf16 v[64:79], a[140:143], v[252:255], v[64:79]
s_bfe_i64 exec, s[96:97], 0x10001
s_nop 10
v_max3_f32 v42, v42, v64, v65
v_max3_f32 v42, v42, v66, v67
v_max3_f32 v42, v42, v68, v69
v_max3_f32 v42, v42, v70, v71
v_max3_f32 v42, v42, v72, v73
v_max3_f32 v42, v42, v74, v75
v_max3_f32 v42, v42, v76, v77
v_max3_f32 v42, v42, v78, v79
s_mov_b64 exec, -1
v_mfma_f32_32x32x16_bf16 v[64:79], a[144:147], v[248:251], 0
v_mfma_f32_32x32x16_bf16 v[64:79], a[148:151], v[252:255], v[64:79]
s_bfe_i64 exec, s[96:97], 0x10002
s_nop 10
v_max3_f32 v42, v42, v64, v65
v_max3_f32 v42, v42, v66, v67
v_max3_f32 v42, v42, v68, v69
v_max3_f32 v42, v42, v70, v71
v_max3_f32 v42, v42, v72, v73
v_max3_f32 v42, v42, v74, v75
v_max3_f32 v42, v42, v76, v77
v_max3_f32 v42, v42, v78, v79
s_mov_b64 exec, -1
v_mfma_f32_32x32x16_bf16 v[64:79], a[152:155], v[248:251], 0
v_mfma_f32_32x32x16_bf16 v[64:79], a[156:159], v[252:255], v[64:79]
s_bfe_i64 exec, s[96:97], 0x10003
s_nop 10
v_max3_f32 v42, v42, v64, v65
v_max3_f32 v42, v42, v66, v67
v_max3_f32 v42, v42, v68, v69
v_max3_f32 v42, v42, v70, v71
v_max3_f32 v42, v42, v72, v73
v_max3_f32 v42, v42, v74, v75
v_max3_f32 v42, v42, v76, v77
v_max3_f32 v42, v42, v78, v79
s_mov_b64 exec, -1
v_mfma_f32_32x32x16_bf16 v[64:79], a[160:163], v[248:251], 0
v_mfma_f32_32x32x16_bf16 v[64:79], a[164:167], v[252:255], v[64:79]
s_bfe_i64 exec, s[96:97], 0x10004
s_nop 10
v_max3_f32 v42, v42, v64, v65
v_max3_f32 v42, v42, v66, v67
v_max3_f32 v42, v42, v68, v69
v_max3_f32 v42, v42, v70, v71
v_max3_f32 v42, v42, v72, v73
v_max3_f32 v42, v42, v74, v75
v_max3_f32 v42, v42, v76, v77
v_max3_f32 v42, v42, v78, v79
s_mov_b64 exec, -1
v_mfma_f32_32x32x16_bf16 v[64:79], a[168:171], v[248:251], 0
v_mfma_f32_32x32x16_bf16 v[64:79], a[172:175], v[252:255], v[64:79]
s_bfe_i64 exec, s[96:97], 0x10005
s_nop 10
v_max3_f32 v42, v42, v64, v65
v_max3_f32 v42, v42, v66, v67
v_max3_f32 v42, v42, v68, v69
v_max3_f32 v42, v42, v70, v71
v_max3_f32 v42, v42, v72, v73
v_max3_f32 v42, v42, v74, v75
v_max3_f32 v42, v42, v76, v77
v_max3_f32 v42, v42, v78, v79
s_mov_b64 exec, -1
v_mfma_f32_32x32x16_bf16 v[64:79], a[176:179], v[248:251], 0
v_mfma_f32_32x32x16_bf16 v[64:79], a[180:183], v[252:255], v[64:79]
s_bfe_i64 exec, s[96:97], 0x10006
s_nop 10
v_max3_f32 v42, v42, v64, v65
v_max3_f32 v42, v42, v66, v67
v_max3_f32 v42, v42, v68, v69
v_max3_f32 v42, v42, v70, v71
v_max3_f32 v42, v42, v72, v73
v_max3_f32 v42, v42, v74, v75
v_max3_f32 v42, v42, v76, v77
v_max3_f32 v42, v42, v78, v79
s_mov_b64 exec, -1
v_mfma_f32_32x32x16_bf16 v[64:79], a[184:187], v[248:251], 0
v_mfma_f32_32x32x16_bf16 v[64:79], a[188:191], v[252:255], v[64:79]
s_bfe_i64 exec, s[96:97], 0x10007
s_nop 10
v_max3_f32 v42, v42, v64, v65
v_max3_f32 v42, v42, v66, v67
v_max3_f32 v42, v42, v68, v69
v_max3_f32 v42, v42, v70, v71
v_max3_f32 v42, v42, v72, v73
v_max3_f32 v42, v42, v74, v75
v_max3_f32 v42, v42, v76, v77
v_max3_f32 v42, v42, v78, v79
s_mov_b64 exec, -1
v_mfma_f32_32x32x16_bf16 v[64:79], v[216:219], v[248:251], v[144:159]
v_mfma_f32_32x32x16_bf16 v[64:79], v[220:223], v[252:255], v[64:79]
s_nop 11
v_max3_f32 v42, v42, v64, v65
v_max3_f32 v42, v42, v66, v67
v_max3_f32 v42, v42, v68, v69
v_max3_f32 v42, v42, v70, v71
v_max3_f32 v42, v42, v72, v73
v_max3_f32 v42, v42, v74, v75
v_max3_f32 v42, v42, v76, v77
v_max3_f32 v42, v42, v78, v79
v_mov_b32 v0, v42
s_nop 1
v_permlane32_swap_b32 v42, v0
v_max_f32 v42, v42, v0
v_mov_b32 v48, 0
v_mov_b32 v49, 0
v_mov_b32 v50, 0
v_mov_b32 v51, 0
v_mov_b32 v52, 0
v_mov_b32 v53, 0
v_mov_b32 v54, 0
v_mov_b32 v55, 0
v_mfma_f32_32x32x16_bf16 v[64:79], a[128:131], v[248:251], v[160:175]
v_mfma_f32_32x32x16_bf16 v[64:79], a[132:135], v[252:255], v[64:79]
s_nop 11
v_sub_f32 v64, v64, v42
v_sub_f32 v65, v65, v42
v_sub_f32 v66, v66, v42
v_sub_f32 v67, v67, v42
v_sub_f32 v68, v68, v42
v_sub_f32 v69, v69, v42
v_sub_f32 v70, v70, v42
v_sub_f32 v71, v71, v42
v_sub_f32 v72, v72, v42
v_sub_f32 v73, v73, v42
v_sub_f32 v74, v74, v42
v_sub_f32 v75, v75, v42
v_sub_f32 v76, v76, v42
v_sub_f32 v77, v77, v42
v_sub_f32 v78, v78, v42
v_sub_f32 v79, v79, v42
v_exp_f32 v64, v64
v_exp_f32 v65, v65
v_exp_f32 v66, v66
v_exp_f32 v67, v67
v_exp_f32 v68, v68
v_exp_f32 v69, v69
v_exp_f32 v70, v70
v_exp_f32 v71, v71
v_exp_f32 v72, v72
v_exp_f32 v73, v73
v_exp_f32 v74, v74
v_exp_f32 v75, v75
v_exp_f32 v76, v76
v_exp_f32 v77, v77
v_exp_f32 v78, v78
v_exp_f32 v79, v79
s_bfe_i64 exec, s[96:97], 0x10000
v_cvt_pk_bf16_f32 v48, v64, v65
v_cvt_pk_bf16_f32 v49, v66, v67
v_cvt_pk_bf16_f32 v50, v68, v69
v_cvt_pk_bf16_f32 v51, v70, v71
v_cvt_pk_bf16_f32 v52, v72, v73
v_cvt_pk_bf16_f32 v53, v74, v75
v_cvt_pk_bf16_f32 v54, v76, v77
v_cvt_pk_bf16_f32 v55, v78, v79
s_mov_b64 exec, -1
v_mfma_f32_32x32x16_bf16 v[128:143], a[192:195], v[48:51], 0
v_mfma_f32_32x32x16_bf16 v[128:143], a[196:199], v[52:55], v[128:143]
v_mfma_f32_16x16x32_bf16 v[44:47], v[36:39], v[48:51], 0
v_mfma_f32_16x16x32_bf16 v[44:47], v[36:39], v[52:55], v[44:47]
v_mfma_f32_32x32x16_bf16 v[64:79], a[136:139], v[248:251], 0
v_mfma_f32_32x32x16_bf16 v[64:79], a[140:143], v[252:255], v[64:79]
s_nop 11
v_sub_f32 v64, v64, v42
v_sub_f32 v65, v65, v42
v_sub_f32 v66, v66, v42
v_sub_f32 v67, v67, v42
v_sub_f32 v68, v68, v42
v_sub_f32 v69, v69, v42
v_sub_f32 v70, v70, v42
v_sub_f32 v71, v71, v42
v_sub_f32 v72, v72, v42
v_sub_f32 v73, v73, v42
v_sub_f32 v74, v74, v42
v_sub_f32 v75, v75, v42
v_sub_f32 v76, v76, v42
v_sub_f32 v77, v77, v42
v_sub_f32 v78, v78, v42
v_sub_f32 v79, v79, v42
v_exp_f32 v64, v64
v_exp_f32 v65, v65
v_exp_f32 v66, v66
v_exp_f32 v67, v67
v_exp_f32 v68, v68
v_exp_f32 v69, v69
v_exp_f32 v70, v70
v_exp_f32 v71, v71
v_exp_f32 v72, v72
v_exp_f32 v73, v73
v_exp_f32 v74, v74
v_exp_f32 v75, v75
v_exp_f32 v76, v76
v_exp_f32 v77, v77
v_exp_f32 v78, v78
v_exp_f32 v79, v79
s_bfe_i64 exec, s[96:97], 0x10001
v_cvt_pk_bf16_f32 v48, v64, v65
v_cvt_pk_bf16_f32 v49, v66, v67
v_cvt_pk_bf16_f32 v50, v68, v69
v_cvt_pk_bf16_f32 v51, v70, v71
v_cvt_pk_bf16_f32 v52, v72, v73
v_cvt_pk_bf16_f32 v53, v74, v75
v_cvt_pk_bf16_f32 v54, v76, v77
v_cvt_pk_bf16_f32 v55, v78, v79
s_mov_b64 exec, -1
v_mfma_f32_32x32x16_bf16 v[128:143], a[200:203], v[48:51], v[128:143]
v_mfma_f32_32x32x16_bf16 v[128:143], a[204:207], v[52:55], v[128:143]
v_mfma_f32_16x16x32_bf16 v[44:47], v[36:39], v[48:51], v[44:47]
v_mfma_f32_16x16x32_bf16 v[44:47], v[36:39], v[52:55], v[44:47]
v_mfma_f32_32x32x16_bf16 v[64:79], a[144:147], v[248:251], 0
v_mfma_f32_32x32x16_bf16 v[64:79], a[148:151], v[252:255], v[64:79]
s_nop 11
v_sub_f32 v64, v64, v42
v_sub_f32 v65, v65, v42
v_sub_f32 v66, v66, v42
v_sub_f32 v67, v67, v42
v_sub_f32 v68, v68, v42
v_sub_f32 v69, v69, v42
v_sub_f32 v70, v70, v42
v_sub_f32 v71, v71, v42
v_sub_f32 v72, v72, v42
v_sub_f32 v73, v73, v42
v_sub_f32 v74, v74, v42
v_sub_f32 v75, v75, v42
v_sub_f32 v76, v76, v42
v_sub_f32 v77, v77, v42
v_sub_f32 v78, v78, v42
v_sub_f32 v79, v79, v42
v_exp_f32 v64, v64
v_exp_f32 v65, v65
v_exp_f32 v66, v66
v_exp_f32 v67, v67
v_exp_f32 v68, v68
v_exp_f32 v69, v69
v_exp_f32 v70, v70
v_exp_f32 v71, v71
v_exp_f32 v72, v72
v_exp_f32 v73, v73
v_exp_f32 v74, v74
v_exp_f32 v75, v75
v_exp_f32 v76, v76
v_exp_f32 v77, v77
v_exp_f32 v78, v78
v_exp_f32 v79, v79
s_bfe_i64 exec, s[96:97], 0x10002
v_cvt_pk_bf16_f32 v48, v64, v65
v_cvt_pk_bf16_f32 v49, v66, v67
v_cvt_pk_bf16_f32 v50, v68, v69
v_cvt_pk_bf16_f32 v51, v70, v71
v_cvt_pk_bf16_f32 v52, v72, v73
v_cvt_pk_bf16_f32 v53, v74, v75
v_cvt_pk_bf16_f32 v54, v76, v77
v_cvt_pk_bf16_f32 v55, v78, v79
s_mov_b64 exec, -1
v_mfma_f32_32x32x16_bf16 v[128:143], a[208:211], v[48:51], v[128:143]
v_mfma_f32_32x32x16_bf16 v[128:143], a[212:215], v[52:55], v[128:143]
v_mfma_f32_16x16x32_bf16 v[44:47], v[36:39], v[48:51], v[44:47]
v_mfma_f32_16x16x32_bf16 v[44:47], v[36:39], v[52:55], v[44:47]
v_mfma_f32_32x32x16_bf16 v[64:79], a[152:155], v[248:251], 0
v_mfma_f32_32x32x16_bf16 v[64:79], a[156:159], v[252:255], v[64:79]
s_nop 11
v_sub_f32 v64, v64, v42
v_sub_f32 v65, v65, v42
v_sub_f32 v66, v66, v42
v_sub_f32 v67, v67, v42
v_sub_f32 v68, v68, v42
v_sub_f32 v69, v69, v42
v_sub_f32 v70, v70, v42
v_sub_f32 v71, v71, v42
v_sub_f32 v72, v72, v42
v_sub_f32 v73, v73, v42
v_sub_f32 v74, v74, v42
v_sub_f32 v75, v75, v42
v_sub_f32 v76, v76, v42
v_sub_f32 v77, v77, v42
v_sub_f32 v78, v78, v42
v_sub_f32 v79, v79, v42
v_exp_f32 v64, v64
v_exp_f32 v65, v65
v_exp_f32 v66, v66
v_exp_f32 v67, v67
v_exp_f32 v68, v68
v_exp_f32 v69, v69
v_exp_f32 v70, v70
v_exp_f32 v71, v71
v_exp_f32 v72, v72
v_exp_f32 v73, v73
v_exp_f32 v74, v74
v_exp_f32 v75, v75
v_exp_f32 v76, v76
v_exp_f32 v77, v77
v_exp_f32 v78, v78
v_exp_f32 v79, v79
s_bfe_i64 exec, s[96:97], 0x10003
v_cvt_pk_bf16_f32 v48, v64, v65
v_cvt_pk_bf16_f32 v49, v66, v67
v_cvt_pk_bf16_f32 v50, v68, v69
v_cvt_pk_bf16_f32 v51, v70, v71
v_cvt_pk_bf16_f32 v52, v72, v73
v_cvt_pk_bf16_f32 v53, v74, v75
v_cvt_pk_bf16_f32 v54, v76, v77
v_cvt_pk_bf16_f32 v55, v78, v79
s_mov_b64 exec, -1
v_mfma_f32_32x32x16_bf16 v[128:143], a[216:219], v[48:51], v[128:143]
v_mfma_f32_32x32x16_bf16 v[128:143], a[220:223], v[52:55], v[128:143]
v_mfma_f32_16x16x32_bf16 v[44:47], v[36:39], v[48:51], v[44:47]
v_mfma_f32_16x16x32_bf16 v[44:47], v[36:39], v[52:55], v[44:47]
v_mfma_f32_32x32x16_bf16 v[64:79], a[160:163], v[248:251], 0
v_mfma_f32_32x32x16_bf16 v[64:79], a[164:167], v[252:255], v[64:79]
s_nop 11
v_sub_f32 v64, v64, v42
v_sub_f32 v65, v65, v42
v_sub_f32 v66, v66, v42
v_sub_f32 v67, v67, v42
v_sub_f32 v68, v68, v42
v_sub_f32 v69, v69, v42
v_sub_f32 v70, v70, v42
v_sub_f32 v71, v71, v42
v_sub_f32 v72, v72, v42
v_sub_f32 v73, v73, v42
v_sub_f32 v74, v74, v42
v_sub_f32 v75, v75, v42
v_sub_f32 v76, v76, v42
v_sub_f32 v77, v77, v42
v_sub_f32 v78, v78, v42
v_sub_f32 v79, v79, v42
v_exp_f32 v64, v64
v_exp_f32 v65, v65
v_exp_f32 v66, v66
v_exp_f32 v67, v67
v_exp_f32 v68, v68
v_exp_f32 v69, v69
v_exp_f32 v70, v70
v_exp_f32 v71, v71
v_exp_f32 v72, v72
v_exp_f32 v73, v73
v_exp_f32 v74, v74
v_exp_f32 v75, v75
v_exp_f32 v76, v76
v_exp_f32 v77, v77
v_exp_f32 v78, v78
v_exp_f32 v79, v79
s_bfe_i64 exec, s[96:97], 0x10004
v_cvt_pk_bf16_f32 v48, v64, v65
v_cvt_pk_bf16_f32 v49, v66, v67
v_cvt_pk_bf16_f32 v50, v68, v69
v_cvt_pk_bf16_f32 v51, v70, v71
v_cvt_pk_bf16_f32 v52, v72, v73
v_cvt_pk_bf16_f32 v53, v74, v75
v_cvt_pk_bf16_f32 v54, v76, v77
v_cvt_pk_bf16_f32 v55, v78, v79
s_mov_b64 exec, -1
v_mfma_f32_32x32x16_bf16 v[128:143], a[224:227], v[48:51], v[128:143]
v_mfma_f32_32x32x16_bf16 v[128:143], a[228:231], v[52:55], v[128:143]
v_mfma_f32_16x16x32_bf16 v[44:47], v[36:39], v[48:51], v[44:47]
v_mfma_f32_16x16x32_bf16 v[44:47], v[36:39], v[52:55], v[44:47]
v_mfma_f32_32x32x16_bf16 v[64:79], a[168:171], v[248:251], 0
v_mfma_f32_32x32x16_bf16 v[64:79], a[172:175], v[252:255], v[64:79]
s_nop 11
v_sub_f32 v64, v64, v42
v_sub_f32 v65, v65, v42
v_sub_f32 v66, v66, v42
v_sub_f32 v67, v67, v42
v_sub_f32 v68, v68, v42
v_sub_f32 v69, v69, v42
v_sub_f32 v70, v70, v42
v_sub_f32 v71, v71, v42
v_sub_f32 v72, v72, v42
v_sub_f32 v73, v73, v42
v_sub_f32 v74, v74, v42
v_sub_f32 v75, v75, v42
v_sub_f32 v76, v76, v42
v_sub_f32 v77, v77, v42
v_sub_f32 v78, v78, v42
v_sub_f32 v79, v79, v42
v_exp_f32 v64, v64
v_exp_f32 v65, v65
v_exp_f32 v66, v66
v_exp_f32 v67, v67
v_exp_f32 v68, v68
v_exp_f32 v69, v69
v_exp_f32 v70, v70
v_exp_f32 v71, v71
v_exp_f32 v72, v72
v_exp_f32 v73, v73
v_exp_f32 v74, v74
v_exp_f32 v75, v75
v_exp_f32 v76, v76
v_exp_f32 v77, v77
v_exp_f32 v78, v78
v_exp_f32 v79, v79
s_bfe_i64 exec, s[96:97], 0x10005
v_cvt_pk_bf16_f32 v48, v64, v65
v_cvt_pk_bf16_f32 v49, v66, v67
v_cvt_pk_bf16_f32 v50, v68, v69
v_cvt_pk_bf16_f32 v51, v70, v71
v_cvt_pk_bf16_f32 v52, v72, v73
v_cvt_pk_bf16_f32 v53, v74, v75
v_cvt_pk_bf16_f32 v54, v76, v77
v_cvt_pk_bf16_f32 v55, v78, v79
s_mov_b64 exec, -1
v_mfma_f32_32x32x16_bf16 v[128:143], a[232:235], v[48:51], v[128:143]
v_mfma_f32_32x32x16_bf16 v[128:143], a[236:239], v[52:55], v[128:143]
v_mfma_f32_16x16x32_bf16 v[44:47], v[36:39], v[48:51], v[44:47]
v_mfma_f32_16x16x32_bf16 v[44:47], v[36:39], v[52:55], v[44:47]
v_mfma_f32_32x32x16_bf16 v[64:79], a[176:179], v[248:251], 0
v_mfma_f32_32x32x16_bf16 v[64:79], a[180:183], v[252:255], v[64:79]
s_nop 11
v_sub_f32 v64, v64, v42
v_sub_f32 v65, v65, v42
v_sub_f32 v66, v66, v42
v_sub_f32 v67, v67, v42
v_sub_f32 v68, v68, v42
v_sub_f32 v69, v69, v42
v_sub_f32 v70, v70, v42
v_sub_f32 v71, v71, v42
v_sub_f32 v72, v72, v42
v_sub_f32 v73, v73, v42
v_sub_f32 v74, v74, v42
v_sub_f32 v75, v75, v42
v_sub_f32 v76, v76, v42
v_sub_f32 v77, v77, v42
v_sub_f32 v78, v78, v42
v_sub_f32 v79, v79, v42
v_exp_f32 v64, v64
v_exp_f32 v65, v65
v_exp_f32 v66, v66
v_exp_f32 v67, v67
v_exp_f32 v68, v68
v_exp_f32 v69, v69
v_exp_f32 v70, v70
v_exp_f32 v71, v71
v_exp_f32 v72, v72
v_exp_f32 v73, v73
v_exp_f32 v74, v74
v_exp_f32 v75, v75
v_exp_f32 v76, v76
v_exp_f32 v77, v77
v_exp_f32 v78, v78
v_exp_f32 v79, v79
s_bfe_i64 exec, s[96:97], 0x10006
v_cvt_pk_bf16_f32 v48, v64, v65
v_cvt_pk_bf16_f32 v49, v66, v67
v_cvt_pk_bf16_f32 v50, v68, v69
v_cvt_pk_bf16_f32 v51, v70, v71
v_cvt_pk_bf16_f32 v52, v72, v73
v_cvt_pk_bf16_f32 v53, v74, v75
v_cvt_pk_bf16_f32 v54, v76, v77
v_cvt_pk_bf16_f32 v55, v78, v79
s_mov_b64 exec, -1
v_mfma_f32_32x32x16_bf16 v[128:143], a[240:243], v[48:51], v[128:143]
v_mfma_f32_32x32x16_bf16 v[128:143], a[244:247], v[52:55], v[128:143]
v_mfma_f32_16x16x32_bf16 v[44:47], v[36:39], v[48:51], v[44:47]
v_mfma_f32_16x16x32_bf16 v[44:47], v[36:39], v[52:55], v[44:47]
v_mfma_f32_32x32x16_bf16 v[64:79], a[184:187], v[248:251], 0
v_mfma_f32_32x32x16_bf16 v[64:79], a[188:191], v[252:255], v[64:79]
s_nop 11
v_sub_f32 v64, v64, v42
v_sub_f32 v65, v65, v42
v_sub_f32 v66, v66, v42
v_sub_f32 v67, v67, v42
v_sub_f32 v68, v68, v42
v_sub_f32 v69, v69, v42
v_sub_f32 v70, v70, v42
v_sub_f32 v71, v71, v42
v_sub_f32 v72, v72, v42
v_sub_f32 v73, v73, v42
v_sub_f32 v74, v74, v42
v_sub_f32 v75, v75, v42
v_sub_f32 v76, v76, v42
v_sub_f32 v77, v77, v42
v_sub_f32 v78, v78, v42
v_sub_f32 v79, v79, v42
v_exp_f32 v64, v64
v_exp_f32 v65, v65
v_exp_f32 v66, v66
v_exp_f32 v67, v67
v_exp_f32 v68, v68
v_exp_f32 v69, v69
v_exp_f32 v70, v70
v_exp_f32 v71, v71
v_exp_f32 v72, v72
v_exp_f32 v73, v73
v_exp_f32 v74, v74
v_exp_f32 v75, v75
v_exp_f32 v76, v76
v_exp_f32 v77, v77
v_exp_f32 v78, v78
v_exp_f32 v79, v79
s_bfe_i64 exec, s[96:97], 0x10007
v_cvt_pk_bf16_f32 v48, v64, v65
v_cvt_pk_bf16_f32 v49, v66, v67
v_cvt_pk_bf16_f32 v50, v68, v69
v_cvt_pk_bf16_f32 v51, v70, v71
v_cvt_pk_bf16_f32 v52, v72, v73
v_cvt_pk_bf16_f32 v53, v74, v75
v_cvt_pk_bf16_f32 v54, v76, v77
v_cvt_pk_bf16_f32 v55, v78, v79
s_mov_b64 exec, -1
v_mfma_f32_32x32x16_bf16 v[128:143], a[248:251], v[48:51], v[128:143]
v_mfma_f32_32x32x16_bf16 v[128:143], a[252:255], v[52:55], v[128:143]
v_mfma_f32_16x16x32_bf16 v[44:47], v[36:39], v[48:51], v[44:47]
v_mfma_f32_16x16x32_bf16 v[44:47], v[36:39], v[52:55], v[44:47]
v_mfma_f32_32x32x16_bf16 v[64:79], v[216:219], v[248:251], v[144:159]
v_mfma_f32_32x32x16_bf16 v[64:79], v[220:223], v[252:255], v[64:79]
s_nop 11
v_sub_f32 v64, v64, v42
v_sub_f32 v65, v65, v42
v_sub_f32 v66, v66, v42
v_sub_f32 v67, v67, v42
v_sub_f32 v68, v68, v42
v_sub_f32 v69, v69, v42
v_sub_f32 v70, v70, v42
v_sub_f32 v71, v71, v42
v_sub_f32 v72, v72, v42
v_sub_f32 v73, v73, v42
v_sub_f32 v74, v74, v42
v_sub_f32 v75, v75, v42
v_sub_f32 v76, v76, v42
v_sub_f32 v77, v77, v42
v_sub_f32 v78, v78, v42
v_sub_f32 v79, v79, v42
v_exp_f32 v64, v64
v_exp_f32 v65, v65
v_exp_f32 v66, v66
v_exp_f32 v67, v67
v_exp_f32 v68, v68
v_exp_f32 v69, v69
v_exp_f32 v70, v70
v_exp_f32 v71, v71
v_exp_f32 v72, v72
v_exp_f32 v73, v73
v_exp_f32 v74, v74
v_exp_f32 v75, v75
v_exp_f32 v76, v76
v_exp_f32 v77, v77
v_exp_f32 v78, v78
v_exp_f32 v79, v79
v_cvt_pk_bf16_f32 v48, v64, v65
v_cvt_pk_bf16_f32 v49, v66, v67
v_cvt_pk_bf16_f32 v50, v68, v69
v_cvt_pk_bf16_f32 v51, v70, v71
v_cvt_pk_bf16_f32 v52, v72, v73
v_cvt_pk_bf16_f32 v53, v74, v75
v_cvt_pk_bf16_f32 v54, v76, v77
v_cvt_pk_bf16_f32 v55, v78, v79
v_mfma_f32_32x32x16_bf16 v[128:143], v[232:235], v[48:51], v[128:143]
s_nop 0
v_mfma_f32_32x32x16_bf16 v[128:143], v[236:239], v[52:55], v[128:143]
v_mfma_f32_16x16x32_bf16 v[44:47], v[36:39], v[48:51], v[44:47]
v_mfma_f32_16x16x32_bf16 v[44:47], v[36:39], v[52:55], v[44:47]
s_nop 15
s_branch Lfbr1
Lslow8035:
v_mov_b32 v25, 0
buffer_atomic_add v25, v11, s[4:7], s76 offen offset:16 sc0 sc1
s_add_u32 s47, s47, 1
s_cmp_ge_u32 s47, 0x40000
s_cbranch_scc1 Lend
s_waitcnt vmcnt(0)
v_readfirstlane_b32 s45, v25
s_nop 0
s_cmp_lt_u32 s45, 16
s_cbranch_scc1 Lslow8035
s_branch Lback8036
Lslow12050:
v_mov_b32 v25, 0
buffer_atomic_add v25, v11, s[4:7], s32 offen offset:28 sc0 sc1
s_add_u32 s47, s47, 1
s_cmp_ge_u32 s47, 0x40000
s_cbranch_scc1 Lend
s_waitcnt vmcnt(0)
v_readfirstlane_b32 s45, v25
s_nop 0
s_cmp_lt_u32 s45, 4
s_cbranch_scc1 Lslow12050
s_branch Lback12051
Lslow12052:
v_mov_b32 v25, 0
buffer_atomic_add v25, v11, s[4:7], s32 offen offset:32 sc0 sc1
s_add_u32 s47, s47, 1
s_cmp_ge_u32 s47, 0x40000
s_cbranch_scc1 Lend
s_waitcnt vmcnt(0)
v_readfirstlane_b32 s45, v25
s_nop 0
s_cmp_lt_u32 s45, 4
s_cbranch_scc1 Lslow12052
s_branch Lback12053
Lslow12054:
v_mov_b32 v25, 0
buffer_atomic_add v25, v11, s[4:7], s32 offen offset:36 sc0 sc1
s_add_u32 s47, s47, 1
s_cmp_ge_u32 s47, 0x40000
s_cbranch_scc1 Lend
s_waitcnt vmcnt(0)
v_readfirstlane_b32 s45, v25
s_nop 0
s_cmp_lt_u32 s45, 4
s_cbranch_scc1 Lslow12054
s_branch Lback12055
Lslow12056:
v_mov_b32 v25, 0
buffer_atomic_add v25, v11, s[4:7], s32 offen offset:40 sc0 sc1
s_add_u32 s47, s47, 1
s_cmp_ge_u32 s47, 0x40000
s_cbranch_scc1 Lend
s_waitcnt vmcnt(0)
v_readfirstlane_b32 s45, v25
s_nop 0
s_cmp_lt_u32 s45, 4
s_cbranch_scc1 Lslow12056
s_branch Lback12057
Lslow12058:
v_mov_b32 v25, 0
buffer_atomic_add v25, v11, s[4:7], s33 offen offset:44 sc0 sc1
s_add_u32 s47, s47, 1
s_cmp_ge_u32 s47, 0x40000
s_cbranch_scc1 Lend
s_waitcnt vmcnt(0)
v_readfirstlane_b32 s45, v25
s_nop 0
s_cmp_lt_u32 s45, 4
s_cbranch_scc1 Lslow12058
s_branch Lback12059
Lslow12060:
v_mov_b32 v25, 0
buffer_atomic_add v25, v11, s[4:7], s34 offen offset:48 sc0 sc1
s_add_u32 s47, s47, 1
s_cmp_ge_u32 s47, 0x40000
s_cbranch_scc1 Lend
s_waitcnt vmcnt(0)
v_readfirstlane_b32 s45, v25
s_nop 0
s_cmp_lt_u32 s45, 2
s_cbranch_scc1 Lslow12060
s_branch Lback12061
Lcodeend:
.section .rodata,"a"
.p2align 6
.amdhsa_kernel interleave_layers__sliding_block__dense_activation_silu__prompt_kernel
  .amdhsa_next_free_vgpr 512
  .amdhsa_next_free_sgpr 102
  .amdhsa_accum_offset 256
  .amdhsa_group_segment_fixed_size 0
  .amdhsa_kernarg_size 72
  .amdhsa_user_sgpr_count 2
  .amdhsa_user_sgpr_kernarg_segment_ptr 1
  .amdhsa_system_sgpr_workgroup_id_x 1
.end_amdhsa_kernel
```
